```python
import torch

def _softmax(x, axis=-1):
    return torch.softmax(x, dim=axis)
def _gelu(x):
    return torch.nn.functional.gelu(x, approximate="tanh")
def _silu(x):
    return torch.nn.functional.silu(x)
def _sigmoid(x):
    return torch.sigmoid(x)
def _layernorm(x, axis=-1, eps=1e-5):
    m = x.mean(dim=axis, keepdim=True)
    v = x.var(dim=axis, keepdim=True, unbiased=False)
    return (x - m) / torch.sqrt(v + eps)
def _scatter_add(tgt, idx, src, axis=0):
    return tgt.clone().index_add_(axis, idx, src)
def _segment_sum(src, seg, n):
    out = torch.zeros((n,) + src.shape[1:], dtype=src.dtype)
    return out.index_add_(0, seg, src)
def _pad(x, pw):
    flat = tuple(v for pair in reversed(pw) for v in pair)
    return torch.nn.functional.pad(x, flat)

kernel_name = 'gated_mix__mha_block__mixer_s_mlp__prompt'

def setup_inputs():

    _w = (lambda a: (lambda t: t.to(torch.bfloat16) if t.is_floating_point() else t)(torch.as_tensor(a)))
    def _A_setup():
        B, S, D, H = 1, 2048, 576, 32
        return {
            "x": _w((lambda *s: torch.randn(*s, dtype=torch.bfloat16) * 0.05)(B, S, D)),
            "wqkv": _w((lambda *s: torch.randn(*s, dtype=torch.bfloat16) * 1.6)(D, 3 * D)),
            "wo": _w((lambda *s: torch.randn(*s, dtype=torch.bfloat16) * 0.1)(D, D)),
        }
    _A_in = _A_setup()

    def _B_setup():
        B, S, D, F = 1, 2048, 576, 4608
        return {
            "x":  _w((lambda *s: torch.randn(*s, dtype=torch.bfloat16) * 0.05)(B, S, D)),
            "w1": _w((lambda *s: torch.randn(*s, dtype=torch.bfloat16) * 3.2)(D, D) * (D ** -0.5)),
            "w2": _w((lambda *s: torch.randn(*s, dtype=torch.bfloat16) * 3.2)(D, D) * (D ** -0.5)),
            "w3": _w((lambda *s: torch.randn(*s, dtype=torch.bfloat16) * 3.2)(D, F) * (D ** -0.5)),
            "w4": _w((lambda *s: torch.randn(*s, dtype=torch.bfloat16) * 3.2)(F, D) * (F ** -0.5)),
        }
    _B_in = _B_setup()

    return {
        "A_x": _A_in["x"],
        "A_wqkv": _A_in["wqkv"],
        "A_wo": _A_in["wo"],
        "B_x": _B_in["x"],
        "B_w1": _B_in["w1"],
        "B_w2": _B_in["w2"],
        "B_w3": _B_in["w3"],
        "B_w4": _B_in["w4"],
        "gate_w": _w((lambda *s: torch.randn(*s, dtype=torch.bfloat16) * 0.05)(576) * 16.0),
    }

def reference(A_x, A_wqkv, A_wo, B_x, B_w1, B_w2, B_w3, B_w4, gate_w):
    def _A_ref(x, wqkv, wo):
        B, S, D = x.shape
        H = 32
        Dh = D // H
        qkv = (lambda x, *d: x.permute(*d))((x @ wqkv).reshape(B, S, 3, H, Dh), 2, 0, 3, 1, 4)
        q, k, v = qkv[0], qkv[1], qkv[2]
        scores = torch.einsum("bhqd,bhkd->bhqk", q, k) * (Dh ** -0.5)
        p = _softmax(scores, axis=-1)
        o = torch.einsum("bhqk,bhkd->bhqd", p, v)
        return (lambda x, *d: x.permute(*d))(o, 0, 2, 1, 3).reshape(B, S, D) @ wo

    def _B_ref(x, w1, w2, w3, w4):
        B, S, D = x.shape
        h = _gelu(_layernorm(x, axis=-1) @ w1)
        c = D // 4
        g0 = _pad(h[:, :, 0*c:1*c], ((0, 0), (1, 0), (0, 0)))[:, :S, :]
        g1 = _pad(h[:, :, 1*c:2*c], ((0, 0), (0, 1), (0, 0)))[:, 1:, :]
        g2 = _pad(h[:, :, 2*c:3*c], ((0, 0), (2, 0), (0, 0)))[:, :S, :]
        g3 = _pad(h[:, :, 3*c:   ], ((0, 0), (0, 2), (0, 0)))[:, 2:, :]
        hs = torch.concatenate([g0, g1, g2, g3], axis=-1) @ w2
        x1 = x + hs
        h2 = _gelu(_layernorm(x1, axis=-1) @ w3) @ w4
        return x1 + h2

    x = A_x
    g = _sigmoid((x * gate_w).sum(-1, keepdims=True))
    a = _A_ref(x, A_wqkv, A_wo)
    b = _B_ref(x, B_w1, B_w2, B_w3, B_w4)
    return g * a + (1 - g) * b
```

```asm
; @launch grid=(512,1,1) block=(256,1,1) lds=81920
.amdgcn_target "amdgcn-amd-amdhsa--gfx950"
.text
.globl gated_mix__mha_block__mixer_s_mlp__prompt_kernel
.p2align 8
.type gated_mix__mha_block__mixer_s_mlp__prompt_kernel,@function
gated_mix__mha_block__mixer_s_mlp__prompt_kernel:
    s_cmp_ge_u32 s2, 512
    s_cbranch_scc1 L_exit
    s_getpc_b64 s[34:35]
L_pc0:
    s_load_dwordx8 s[60:67], s[0:1], 0
    s_load_dwordx8 s[68:75], s[0:1], 32
    s_load_dwordx4 s[76:79], s[0:1], 64
    s_load_dwordx2 s[80:81], s[0:1], 80
    s_load_dwordx2 s[40:41], s[0:1], 88
    s_lshr_b32 s3, s2, 3
    v_lshlrev_b32 v1, 6, v0
    v_add_u32 v1, s3, v1
    v_lshlrev_b32 v1, 7, v1
    v_min_u32 v1, L_exit-L_pc0, v1
    s_mov_b64 exec, 0xffff
    global_load_dword v255, v1, s[34:35]
    s_mov_b64 exec, -1
    v_lshrrev_b32 v1, 6, v0
    s_nop 0
    v_readfirstlane_b32 s18, v1
    s_and_b32 s42, s2, 3
    s_bfe_u32 s26, s2, 0x10002
    s_bfe_u32 s43, s2, 0x30003
    s_lshl_b32 s26, s26, 3
    s_add_u32 s43, s43, s26
    s_bfe_u32 s44, s2, 0x20006
    s_cmp_ge_u32 s2, 256
    s_cbranch_scc1 L_b
    s_cmp_eq_u32 s42, 3
    s_cbranch_scc1 L_a_side
    s_setprio 2
    s_cmp_eq_u32 s42, 2
    s_cbranch_scc1 L_a_v
    s_lshl_b32 s20, s43, 2
    s_add_u32 s20, s20, s18
    s_lshl_b32 s26, s44, 1
    s_add_u32 s21, s43, s26
    s_add_u32 s21, s21, s42
    s_cmp_ge_u32 s21, 18
    s_cselect_b32 s26, 18, 0
    s_sub_u32 s21, s21, s26
    s_cmp_ge_u32 s21, 9
    s_cselect_b32 s26, 9, 0
    s_sub_u32 s21, s21, s26
    s_mul_i32 s25, s44, 288
    s_mul_i32 s21, s21, 21846
    s_lshr_b32 s21, s21, 16
    s_mul_i32 s21, s21, 3
    s_mul_i32 s26, s42, 1152
    s_add_u32 s25, s25, s26
    v_and_b32 v12, 63, v0
    v_lshrrev_b32 v13, 3, v12
    s_lshl_b32 s26, s20, 5
    v_add_u32 v14, s26, v13
    v_mul_u32_u24 v14, 1152, v14
    v_lshrrev_b32 v13, 4, v12
    v_xor_b32 v13, v13, v12
    v_and_b32 v13, 7, v13
    v_lshl_add_u32 v4, v13, 4, v14
    v_xor_b32 v13, 4, v13
    v_lshl_add_u32 v5, v13, 4, v14
    v_add_u32 v5, 9216, v5
    s_lshl_b32 s48, s18, 12
    s_add_u32 s48, s48, 49152
    s_mov_b32 s49, s21
    s_lshl_b32 s21, s21, 1
    s_lshr_b32 s26, s18, 1
    s_and_b32 s27, s18, 1
    s_mul_i32 s28, s18, 3072
    s_lshl_b32 s26, s26, 4
    v_lshrrev_b32 v13, 2, v12
    v_add_u32 v13, s26, v13
    v_mul_u32_u24 v13, 3456, v13
    v_and_b32 v14, 3, v12
    s_mul_i32 s26, s27, 12
    v_add_u32 v14, s26, v14
    v_lshl_add_u32 v1, v14, 4, v13
    v_mov_b32 v13, 0x80000000
    v_cmp_gt_u32 vcc, 14, v14
    s_nop 1
    v_cndmask_b32 v2, v13, v1, vcc
    v_cmp_gt_u32 vcc, 10, v14
    s_nop 1
    v_cndmask_b32 v3, v13, v1, vcc
    s_waitcnt lgkmcnt(0)
    s_mov_b32 s12, s60
    s_and_b32 s13, s61, 0xffff
    s_mov_b32 s14, 0x00240000
    s_mov_b32 s15, 0x00020000
    s_mov_b32 s4, s62
    s_and_b32 s5, s63, 0xffff
    s_mov_b32 s6, 0x001e6000
    s_mov_b32 s7, 0x00020000
    s_lshl_b32 s23, s49, 7
    s_add_u32 s49, s49, 1
    s_cmp_eq_u32 s49, 9
    s_cselect_b32 s49, 0, s49
    s_add_u32 m0, s48, 0
    s_nop 0
    buffer_load_dwordx4 v4, s[12:15], s23 offen lds
    s_add_u32 m0, s48, 1024
    s_nop 0
    buffer_load_dwordx4 v5, s[12:15], s23 offen lds
    s_add_u32 s23, s23, 18432
    s_add_u32 m0, s48, 2048
    s_nop 0
    buffer_load_dwordx4 v4, s[12:15], s23 offen lds
    s_add_u32 m0, s48, 3072
    s_nop 0
    buffer_load_dwordx4 v5, s[12:15], s23 offen lds
    s_mul_i32 s22, s21, 110592
    s_add_u32 s22, s22, s25
    s_add_u32 s21, s21, 1
    s_add_u32 m0, s28, 0
    s_nop 0
    buffer_load_dwordx4 v1, s[4:7], s22 offen offset:0 lds
    s_add_u32 m0, s28, 960
    s_nop 0
    buffer_load_dwordx4 v2, s[4:7], s22 offen offset:64 lds
    s_add_u32 m0, s28, 1920
    s_nop 0
    buffer_load_dwordx4 v3, s[4:7], s22 offen offset:128 lds
    s_mul_i32 s22, s21, 110592
    s_add_u32 s22, s22, s25
    s_add_u32 s21, s21, 1
    s_cmp_eq_u32 s21, 18
    s_cselect_b32 s21, 0, s21
    s_add_u32 m0, s28, 12288
    s_nop 0
    buffer_load_dwordx4 v1, s[4:7], s22 offen offset:0 lds
    s_add_u32 m0, s28, 13248
    s_nop 0
    buffer_load_dwordx4 v2, s[4:7], s22 offen offset:64 lds
    s_add_u32 m0, s28, 14208
    s_nop 0
    buffer_load_dwordx4 v3, s[4:7], s22 offen offset:128 lds
    s_mov_b32 s8, s40
    s_and_b32 s9, s41, 0xffff
    s_mov_b32 s10, 0x03000000
    s_mov_b32 s11, 0x00020000
    v_bfe_u32 v13, v12, 2, 2
    v_lshlrev_b32 v6, 6, v13
    v_bfe_u32 v13, v12, 4, 1
    v_lshl_add_u32 v6, v13, 5, v6
    v_and_b32 v13, 3, v12
    v_lshl_add_u32 v6, v13, 3, v6
    v_lshrrev_b32 v13, 5, v12
    v_mul_u32_u24 v13, 512, v13
    v_add_u32 v6, v6, v13
    v_and_b32 v13, 31, v12
    v_bfe_u32 v14, v12, 1, 3
    v_lshrrev_b32 v15, 5, v12
    v_xor_b32 v14, v14, v15
    v_lshlrev_b32 v14, 4, v14
    v_lshlrev_b32 v13, 7, v13
    v_add_u32 v13, s48, v13
    v_xor_b32 v7, 0, v14
    v_add_u32 v7, v7, v13
    v_xor_b32 v8, 32, v14
    v_add_u32 v8, v8, v13
    v_xor_b32 v9, 64, v14
    v_add_u32 v9, v9, v13
    v_xor_b32 v10, 96, v14
    v_add_u32 v10, v10, v13
    s_lshl_b32 s23, s49, 7
    s_add_u32 s49, s49, 1
    s_cmp_eq_u32 s49, 9
    s_cselect_b32 s49, 0, s49
    s_add_u32 m0, s48, 16384
    s_nop 0
    buffer_load_dwordx4 v4, s[12:15], s23 offen lds
    s_add_u32 m0, s48, 17408
    s_nop 0
    buffer_load_dwordx4 v5, s[12:15], s23 offen lds
    s_add_u32 s23, s23, 18432
    s_add_u32 m0, s48, 18432
    s_nop 0
    buffer_load_dwordx4 v4, s[12:15], s23 offen lds
    s_add_u32 m0, s48, 19456
    s_nop 0
    buffer_load_dwordx4 v5, s[12:15], s23 offen lds
    s_mul_i32 s22, s21, 110592
    s_add_u32 s22, s22, s25
    s_add_u32 s21, s21, 1
    s_add_u32 m0, s28, 24576
    s_nop 0
    buffer_load_dwordx4 v1, s[4:7], s22 offen offset:0 lds
    s_add_u32 m0, s28, 25536
    s_nop 0
    buffer_load_dwordx4 v2, s[4:7], s22 offen offset:64 lds
    s_add_u32 m0, s28, 26496
    s_nop 0
    buffer_load_dwordx4 v3, s[4:7], s22 offen offset:128 lds
    s_waitcnt vmcnt(10)
    s_barrier
    ds_read_b128 v[116:119], v7 offset:0
    ds_read_b128 v[120:123], v8 offset:0
    ds_read_b128 v[124:127], v9 offset:0
    ds_read_b128 v[128:131], v10 offset:0
    ds_read_b64_tr_b16 v[92:93], v6 offset:0
    ds_read_b64_tr_b16 v[94:95], v6 offset:256
    ds_read_b64_tr_b16 v[96:97], v6 offset:1024
    ds_read_b64_tr_b16 v[98:99], v6 offset:1280
    ds_read_b64_tr_b16 v[100:101], v6 offset:2048
    ds_read_b64_tr_b16 v[102:103], v6 offset:2304
    ds_read_b64_tr_b16 v[104:105], v6 offset:3072
    ds_read_b64_tr_b16 v[106:107], v6 offset:3328
    ds_read_b64_tr_b16 v[108:109], v6 offset:4096
    ds_read_b64_tr_b16 v[110:111], v6 offset:4352
    s_waitcnt lgkmcnt(6)
    v_mfma_f32_32x32x16_bf16 v[12:27], v[92:95], v[116:119], 0
    s_mul_i32 s22, s21, 110592
    s_add_u32 s22, s22, s25
    s_add_u32 s21, s21, 1
    s_cmp_eq_u32 s21, 18
    s_cselect_b32 s21, 0, s21
    s_add_u32 m0, s28, 36864
    ds_read_b64_tr_b16 v[112:113], v6 offset:6144
    ds_read_b64_tr_b16 v[114:115], v6 offset:6400
    buffer_load_dwordx4 v1, s[4:7], s22 offen offset:0 lds
    s_add_u32 m0, s28, 37824
    s_nop 0
    buffer_load_dwordx4 v2, s[4:7], s22 offen offset:64 lds
    v_mfma_f32_32x32x16_bf16 v[28:43], v[96:99], v[116:119], 0
    s_add_u32 m0, s28, 38784
    ds_read_b64_tr_b16 v[92:93], v6 offset:7168
    ds_read_b64_tr_b16 v[94:95], v6 offset:7424
    buffer_load_dwordx4 v3, s[4:7], s22 offen offset:128 lds
    s_waitcnt lgkmcnt(6)
    v_mfma_f32_32x32x16_bf16 v[44:59], v[100:103], v[116:119], 0
    s_lshl_b32 s23, s49, 7
    s_add_u32 s49, s49, 1
    s_cmp_eq_u32 s49, 9
    s_cselect_b32 s49, 0, s49
    s_add_u32 m0, s48, 0
    ds_read_b64_tr_b16 v[96:97], v6 offset:8192
    ds_read_b64_tr_b16 v[98:99], v6 offset:8448
    buffer_load_dwordx4 v4, s[12:15], s23 offen lds
    v_mfma_f32_32x32x16_bf16 v[60:75], v[104:107], v[116:119], 0
    s_add_u32 m0, s48, 1024
    ds_read_b64_tr_b16 v[100:101], v6 offset:9216
    ds_read_b64_tr_b16 v[102:103], v6 offset:9472
    buffer_load_dwordx4 v5, s[12:15], s23 offen lds
    s_waitcnt lgkmcnt(6)
    v_mfma_f32_32x32x16_bf16 v[76:91], v[108:111], v[116:119], 0
    s_add_u32 s23, s23, 18432
    s_add_u32 m0, s48, 2048
    ds_read_b64_tr_b16 v[104:105], v6 offset:10240
    ds_read_b64_tr_b16 v[106:107], v6 offset:10496
    buffer_load_dwordx4 v4, s[12:15], s23 offen lds
    v_mfma_f32_32x32x16_bf16 v[12:27], v[112:115], v[120:123], v[12:27]
    s_add_u32 m0, s48, 3072
    s_nop 0
    buffer_load_dwordx4 v5, s[12:15], s23 offen lds
    s_waitcnt lgkmcnt(4)
    v_mfma_f32_32x32x16_bf16 v[28:43], v[92:95], v[120:123], v[28:43]
    s_waitcnt vmcnt(14) lgkmcnt(0)
    s_barrier
    ds_read_b64_tr_b16 v[108:109], v6 offset:12288
    ds_read_b64_tr_b16 v[110:111], v6 offset:12544
    ds_read_b64_tr_b16 v[112:113], v6 offset:13312
    ds_read_b64_tr_b16 v[114:115], v6 offset:13568
    v_mfma_f32_32x32x16_bf16 v[44:59], v[96:99], v[120:123], v[44:59]
    ds_read_b64_tr_b16 v[92:93], v6 offset:14336
    ds_read_b64_tr_b16 v[94:95], v6 offset:14592
    v_mfma_f32_32x32x16_bf16 v[60:75], v[100:103], v[120:123], v[60:75]
    ds_read_b64_tr_b16 v[96:97], v6 offset:15360
    ds_read_b64_tr_b16 v[98:99], v6 offset:15616
    v_mfma_f32_32x32x16_bf16 v[76:91], v[104:107], v[120:123], v[76:91]
    ds_read_b64_tr_b16 v[100:101], v6 offset:16384
    ds_read_b64_tr_b16 v[102:103], v6 offset:16640
    s_waitcnt lgkmcnt(6)
    v_mfma_f32_32x32x16_bf16 v[12:27], v[108:111], v[124:127], v[12:27]
    s_mul_i32 s22, s21, 110592
    s_add_u32 s22, s22, s25
    s_add_u32 s21, s21, 1
    s_add_u32 m0, s28, 0
    ds_read_b64_tr_b16 v[104:105], v6 offset:18432
    ds_read_b64_tr_b16 v[106:107], v6 offset:18688
    buffer_load_dwordx4 v1, s[4:7], s22 offen offset:0 lds
    v_mfma_f32_32x32x16_bf16 v[28:43], v[112:115], v[124:127], v[28:43]
    ds_read_b64_tr_b16 v[108:109], v6 offset:19456
    ds_read_b64_tr_b16 v[110:111], v6 offset:19712
    s_waitcnt lgkmcnt(6)
    v_mfma_f32_32x32x16_bf16 v[44:59], v[92:95], v[124:127], v[44:59]
    s_add_u32 m0, s28, 960
    ds_read_b64_tr_b16 v[112:113], v6 offset:20480
    ds_read_b64_tr_b16 v[114:115], v6 offset:20736
    buffer_load_dwordx4 v2, s[4:7], s22 offen offset:64 lds
    v_mfma_f32_32x32x16_bf16 v[60:75], v[96:99], v[124:127], v[60:75]
    ds_read_b64_tr_b16 v[92:93], v6 offset:21504
    ds_read_b64_tr_b16 v[94:95], v6 offset:21760
    s_waitcnt lgkmcnt(6)
    v_mfma_f32_32x32x16_bf16 v[76:91], v[100:103], v[124:127], v[76:91]
    s_add_u32 m0, s28, 1920
    ds_read_b64_tr_b16 v[96:97], v6 offset:22528
    ds_read_b64_tr_b16 v[98:99], v6 offset:22784
    buffer_load_dwordx4 v3, s[4:7], s22 offen offset:128 lds
    v_mfma_f32_32x32x16_bf16 v[12:27], v[104:107], v[128:131], v[12:27]
    s_waitcnt lgkmcnt(4)
    v_mfma_f32_32x32x16_bf16 v[28:43], v[108:111], v[128:131], v[28:43]
    s_waitcnt vmcnt(10) lgkmcnt(0)
    s_barrier
    ds_read_b128 v[132:135], v7 offset:16384
    ds_read_b128 v[136:139], v8 offset:16384
    ds_read_b128 v[140:143], v9 offset:16384
    ds_read_b128 v[144:147], v10 offset:16384
    ds_read_b64_tr_b16 v[100:101], v6 offset:24576
    ds_read_b64_tr_b16 v[102:103], v6 offset:24832
    ds_read_b64_tr_b16 v[104:105], v6 offset:25600
    ds_read_b64_tr_b16 v[106:107], v6 offset:25856
    v_mfma_f32_32x32x16_bf16 v[44:59], v[112:115], v[128:131], v[44:59]
    ds_read_b64_tr_b16 v[108:109], v6 offset:26624
    ds_read_b64_tr_b16 v[110:111], v6 offset:26880
    v_mfma_f32_32x32x16_bf16 v[60:75], v[92:95], v[128:131], v[60:75]
    ds_read_b64_tr_b16 v[112:113], v6 offset:27648
    ds_read_b64_tr_b16 v[114:115], v6 offset:27904
    v_mfma_f32_32x32x16_bf16 v[76:91], v[96:99], v[128:131], v[76:91]
    ds_read_b64_tr_b16 v[92:93], v6 offset:28672
    ds_read_b64_tr_b16 v[94:95], v6 offset:28928
    s_waitcnt lgkmcnt(6)
    v_mfma_f32_32x32x16_bf16 v[12:27], v[100:103], v[132:135], v[12:27]
    s_mul_i32 s22, s21, 110592
    s_add_u32 s22, s22, s25
    s_add_u32 s21, s21, 1
    s_cmp_eq_u32 s21, 18
    s_cselect_b32 s21, 0, s21
    s_add_u32 m0, s28, 12288
    ds_read_b64_tr_b16 v[96:97], v6 offset:30720
    ds_read_b64_tr_b16 v[98:99], v6 offset:30976
    buffer_load_dwordx4 v1, s[4:7], s22 offen offset:0 lds
    s_add_u32 m0, s28, 13248
    s_nop 0
    buffer_load_dwordx4 v2, s[4:7], s22 offen offset:64 lds
    v_mfma_f32_32x32x16_bf16 v[28:43], v[104:107], v[132:135], v[28:43]
    s_add_u32 m0, s28, 14208
    ds_read_b64_tr_b16 v[100:101], v6 offset:31744
    ds_read_b64_tr_b16 v[102:103], v6 offset:32000
    buffer_load_dwordx4 v3, s[4:7], s22 offen offset:128 lds
    s_waitcnt lgkmcnt(6)
    v_mfma_f32_32x32x16_bf16 v[44:59], v[108:111], v[132:135], v[44:59]
    s_lshl_b32 s23, s49, 7
    s_add_u32 s49, s49, 1
    s_cmp_eq_u32 s49, 9
    s_cselect_b32 s49, 0, s49
    s_add_u32 m0, s48, 16384
    ds_read_b64_tr_b16 v[104:105], v6 offset:32768
    ds_read_b64_tr_b16 v[106:107], v6 offset:33024
    buffer_load_dwordx4 v4, s[12:15], s23 offen lds
    v_mfma_f32_32x32x16_bf16 v[60:75], v[112:115], v[132:135], v[60:75]
    s_add_u32 m0, s48, 17408
    ds_read_b64_tr_b16 v[108:109], v6 offset:33792
    ds_read_b64_tr_b16 v[110:111], v6 offset:34048
    buffer_load_dwordx4 v5, s[12:15], s23 offen lds
    s_waitcnt lgkmcnt(6)
    v_mfma_f32_32x32x16_bf16 v[76:91], v[92:95], v[132:135], v[76:91]
    s_add_u32 s23, s23, 18432
    s_add_u32 m0, s48, 18432
    ds_read_b64_tr_b16 v[112:113], v6 offset:34816
    ds_read_b64_tr_b16 v[114:115], v6 offset:35072
    buffer_load_dwordx4 v4, s[12:15], s23 offen lds
    v_mfma_f32_32x32x16_bf16 v[12:27], v[96:99], v[136:139], v[12:27]
    s_add_u32 m0, s48, 19456
    s_nop 0
    buffer_load_dwordx4 v5, s[12:15], s23 offen lds
    s_waitcnt lgkmcnt(4)
    v_mfma_f32_32x32x16_bf16 v[28:43], v[100:103], v[136:139], v[28:43]
    s_waitcnt vmcnt(14) lgkmcnt(0)
    s_barrier
    ds_read_b64_tr_b16 v[92:93], v6 offset:36864
    ds_read_b64_tr_b16 v[94:95], v6 offset:37120
    ds_read_b64_tr_b16 v[96:97], v6 offset:37888
    ds_read_b64_tr_b16 v[98:99], v6 offset:38144
    v_mfma_f32_32x32x16_bf16 v[44:59], v[104:107], v[136:139], v[44:59]
    ds_read_b64_tr_b16 v[100:101], v6 offset:38912
    ds_read_b64_tr_b16 v[102:103], v6 offset:39168
    v_mfma_f32_32x32x16_bf16 v[60:75], v[108:111], v[136:139], v[60:75]
    ds_read_b64_tr_b16 v[104:105], v6 offset:39936
    ds_read_b64_tr_b16 v[106:107], v6 offset:40192
    v_mfma_f32_32x32x16_bf16 v[76:91], v[112:115], v[136:139], v[76:91]
    ds_read_b64_tr_b16 v[108:109], v6 offset:40960
    ds_read_b64_tr_b16 v[110:111], v6 offset:41216
    s_waitcnt lgkmcnt(6)
    v_mfma_f32_32x32x16_bf16 v[12:27], v[92:95], v[140:143], v[12:27]
    s_mul_i32 s22, s21, 110592
    s_add_u32 s22, s22, s25
    s_add_u32 s21, s21, 1
    s_add_u32 m0, s28, 24576
    ds_read_b64_tr_b16 v[112:113], v6 offset:43008
    ds_read_b64_tr_b16 v[114:115], v6 offset:43264
    buffer_load_dwordx4 v1, s[4:7], s22 offen offset:0 lds
    v_mfma_f32_32x32x16_bf16 v[28:43], v[96:99], v[140:143], v[28:43]
    s_add_u32 m0, s28, 25536
    ds_read_b64_tr_b16 v[92:93], v6 offset:44032
    ds_read_b64_tr_b16 v[94:95], v6 offset:44288
    buffer_load_dwordx4 v2, s[4:7], s22 offen offset:64 lds
    s_waitcnt lgkmcnt(6)
    v_mfma_f32_32x32x16_bf16 v[44:59], v[100:103], v[140:143], v[44:59]
    ds_read_b64_tr_b16 v[96:97], v6 offset:45056
    ds_read_b64_tr_b16 v[98:99], v6 offset:45312
    v_mfma_f32_32x32x16_bf16 v[60:75], v[104:107], v[140:143], v[60:75]
    s_add_u32 m0, s28, 26496
    ds_read_b64_tr_b16 v[100:101], v6 offset:46080
    ds_read_b64_tr_b16 v[102:103], v6 offset:46336
    buffer_load_dwordx4 v3, s[4:7], s22 offen offset:128 lds
    s_waitcnt lgkmcnt(6)
    v_mfma_f32_32x32x16_bf16 v[76:91], v[108:111], v[140:143], v[76:91]
    v_mov_b32 v181, 0
    ds_read_b64_tr_b16 v[104:105], v6 offset:47104
    ds_read_b64_tr_b16 v[106:107], v6 offset:47360
    global_load_dword v180, v181, s[80:81] sc1
    v_mfma_f32_32x32x16_bf16 v[12:27], v[112:115], v[144:147], v[12:27]
    s_waitcnt lgkmcnt(4)
    v_mfma_f32_32x32x16_bf16 v[28:43], v[92:95], v[144:147], v[28:43]
    s_waitcnt vmcnt(11) lgkmcnt(0)
    s_barrier
    ds_read_b128 v[116:119], v7 offset:0
    ds_read_b128 v[120:123], v8 offset:0
    ds_read_b128 v[124:127], v9 offset:0
    ds_read_b128 v[128:131], v10 offset:0
    ds_read_b64_tr_b16 v[108:109], v6 offset:0
    ds_read_b64_tr_b16 v[110:111], v6 offset:256
    ds_read_b64_tr_b16 v[112:113], v6 offset:1024
    ds_read_b64_tr_b16 v[114:115], v6 offset:1280
    v_mfma_f32_32x32x16_bf16 v[44:59], v[96:99], v[144:147], v[44:59]
    ds_read_b64_tr_b16 v[92:93], v6 offset:2048
    ds_read_b64_tr_b16 v[94:95], v6 offset:2304
    v_mfma_f32_32x32x16_bf16 v[60:75], v[100:103], v[144:147], v[60:75]
    ds_read_b64_tr_b16 v[96:97], v6 offset:3072
    ds_read_b64_tr_b16 v[98:99], v6 offset:3328
    v_mfma_f32_32x32x16_bf16 v[76:91], v[104:107], v[144:147], v[76:91]
    ds_read_b64_tr_b16 v[100:101], v6 offset:4096
    ds_read_b64_tr_b16 v[102:103], v6 offset:4352
    s_waitcnt lgkmcnt(6)
    v_mfma_f32_32x32x16_bf16 v[12:27], v[108:111], v[116:119], v[12:27]
    s_mul_i32 s22, s21, 110592
    s_add_u32 s22, s22, s25
    s_add_u32 s21, s21, 1
    s_cmp_eq_u32 s21, 18
    s_cselect_b32 s21, 0, s21
    s_add_u32 m0, s28, 36864
    ds_read_b64_tr_b16 v[104:105], v6 offset:6144
    ds_read_b64_tr_b16 v[106:107], v6 offset:6400
    buffer_load_dwordx4 v1, s[4:7], s22 offen offset:0 lds
    s_add_u32 m0, s28, 37824
    s_nop 0
    buffer_load_dwordx4 v2, s[4:7], s22 offen offset:64 lds
    v_mfma_f32_32x32x16_bf16 v[28:43], v[112:115], v[116:119], v[28:43]
    s_add_u32 m0, s28, 38784
    ds_read_b64_tr_b16 v[108:109], v6 offset:7168
    ds_read_b64_tr_b16 v[110:111], v6 offset:7424
    buffer_load_dwordx4 v3, s[4:7], s22 offen offset:128 lds
    s_waitcnt lgkmcnt(6)
    v_mfma_f32_32x32x16_bf16 v[44:59], v[92:95], v[116:119], v[44:59]
    s_lshl_b32 s23, s49, 7
    s_add_u32 s49, s49, 1
    s_cmp_eq_u32 s49, 9
    s_cselect_b32 s49, 0, s49
    s_add_u32 m0, s48, 0
    ds_read_b64_tr_b16 v[112:113], v6 offset:8192
    ds_read_b64_tr_b16 v[114:115], v6 offset:8448
    buffer_load_dwordx4 v4, s[12:15], s23 offen lds
    v_mfma_f32_32x32x16_bf16 v[60:75], v[96:99], v[116:119], v[60:75]
    s_add_u32 m0, s48, 1024
    ds_read_b64_tr_b16 v[92:93], v6 offset:9216
    ds_read_b64_tr_b16 v[94:95], v6 offset:9472
    buffer_load_dwordx4 v5, s[12:15], s23 offen lds
    s_waitcnt lgkmcnt(6)
    v_mfma_f32_32x32x16_bf16 v[76:91], v[100:103], v[116:119], v[76:91]
    s_add_u32 s23, s23, 18432
    s_add_u32 m0, s48, 2048
    ds_read_b64_tr_b16 v[96:97], v6 offset:10240
    ds_read_b64_tr_b16 v[98:99], v6 offset:10496
    buffer_load_dwordx4 v4, s[12:15], s23 offen lds
    v_mfma_f32_32x32x16_bf16 v[12:27], v[104:107], v[120:123], v[12:27]
    s_add_u32 m0, s48, 3072
    s_nop 0
    buffer_load_dwordx4 v5, s[12:15], s23 offen lds
    s_waitcnt lgkmcnt(4)
    v_mfma_f32_32x32x16_bf16 v[28:43], v[108:111], v[120:123], v[28:43]
    s_waitcnt vmcnt(15) lgkmcnt(0)
    s_barrier
    ds_read_b64_tr_b16 v[100:101], v6 offset:12288
    ds_read_b64_tr_b16 v[102:103], v6 offset:12544
    ds_read_b64_tr_b16 v[104:105], v6 offset:13312
    ds_read_b64_tr_b16 v[106:107], v6 offset:13568
    v_mfma_f32_32x32x16_bf16 v[44:59], v[112:115], v[120:123], v[44:59]
    ds_read_b64_tr_b16 v[108:109], v6 offset:14336
    ds_read_b64_tr_b16 v[110:111], v6 offset:14592
    v_mfma_f32_32x32x16_bf16 v[60:75], v[92:95], v[120:123], v[60:75]
    ds_read_b64_tr_b16 v[112:113], v6 offset:15360
    ds_read_b64_tr_b16 v[114:115], v6 offset:15616
    v_mfma_f32_32x32x16_bf16 v[76:91], v[96:99], v[120:123], v[76:91]
    ds_read_b64_tr_b16 v[92:93], v6 offset:16384
    ds_read_b64_tr_b16 v[94:95], v6 offset:16640
    s_waitcnt lgkmcnt(6)
    v_mfma_f32_32x32x16_bf16 v[12:27], v[100:103], v[124:127], v[12:27]
    s_mul_i32 s22, s21, 110592
    s_add_u32 s22, s22, s25
    s_add_u32 s21, s21, 1
    s_add_u32 m0, s28, 0
    ds_read_b64_tr_b16 v[96:97], v6 offset:18432
    ds_read_b64_tr_b16 v[98:99], v6 offset:18688
    buffer_load_dwordx4 v1, s[4:7], s22 offen offset:0 lds
    v_mfma_f32_32x32x16_bf16 v[28:43], v[104:107], v[124:127], v[28:43]
    ds_read_b64_tr_b16 v[100:101], v6 offset:19456
    ds_read_b64_tr_b16 v[102:103], v6 offset:19712
    s_waitcnt lgkmcnt(6)
    v_mfma_f32_32x32x16_bf16 v[44:59], v[108:111], v[124:127], v[44:59]
    s_add_u32 m0, s28, 960
    ds_read_b64_tr_b16 v[104:105], v6 offset:20480
    ds_read_b64_tr_b16 v[106:107], v6 offset:20736
    buffer_load_dwordx4 v2, s[4:7], s22 offen offset:64 lds
    v_mfma_f32_32x32x16_bf16 v[60:75], v[112:115], v[124:127], v[60:75]
    ds_read_b64_tr_b16 v[108:109], v6 offset:21504
    ds_read_b64_tr_b16 v[110:111], v6 offset:21760
    s_waitcnt lgkmcnt(6)
    v_mfma_f32_32x32x16_bf16 v[76:91], v[92:95], v[124:127], v[76:91]
    s_add_u32 m0, s28, 1920
    ds_read_b64_tr_b16 v[112:113], v6 offset:22528
    ds_read_b64_tr_b16 v[114:115], v6 offset:22784
    buffer_load_dwordx4 v3, s[4:7], s22 offen offset:128 lds
    v_mfma_f32_32x32x16_bf16 v[12:27], v[96:99], v[128:131], v[12:27]
    s_waitcnt lgkmcnt(4)
    v_mfma_f32_32x32x16_bf16 v[28:43], v[100:103], v[128:131], v[28:43]
    s_waitcnt vmcnt(11) lgkmcnt(0)
    s_barrier
    ds_read_b128 v[132:135], v7 offset:16384
    ds_read_b128 v[136:139], v8 offset:16384
    ds_read_b128 v[140:143], v9 offset:16384
    ds_read_b128 v[144:147], v10 offset:16384
    ds_read_b64_tr_b16 v[92:93], v6 offset:24576
    ds_read_b64_tr_b16 v[94:95], v6 offset:24832
    ds_read_b64_tr_b16 v[96:97], v6 offset:25600
    ds_read_b64_tr_b16 v[98:99], v6 offset:25856
    v_mfma_f32_32x32x16_bf16 v[44:59], v[104:107], v[128:131], v[44:59]
    ds_read_b64_tr_b16 v[100:101], v6 offset:26624
    ds_read_b64_tr_b16 v[102:103], v6 offset:26880
    v_mfma_f32_32x32x16_bf16 v[60:75], v[108:111], v[128:131], v[60:75]
    ds_read_b64_tr_b16 v[104:105], v6 offset:27648
    ds_read_b64_tr_b16 v[106:107], v6 offset:27904
    v_mfma_f32_32x32x16_bf16 v[76:91], v[112:115], v[128:131], v[76:91]
    ds_read_b64_tr_b16 v[108:109], v6 offset:28672
    ds_read_b64_tr_b16 v[110:111], v6 offset:28928
    s_waitcnt lgkmcnt(6)
    v_mfma_f32_32x32x16_bf16 v[12:27], v[92:95], v[132:135], v[12:27]
    s_mul_i32 s22, s21, 110592
    s_add_u32 s22, s22, s25
    s_add_u32 s21, s21, 1
    s_cmp_eq_u32 s21, 18
    s_cselect_b32 s21, 0, s21
    s_add_u32 m0, s28, 12288
    ds_read_b64_tr_b16 v[112:113], v6 offset:30720
    ds_read_b64_tr_b16 v[114:115], v6 offset:30976
    buffer_load_dwordx4 v1, s[4:7], s22 offen offset:0 lds
    s_add_u32 m0, s28, 13248
    s_nop 0
    buffer_load_dwordx4 v2, s[4:7], s22 offen offset:64 lds
    v_mfma_f32_32x32x16_bf16 v[28:43], v[96:99], v[132:135], v[28:43]
    s_add_u32 m0, s28, 14208
    ds_read_b64_tr_b16 v[92:93], v6 offset:31744
    ds_read_b64_tr_b16 v[94:95], v6 offset:32000
    buffer_load_dwordx4 v3, s[4:7], s22 offen offset:128 lds
    s_waitcnt lgkmcnt(6)
    v_mfma_f32_32x32x16_bf16 v[44:59], v[100:103], v[132:135], v[44:59]
    s_lshl_b32 s23, s49, 7
    s_add_u32 s49, s49, 1
    s_cmp_eq_u32 s49, 9
    s_cselect_b32 s49, 0, s49
    s_add_u32 m0, s48, 16384
    ds_read_b64_tr_b16 v[96:97], v6 offset:32768
    ds_read_b64_tr_b16 v[98:99], v6 offset:33024
    buffer_load_dwordx4 v4, s[12:15], s23 offen lds
    v_mfma_f32_32x32x16_bf16 v[60:75], v[104:107], v[132:135], v[60:75]
    s_add_u32 m0, s48, 17408
    ds_read_b64_tr_b16 v[100:101], v6 offset:33792
    ds_read_b64_tr_b16 v[102:103], v6 offset:34048
    buffer_load_dwordx4 v5, s[12:15], s23 offen lds
    s_waitcnt lgkmcnt(6)
    v_mfma_f32_32x32x16_bf16 v[76:91], v[108:111], v[132:135], v[76:91]
    s_add_u32 s23, s23, 18432
    s_add_u32 m0, s48, 18432
    ds_read_b64_tr_b16 v[104:105], v6 offset:34816
    ds_read_b64_tr_b16 v[106:107], v6 offset:35072
    buffer_load_dwordx4 v4, s[12:15], s23 offen lds
    v_mfma_f32_32x32x16_bf16 v[12:27], v[112:115], v[136:139], v[12:27]
    s_add_u32 m0, s48, 19456
    s_nop 0
    buffer_load_dwordx4 v5, s[12:15], s23 offen lds
    s_waitcnt lgkmcnt(4)
    v_mfma_f32_32x32x16_bf16 v[28:43], v[92:95], v[136:139], v[28:43]
    s_waitcnt vmcnt(14) lgkmcnt(0)
    s_barrier
    ds_read_b64_tr_b16 v[108:109], v6 offset:36864
    ds_read_b64_tr_b16 v[110:111], v6 offset:37120
    ds_read_b64_tr_b16 v[112:113], v6 offset:37888
    ds_read_b64_tr_b16 v[114:115], v6 offset:38144
    v_mfma_f32_32x32x16_bf16 v[44:59], v[96:99], v[136:139], v[44:59]
    ds_read_b64_tr_b16 v[92:93], v6 offset:38912
    ds_read_b64_tr_b16 v[94:95], v6 offset:39168
    v_mfma_f32_32x32x16_bf16 v[60:75], v[100:103], v[136:139], v[60:75]
    ds_read_b64_tr_b16 v[96:97], v6 offset:39936
    ds_read_b64_tr_b16 v[98:99], v6 offset:40192
    v_mfma_f32_32x32x16_bf16 v[76:91], v[104:107], v[136:139], v[76:91]
    ds_read_b64_tr_b16 v[100:101], v6 offset:40960
    ds_read_b64_tr_b16 v[102:103], v6 offset:41216
    s_waitcnt lgkmcnt(6)
    v_mfma_f32_32x32x16_bf16 v[12:27], v[108:111], v[140:143], v[12:27]
    s_mul_i32 s22, s21, 110592
    s_add_u32 s22, s22, s25
    s_add_u32 s21, s21, 1
    s_add_u32 m0, s28, 24576
    ds_read_b64_tr_b16 v[104:105], v6 offset:43008
    ds_read_b64_tr_b16 v[106:107], v6 offset:43264
    buffer_load_dwordx4 v1, s[4:7], s22 offen offset:0 lds
    v_mfma_f32_32x32x16_bf16 v[28:43], v[112:115], v[140:143], v[28:43]
    ds_read_b64_tr_b16 v[108:109], v6 offset:44032
    ds_read_b64_tr_b16 v[110:111], v6 offset:44288
    s_waitcnt lgkmcnt(6)
    v_mfma_f32_32x32x16_bf16 v[44:59], v[92:95], v[140:143], v[44:59]
    s_add_u32 m0, s28, 25536
    ds_read_b64_tr_b16 v[112:113], v6 offset:45056
    ds_read_b64_tr_b16 v[114:115], v6 offset:45312
    buffer_load_dwordx4 v2, s[4:7], s22 offen offset:64 lds
    v_mfma_f32_32x32x16_bf16 v[60:75], v[96:99], v[140:143], v[60:75]
    ds_read_b64_tr_b16 v[92:93], v6 offset:46080
    ds_read_b64_tr_b16 v[94:95], v6 offset:46336
    s_waitcnt lgkmcnt(6)
    v_mfma_f32_32x32x16_bf16 v[76:91], v[100:103], v[140:143], v[76:91]
    s_add_u32 m0, s28, 26496
    ds_read_b64_tr_b16 v[96:97], v6 offset:47104
    ds_read_b64_tr_b16 v[98:99], v6 offset:47360
    buffer_load_dwordx4 v3, s[4:7], s22 offen offset:128 lds
    v_mfma_f32_32x32x16_bf16 v[12:27], v[104:107], v[144:147], v[12:27]
    s_waitcnt lgkmcnt(4)
    v_mfma_f32_32x32x16_bf16 v[28:43], v[108:111], v[144:147], v[28:43]
    s_waitcnt vmcnt(10) lgkmcnt(0)
    s_barrier
    ds_read_b128 v[116:119], v7 offset:0
    ds_read_b128 v[120:123], v8 offset:0
    ds_read_b128 v[124:127], v9 offset:0
    ds_read_b128 v[128:131], v10 offset:0
    ds_read_b64_tr_b16 v[100:101], v6 offset:0
    ds_read_b64_tr_b16 v[102:103], v6 offset:256
    ds_read_b64_tr_b16 v[104:105], v6 offset:1024
    ds_read_b64_tr_b16 v[106:107], v6 offset:1280
    v_mfma_f32_32x32x16_bf16 v[44:59], v[112:115], v[144:147], v[44:59]
    ds_read_b64_tr_b16 v[108:109], v6 offset:2048
    ds_read_b64_tr_b16 v[110:111], v6 offset:2304
    v_mfma_f32_32x32x16_bf16 v[60:75], v[92:95], v[144:147], v[60:75]
    ds_read_b64_tr_b16 v[112:113], v6 offset:3072
    ds_read_b64_tr_b16 v[114:115], v6 offset:3328
    v_mfma_f32_32x32x16_bf16 v[76:91], v[96:99], v[144:147], v[76:91]
    ds_read_b64_tr_b16 v[92:93], v6 offset:4096
    ds_read_b64_tr_b16 v[94:95], v6 offset:4352
    s_waitcnt lgkmcnt(6)
    v_mfma_f32_32x32x16_bf16 v[12:27], v[100:103], v[116:119], v[12:27]
    s_mul_i32 s22, s21, 110592
    s_add_u32 s22, s22, s25
    s_add_u32 s21, s21, 1
    s_cmp_eq_u32 s21, 18
    s_cselect_b32 s21, 0, s21
    s_add_u32 m0, s28, 36864
    ds_read_b64_tr_b16 v[96:97], v6 offset:6144
    ds_read_b64_tr_b16 v[98:99], v6 offset:6400
    buffer_load_dwordx4 v1, s[4:7], s22 offen offset:0 lds
    s_add_u32 m0, s28, 37824
    s_nop 0
    buffer_load_dwordx4 v2, s[4:7], s22 offen offset:64 lds
    v_mfma_f32_32x32x16_bf16 v[28:43], v[104:107], v[116:119], v[28:43]
    s_add_u32 m0, s28, 38784
    ds_read_b64_tr_b16 v[100:101], v6 offset:7168
    ds_read_b64_tr_b16 v[102:103], v6 offset:7424
    buffer_load_dwordx4 v3, s[4:7], s22 offen offset:128 lds
    s_waitcnt lgkmcnt(6)
    v_mfma_f32_32x32x16_bf16 v[44:59], v[108:111], v[116:119], v[44:59]
    s_lshl_b32 s23, s49, 7
    s_add_u32 s49, s49, 1
    s_cmp_eq_u32 s49, 9
    s_cselect_b32 s49, 0, s49
    s_add_u32 m0, s48, 0
    ds_read_b64_tr_b16 v[104:105], v6 offset:8192
    ds_read_b64_tr_b16 v[106:107], v6 offset:8448
    buffer_load_dwordx4 v4, s[12:15], s23 offen lds
    v_mfma_f32_32x32x16_bf16 v[60:75], v[112:115], v[116:119], v[60:75]
    s_add_u32 m0, s48, 1024
    ds_read_b64_tr_b16 v[108:109], v6 offset:9216
    ds_read_b64_tr_b16 v[110:111], v6 offset:9472
    buffer_load_dwordx4 v5, s[12:15], s23 offen lds
    s_waitcnt lgkmcnt(6)
    v_mfma_f32_32x32x16_bf16 v[76:91], v[92:95], v[116:119], v[76:91]
    s_add_u32 s23, s23, 18432
    s_add_u32 m0, s48, 2048
    ds_read_b64_tr_b16 v[112:113], v6 offset:10240
    ds_read_b64_tr_b16 v[114:115], v6 offset:10496
    buffer_load_dwordx4 v4, s[12:15], s23 offen lds
    v_mfma_f32_32x32x16_bf16 v[12:27], v[96:99], v[120:123], v[12:27]
    s_add_u32 m0, s48, 3072
    s_nop 0
    buffer_load_dwordx4 v5, s[12:15], s23 offen lds
    s_waitcnt lgkmcnt(4)
    v_mfma_f32_32x32x16_bf16 v[28:43], v[100:103], v[120:123], v[28:43]
    s_waitcnt vmcnt(14) lgkmcnt(0)
    v_readfirstlane_b32 s57, v180
    s_nop 1
    s_cmp_ge_u32 s57, 16
    s_cbranch_scc1 L_f_rk_1
    s_cmp_lg_u32 s18, 0
    s_cbranch_scc1 L_f_rd_2
    s_mov_b32 s57, 262144
    v_mov_b32 v181, 0
L_f_rp_3:
    global_load_dword v180, v181, s[80:81] sc1
    s_waitcnt vmcnt(0)
    v_readfirstlane_b32 s58, v180
    s_nop 1
    s_cmp_ge_u32 s58, 16
    s_cbranch_scc1 L_f_rd_2
    s_sleep 8
    s_sub_u32 s57, s57, 1
    s_cmp_gt_i32 s57, 0
    s_cbranch_scc1 L_f_rp_3
L_f_rd_2:
L_f_rk_1:
    s_barrier
    ds_read_b64_tr_b16 v[92:93], v6 offset:12288
    ds_read_b64_tr_b16 v[94:95], v6 offset:12544
    ds_read_b64_tr_b16 v[96:97], v6 offset:13312
    ds_read_b64_tr_b16 v[98:99], v6 offset:13568
    v_mfma_f32_32x32x16_bf16 v[44:59], v[104:107], v[120:123], v[44:59]
    ds_read_b64_tr_b16 v[100:101], v6 offset:14336
    ds_read_b64_tr_b16 v[102:103], v6 offset:14592
    v_mfma_f32_32x32x16_bf16 v[60:75], v[108:111], v[120:123], v[60:75]
    ds_read_b64_tr_b16 v[104:105], v6 offset:15360
    ds_read_b64_tr_b16 v[106:107], v6 offset:15616
    v_mfma_f32_32x32x16_bf16 v[76:91], v[112:115], v[120:123], v[76:91]
    ds_read_b64_tr_b16 v[108:109], v6 offset:16384
    ds_read_b64_tr_b16 v[110:111], v6 offset:16640
    s_waitcnt lgkmcnt(6)
    v_mfma_f32_32x32x16_bf16 v[12:27], v[92:95], v[124:127], v[12:27]
    s_mul_i32 s22, s21, 110592
    s_add_u32 s22, s22, s25
    s_add_u32 s21, s21, 1
    s_add_u32 m0, s28, 0
    ds_read_b64_tr_b16 v[112:113], v6 offset:18432
    ds_read_b64_tr_b16 v[114:115], v6 offset:18688
    buffer_load_dwordx4 v1, s[4:7], s22 offen offset:0 lds
    v_mfma_f32_32x32x16_bf16 v[28:43], v[96:99], v[124:127], v[28:43]
    ds_read_b64_tr_b16 v[92:93], v6 offset:19456
    ds_read_b64_tr_b16 v[94:95], v6 offset:19712
    s_waitcnt lgkmcnt(6)
    v_mfma_f32_32x32x16_bf16 v[44:59], v[100:103], v[124:127], v[44:59]
    s_add_u32 m0, s28, 960
    ds_read_b64_tr_b16 v[96:97], v6 offset:20480
    ds_read_b64_tr_b16 v[98:99], v6 offset:20736
    buffer_load_dwordx4 v2, s[4:7], s22 offen offset:64 lds
    v_mfma_f32_32x32x16_bf16 v[60:75], v[104:107], v[124:127], v[60:75]
    ds_read_b64_tr_b16 v[100:101], v6 offset:21504
    ds_read_b64_tr_b16 v[102:103], v6 offset:21760
    s_waitcnt lgkmcnt(6)
    v_mfma_f32_32x32x16_bf16 v[76:91], v[108:111], v[124:127], v[76:91]
    s_add_u32 m0, s28, 1920
    ds_read_b64_tr_b16 v[104:105], v6 offset:22528
    ds_read_b64_tr_b16 v[106:107], v6 offset:22784
    buffer_load_dwordx4 v3, s[4:7], s22 offen offset:128 lds
    v_mfma_f32_32x32x16_bf16 v[12:27], v[112:115], v[128:131], v[12:27]
    s_waitcnt lgkmcnt(4)
    v_mfma_f32_32x32x16_bf16 v[28:43], v[92:95], v[128:131], v[28:43]
    s_waitcnt vmcnt(10) lgkmcnt(0)
    s_barrier
    ds_read_b128 v[132:135], v7 offset:16384
    ds_read_b128 v[136:139], v8 offset:16384
    ds_read_b128 v[140:143], v9 offset:16384
    ds_read_b128 v[144:147], v10 offset:16384
    ds_read_b64_tr_b16 v[108:109], v6 offset:24576
    ds_read_b64_tr_b16 v[110:111], v6 offset:24832
    ds_read_b64_tr_b16 v[112:113], v6 offset:25600
    ds_read_b64_tr_b16 v[114:115], v6 offset:25856
    v_mfma_f32_32x32x16_bf16 v[44:59], v[96:99], v[128:131], v[44:59]
    ds_read_b64_tr_b16 v[92:93], v6 offset:26624
    ds_read_b64_tr_b16 v[94:95], v6 offset:26880
    v_mfma_f32_32x32x16_bf16 v[60:75], v[100:103], v[128:131], v[60:75]
    ds_read_b64_tr_b16 v[96:97], v6 offset:27648
    ds_read_b64_tr_b16 v[98:99], v6 offset:27904
    v_mfma_f32_32x32x16_bf16 v[76:91], v[104:107], v[128:131], v[76:91]
    ds_read_b64_tr_b16 v[100:101], v6 offset:28672
    ds_read_b64_tr_b16 v[102:103], v6 offset:28928
    s_waitcnt lgkmcnt(6)
    v_mfma_f32_32x32x16_bf16 v[12:27], v[108:111], v[132:135], v[12:27]
    s_mul_i32 s22, s21, 110592
    s_add_u32 s22, s22, s25
    s_add_u32 s21, s21, 1
    s_cmp_eq_u32 s21, 18
    s_cselect_b32 s21, 0, s21
    s_add_u32 m0, s28, 12288
    ds_read_b64_tr_b16 v[104:105], v6 offset:30720
    ds_read_b64_tr_b16 v[106:107], v6 offset:30976
    buffer_load_dwordx4 v1, s[4:7], s22 offen offset:0 lds
    s_add_u32 m0, s28, 13248
    s_nop 0
    buffer_load_dwordx4 v2, s[4:7], s22 offen offset:64 lds
    v_mfma_f32_32x32x16_bf16 v[28:43], v[112:115], v[132:135], v[28:43]
    s_add_u32 m0, s28, 14208
    ds_read_b64_tr_b16 v[108:109], v6 offset:31744
    ds_read_b64_tr_b16 v[110:111], v6 offset:32000
    buffer_load_dwordx4 v3, s[4:7], s22 offen offset:128 lds
    s_waitcnt lgkmcnt(6)
    v_mfma_f32_32x32x16_bf16 v[44:59], v[92:95], v[132:135], v[44:59]
    s_lshl_b32 s23, s49, 7
    s_add_u32 s49, s49, 1
    s_cmp_eq_u32 s49, 9
    s_cselect_b32 s49, 0, s49
    s_add_u32 m0, s48, 16384
    ds_read_b64_tr_b16 v[112:113], v6 offset:32768
    ds_read_b64_tr_b16 v[114:115], v6 offset:33024
    buffer_load_dwordx4 v4, s[12:15], s23 offen lds
    v_mfma_f32_32x32x16_bf16 v[60:75], v[96:99], v[132:135], v[60:75]
    s_add_u32 m0, s48, 17408
    ds_read_b64_tr_b16 v[92:93], v6 offset:33792
    ds_read_b64_tr_b16 v[94:95], v6 offset:34048
    buffer_load_dwordx4 v5, s[12:15], s23 offen lds
    s_waitcnt lgkmcnt(6)
    v_mfma_f32_32x32x16_bf16 v[76:91], v[100:103], v[132:135], v[76:91]
    s_add_u32 s23, s23, 18432
    s_add_u32 m0, s48, 18432
    ds_read_b64_tr_b16 v[96:97], v6 offset:34816
    ds_read_b64_tr_b16 v[98:99], v6 offset:35072
    buffer_load_dwordx4 v4, s[12:15], s23 offen lds
    v_mfma_f32_32x32x16_bf16 v[12:27], v[104:107], v[136:139], v[12:27]
    s_add_u32 m0, s48, 19456
    s_nop 0
    buffer_load_dwordx4 v5, s[12:15], s23 offen lds
    s_waitcnt lgkmcnt(4)
    v_mfma_f32_32x32x16_bf16 v[28:43], v[108:111], v[136:139], v[28:43]
    s_waitcnt vmcnt(14) lgkmcnt(0)
    s_barrier
    ds_read_b64_tr_b16 v[100:101], v6 offset:36864
    ds_read_b64_tr_b16 v[102:103], v6 offset:37120
    ds_read_b64_tr_b16 v[104:105], v6 offset:37888
    ds_read_b64_tr_b16 v[106:107], v6 offset:38144
    v_mfma_f32_32x32x16_bf16 v[44:59], v[112:115], v[136:139], v[44:59]
    ds_read_b64_tr_b16 v[108:109], v6 offset:38912
    ds_read_b64_tr_b16 v[110:111], v6 offset:39168
    v_mfma_f32_32x32x16_bf16 v[60:75], v[92:95], v[136:139], v[60:75]
    ds_read_b64_tr_b16 v[112:113], v6 offset:39936
    ds_read_b64_tr_b16 v[114:115], v6 offset:40192
    v_mfma_f32_32x32x16_bf16 v[76:91], v[96:99], v[136:139], v[76:91]
    ds_read_b64_tr_b16 v[92:93], v6 offset:40960
    ds_read_b64_tr_b16 v[94:95], v6 offset:41216
    s_waitcnt lgkmcnt(6)
    v_mfma_f32_32x32x16_bf16 v[12:27], v[100:103], v[140:143], v[12:27]
    s_mul_i32 s22, s21, 110592
    s_add_u32 s22, s22, s25
    s_add_u32 s21, s21, 1
    s_add_u32 m0, s28, 24576
    ds_read_b64_tr_b16 v[96:97], v6 offset:43008
    ds_read_b64_tr_b16 v[98:99], v6 offset:43264
    buffer_load_dwordx4 v1, s[4:7], s22 offen offset:0 lds
    v_mfma_f32_32x32x16_bf16 v[28:43], v[104:107], v[140:143], v[28:43]
    ds_read_b64_tr_b16 v[100:101], v6 offset:44032
    ds_read_b64_tr_b16 v[102:103], v6 offset:44288
    s_waitcnt lgkmcnt(6)
    v_mfma_f32_32x32x16_bf16 v[44:59], v[108:111], v[140:143], v[44:59]
    s_add_u32 m0, s28, 25536
    ds_read_b64_tr_b16 v[104:105], v6 offset:45056
    ds_read_b64_tr_b16 v[106:107], v6 offset:45312
    buffer_load_dwordx4 v2, s[4:7], s22 offen offset:64 lds
    v_mfma_f32_32x32x16_bf16 v[60:75], v[112:115], v[140:143], v[60:75]
    ds_read_b64_tr_b16 v[108:109], v6 offset:46080
    ds_read_b64_tr_b16 v[110:111], v6 offset:46336
    s_waitcnt lgkmcnt(6)
    v_mfma_f32_32x32x16_bf16 v[76:91], v[92:95], v[140:143], v[76:91]
    s_add_u32 m0, s28, 26496
    ds_read_b64_tr_b16 v[112:113], v6 offset:47104
    ds_read_b64_tr_b16 v[114:115], v6 offset:47360
    buffer_load_dwordx4 v3, s[4:7], s22 offen offset:128 lds
    v_mfma_f32_32x32x16_bf16 v[12:27], v[96:99], v[144:147], v[12:27]
    s_waitcnt lgkmcnt(4)
    v_mfma_f32_32x32x16_bf16 v[28:43], v[100:103], v[144:147], v[28:43]
    s_waitcnt vmcnt(10) lgkmcnt(0)
    s_barrier
    ds_read_b128 v[116:119], v7 offset:0
    ds_read_b128 v[120:123], v8 offset:0
    ds_read_b128 v[124:127], v9 offset:0
    ds_read_b128 v[128:131], v10 offset:0
    ds_read_b64_tr_b16 v[92:93], v6 offset:0
    ds_read_b64_tr_b16 v[94:95], v6 offset:256
    ds_read_b64_tr_b16 v[96:97], v6 offset:1024
    ds_read_b64_tr_b16 v[98:99], v6 offset:1280
    v_mfma_f32_32x32x16_bf16 v[44:59], v[104:107], v[144:147], v[44:59]
    ds_read_b64_tr_b16 v[100:101], v6 offset:2048
    ds_read_b64_tr_b16 v[102:103], v6 offset:2304
    v_mfma_f32_32x32x16_bf16 v[60:75], v[108:111], v[144:147], v[60:75]
    ds_read_b64_tr_b16 v[104:105], v6 offset:3072
    ds_read_b64_tr_b16 v[106:107], v6 offset:3328
    v_mfma_f32_32x32x16_bf16 v[76:91], v[112:115], v[144:147], v[76:91]
    ds_read_b64_tr_b16 v[108:109], v6 offset:4096
    ds_read_b64_tr_b16 v[110:111], v6 offset:4352
    s_waitcnt lgkmcnt(6)
    v_mfma_f32_32x32x16_bf16 v[12:27], v[92:95], v[116:119], v[12:27]
    s_mul_i32 s22, s21, 110592
    s_add_u32 s22, s22, s25
    s_add_u32 s21, s21, 1
    s_cmp_eq_u32 s21, 18
    s_cselect_b32 s21, 0, s21
    s_add_u32 m0, s28, 36864
    ds_read_b64_tr_b16 v[112:113], v6 offset:6144
    ds_read_b64_tr_b16 v[114:115], v6 offset:6400
    buffer_load_dwordx4 v1, s[4:7], s22 offen offset:0 lds
    s_add_u32 m0, s28, 37824
    s_nop 0
    buffer_load_dwordx4 v2, s[4:7], s22 offen offset:64 lds
    v_mfma_f32_32x32x16_bf16 v[28:43], v[96:99], v[116:119], v[28:43]
    s_add_u32 m0, s28, 38784
    ds_read_b64_tr_b16 v[92:93], v6 offset:7168
    ds_read_b64_tr_b16 v[94:95], v6 offset:7424
    buffer_load_dwordx4 v3, s[4:7], s22 offen offset:128 lds
    s_waitcnt lgkmcnt(6)
    v_mfma_f32_32x32x16_bf16 v[44:59], v[100:103], v[116:119], v[44:59]
    s_lshl_b32 s23, s49, 7
    s_add_u32 s49, s49, 1
    s_cmp_eq_u32 s49, 9
    s_cselect_b32 s49, 0, s49
    s_add_u32 m0, s48, 0
    ds_read_b64_tr_b16 v[96:97], v6 offset:8192
    ds_read_b64_tr_b16 v[98:99], v6 offset:8448
    buffer_load_dwordx4 v4, s[12:15], s23 offen lds
    v_mfma_f32_32x32x16_bf16 v[60:75], v[104:107], v[116:119], v[60:75]
    s_add_u32 m0, s48, 1024
    ds_read_b64_tr_b16 v[100:101], v6 offset:9216
    ds_read_b64_tr_b16 v[102:103], v6 offset:9472
    buffer_load_dwordx4 v5, s[12:15], s23 offen lds
    s_waitcnt lgkmcnt(6)
    v_mfma_f32_32x32x16_bf16 v[76:91], v[108:111], v[116:119], v[76:91]
    s_add_u32 s23, s23, 18432
    s_add_u32 m0, s48, 2048
    ds_read_b64_tr_b16 v[104:105], v6 offset:10240
    ds_read_b64_tr_b16 v[106:107], v6 offset:10496
    buffer_load_dwordx4 v4, s[12:15], s23 offen lds
    v_mfma_f32_32x32x16_bf16 v[12:27], v[112:115], v[120:123], v[12:27]
    s_add_u32 m0, s48, 3072
    s_nop 0
    buffer_load_dwordx4 v5, s[12:15], s23 offen lds
    s_waitcnt lgkmcnt(4)
    v_mfma_f32_32x32x16_bf16 v[28:43], v[92:95], v[120:123], v[28:43]
    s_waitcnt vmcnt(14) lgkmcnt(0)
    s_barrier
    ds_read_b64_tr_b16 v[108:109], v6 offset:12288
    ds_read_b64_tr_b16 v[110:111], v6 offset:12544
    ds_read_b64_tr_b16 v[112:113], v6 offset:13312
    ds_read_b64_tr_b16 v[114:115], v6 offset:13568
    v_mfma_f32_32x32x16_bf16 v[44:59], v[96:99], v[120:123], v[44:59]
    ds_read_b64_tr_b16 v[92:93], v6 offset:14336
    ds_read_b64_tr_b16 v[94:95], v6 offset:14592
    v_mfma_f32_32x32x16_bf16 v[60:75], v[100:103], v[120:123], v[60:75]
    ds_read_b64_tr_b16 v[96:97], v6 offset:15360
    ds_read_b64_tr_b16 v[98:99], v6 offset:15616
    v_mfma_f32_32x32x16_bf16 v[76:91], v[104:107], v[120:123], v[76:91]
    ds_read_b64_tr_b16 v[100:101], v6 offset:16384
    ds_read_b64_tr_b16 v[102:103], v6 offset:16640
    s_waitcnt lgkmcnt(6)
    v_mfma_f32_32x32x16_bf16 v[12:27], v[108:111], v[124:127], v[12:27]
    s_mul_i32 s22, s21, 110592
    s_add_u32 s22, s22, s25
    s_add_u32 s21, s21, 1
    s_add_u32 m0, s28, 0
    ds_read_b64_tr_b16 v[104:105], v6 offset:18432
    ds_read_b64_tr_b16 v[106:107], v6 offset:18688
    buffer_load_dwordx4 v1, s[4:7], s22 offen offset:0 lds
    v_mfma_f32_32x32x16_bf16 v[28:43], v[112:115], v[124:127], v[28:43]
    ds_read_b64_tr_b16 v[108:109], v6 offset:19456
    ds_read_b64_tr_b16 v[110:111], v6 offset:19712
    s_waitcnt lgkmcnt(6)
    v_mfma_f32_32x32x16_bf16 v[44:59], v[92:95], v[124:127], v[44:59]
    s_add_u32 m0, s28, 960
    ds_read_b64_tr_b16 v[112:113], v6 offset:20480
    ds_read_b64_tr_b16 v[114:115], v6 offset:20736
    buffer_load_dwordx4 v2, s[4:7], s22 offen offset:64 lds
    v_mfma_f32_32x32x16_bf16 v[60:75], v[96:99], v[124:127], v[60:75]
    ds_read_b64_tr_b16 v[92:93], v6 offset:21504
    ds_read_b64_tr_b16 v[94:95], v6 offset:21760
    s_waitcnt lgkmcnt(6)
    v_mfma_f32_32x32x16_bf16 v[76:91], v[100:103], v[124:127], v[76:91]
    s_add_u32 m0, s28, 1920
    ds_read_b64_tr_b16 v[96:97], v6 offset:22528
    ds_read_b64_tr_b16 v[98:99], v6 offset:22784
    buffer_load_dwordx4 v3, s[4:7], s22 offen offset:128 lds
    v_mfma_f32_32x32x16_bf16 v[12:27], v[104:107], v[128:131], v[12:27]
    s_waitcnt lgkmcnt(4)
    v_mfma_f32_32x32x16_bf16 v[28:43], v[108:111], v[128:131], v[28:43]
    s_waitcnt vmcnt(10) lgkmcnt(0)
    s_barrier
    ds_read_b128 v[132:135], v7 offset:16384
    ds_read_b128 v[136:139], v8 offset:16384
    ds_read_b128 v[140:143], v9 offset:16384
    ds_read_b128 v[144:147], v10 offset:16384
    ds_read_b64_tr_b16 v[100:101], v6 offset:24576
    ds_read_b64_tr_b16 v[102:103], v6 offset:24832
    ds_read_b64_tr_b16 v[104:105], v6 offset:25600
    ds_read_b64_tr_b16 v[106:107], v6 offset:25856
    v_mfma_f32_32x32x16_bf16 v[44:59], v[112:115], v[128:131], v[44:59]
    ds_read_b64_tr_b16 v[108:109], v6 offset:26624
    ds_read_b64_tr_b16 v[110:111], v6 offset:26880
    v_mfma_f32_32x32x16_bf16 v[60:75], v[92:95], v[128:131], v[60:75]
    ds_read_b64_tr_b16 v[112:113], v6 offset:27648
    ds_read_b64_tr_b16 v[114:115], v6 offset:27904
    v_mfma_f32_32x32x16_bf16 v[76:91], v[96:99], v[128:131], v[76:91]
    ds_read_b64_tr_b16 v[92:93], v6 offset:28672
    ds_read_b64_tr_b16 v[94:95], v6 offset:28928
    s_waitcnt lgkmcnt(6)
    v_mfma_f32_32x32x16_bf16 v[12:27], v[100:103], v[132:135], v[12:27]
    s_mul_i32 s22, s21, 110592
    s_add_u32 s22, s22, s25
    s_add_u32 s21, s21, 1
    s_cmp_eq_u32 s21, 18
    s_cselect_b32 s21, 0, s21
    s_add_u32 m0, s28, 12288
    ds_read_b64_tr_b16 v[96:97], v6 offset:30720
    ds_read_b64_tr_b16 v[98:99], v6 offset:30976
    buffer_load_dwordx4 v1, s[4:7], s22 offen offset:0 lds
    v_mfma_f32_32x32x16_bf16 v[28:43], v[104:107], v[132:135], v[28:43]
    ds_read_b64_tr_b16 v[100:101], v6 offset:31744
    ds_read_b64_tr_b16 v[102:103], v6 offset:32000
    s_waitcnt lgkmcnt(6)
    v_mfma_f32_32x32x16_bf16 v[44:59], v[108:111], v[132:135], v[44:59]
    s_add_u32 m0, s28, 13248
    ds_read_b64_tr_b16 v[104:105], v6 offset:32768
    ds_read_b64_tr_b16 v[106:107], v6 offset:33024
    buffer_load_dwordx4 v2, s[4:7], s22 offen offset:64 lds
    v_mfma_f32_32x32x16_bf16 v[60:75], v[112:115], v[132:135], v[60:75]
    ds_read_b64_tr_b16 v[108:109], v6 offset:33792
    ds_read_b64_tr_b16 v[110:111], v6 offset:34048
    s_waitcnt lgkmcnt(6)
    v_mfma_f32_32x32x16_bf16 v[76:91], v[92:95], v[132:135], v[76:91]
    s_add_u32 m0, s28, 14208
    ds_read_b64_tr_b16 v[112:113], v6 offset:34816
    ds_read_b64_tr_b16 v[114:115], v6 offset:35072
    buffer_load_dwordx4 v3, s[4:7], s22 offen offset:128 lds
    v_mfma_f32_32x32x16_bf16 v[12:27], v[96:99], v[136:139], v[12:27]
    s_waitcnt lgkmcnt(4)
    v_mfma_f32_32x32x16_bf16 v[28:43], v[100:103], v[136:139], v[28:43]
    s_waitcnt vmcnt(10) lgkmcnt(0)
    s_barrier
    ds_read_b64_tr_b16 v[92:93], v6 offset:36864
    ds_read_b64_tr_b16 v[94:95], v6 offset:37120
    ds_read_b64_tr_b16 v[96:97], v6 offset:37888
    ds_read_b64_tr_b16 v[98:99], v6 offset:38144
    v_mfma_f32_32x32x16_bf16 v[44:59], v[104:107], v[136:139], v[44:59]
    ds_read_b64_tr_b16 v[100:101], v6 offset:38912
    ds_read_b64_tr_b16 v[102:103], v6 offset:39168
    v_mfma_f32_32x32x16_bf16 v[60:75], v[108:111], v[136:139], v[60:75]
    ds_read_b64_tr_b16 v[104:105], v6 offset:39936
    ds_read_b64_tr_b16 v[106:107], v6 offset:40192
    v_mfma_f32_32x32x16_bf16 v[76:91], v[112:115], v[136:139], v[76:91]
    ds_read_b64_tr_b16 v[108:109], v6 offset:40960
    ds_read_b64_tr_b16 v[110:111], v6 offset:41216
    s_waitcnt lgkmcnt(6)
    v_mfma_f32_32x32x16_bf16 v[12:27], v[92:95], v[140:143], v[12:27]
    ds_read_b64_tr_b16 v[112:113], v6 offset:43008
    ds_read_b64_tr_b16 v[114:115], v6 offset:43264
    v_mfma_f32_32x32x16_bf16 v[28:43], v[96:99], v[140:143], v[28:43]
    ds_read_b64_tr_b16 v[92:93], v6 offset:44032
    ds_read_b64_tr_b16 v[94:95], v6 offset:44288
    s_waitcnt lgkmcnt(6)
    v_mfma_f32_32x32x16_bf16 v[44:59], v[100:103], v[140:143], v[44:59]
    ds_read_b64_tr_b16 v[96:97], v6 offset:45056
    ds_read_b64_tr_b16 v[98:99], v6 offset:45312
    v_mfma_f32_32x32x16_bf16 v[60:75], v[104:107], v[140:143], v[60:75]
    ds_read_b64_tr_b16 v[100:101], v6 offset:46080
    ds_read_b64_tr_b16 v[102:103], v6 offset:46336
    s_waitcnt lgkmcnt(6)
    v_mfma_f32_32x32x16_bf16 v[76:91], v[108:111], v[140:143], v[76:91]
    ds_read_b64_tr_b16 v[104:105], v6 offset:47104
    ds_read_b64_tr_b16 v[106:107], v6 offset:47360
    v_mfma_f32_32x32x16_bf16 v[12:27], v[112:115], v[144:147], v[12:27]
    s_waitcnt lgkmcnt(4)
    v_mfma_f32_32x32x16_bf16 v[28:43], v[92:95], v[144:147], v[28:43]
    s_waitcnt vmcnt(3) lgkmcnt(0)
    s_barrier
    ds_read_b128 v[116:119], v7 offset:0
    ds_read_b128 v[120:123], v8 offset:0
    ds_read_b128 v[124:127], v9 offset:0
    ds_read_b128 v[128:131], v10 offset:0
    ds_read_b64_tr_b16 v[108:109], v6 offset:0
    ds_read_b64_tr_b16 v[110:111], v6 offset:256
    ds_read_b64_tr_b16 v[112:113], v6 offset:1024
    ds_read_b64_tr_b16 v[114:115], v6 offset:1280
    v_mfma_f32_32x32x16_bf16 v[44:59], v[96:99], v[144:147], v[44:59]
    ds_read_b64_tr_b16 v[92:93], v6 offset:2048
    ds_read_b64_tr_b16 v[94:95], v6 offset:2304
    v_mfma_f32_32x32x16_bf16 v[60:75], v[100:103], v[144:147], v[60:75]
    ds_read_b64_tr_b16 v[96:97], v6 offset:3072
    ds_read_b64_tr_b16 v[98:99], v6 offset:3328
    v_mfma_f32_32x32x16_bf16 v[76:91], v[104:107], v[144:147], v[76:91]
    ds_read_b64_tr_b16 v[100:101], v6 offset:4096
    ds_read_b64_tr_b16 v[102:103], v6 offset:4352
    s_waitcnt lgkmcnt(6)
    v_mfma_f32_32x32x16_bf16 v[12:27], v[108:111], v[116:119], v[12:27]
    ds_read_b64_tr_b16 v[104:105], v6 offset:6144
    ds_read_b64_tr_b16 v[106:107], v6 offset:6400
    v_mfma_f32_32x32x16_bf16 v[28:43], v[112:115], v[116:119], v[28:43]
    ds_read_b64_tr_b16 v[108:109], v6 offset:7168
    ds_read_b64_tr_b16 v[110:111], v6 offset:7424
    s_waitcnt lgkmcnt(6)
    v_mfma_f32_32x32x16_bf16 v[44:59], v[92:95], v[116:119], v[44:59]
    ds_read_b64_tr_b16 v[112:113], v6 offset:8192
    ds_read_b64_tr_b16 v[114:115], v6 offset:8448
    v_mfma_f32_32x32x16_bf16 v[60:75], v[96:99], v[116:119], v[60:75]
    ds_read_b64_tr_b16 v[92:93], v6 offset:9216
    ds_read_b64_tr_b16 v[94:95], v6 offset:9472
    s_waitcnt lgkmcnt(6)
    v_mfma_f32_32x32x16_bf16 v[76:91], v[100:103], v[116:119], v[76:91]
    ds_read_b64_tr_b16 v[96:97], v6 offset:10240
    ds_read_b64_tr_b16 v[98:99], v6 offset:10496
    v_mfma_f32_32x32x16_bf16 v[12:27], v[104:107], v[120:123], v[12:27]
    s_waitcnt lgkmcnt(4)
    v_mfma_f32_32x32x16_bf16 v[28:43], v[108:111], v[120:123], v[28:43]
    s_waitcnt vmcnt(0) lgkmcnt(0)
    s_barrier
    ds_read_b64_tr_b16 v[100:101], v6 offset:12288
    ds_read_b64_tr_b16 v[102:103], v6 offset:12544
    ds_read_b64_tr_b16 v[104:105], v6 offset:13312
    ds_read_b64_tr_b16 v[106:107], v6 offset:13568
    v_mfma_f32_32x32x16_bf16 v[44:59], v[112:115], v[120:123], v[44:59]
    ds_read_b64_tr_b16 v[108:109], v6 offset:14336
    ds_read_b64_tr_b16 v[110:111], v6 offset:14592
    v_mfma_f32_32x32x16_bf16 v[60:75], v[92:95], v[120:123], v[60:75]
    ds_read_b64_tr_b16 v[112:113], v6 offset:15360
    ds_read_b64_tr_b16 v[114:115], v6 offset:15616
    v_mfma_f32_32x32x16_bf16 v[76:91], v[96:99], v[120:123], v[76:91]
    ds_read_b64_tr_b16 v[92:93], v6 offset:16384
    ds_read_b64_tr_b16 v[94:95], v6 offset:16640
    s_waitcnt lgkmcnt(6)
    v_mfma_f32_32x32x16_bf16 v[12:27], v[100:103], v[124:127], v[12:27]
    ds_read_b64_tr_b16 v[96:97], v6 offset:18432
    ds_read_b64_tr_b16 v[98:99], v6 offset:18688
    v_mfma_f32_32x32x16_bf16 v[28:43], v[104:107], v[124:127], v[28:43]
    ds_read_b64_tr_b16 v[100:101], v6 offset:19456
    ds_read_b64_tr_b16 v[102:103], v6 offset:19712
    s_waitcnt lgkmcnt(6)
    v_mfma_f32_32x32x16_bf16 v[44:59], v[108:111], v[124:127], v[44:59]
    ds_read_b64_tr_b16 v[104:105], v6 offset:20480
    ds_read_b64_tr_b16 v[106:107], v6 offset:20736
    v_mfma_f32_32x32x16_bf16 v[60:75], v[112:115], v[124:127], v[60:75]
    ds_read_b64_tr_b16 v[108:109], v6 offset:21504
    ds_read_b64_tr_b16 v[110:111], v6 offset:21760
    s_waitcnt lgkmcnt(6)
    v_mfma_f32_32x32x16_bf16 v[76:91], v[92:95], v[124:127], v[76:91]
    ds_read_b64_tr_b16 v[112:113], v6 offset:22528
    ds_read_b64_tr_b16 v[114:115], v6 offset:22784
    v_mfma_f32_32x32x16_bf16 v[12:27], v[96:99], v[128:131], v[12:27]
    s_waitcnt lgkmcnt(4)
    v_mfma_f32_32x32x16_bf16 v[28:43], v[100:103], v[128:131], v[28:43]
    v_mfma_f32_32x32x16_bf16 v[44:59], v[104:107], v[128:131], v[44:59]
    s_waitcnt lgkmcnt(0)
    v_mfma_f32_32x32x16_bf16 v[60:75], v[108:111], v[128:131], v[60:75]
    v_mfma_f32_32x32x16_bf16 v[76:91], v[112:115], v[128:131], v[76:91]
    v_and_b32 v187, 63, v0
    s_cmp_eq_u32 s42, 0
    s_cselect_b32 s30, 0x3eae1a93, 1.0
    v_lshlrev_b32 v184, 4, v187
    v_and_b32 v185, 31, v187
    v_lshlrev_b32 v185, 2, v185
    v_lshrrev_b32 v182, 5, v187
    v_mul_u32_u24 v183, 24576, v182
    v_add_u32 v186, v185, v183
    v_lshl_add_u32 v185, v182, 13, v185
    v_cmp_lt_u32 vcc, 31, v187
    s_lshl_b32 s26, s44, 9
    s_add_u32 s26, s26, s20
    s_lshl_b32 s27, s26, 7
    s_lshl_b32 s26, s26, 10
    s_lshl_b32 s21, s42, 21
    s_add_u32 s26, s26, s21
    s_lshl_b32 s21, s42, 18
    s_add_u32 s27, s27, s21
    s_add_u32 s27, s27, 4194304
    s_cmp_lg_u32 s42, 0
    s_cbranch_scc1 L_f_ns_4
    v_pk_mul_f32 v[12:13], v[12:13], s[30:31] op_sel_hi:[1,0]
    v_pk_mul_f32 v[14:15], v[14:15], s[30:31] op_sel_hi:[1,0]
    v_pk_mul_f32 v[16:17], v[16:17], s[30:31] op_sel_hi:[1,0]
    v_pk_mul_f32 v[18:19], v[18:19], s[30:31] op_sel_hi:[1,0]
    v_pk_mul_f32 v[20:21], v[20:21], s[30:31] op_sel_hi:[1,0]
    v_pk_mul_f32 v[22:23], v[22:23], s[30:31] op_sel_hi:[1,0]
    v_pk_mul_f32 v[24:25], v[24:25], s[30:31] op_sel_hi:[1,0]
    v_pk_mul_f32 v[26:27], v[26:27], s[30:31] op_sel_hi:[1,0]
    v_pk_mul_f32 v[28:29], v[28:29], s[30:31] op_sel_hi:[1,0]
    v_pk_mul_f32 v[30:31], v[30:31], s[30:31] op_sel_hi:[1,0]
    v_pk_mul_f32 v[32:33], v[32:33], s[30:31] op_sel_hi:[1,0]
    v_pk_mul_f32 v[34:35], v[34:35], s[30:31] op_sel_hi:[1,0]
    v_pk_mul_f32 v[36:37], v[36:37], s[30:31] op_sel_hi:[1,0]
    v_pk_mul_f32 v[38:39], v[38:39], s[30:31] op_sel_hi:[1,0]
    v_pk_mul_f32 v[40:41], v[40:41], s[30:31] op_sel_hi:[1,0]
    v_pk_mul_f32 v[42:43], v[42:43], s[30:31] op_sel_hi:[1,0]
    v_pk_mul_f32 v[44:45], v[44:45], s[30:31] op_sel_hi:[1,0]
    v_pk_mul_f32 v[46:47], v[46:47], s[30:31] op_sel_hi:[1,0]
    v_pk_mul_f32 v[48:49], v[48:49], s[30:31] op_sel_hi:[1,0]
    v_pk_mul_f32 v[50:51], v[50:51], s[30:31] op_sel_hi:[1,0]
    v_pk_mul_f32 v[52:53], v[52:53], s[30:31] op_sel_hi:[1,0]
    v_pk_mul_f32 v[54:55], v[54:55], s[30:31] op_sel_hi:[1,0]
    v_pk_mul_f32 v[56:57], v[56:57], s[30:31] op_sel_hi:[1,0]
    v_pk_mul_f32 v[58:59], v[58:59], s[30:31] op_sel_hi:[1,0]
    v_pk_mul_f32 v[60:61], v[60:61], s[30:31] op_sel_hi:[1,0]
    v_pk_mul_f32 v[62:63], v[62:63], s[30:31] op_sel_hi:[1,0]
    v_pk_mul_f32 v[64:65], v[64:65], s[30:31] op_sel_hi:[1,0]
    v_pk_mul_f32 v[66:67], v[66:67], s[30:31] op_sel_hi:[1,0]
    v_pk_mul_f32 v[68:69], v[68:69], s[30:31] op_sel_hi:[1,0]
    v_pk_mul_f32 v[70:71], v[70:71], s[30:31] op_sel_hi:[1,0]
    v_pk_mul_f32 v[72:73], v[72:73], s[30:31] op_sel_hi:[1,0]
    v_pk_mul_f32 v[74:75], v[74:75], s[30:31] op_sel_hi:[1,0]
    v_pk_mul_f32 v[76:77], v[76:77], s[30:31] op_sel_hi:[1,0]
    v_pk_mul_f32 v[78:79], v[78:79], s[30:31] op_sel_hi:[1,0]
    v_pk_mul_f32 v[80:81], v[80:81], s[30:31] op_sel_hi:[1,0]
    v_pk_mul_f32 v[82:83], v[82:83], s[30:31] op_sel_hi:[1,0]
L_f_ns_4:
    v_cvt_pk_bf16_f32 v92, v12, v13
    v_cvt_pk_bf16_f32 v93, v14, v15
    v_cvt_pk_bf16_f32 v94, v16, v17
    v_cvt_pk_bf16_f32 v95, v18, v19
    v_cvt_pk_bf16_f32 v108, v20, v21
    v_cvt_pk_bf16_f32 v97, v22, v23
    v_cvt_pk_bf16_f32 v98, v24, v25
    v_cvt_pk_bf16_f32 v99, v26, v27
    v_cvt_pk_bf16_f32 v109, v28, v29
    v_cvt_pk_bf16_f32 v110, v30, v31
    v_cvt_pk_bf16_f32 v100, v32, v33
    v_cvt_pk_bf16_f32 v101, v34, v35
    v_cvt_pk_bf16_f32 v102, v36, v37
    v_cvt_pk_bf16_f32 v111, v38, v39
    v_cvt_pk_bf16_f32 v104, v40, v41
    v_cvt_pk_bf16_f32 v105, v42, v43
    v_cvt_pk_bf16_f32 v106, v44, v45
    v_cvt_pk_bf16_f32 v107, v46, v47
    v_cndmask_b32 v96, v109, v108, vcc
    v_cndmask_b32 v103, v111, v109, vcc
    v_cndmask_b32 v108, v108, v111, vcc
    buffer_store_dwordx4 v[92:95], v184, s[8:11], s26 offen sc1
    s_add_u32 s26, s26, 65536
    buffer_store_dwordx4 v[96:99], v184, s[8:11], s26 offen sc1
    s_add_u32 s26, s26, 65536
    buffer_store_dwordx4 v[100:103], v184, s[8:11], s26 offen sc1
    s_add_u32 s26, s26, 65536
    buffer_store_dwordx4 v[104:107], v184, s[8:11], s26 offen sc1
    s_add_u32 s26, s26, 65536
    buffer_store_dword v108, v186, s[8:11], s27 offen sc1
    s_add_u32 s27, s27, 8192
    buffer_store_dword v110, v185, s[8:11], s27 offen sc1
    s_add_u32 s27, s27, 24576
    v_cvt_pk_bf16_f32 v112, v48, v49
    v_cvt_pk_bf16_f32 v113, v50, v51
    v_cvt_pk_bf16_f32 v114, v52, v53
    v_cvt_pk_bf16_f32 v115, v54, v55
    v_cvt_pk_bf16_f32 v128, v56, v57
    v_cvt_pk_bf16_f32 v117, v58, v59
    v_cvt_pk_bf16_f32 v118, v60, v61
    v_cvt_pk_bf16_f32 v119, v62, v63
    v_cvt_pk_bf16_f32 v129, v64, v65
    v_cvt_pk_bf16_f32 v130, v66, v67
    v_cvt_pk_bf16_f32 v120, v68, v69
    v_cvt_pk_bf16_f32 v121, v70, v71
    v_cvt_pk_bf16_f32 v122, v72, v73
    v_cvt_pk_bf16_f32 v131, v74, v75
    v_cvt_pk_bf16_f32 v124, v76, v77
    v_cvt_pk_bf16_f32 v125, v78, v79
    v_cvt_pk_bf16_f32 v126, v80, v81
    v_cvt_pk_bf16_f32 v127, v82, v83
    v_cndmask_b32 v116, v129, v128, vcc
    v_cndmask_b32 v123, v131, v129, vcc
    v_cndmask_b32 v128, v128, v131, vcc
    buffer_store_dwordx4 v[112:115], v184, s[8:11], s26 offen sc1
    s_add_u32 s26, s26, 65536
    buffer_store_dwordx4 v[116:119], v184, s[8:11], s26 offen sc1
    s_add_u32 s26, s26, 65536
    buffer_store_dwordx4 v[120:123], v184, s[8:11], s26 offen sc1
    s_add_u32 s26, s26, 65536
    buffer_store_dwordx4 v[124:127], v184, s[8:11], s26 offen sc1
    s_add_u32 s26, s26, 65536
    buffer_store_dword v128, v186, s[8:11], s27 offen sc1
    s_add_u32 s27, s27, 8192
    buffer_store_dword v130, v185, s[8:11], s27 offen sc1
    s_add_u32 s27, s27, 24576
    s_branch L_a_sig
L_a_v:
    s_lshl_b32 s20, s43, 2
    s_add_u32 s20, s20, s18
    s_lshl_b32 s26, s44, 1
    s_add_u32 s21, s43, s26
    s_add_u32 s21, s21, s42
    s_cmp_ge_u32 s21, 18
    s_cselect_b32 s26, 18, 0
    s_sub_u32 s21, s21, s26
    s_cmp_ge_u32 s21, 9
    s_cselect_b32 s26, 9, 0
    s_sub_u32 s21, s21, s26
    s_mul_i32 s25, s44, 288
    s_mul_i32 s21, s21, 21846
    s_lshr_b32 s21, s21, 16
    s_mul_i32 s21, s21, 3
    s_mul_i32 s26, s42, 1152
    s_add_u32 s25, s25, s26
    v_and_b32 v12, 63, v0
    v_lshrrev_b32 v13, 3, v12
    s_lshl_b32 s26, s20, 5
    v_add_u32 v14, s26, v13
    v_mul_u32_u24 v14, 1152, v14
    v_lshrrev_b32 v13, 4, v12
    v_xor_b32 v13, v13, v12
    v_and_b32 v13, 7, v13
    v_lshl_add_u32 v4, v13, 4, v14
    v_xor_b32 v13, 4, v13
    v_lshl_add_u32 v5, v13, 4, v14
    v_add_u32 v5, 9216, v5
    s_lshl_b32 s48, s18, 12
    s_add_u32 s48, s48, 49152
    s_mov_b32 s49, s21
    s_lshl_b32 s21, s21, 1
    s_lshr_b32 s26, s18, 1
    s_and_b32 s27, s18, 1
    s_mul_i32 s28, s18, 3072
    s_lshl_b32 s26, s26, 4
    v_lshrrev_b32 v13, 2, v12
    v_add_u32 v13, s26, v13
    v_mul_u32_u24 v13, 3456, v13
    v_and_b32 v14, 3, v12
    s_mul_i32 s26, s27, 12
    v_add_u32 v14, s26, v14
    v_lshl_add_u32 v1, v14, 4, v13
    v_mov_b32 v13, 0x80000000
    v_cmp_gt_u32 vcc, 14, v14
    s_nop 1
    v_cndmask_b32 v2, v13, v1, vcc
    v_cmp_gt_u32 vcc, 10, v14
    s_nop 1
    v_cndmask_b32 v3, v13, v1, vcc
    s_waitcnt lgkmcnt(0)
    s_mov_b32 s12, s60
    s_and_b32 s13, s61, 0xffff
    s_mov_b32 s14, 0x00240000
    s_mov_b32 s15, 0x00020000
    s_mov_b32 s4, s62
    s_and_b32 s5, s63, 0xffff
    s_mov_b32 s6, 0x001e6000
    s_mov_b32 s7, 0x00020000
    s_lshl_b32 s23, s49, 7
    s_add_u32 s49, s49, 1
    s_cmp_eq_u32 s49, 9
    s_cselect_b32 s49, 0, s49
    s_add_u32 m0, s48, 0
    s_nop 0
    buffer_load_dwordx4 v4, s[12:15], s23 offen lds
    s_add_u32 m0, s48, 1024
    s_nop 0
    buffer_load_dwordx4 v5, s[12:15], s23 offen lds
    s_add_u32 s23, s23, 18432
    s_add_u32 m0, s48, 2048
    s_nop 0
    buffer_load_dwordx4 v4, s[12:15], s23 offen lds
    s_add_u32 m0, s48, 3072
    s_nop 0
    buffer_load_dwordx4 v5, s[12:15], s23 offen lds
    s_mul_i32 s22, s21, 110592
    s_add_u32 s22, s22, s25
    s_add_u32 s21, s21, 1
    s_add_u32 m0, s28, 0
    s_nop 0
    buffer_load_dwordx4 v1, s[4:7], s22 offen offset:0 lds
    s_add_u32 m0, s28, 960
    s_nop 0
    buffer_load_dwordx4 v2, s[4:7], s22 offen offset:64 lds
    s_add_u32 m0, s28, 1920
    s_nop 0
    buffer_load_dwordx4 v3, s[4:7], s22 offen offset:128 lds
    s_mul_i32 s22, s21, 110592
    s_add_u32 s22, s22, s25
    s_add_u32 s21, s21, 1
    s_cmp_eq_u32 s21, 18
    s_cselect_b32 s21, 0, s21
    s_add_u32 m0, s28, 12288
    s_nop 0
    buffer_load_dwordx4 v1, s[4:7], s22 offen offset:0 lds
    s_add_u32 m0, s28, 13248
    s_nop 0
    buffer_load_dwordx4 v2, s[4:7], s22 offen offset:64 lds
    s_add_u32 m0, s28, 14208
    s_nop 0
    buffer_load_dwordx4 v3, s[4:7], s22 offen offset:128 lds
    s_mov_b32 s8, s40
    s_and_b32 s9, s41, 0xffff
    s_mov_b32 s10, 0x03000000
    s_mov_b32 s11, 0x00020000
    v_bfe_u32 v13, v12, 2, 2
    v_lshlrev_b32 v6, 6, v13
    v_bfe_u32 v13, v12, 4, 1
    v_lshl_add_u32 v6, v13, 5, v6
    v_and_b32 v13, 3, v12
    v_lshl_add_u32 v6, v13, 3, v6
    v_lshrrev_b32 v13, 5, v12
    v_mul_u32_u24 v13, 512, v13
    v_add_u32 v6, v6, v13
    v_and_b32 v13, 31, v12
    v_bfe_u32 v14, v12, 1, 3
    v_lshrrev_b32 v15, 5, v12
    v_xor_b32 v14, v14, v15
    v_lshlrev_b32 v14, 4, v14
    v_lshlrev_b32 v13, 7, v13
    v_add_u32 v13, s48, v13
    v_xor_b32 v7, 0, v14
    v_add_u32 v7, v7, v13
    v_xor_b32 v8, 32, v14
    v_add_u32 v8, v8, v13
    v_xor_b32 v9, 64, v14
    v_add_u32 v9, v9, v13
    v_xor_b32 v10, 96, v14
    v_add_u32 v10, v10, v13
    s_lshl_b32 s23, s49, 7
    s_add_u32 s49, s49, 1
    s_cmp_eq_u32 s49, 9
    s_cselect_b32 s49, 0, s49
    s_add_u32 m0, s48, 16384
    s_nop 0
    buffer_load_dwordx4 v4, s[12:15], s23 offen lds
    s_add_u32 m0, s48, 17408
    s_nop 0
    buffer_load_dwordx4 v5, s[12:15], s23 offen lds
    s_add_u32 s23, s23, 18432
    s_add_u32 m0, s48, 18432
    s_nop 0
    buffer_load_dwordx4 v4, s[12:15], s23 offen lds
    s_add_u32 m0, s48, 19456
    s_nop 0
    buffer_load_dwordx4 v5, s[12:15], s23 offen lds
    s_mul_i32 s22, s21, 110592
    s_add_u32 s22, s22, s25
    s_add_u32 s21, s21, 1
    s_add_u32 m0, s28, 24576
    s_nop 0
    buffer_load_dwordx4 v1, s[4:7], s22 offen offset:0 lds
    s_add_u32 m0, s28, 25536
    s_nop 0
    buffer_load_dwordx4 v2, s[4:7], s22 offen offset:64 lds
    s_add_u32 m0, s28, 26496
    s_nop 0
    buffer_load_dwordx4 v3, s[4:7], s22 offen offset:128 lds
    v_and_b32 v192, 63, v0
    s_mul_i32 s26, s18, 1280
    v_lshrrev_b32 v191, 5, v192
    v_mul_u32_u24 v191, 320, v191
    v_add_u32 v191, s26, v191
    v_and_b32 v182, 31, v192
    v_add_u32 v182, 0, v182
    v_mul_u32_u24 v183, 3641, v182
    v_lshrrev_b32 v183, 16, v183
    v_mul_u32_u24 v184, 18, v183
    v_sub_u32 v184, v182, v184
    v_mul_u32_u24 v183, 5120, v183
    v_lshl_add_u32 v184, v184, 4, v183
    v_add_u32 v184, v184, v191
    v_and_b32 v182, 31, v192
    v_add_u32 v182, 32, v182
    v_mul_u32_u24 v183, 3641, v182
    v_lshrrev_b32 v183, 16, v183
    v_mul_u32_u24 v185, 18, v183
    v_sub_u32 v185, v182, v185
    v_mul_u32_u24 v183, 5120, v183
    v_lshl_add_u32 v185, v185, 4, v183
    v_add_u32 v185, v185, v191
    v_and_b32 v182, 31, v192
    v_add_u32 v182, 64, v182
    v_mul_u32_u24 v183, 3641, v182
    v_lshrrev_b32 v183, 16, v183
    v_mul_u32_u24 v186, 18, v183
    v_sub_u32 v186, v182, v186
    v_mul_u32_u24 v183, 5120, v183
    v_lshl_add_u32 v186, v186, 4, v183
    v_add_u32 v186, v186, v191
    v_and_b32 v182, 31, v192
    v_add_u32 v182, 96, v182
    v_mul_u32_u24 v183, 3641, v182
    v_lshrrev_b32 v183, 16, v183
    v_mul_u32_u24 v187, 18, v183
    v_sub_u32 v187, v182, v187
    v_mul_u32_u24 v183, 5120, v183
    v_lshl_add_u32 v187, v187, 4, v183
    v_add_u32 v187, v187, v191
    v_and_b32 v182, 31, v192
    v_add_u32 v182, 128, v182
    v_mul_u32_u24 v183, 3641, v182
    v_lshrrev_b32 v183, 16, v183
    v_mul_u32_u24 v188, 18, v183
    v_sub_u32 v188, v182, v188
    v_cmp_lt_u32 vcc, 143, v182
    v_and_b32 v189, 7, v182
    s_nop 0
    v_cndmask_b32 v183, v183, v189, vcc
    v_bfe_u32 v189, v182, 3, 1
    v_subrev_u32 v190, 1, v189
    v_and_b32 v190, 0x3f803f80, v190
    v_add_u32 v189, 18, v189
    v_cndmask_b32 v188, v188, v189, vcc
    v_mul_u32_u24 v183, 5120, v183
    v_lshl_add_u32 v188, v188, 4, v183
    v_add_u32 v188, v188, v191
    s_waitcnt vmcnt(10)
    s_barrier
    ds_read_b128 v[116:119], v7 offset:0
    ds_read_b128 v[120:123], v8 offset:0
    ds_read_b128 v[124:127], v9 offset:0
    ds_read_b128 v[128:131], v10 offset:0
    ds_read_b64_tr_b16 v[92:93], v6 offset:0
    ds_read_b64_tr_b16 v[94:95], v6 offset:256
    ds_read_b64_tr_b16 v[96:97], v6 offset:1024
    ds_read_b64_tr_b16 v[98:99], v6 offset:1280
    ds_read_b64_tr_b16 v[100:101], v6 offset:2048
    ds_read_b64_tr_b16 v[102:103], v6 offset:2304
    ds_read_b64_tr_b16 v[104:105], v6 offset:3072
    ds_read_b64_tr_b16 v[106:107], v6 offset:3328
    ds_read_b64_tr_b16 v[108:109], v6 offset:4096
    ds_read_b64_tr_b16 v[110:111], v6 offset:4352
    s_waitcnt lgkmcnt(6)
    v_mfma_f32_32x32x16_bf16 v[12:27], v[116:119], v[92:95], 0
    s_mul_i32 s22, s21, 110592
    s_add_u32 s22, s22, s25
    s_add_u32 s21, s21, 1
    s_cmp_eq_u32 s21, 18
    s_cselect_b32 s21, 0, s21
    s_add_u32 m0, s28, 36864
    ds_read_b64_tr_b16 v[112:113], v6 offset:6144
    ds_read_b64_tr_b16 v[114:115], v6 offset:6400
    buffer_load_dwordx4 v1, s[4:7], s22 offen offset:0 lds
    s_add_u32 m0, s28, 37824
    s_nop 0
    buffer_load_dwordx4 v2, s[4:7], s22 offen offset:64 lds
    v_mfma_f32_32x32x16_bf16 v[28:43], v[116:119], v[96:99], 0
    s_add_u32 m0, s28, 38784
    ds_read_b64_tr_b16 v[92:93], v6 offset:7168
    ds_read_b64_tr_b16 v[94:95], v6 offset:7424
    buffer_load_dwordx4 v3, s[4:7], s22 offen offset:128 lds
    s_waitcnt lgkmcnt(6)
    v_mfma_f32_32x32x16_bf16 v[44:59], v[116:119], v[100:103], 0
    s_lshl_b32 s23, s49, 7
    s_add_u32 s49, s49, 1
    s_cmp_eq_u32 s49, 9
    s_cselect_b32 s49, 0, s49
    s_add_u32 m0, s48, 0
    ds_read_b64_tr_b16 v[96:97], v6 offset:8192
    ds_read_b64_tr_b16 v[98:99], v6 offset:8448
    buffer_load_dwordx4 v4, s[12:15], s23 offen lds
    v_mfma_f32_32x32x16_bf16 v[60:75], v[116:119], v[104:107], 0
    s_add_u32 m0, s48, 1024
    ds_read_b64_tr_b16 v[100:101], v6 offset:9216
    ds_read_b64_tr_b16 v[102:103], v6 offset:9472
    buffer_load_dwordx4 v5, s[12:15], s23 offen lds
    s_waitcnt lgkmcnt(6)
    v_mfma_f32_32x32x16_bf16 v[76:91], v[116:119], v[108:111], 0
    s_add_u32 s23, s23, 18432
    s_add_u32 m0, s48, 2048
    ds_read_b64_tr_b16 v[104:105], v6 offset:10240
    ds_read_b64_tr_b16 v[106:107], v6 offset:10496
    buffer_load_dwordx4 v4, s[12:15], s23 offen lds
    v_mfma_f32_32x32x16_bf16 v[12:27], v[120:123], v[112:115], v[12:27]
    s_add_u32 m0, s48, 3072
    s_nop 0
    buffer_load_dwordx4 v5, s[12:15], s23 offen lds
    s_waitcnt lgkmcnt(4)
    v_mfma_f32_32x32x16_bf16 v[28:43], v[120:123], v[92:95], v[28:43]
    s_waitcnt vmcnt(14) lgkmcnt(0)
    s_barrier
    ds_read_b64_tr_b16 v[108:109], v6 offset:12288
    ds_read_b64_tr_b16 v[110:111], v6 offset:12544
    ds_read_b64_tr_b16 v[112:113], v6 offset:13312
    ds_read_b64_tr_b16 v[114:115], v6 offset:13568
    v_mfma_f32_32x32x16_bf16 v[44:59], v[120:123], v[96:99], v[44:59]
    ds_read_b64_tr_b16 v[92:93], v6 offset:14336
    ds_read_b64_tr_b16 v[94:95], v6 offset:14592
    v_mfma_f32_32x32x16_bf16 v[60:75], v[120:123], v[100:103], v[60:75]
    ds_read_b64_tr_b16 v[96:97], v6 offset:15360
    ds_read_b64_tr_b16 v[98:99], v6 offset:15616
    v_mfma_f32_32x32x16_bf16 v[76:91], v[120:123], v[104:107], v[76:91]
    ds_read_b64_tr_b16 v[100:101], v6 offset:16384
    ds_read_b64_tr_b16 v[102:103], v6 offset:16640
    s_waitcnt lgkmcnt(6)
    v_mfma_f32_32x32x16_bf16 v[12:27], v[124:127], v[108:111], v[12:27]
    s_mul_i32 s22, s21, 110592
    s_add_u32 s22, s22, s25
    s_add_u32 s21, s21, 1
    s_add_u32 m0, s28, 0
    ds_read_b64_tr_b16 v[104:105], v6 offset:18432
    ds_read_b64_tr_b16 v[106:107], v6 offset:18688
    buffer_load_dwordx4 v1, s[4:7], s22 offen offset:0 lds
    v_mfma_f32_32x32x16_bf16 v[28:43], v[124:127], v[112:115], v[28:43]
    ds_read_b64_tr_b16 v[108:109], v6 offset:19456
    ds_read_b64_tr_b16 v[110:111], v6 offset:19712
    s_waitcnt lgkmcnt(6)
    v_mfma_f32_32x32x16_bf16 v[44:59], v[124:127], v[92:95], v[44:59]
    s_add_u32 m0, s28, 960
    ds_read_b64_tr_b16 v[112:113], v6 offset:20480
    ds_read_b64_tr_b16 v[114:115], v6 offset:20736
    buffer_load_dwordx4 v2, s[4:7], s22 offen offset:64 lds
    v_mfma_f32_32x32x16_bf16 v[60:75], v[124:127], v[96:99], v[60:75]
    ds_read_b64_tr_b16 v[92:93], v6 offset:21504
    ds_read_b64_tr_b16 v[94:95], v6 offset:21760
    s_waitcnt lgkmcnt(6)
    v_mfma_f32_32x32x16_bf16 v[76:91], v[124:127], v[100:103], v[76:91]
    s_add_u32 m0, s28, 1920
    ds_read_b64_tr_b16 v[96:97], v6 offset:22528
    ds_read_b64_tr_b16 v[98:99], v6 offset:22784
    buffer_load_dwordx4 v3, s[4:7], s22 offen offset:128 lds
    v_mfma_f32_32x32x16_bf16 v[12:27], v[128:131], v[104:107], v[12:27]
    s_waitcnt lgkmcnt(4)
    v_mfma_f32_32x32x16_bf16 v[28:43], v[128:131], v[108:111], v[28:43]
    s_waitcnt vmcnt(10) lgkmcnt(0)
    s_barrier
    ds_read_b128 v[132:135], v7 offset:16384
    ds_read_b128 v[136:139], v8 offset:16384
    ds_read_b128 v[140:143], v9 offset:16384
    ds_read_b128 v[144:147], v10 offset:16384
    ds_read_b64_tr_b16 v[100:101], v6 offset:24576
    ds_read_b64_tr_b16 v[102:103], v6 offset:24832
    ds_read_b64_tr_b16 v[104:105], v6 offset:25600
    ds_read_b64_tr_b16 v[106:107], v6 offset:25856
    v_mfma_f32_32x32x16_bf16 v[44:59], v[128:131], v[112:115], v[44:59]
    ds_read_b64_tr_b16 v[108:109], v6 offset:26624
    ds_read_b64_tr_b16 v[110:111], v6 offset:26880
    v_mfma_f32_32x32x16_bf16 v[60:75], v[128:131], v[92:95], v[60:75]
    ds_read_b64_tr_b16 v[112:113], v6 offset:27648
    ds_read_b64_tr_b16 v[114:115], v6 offset:27904
    v_mfma_f32_32x32x16_bf16 v[76:91], v[128:131], v[96:99], v[76:91]
    ds_read_b64_tr_b16 v[92:93], v6 offset:28672
    ds_read_b64_tr_b16 v[94:95], v6 offset:28928
    s_waitcnt lgkmcnt(6)
    v_mfma_f32_32x32x16_bf16 v[12:27], v[132:135], v[100:103], v[12:27]
    s_mul_i32 s22, s21, 110592
    s_add_u32 s22, s22, s25
    s_add_u32 s21, s21, 1
    s_cmp_eq_u32 s21, 18
    s_cselect_b32 s21, 0, s21
    s_add_u32 m0, s28, 12288
    ds_read_b64_tr_b16 v[96:97], v6 offset:30720
    ds_read_b64_tr_b16 v[98:99], v6 offset:30976
    buffer_load_dwordx4 v1, s[4:7], s22 offen offset:0 lds
    s_add_u32 m0, s28, 13248
    s_nop 0
    buffer_load_dwordx4 v2, s[4:7], s22 offen offset:64 lds
    v_mfma_f32_32x32x16_bf16 v[28:43], v[132:135], v[104:107], v[28:43]
    s_add_u32 m0, s28, 14208
    ds_read_b64_tr_b16 v[100:101], v6 offset:31744
    ds_read_b64_tr_b16 v[102:103], v6 offset:32000
    buffer_load_dwordx4 v3, s[4:7], s22 offen offset:128 lds
    s_waitcnt lgkmcnt(6)
    v_mfma_f32_32x32x16_bf16 v[44:59], v[132:135], v[108:111], v[44:59]
    s_lshl_b32 s23, s49, 7
    s_add_u32 s49, s49, 1
    s_cmp_eq_u32 s49, 9
    s_cselect_b32 s49, 0, s49
    s_add_u32 m0, s48, 16384
    ds_read_b64_tr_b16 v[104:105], v6 offset:32768
    ds_read_b64_tr_b16 v[106:107], v6 offset:33024
    buffer_load_dwordx4 v4, s[12:15], s23 offen lds
    v_mfma_f32_32x32x16_bf16 v[60:75], v[132:135], v[112:115], v[60:75]
    s_add_u32 m0, s48, 17408
    ds_read_b64_tr_b16 v[108:109], v6 offset:33792
    ds_read_b64_tr_b16 v[110:111], v6 offset:34048
    buffer_load_dwordx4 v5, s[12:15], s23 offen lds
    s_waitcnt lgkmcnt(6)
    v_mfma_f32_32x32x16_bf16 v[76:91], v[132:135], v[92:95], v[76:91]
    s_add_u32 s23, s23, 18432
    s_add_u32 m0, s48, 18432
    ds_read_b64_tr_b16 v[112:113], v6 offset:34816
    ds_read_b64_tr_b16 v[114:115], v6 offset:35072
    buffer_load_dwordx4 v4, s[12:15], s23 offen lds
    v_mfma_f32_32x32x16_bf16 v[12:27], v[136:139], v[96:99], v[12:27]
    s_add_u32 m0, s48, 19456
    s_nop 0
    buffer_load_dwordx4 v5, s[12:15], s23 offen lds
    s_waitcnt lgkmcnt(4)
    v_mfma_f32_32x32x16_bf16 v[28:43], v[136:139], v[100:103], v[28:43]
    s_waitcnt vmcnt(14) lgkmcnt(0)
    s_barrier
    ds_read_b64_tr_b16 v[92:93], v6 offset:36864
    ds_read_b64_tr_b16 v[94:95], v6 offset:37120
    ds_read_b64_tr_b16 v[96:97], v6 offset:37888
    ds_read_b64_tr_b16 v[98:99], v6 offset:38144
    v_mfma_f32_32x32x16_bf16 v[44:59], v[136:139], v[104:107], v[44:59]
    ds_read_b64_tr_b16 v[100:101], v6 offset:38912
    ds_read_b64_tr_b16 v[102:103], v6 offset:39168
    v_mfma_f32_32x32x16_bf16 v[60:75], v[136:139], v[108:111], v[60:75]
    ds_read_b64_tr_b16 v[104:105], v6 offset:39936
    ds_read_b64_tr_b16 v[106:107], v6 offset:40192
    v_mfma_f32_32x32x16_bf16 v[76:91], v[136:139], v[112:115], v[76:91]
    ds_read_b64_tr_b16 v[108:109], v6 offset:40960
    ds_read_b64_tr_b16 v[110:111], v6 offset:41216
    s_waitcnt lgkmcnt(6)
    v_mfma_f32_32x32x16_bf16 v[12:27], v[140:143], v[92:95], v[12:27]
    s_mul_i32 s22, s21, 110592
    s_add_u32 s22, s22, s25
    s_add_u32 s21, s21, 1
    s_add_u32 m0, s28, 24576
    ds_read_b64_tr_b16 v[112:113], v6 offset:43008
    ds_read_b64_tr_b16 v[114:115], v6 offset:43264
    buffer_load_dwordx4 v1, s[4:7], s22 offen offset:0 lds
    v_mfma_f32_32x32x16_bf16 v[28:43], v[140:143], v[96:99], v[28:43]
    s_add_u32 m0, s28, 25536
    ds_read_b64_tr_b16 v[92:93], v6 offset:44032
    ds_read_b64_tr_b16 v[94:95], v6 offset:44288
    buffer_load_dwordx4 v2, s[4:7], s22 offen offset:64 lds
    s_waitcnt lgkmcnt(6)
    v_mfma_f32_32x32x16_bf16 v[44:59], v[140:143], v[100:103], v[44:59]
    ds_read_b64_tr_b16 v[96:97], v6 offset:45056
    ds_read_b64_tr_b16 v[98:99], v6 offset:45312
    v_mfma_f32_32x32x16_bf16 v[60:75], v[140:143], v[104:107], v[60:75]
    s_add_u32 m0, s28, 26496
    ds_read_b64_tr_b16 v[100:101], v6 offset:46080
    ds_read_b64_tr_b16 v[102:103], v6 offset:46336
    buffer_load_dwordx4 v3, s[4:7], s22 offen offset:128 lds
    s_waitcnt lgkmcnt(6)
    v_mfma_f32_32x32x16_bf16 v[76:91], v[140:143], v[108:111], v[76:91]
    v_mov_b32 v181, 0
    ds_read_b64_tr_b16 v[104:105], v6 offset:47104
    ds_read_b64_tr_b16 v[106:107], v6 offset:47360
    global_load_dword v180, v181, s[80:81] sc1
    v_mfma_f32_32x32x16_bf16 v[12:27], v[144:147], v[112:115], v[12:27]
    s_waitcnt lgkmcnt(4)
    v_mfma_f32_32x32x16_bf16 v[28:43], v[144:147], v[92:95], v[28:43]
    s_waitcnt vmcnt(11) lgkmcnt(0)
    s_barrier
    ds_read_b128 v[116:119], v7 offset:0
    ds_read_b128 v[120:123], v8 offset:0
    ds_read_b128 v[124:127], v9 offset:0
    ds_read_b128 v[128:131], v10 offset:0
    ds_read_b64_tr_b16 v[108:109], v6 offset:0
    ds_read_b64_tr_b16 v[110:111], v6 offset:256
    ds_read_b64_tr_b16 v[112:113], v6 offset:1024
    ds_read_b64_tr_b16 v[114:115], v6 offset:1280
    v_mfma_f32_32x32x16_bf16 v[44:59], v[144:147], v[96:99], v[44:59]
    ds_read_b64_tr_b16 v[92:93], v6 offset:2048
    ds_read_b64_tr_b16 v[94:95], v6 offset:2304
    v_mfma_f32_32x32x16_bf16 v[60:75], v[144:147], v[100:103], v[60:75]
    ds_read_b64_tr_b16 v[96:97], v6 offset:3072
    ds_read_b64_tr_b16 v[98:99], v6 offset:3328
    v_mfma_f32_32x32x16_bf16 v[76:91], v[144:147], v[104:107], v[76:91]
    ds_read_b64_tr_b16 v[100:101], v6 offset:4096
    ds_read_b64_tr_b16 v[102:103], v6 offset:4352
    s_waitcnt lgkmcnt(6)
    v_mfma_f32_32x32x16_bf16 v[12:27], v[116:119], v[108:111], v[12:27]
    s_mul_i32 s22, s21, 110592
    s_add_u32 s22, s22, s25
    s_add_u32 s21, s21, 1
    s_cmp_eq_u32 s21, 18
    s_cselect_b32 s21, 0, s21
    s_add_u32 m0, s28, 36864
    ds_read_b64_tr_b16 v[104:105], v6 offset:6144
    ds_read_b64_tr_b16 v[106:107], v6 offset:6400
    buffer_load_dwordx4 v1, s[4:7], s22 offen offset:0 lds
    s_add_u32 m0, s28, 37824
    s_nop 0
    buffer_load_dwordx4 v2, s[4:7], s22 offen offset:64 lds
    v_mfma_f32_32x32x16_bf16 v[28:43], v[116:119], v[112:115], v[28:43]
    s_add_u32 m0, s28, 38784
    ds_read_b64_tr_b16 v[108:109], v6 offset:7168
    ds_read_b64_tr_b16 v[110:111], v6 offset:7424
    buffer_load_dwordx4 v3, s[4:7], s22 offen offset:128 lds
    s_waitcnt lgkmcnt(6)
    v_mfma_f32_32x32x16_bf16 v[44:59], v[116:119], v[92:95], v[44:59]
    s_lshl_b32 s23, s49, 7
    s_add_u32 s49, s49, 1
    s_cmp_eq_u32 s49, 9
    s_cselect_b32 s49, 0, s49
    s_add_u32 m0, s48, 0
    ds_read_b64_tr_b16 v[112:113], v6 offset:8192
    ds_read_b64_tr_b16 v[114:115], v6 offset:8448
    buffer_load_dwordx4 v4, s[12:15], s23 offen lds
    v_mfma_f32_32x32x16_bf16 v[60:75], v[116:119], v[96:99], v[60:75]
    s_add_u32 m0, s48, 1024
    ds_read_b64_tr_b16 v[92:93], v6 offset:9216
    ds_read_b64_tr_b16 v[94:95], v6 offset:9472
    buffer_load_dwordx4 v5, s[12:15], s23 offen lds
    s_waitcnt lgkmcnt(6)
    v_mfma_f32_32x32x16_bf16 v[76:91], v[116:119], v[100:103], v[76:91]
    s_add_u32 s23, s23, 18432
    s_add_u32 m0, s48, 2048
    ds_read_b64_tr_b16 v[96:97], v6 offset:10240
    ds_read_b64_tr_b16 v[98:99], v6 offset:10496
    buffer_load_dwordx4 v4, s[12:15], s23 offen lds
    v_mfma_f32_32x32x16_bf16 v[12:27], v[120:123], v[104:107], v[12:27]
    s_add_u32 m0, s48, 3072
    s_nop 0
    buffer_load_dwordx4 v5, s[12:15], s23 offen lds
    s_waitcnt lgkmcnt(4)
    v_mfma_f32_32x32x16_bf16 v[28:43], v[120:123], v[108:111], v[28:43]
    s_waitcnt vmcnt(15) lgkmcnt(0)
    s_barrier
    ds_read_b64_tr_b16 v[100:101], v6 offset:12288
    ds_read_b64_tr_b16 v[102:103], v6 offset:12544
    ds_read_b64_tr_b16 v[104:105], v6 offset:13312
    ds_read_b64_tr_b16 v[106:107], v6 offset:13568
    v_mfma_f32_32x32x16_bf16 v[44:59], v[120:123], v[112:115], v[44:59]
    ds_read_b64_tr_b16 v[108:109], v6 offset:14336
    ds_read_b64_tr_b16 v[110:111], v6 offset:14592
    v_mfma_f32_32x32x16_bf16 v[60:75], v[120:123], v[92:95], v[60:75]
    ds_read_b64_tr_b16 v[112:113], v6 offset:15360
    ds_read_b64_tr_b16 v[114:115], v6 offset:15616
    v_mfma_f32_32x32x16_bf16 v[76:91], v[120:123], v[96:99], v[76:91]
    ds_read_b64_tr_b16 v[92:93], v6 offset:16384
    ds_read_b64_tr_b16 v[94:95], v6 offset:16640
    s_waitcnt lgkmcnt(6)
    v_mfma_f32_32x32x16_bf16 v[12:27], v[124:127], v[100:103], v[12:27]
    s_mul_i32 s22, s21, 110592
    s_add_u32 s22, s22, s25
    s_add_u32 s21, s21, 1
    s_add_u32 m0, s28, 0
    ds_read_b64_tr_b16 v[96:97], v6 offset:18432
    ds_read_b64_tr_b16 v[98:99], v6 offset:18688
    buffer_load_dwordx4 v1, s[4:7], s22 offen offset:0 lds
    v_mfma_f32_32x32x16_bf16 v[28:43], v[124:127], v[104:107], v[28:43]
    ds_read_b64_tr_b16 v[100:101], v6 offset:19456
    ds_read_b64_tr_b16 v[102:103], v6 offset:19712
    s_waitcnt lgkmcnt(6)
    v_mfma_f32_32x32x16_bf16 v[44:59], v[124:127], v[108:111], v[44:59]
    s_add_u32 m0, s28, 960
    ds_read_b64_tr_b16 v[104:105], v6 offset:20480
    ds_read_b64_tr_b16 v[106:107], v6 offset:20736
    buffer_load_dwordx4 v2, s[4:7], s22 offen offset:64 lds
    v_mfma_f32_32x32x16_bf16 v[60:75], v[124:127], v[112:115], v[60:75]
    ds_read_b64_tr_b16 v[108:109], v6 offset:21504
    ds_read_b64_tr_b16 v[110:111], v6 offset:21760
    s_waitcnt lgkmcnt(6)
    v_mfma_f32_32x32x16_bf16 v[76:91], v[124:127], v[92:95], v[76:91]
    s_add_u32 m0, s28, 1920
    ds_read_b64_tr_b16 v[112:113], v6 offset:22528
    ds_read_b64_tr_b16 v[114:115], v6 offset:22784
    buffer_load_dwordx4 v3, s[4:7], s22 offen offset:128 lds
    v_mfma_f32_32x32x16_bf16 v[12:27], v[128:131], v[96:99], v[12:27]
    s_waitcnt lgkmcnt(4)
    v_mfma_f32_32x32x16_bf16 v[28:43], v[128:131], v[100:103], v[28:43]
    s_waitcnt vmcnt(11) lgkmcnt(0)
    s_barrier
    ds_read_b128 v[132:135], v7 offset:16384
    ds_read_b128 v[136:139], v8 offset:16384
    ds_read_b128 v[140:143], v9 offset:16384
    ds_read_b128 v[144:147], v10 offset:16384
    ds_read_b64_tr_b16 v[92:93], v6 offset:24576
    ds_read_b64_tr_b16 v[94:95], v6 offset:24832
    ds_read_b64_tr_b16 v[96:97], v6 offset:25600
    ds_read_b64_tr_b16 v[98:99], v6 offset:25856
    v_mfma_f32_32x32x16_bf16 v[44:59], v[128:131], v[104:107], v[44:59]
    ds_read_b64_tr_b16 v[100:101], v6 offset:26624
    ds_read_b64_tr_b16 v[102:103], v6 offset:26880
    v_mfma_f32_32x32x16_bf16 v[60:75], v[128:131], v[108:111], v[60:75]
    ds_read_b64_tr_b16 v[104:105], v6 offset:27648
    ds_read_b64_tr_b16 v[106:107], v6 offset:27904
    v_mfma_f32_32x32x16_bf16 v[76:91], v[128:131], v[112:115], v[76:91]
    ds_read_b64_tr_b16 v[108:109], v6 offset:28672
    ds_read_b64_tr_b16 v[110:111], v6 offset:28928
    s_waitcnt lgkmcnt(6)
    v_mfma_f32_32x32x16_bf16 v[12:27], v[132:135], v[92:95], v[12:27]
    s_mul_i32 s22, s21, 110592
    s_add_u32 s22, s22, s25
    s_add_u32 s21, s21, 1
    s_cmp_eq_u32 s21, 18
    s_cselect_b32 s21, 0, s21
    s_add_u32 m0, s28, 12288
    ds_read_b64_tr_b16 v[112:113], v6 offset:30720
    ds_read_b64_tr_b16 v[114:115], v6 offset:30976
    buffer_load_dwordx4 v1, s[4:7], s22 offen offset:0 lds
    s_add_u32 m0, s28, 13248
    s_nop 0
    buffer_load_dwordx4 v2, s[4:7], s22 offen offset:64 lds
    v_mfma_f32_32x32x16_bf16 v[28:43], v[132:135], v[96:99], v[28:43]
    s_add_u32 m0, s28, 14208
    ds_read_b64_tr_b16 v[92:93], v6 offset:31744
    ds_read_b64_tr_b16 v[94:95], v6 offset:32000
    buffer_load_dwordx4 v3, s[4:7], s22 offen offset:128 lds
    s_waitcnt lgkmcnt(6)
    v_mfma_f32_32x32x16_bf16 v[44:59], v[132:135], v[100:103], v[44:59]
    s_lshl_b32 s23, s49, 7
    s_add_u32 s49, s49, 1
    s_cmp_eq_u32 s49, 9
    s_cselect_b32 s49, 0, s49
    s_add_u32 m0, s48, 16384
    ds_read_b64_tr_b16 v[96:97], v6 offset:32768
    ds_read_b64_tr_b16 v[98:99], v6 offset:33024
    buffer_load_dwordx4 v4, s[12:15], s23 offen lds
    v_mfma_f32_32x32x16_bf16 v[60:75], v[132:135], v[104:107], v[60:75]
    s_add_u32 m0, s48, 17408
    ds_read_b64_tr_b16 v[100:101], v6 offset:33792
    ds_read_b64_tr_b16 v[102:103], v6 offset:34048
    buffer_load_dwordx4 v5, s[12:15], s23 offen lds
    s_waitcnt lgkmcnt(6)
    v_mfma_f32_32x32x16_bf16 v[76:91], v[132:135], v[108:111], v[76:91]
    s_add_u32 s23, s23, 18432
    s_add_u32 m0, s48, 18432
    ds_read_b64_tr_b16 v[104:105], v6 offset:34816
    ds_read_b64_tr_b16 v[106:107], v6 offset:35072
    buffer_load_dwordx4 v4, s[12:15], s23 offen lds
    v_mfma_f32_32x32x16_bf16 v[12:27], v[136:139], v[112:115], v[12:27]
    s_add_u32 m0, s48, 19456
    s_nop 0
    buffer_load_dwordx4 v5, s[12:15], s23 offen lds
    s_waitcnt lgkmcnt(4)
    v_mfma_f32_32x32x16_bf16 v[28:43], v[136:139], v[92:95], v[28:43]
    s_waitcnt vmcnt(14) lgkmcnt(0)
    s_barrier
    ds_read_b64_tr_b16 v[108:109], v6 offset:36864
    ds_read_b64_tr_b16 v[110:111], v6 offset:37120
    ds_read_b64_tr_b16 v[112:113], v6 offset:37888
    ds_read_b64_tr_b16 v[114:115], v6 offset:38144
    v_mfma_f32_32x32x16_bf16 v[44:59], v[136:139], v[96:99], v[44:59]
    ds_read_b64_tr_b16 v[92:93], v6 offset:38912
    ds_read_b64_tr_b16 v[94:95], v6 offset:39168
    v_mfma_f32_32x32x16_bf16 v[60:75], v[136:139], v[100:103], v[60:75]
    ds_read_b64_tr_b16 v[96:97], v6 offset:39936
    ds_read_b64_tr_b16 v[98:99], v6 offset:40192
    v_mfma_f32_32x32x16_bf16 v[76:91], v[136:139], v[104:107], v[76:91]
    ds_read_b64_tr_b16 v[100:101], v6 offset:40960
    ds_read_b64_tr_b16 v[102:103], v6 offset:41216
    s_waitcnt lgkmcnt(6)
    v_mfma_f32_32x32x16_bf16 v[12:27], v[140:143], v[108:111], v[12:27]
    s_mul_i32 s22, s21, 110592
    s_add_u32 s22, s22, s25
    s_add_u32 s21, s21, 1
    s_add_u32 m0, s28, 24576
    ds_read_b64_tr_b16 v[104:105], v6 offset:43008
    ds_read_b64_tr_b16 v[106:107], v6 offset:43264
    buffer_load_dwordx4 v1, s[4:7], s22 offen offset:0 lds
    v_mfma_f32_32x32x16_bf16 v[28:43], v[140:143], v[112:115], v[28:43]
    ds_read_b64_tr_b16 v[108:109], v6 offset:44032
    ds_read_b64_tr_b16 v[110:111], v6 offset:44288
    s_waitcnt lgkmcnt(6)
    v_mfma_f32_32x32x16_bf16 v[44:59], v[140:143], v[92:95], v[44:59]
    s_add_u32 m0, s28, 25536
    ds_read_b64_tr_b16 v[112:113], v6 offset:45056
    ds_read_b64_tr_b16 v[114:115], v6 offset:45312
    buffer_load_dwordx4 v2, s[4:7], s22 offen offset:64 lds
    v_mfma_f32_32x32x16_bf16 v[60:75], v[140:143], v[96:99], v[60:75]
    ds_read_b64_tr_b16 v[92:93], v6 offset:46080
    ds_read_b64_tr_b16 v[94:95], v6 offset:46336
    s_waitcnt lgkmcnt(6)
    v_mfma_f32_32x32x16_bf16 v[76:91], v[140:143], v[100:103], v[76:91]
    s_add_u32 m0, s28, 26496
    ds_read_b64_tr_b16 v[96:97], v6 offset:47104
    ds_read_b64_tr_b16 v[98:99], v6 offset:47360
    buffer_load_dwordx4 v3, s[4:7], s22 offen offset:128 lds
    v_mfma_f32_32x32x16_bf16 v[12:27], v[144:147], v[104:107], v[12:27]
    s_waitcnt lgkmcnt(4)
    v_mfma_f32_32x32x16_bf16 v[28:43], v[144:147], v[108:111], v[28:43]
    s_waitcnt vmcnt(10) lgkmcnt(0)
    s_barrier
    ds_read_b128 v[116:119], v7 offset:0
    ds_read_b128 v[120:123], v8 offset:0
    ds_read_b128 v[124:127], v9 offset:0
    ds_read_b128 v[128:131], v10 offset:0
    ds_read_b64_tr_b16 v[100:101], v6 offset:0
    ds_read_b64_tr_b16 v[102:103], v6 offset:256
    ds_read_b64_tr_b16 v[104:105], v6 offset:1024
    ds_read_b64_tr_b16 v[106:107], v6 offset:1280
    v_mfma_f32_32x32x16_bf16 v[44:59], v[144:147], v[112:115], v[44:59]
    ds_read_b64_tr_b16 v[108:109], v6 offset:2048
    ds_read_b64_tr_b16 v[110:111], v6 offset:2304
    v_mfma_f32_32x32x16_bf16 v[60:75], v[144:147], v[92:95], v[60:75]
    ds_read_b64_tr_b16 v[112:113], v6 offset:3072
    ds_read_b64_tr_b16 v[114:115], v6 offset:3328
    v_mfma_f32_32x32x16_bf16 v[76:91], v[144:147], v[96:99], v[76:91]
    ds_read_b64_tr_b16 v[92:93], v6 offset:4096
    ds_read_b64_tr_b16 v[94:95], v6 offset:4352
    s_waitcnt lgkmcnt(6)
    v_mfma_f32_32x32x16_bf16 v[12:27], v[116:119], v[100:103], v[12:27]
    s_mul_i32 s22, s21, 110592
    s_add_u32 s22, s22, s25
    s_add_u32 s21, s21, 1
    s_cmp_eq_u32 s21, 18
    s_cselect_b32 s21, 0, s21
    s_add_u32 m0, s28, 36864
    ds_read_b64_tr_b16 v[96:97], v6 offset:6144
    ds_read_b64_tr_b16 v[98:99], v6 offset:6400
    buffer_load_dwordx4 v1, s[4:7], s22 offen offset:0 lds
    s_add_u32 m0, s28, 37824
    s_nop 0
    buffer_load_dwordx4 v2, s[4:7], s22 offen offset:64 lds
    v_mfma_f32_32x32x16_bf16 v[28:43], v[116:119], v[104:107], v[28:43]
    s_add_u32 m0, s28, 38784
    ds_read_b64_tr_b16 v[100:101], v6 offset:7168
    ds_read_b64_tr_b16 v[102:103], v6 offset:7424
    buffer_load_dwordx4 v3, s[4:7], s22 offen offset:128 lds
    s_waitcnt lgkmcnt(6)
    v_mfma_f32_32x32x16_bf16 v[44:59], v[116:119], v[108:111], v[44:59]
    s_lshl_b32 s23, s49, 7
    s_add_u32 s49, s49, 1
    s_cmp_eq_u32 s49, 9
    s_cselect_b32 s49, 0, s49
    s_add_u32 m0, s48, 0
    ds_read_b64_tr_b16 v[104:105], v6 offset:8192
    ds_read_b64_tr_b16 v[106:107], v6 offset:8448
    buffer_load_dwordx4 v4, s[12:15], s23 offen lds
    v_mfma_f32_32x32x16_bf16 v[60:75], v[116:119], v[112:115], v[60:75]
    s_add_u32 m0, s48, 1024
    ds_read_b64_tr_b16 v[108:109], v6 offset:9216
    ds_read_b64_tr_b16 v[110:111], v6 offset:9472
    buffer_load_dwordx4 v5, s[12:15], s23 offen lds
    s_waitcnt lgkmcnt(6)
    v_mfma_f32_32x32x16_bf16 v[76:91], v[116:119], v[92:95], v[76:91]
    s_add_u32 s23, s23, 18432
    s_add_u32 m0, s48, 2048
    ds_read_b64_tr_b16 v[112:113], v6 offset:10240
    ds_read_b64_tr_b16 v[114:115], v6 offset:10496
    buffer_load_dwordx4 v4, s[12:15], s23 offen lds
    v_mfma_f32_32x32x16_bf16 v[12:27], v[120:123], v[96:99], v[12:27]
    s_add_u32 m0, s48, 3072
    s_nop 0
    buffer_load_dwordx4 v5, s[12:15], s23 offen lds
    s_waitcnt lgkmcnt(4)
    v_mfma_f32_32x32x16_bf16 v[28:43], v[120:123], v[100:103], v[28:43]
    s_waitcnt vmcnt(14) lgkmcnt(0)
    v_readfirstlane_b32 s57, v180
    s_nop 1
    s_cmp_ge_u32 s57, 16
    s_cbranch_scc1 L_f_rk_5
    s_cmp_lg_u32 s18, 0
    s_cbranch_scc1 L_f_rd_6
    s_mov_b32 s57, 262144
    v_mov_b32 v181, 0
L_f_rp_7:
    global_load_dword v180, v181, s[80:81] sc1
    s_waitcnt vmcnt(0)
    v_readfirstlane_b32 s58, v180
    s_nop 1
    s_cmp_ge_u32 s58, 16
    s_cbranch_scc1 L_f_rd_6
    s_sleep 8
    s_sub_u32 s57, s57, 1
    s_cmp_gt_i32 s57, 0
    s_cbranch_scc1 L_f_rp_7
L_f_rd_6:
L_f_rk_5:
    s_barrier
    ds_read_b64_tr_b16 v[92:93], v6 offset:12288
    ds_read_b64_tr_b16 v[94:95], v6 offset:12544
    ds_read_b64_tr_b16 v[96:97], v6 offset:13312
    ds_read_b64_tr_b16 v[98:99], v6 offset:13568
    v_mfma_f32_32x32x16_bf16 v[44:59], v[120:123], v[104:107], v[44:59]
    ds_read_b64_tr_b16 v[100:101], v6 offset:14336
    ds_read_b64_tr_b16 v[102:103], v6 offset:14592
    v_mfma_f32_32x32x16_bf16 v[60:75], v[120:123], v[108:111], v[60:75]
    ds_read_b64_tr_b16 v[104:105], v6 offset:15360
    ds_read_b64_tr_b16 v[106:107], v6 offset:15616
    v_mfma_f32_32x32x16_bf16 v[76:91], v[120:123], v[112:115], v[76:91]
    ds_read_b64_tr_b16 v[108:109], v6 offset:16384
    ds_read_b64_tr_b16 v[110:111], v6 offset:16640
    s_waitcnt lgkmcnt(6)
    v_mfma_f32_32x32x16_bf16 v[12:27], v[124:127], v[92:95], v[12:27]
    s_mul_i32 s22, s21, 110592
    s_add_u32 s22, s22, s25
    s_add_u32 s21, s21, 1
    s_add_u32 m0, s28, 0
    ds_read_b64_tr_b16 v[112:113], v6 offset:18432
    ds_read_b64_tr_b16 v[114:115], v6 offset:18688
    buffer_load_dwordx4 v1, s[4:7], s22 offen offset:0 lds
    v_mfma_f32_32x32x16_bf16 v[28:43], v[124:127], v[96:99], v[28:43]
    ds_read_b64_tr_b16 v[92:93], v6 offset:19456
    ds_read_b64_tr_b16 v[94:95], v6 offset:19712
    s_waitcnt lgkmcnt(6)
    v_mfma_f32_32x32x16_bf16 v[44:59], v[124:127], v[100:103], v[44:59]
    s_add_u32 m0, s28, 960
    ds_read_b64_tr_b16 v[96:97], v6 offset:20480
    ds_read_b64_tr_b16 v[98:99], v6 offset:20736
    buffer_load_dwordx4 v2, s[4:7], s22 offen offset:64 lds
    v_mfma_f32_32x32x16_bf16 v[60:75], v[124:127], v[104:107], v[60:75]
    ds_read_b64_tr_b16 v[100:101], v6 offset:21504
    ds_read_b64_tr_b16 v[102:103], v6 offset:21760
    s_waitcnt lgkmcnt(6)
    v_mfma_f32_32x32x16_bf16 v[76:91], v[124:127], v[108:111], v[76:91]
    s_add_u32 m0, s28, 1920
    ds_read_b64_tr_b16 v[104:105], v6 offset:22528
    ds_read_b64_tr_b16 v[106:107], v6 offset:22784
    buffer_load_dwordx4 v3, s[4:7], s22 offen offset:128 lds
    v_mfma_f32_32x32x16_bf16 v[12:27], v[128:131], v[112:115], v[12:27]
    s_waitcnt lgkmcnt(4)
    v_mfma_f32_32x32x16_bf16 v[28:43], v[128:131], v[92:95], v[28:43]
    s_waitcnt vmcnt(10) lgkmcnt(0)
    s_barrier
    ds_read_b128 v[132:135], v7 offset:16384
    ds_read_b128 v[136:139], v8 offset:16384
    ds_read_b128 v[140:143], v9 offset:16384
    ds_read_b128 v[144:147], v10 offset:16384
    ds_read_b64_tr_b16 v[108:109], v6 offset:24576
    ds_read_b64_tr_b16 v[110:111], v6 offset:24832
    ds_read_b64_tr_b16 v[112:113], v6 offset:25600
    ds_read_b64_tr_b16 v[114:115], v6 offset:25856
    v_mfma_f32_32x32x16_bf16 v[44:59], v[128:131], v[96:99], v[44:59]
    ds_read_b64_tr_b16 v[92:93], v6 offset:26624
    ds_read_b64_tr_b16 v[94:95], v6 offset:26880
    v_mfma_f32_32x32x16_bf16 v[60:75], v[128:131], v[100:103], v[60:75]
    ds_read_b64_tr_b16 v[96:97], v6 offset:27648
    ds_read_b64_tr_b16 v[98:99], v6 offset:27904
    v_mfma_f32_32x32x16_bf16 v[76:91], v[128:131], v[104:107], v[76:91]
    ds_read_b64_tr_b16 v[100:101], v6 offset:28672
    ds_read_b64_tr_b16 v[102:103], v6 offset:28928
    s_waitcnt lgkmcnt(6)
    v_mfma_f32_32x32x16_bf16 v[12:27], v[132:135], v[108:111], v[12:27]
    s_mul_i32 s22, s21, 110592
    s_add_u32 s22, s22, s25
    s_add_u32 s21, s21, 1
    s_cmp_eq_u32 s21, 18
    s_cselect_b32 s21, 0, s21
    s_add_u32 m0, s28, 12288
    ds_read_b64_tr_b16 v[104:105], v6 offset:30720
    ds_read_b64_tr_b16 v[106:107], v6 offset:30976
    buffer_load_dwordx4 v1, s[4:7], s22 offen offset:0 lds
    s_add_u32 m0, s28, 13248
    s_nop 0
    buffer_load_dwordx4 v2, s[4:7], s22 offen offset:64 lds
    v_mfma_f32_32x32x16_bf16 v[28:43], v[132:135], v[112:115], v[28:43]
    s_add_u32 m0, s28, 14208
    ds_read_b64_tr_b16 v[108:109], v6 offset:31744
    ds_read_b64_tr_b16 v[110:111], v6 offset:32000
    buffer_load_dwordx4 v3, s[4:7], s22 offen offset:128 lds
    s_waitcnt lgkmcnt(6)
    v_mfma_f32_32x32x16_bf16 v[44:59], v[132:135], v[92:95], v[44:59]
    s_lshl_b32 s23, s49, 7
    s_add_u32 s49, s49, 1
    s_cmp_eq_u32 s49, 9
    s_cselect_b32 s49, 0, s49
    s_add_u32 m0, s48, 16384
    ds_read_b64_tr_b16 v[112:113], v6 offset:32768
    ds_read_b64_tr_b16 v[114:115], v6 offset:33024
    buffer_load_dwordx4 v4, s[12:15], s23 offen lds
    v_mfma_f32_32x32x16_bf16 v[60:75], v[132:135], v[96:99], v[60:75]
    s_add_u32 m0, s48, 17408
    ds_read_b64_tr_b16 v[92:93], v6 offset:33792
    ds_read_b64_tr_b16 v[94:95], v6 offset:34048
    buffer_load_dwordx4 v5, s[12:15], s23 offen lds
    s_waitcnt lgkmcnt(6)
    v_mfma_f32_32x32x16_bf16 v[76:91], v[132:135], v[100:103], v[76:91]
    s_add_u32 s23, s23, 18432
    s_add_u32 m0, s48, 18432
    ds_read_b64_tr_b16 v[96:97], v6 offset:34816
    ds_read_b64_tr_b16 v[98:99], v6 offset:35072
    buffer_load_dwordx4 v4, s[12:15], s23 offen lds
    v_mfma_f32_32x32x16_bf16 v[12:27], v[136:139], v[104:107], v[12:27]
    s_add_u32 m0, s48, 19456
    s_nop 0
    buffer_load_dwordx4 v5, s[12:15], s23 offen lds
    s_waitcnt lgkmcnt(4)
    v_mfma_f32_32x32x16_bf16 v[28:43], v[136:139], v[108:111], v[28:43]
    s_waitcnt vmcnt(14) lgkmcnt(0)
    s_barrier
    ds_read_b64_tr_b16 v[100:101], v6 offset:36864
    ds_read_b64_tr_b16 v[102:103], v6 offset:37120
    ds_read_b64_tr_b16 v[104:105], v6 offset:37888
    ds_read_b64_tr_b16 v[106:107], v6 offset:38144
    v_mfma_f32_32x32x16_bf16 v[44:59], v[136:139], v[112:115], v[44:59]
    ds_read_b64_tr_b16 v[108:109], v6 offset:38912
    ds_read_b64_tr_b16 v[110:111], v6 offset:39168
    v_mfma_f32_32x32x16_bf16 v[60:75], v[136:139], v[92:95], v[60:75]
    ds_read_b64_tr_b16 v[112:113], v6 offset:39936
    ds_read_b64_tr_b16 v[114:115], v6 offset:40192
    v_mfma_f32_32x32x16_bf16 v[76:91], v[136:139], v[96:99], v[76:91]
    ds_read_b64_tr_b16 v[92:93], v6 offset:40960
    ds_read_b64_tr_b16 v[94:95], v6 offset:41216
    s_waitcnt lgkmcnt(6)
    v_mfma_f32_32x32x16_bf16 v[12:27], v[140:143], v[100:103], v[12:27]
    s_mul_i32 s22, s21, 110592
    s_add_u32 s22, s22, s25
    s_add_u32 s21, s21, 1
    s_add_u32 m0, s28, 24576
    ds_read_b64_tr_b16 v[96:97], v6 offset:43008
    ds_read_b64_tr_b16 v[98:99], v6 offset:43264
    buffer_load_dwordx4 v1, s[4:7], s22 offen offset:0 lds
    v_mfma_f32_32x32x16_bf16 v[28:43], v[140:143], v[104:107], v[28:43]
    ds_read_b64_tr_b16 v[100:101], v6 offset:44032
    ds_read_b64_tr_b16 v[102:103], v6 offset:44288
    s_waitcnt lgkmcnt(6)
    v_mfma_f32_32x32x16_bf16 v[44:59], v[140:143], v[108:111], v[44:59]
    s_add_u32 m0, s28, 25536
    ds_read_b64_tr_b16 v[104:105], v6 offset:45056
    ds_read_b64_tr_b16 v[106:107], v6 offset:45312
    buffer_load_dwordx4 v2, s[4:7], s22 offen offset:64 lds
    v_mfma_f32_32x32x16_bf16 v[60:75], v[140:143], v[112:115], v[60:75]
    ds_read_b64_tr_b16 v[108:109], v6 offset:46080
    ds_read_b64_tr_b16 v[110:111], v6 offset:46336
    s_waitcnt lgkmcnt(6)
    v_mfma_f32_32x32x16_bf16 v[76:91], v[140:143], v[92:95], v[76:91]
    s_add_u32 m0, s28, 26496
    ds_read_b64_tr_b16 v[112:113], v6 offset:47104
    ds_read_b64_tr_b16 v[114:115], v6 offset:47360
    buffer_load_dwordx4 v3, s[4:7], s22 offen offset:128 lds
    v_mfma_f32_32x32x16_bf16 v[12:27], v[144:147], v[96:99], v[12:27]
    s_waitcnt lgkmcnt(4)
    v_mfma_f32_32x32x16_bf16 v[28:43], v[144:147], v[100:103], v[28:43]
    s_waitcnt vmcnt(10) lgkmcnt(0)
    s_barrier
    ds_read_b128 v[116:119], v7 offset:0
    ds_read_b128 v[120:123], v8 offset:0
    ds_read_b128 v[124:127], v9 offset:0
    ds_read_b128 v[128:131], v10 offset:0
    ds_read_b64_tr_b16 v[92:93], v6 offset:0
    ds_read_b64_tr_b16 v[94:95], v6 offset:256
    ds_read_b64_tr_b16 v[96:97], v6 offset:1024
    ds_read_b64_tr_b16 v[98:99], v6 offset:1280
    v_mfma_f32_32x32x16_bf16 v[44:59], v[144:147], v[104:107], v[44:59]
    ds_read_b64_tr_b16 v[100:101], v6 offset:2048
    ds_read_b64_tr_b16 v[102:103], v6 offset:2304
    v_mfma_f32_32x32x16_bf16 v[60:75], v[144:147], v[108:111], v[60:75]
    ds_read_b64_tr_b16 v[104:105], v6 offset:3072
    ds_read_b64_tr_b16 v[106:107], v6 offset:3328
    v_mfma_f32_32x32x16_bf16 v[76:91], v[144:147], v[112:115], v[76:91]
    ds_read_b64_tr_b16 v[108:109], v6 offset:4096
    ds_read_b64_tr_b16 v[110:111], v6 offset:4352
    s_waitcnt lgkmcnt(6)
    v_mfma_f32_32x32x16_bf16 v[12:27], v[116:119], v[92:95], v[12:27]
    s_mul_i32 s22, s21, 110592
    s_add_u32 s22, s22, s25
    s_add_u32 s21, s21, 1
    s_cmp_eq_u32 s21, 18
    s_cselect_b32 s21, 0, s21
    s_add_u32 m0, s28, 36864
    ds_read_b64_tr_b16 v[112:113], v6 offset:6144
    ds_read_b64_tr_b16 v[114:115], v6 offset:6400
    buffer_load_dwordx4 v1, s[4:7], s22 offen offset:0 lds
    s_add_u32 m0, s28, 37824
    s_nop 0
    buffer_load_dwordx4 v2, s[4:7], s22 offen offset:64 lds
    v_mfma_f32_32x32x16_bf16 v[28:43], v[116:119], v[96:99], v[28:43]
    s_add_u32 m0, s28, 38784
    ds_read_b64_tr_b16 v[92:93], v6 offset:7168
    ds_read_b64_tr_b16 v[94:95], v6 offset:7424
    buffer_load_dwordx4 v3, s[4:7], s22 offen offset:128 lds
    s_waitcnt lgkmcnt(6)
    v_mfma_f32_32x32x16_bf16 v[44:59], v[116:119], v[100:103], v[44:59]
    s_lshl_b32 s23, s49, 7
    s_add_u32 s49, s49, 1
    s_cmp_eq_u32 s49, 9
    s_cselect_b32 s49, 0, s49
    s_add_u32 m0, s48, 0
    ds_read_b64_tr_b16 v[96:97], v6 offset:8192
    ds_read_b64_tr_b16 v[98:99], v6 offset:8448
    buffer_load_dwordx4 v4, s[12:15], s23 offen lds
    v_mfma_f32_32x32x16_bf16 v[60:75], v[116:119], v[104:107], v[60:75]
    s_add_u32 m0, s48, 1024
    ds_read_b64_tr_b16 v[100:101], v6 offset:9216
    ds_read_b64_tr_b16 v[102:103], v6 offset:9472
    buffer_load_dwordx4 v5, s[12:15], s23 offen lds
    s_waitcnt lgkmcnt(6)
    v_mfma_f32_32x32x16_bf16 v[76:91], v[116:119], v[108:111], v[76:91]
    s_add_u32 s23, s23, 18432
    s_add_u32 m0, s48, 2048
    ds_read_b64_tr_b16 v[104:105], v6 offset:10240
    ds_read_b64_tr_b16 v[106:107], v6 offset:10496
    buffer_load_dwordx4 v4, s[12:15], s23 offen lds
    v_mfma_f32_32x32x16_bf16 v[12:27], v[120:123], v[112:115], v[12:27]
    s_add_u32 m0, s48, 3072
    s_nop 0
    buffer_load_dwordx4 v5, s[12:15], s23 offen lds
    s_waitcnt lgkmcnt(4)
    v_mfma_f32_32x32x16_bf16 v[28:43], v[120:123], v[92:95], v[28:43]
    s_waitcnt vmcnt(14) lgkmcnt(0)
    s_barrier
    ds_read_b64_tr_b16 v[108:109], v6 offset:12288
    ds_read_b64_tr_b16 v[110:111], v6 offset:12544
    ds_read_b64_tr_b16 v[112:113], v6 offset:13312
    ds_read_b64_tr_b16 v[114:115], v6 offset:13568
    v_mfma_f32_32x32x16_bf16 v[44:59], v[120:123], v[96:99], v[44:59]
    ds_read_b64_tr_b16 v[92:93], v6 offset:14336
    ds_read_b64_tr_b16 v[94:95], v6 offset:14592
    v_mfma_f32_32x32x16_bf16 v[60:75], v[120:123], v[100:103], v[60:75]
    ds_read_b64_tr_b16 v[96:97], v6 offset:15360
    ds_read_b64_tr_b16 v[98:99], v6 offset:15616
    v_mfma_f32_32x32x16_bf16 v[76:91], v[120:123], v[104:107], v[76:91]
    ds_read_b64_tr_b16 v[100:101], v6 offset:16384
    ds_read_b64_tr_b16 v[102:103], v6 offset:16640
    s_waitcnt lgkmcnt(6)
    v_mfma_f32_32x32x16_bf16 v[12:27], v[124:127], v[108:111], v[12:27]
    s_mul_i32 s22, s21, 110592
    s_add_u32 s22, s22, s25
    s_add_u32 s21, s21, 1
    s_add_u32 m0, s28, 0
    ds_read_b64_tr_b16 v[104:105], v6 offset:18432
    ds_read_b64_tr_b16 v[106:107], v6 offset:18688
    buffer_load_dwordx4 v1, s[4:7], s22 offen offset:0 lds
    v_mfma_f32_32x32x16_bf16 v[28:43], v[124:127], v[112:115], v[28:43]
    ds_read_b64_tr_b16 v[108:109], v6 offset:19456
    ds_read_b64_tr_b16 v[110:111], v6 offset:19712
    s_waitcnt lgkmcnt(6)
    v_mfma_f32_32x32x16_bf16 v[44:59], v[124:127], v[92:95], v[44:59]
    s_add_u32 m0, s28, 960
    ds_read_b64_tr_b16 v[112:113], v6 offset:20480
    ds_read_b64_tr_b16 v[114:115], v6 offset:20736
    buffer_load_dwordx4 v2, s[4:7], s22 offen offset:64 lds
    v_mfma_f32_32x32x16_bf16 v[60:75], v[124:127], v[96:99], v[60:75]
    ds_read_b64_tr_b16 v[92:93], v6 offset:21504
    ds_read_b64_tr_b16 v[94:95], v6 offset:21760
    s_waitcnt lgkmcnt(6)
    v_mfma_f32_32x32x16_bf16 v[76:91], v[124:127], v[100:103], v[76:91]
    s_add_u32 m0, s28, 1920
    ds_read_b64_tr_b16 v[96:97], v6 offset:22528
    ds_read_b64_tr_b16 v[98:99], v6 offset:22784
    buffer_load_dwordx4 v3, s[4:7], s22 offen offset:128 lds
    v_mfma_f32_32x32x16_bf16 v[12:27], v[128:131], v[104:107], v[12:27]
    s_waitcnt lgkmcnt(4)
    v_mfma_f32_32x32x16_bf16 v[28:43], v[128:131], v[108:111], v[28:43]
    s_waitcnt vmcnt(10) lgkmcnt(0)
    s_barrier
    ds_read_b128 v[132:135], v7 offset:16384
    ds_read_b128 v[136:139], v8 offset:16384
    ds_read_b128 v[140:143], v9 offset:16384
    ds_read_b128 v[144:147], v10 offset:16384
    ds_read_b64_tr_b16 v[100:101], v6 offset:24576
    ds_read_b64_tr_b16 v[102:103], v6 offset:24832
    ds_read_b64_tr_b16 v[104:105], v6 offset:25600
    ds_read_b64_tr_b16 v[106:107], v6 offset:25856
    v_mfma_f32_32x32x16_bf16 v[44:59], v[128:131], v[112:115], v[44:59]
    ds_read_b64_tr_b16 v[108:109], v6 offset:26624
    ds_read_b64_tr_b16 v[110:111], v6 offset:26880
    v_mfma_f32_32x32x16_bf16 v[60:75], v[128:131], v[92:95], v[60:75]
    ds_read_b64_tr_b16 v[112:113], v6 offset:27648
    ds_read_b64_tr_b16 v[114:115], v6 offset:27904
    v_mfma_f32_32x32x16_bf16 v[76:91], v[128:131], v[96:99], v[76:91]
    ds_read_b64_tr_b16 v[92:93], v6 offset:28672
    ds_read_b64_tr_b16 v[94:95], v6 offset:28928
    s_waitcnt lgkmcnt(6)
    v_mfma_f32_32x32x16_bf16 v[12:27], v[132:135], v[100:103], v[12:27]
    s_mul_i32 s22, s21, 110592
    s_add_u32 s22, s22, s25
    s_add_u32 s21, s21, 1
    s_cmp_eq_u32 s21, 18
    s_cselect_b32 s21, 0, s21
    s_add_u32 m0, s28, 12288
    ds_read_b64_tr_b16 v[96:97], v6 offset:30720
    ds_read_b64_tr_b16 v[98:99], v6 offset:30976
    buffer_load_dwordx4 v1, s[4:7], s22 offen offset:0 lds
    v_mfma_f32_32x32x16_bf16 v[28:43], v[132:135], v[104:107], v[28:43]
    ds_read_b64_tr_b16 v[100:101], v6 offset:31744
    ds_read_b64_tr_b16 v[102:103], v6 offset:32000
    s_waitcnt lgkmcnt(6)
    v_mfma_f32_32x32x16_bf16 v[44:59], v[132:135], v[108:111], v[44:59]
    s_add_u32 m0, s28, 13248
    ds_read_b64_tr_b16 v[104:105], v6 offset:32768
    ds_read_b64_tr_b16 v[106:107], v6 offset:33024
    buffer_load_dwordx4 v2, s[4:7], s22 offen offset:64 lds
    v_mfma_f32_32x32x16_bf16 v[60:75], v[132:135], v[112:115], v[60:75]
    ds_read_b64_tr_b16 v[108:109], v6 offset:33792
    ds_read_b64_tr_b16 v[110:111], v6 offset:34048
    s_waitcnt lgkmcnt(6)
    v_mfma_f32_32x32x16_bf16 v[76:91], v[132:135], v[92:95], v[76:91]
    s_add_u32 m0, s28, 14208
    ds_read_b64_tr_b16 v[112:113], v6 offset:34816
    ds_read_b64_tr_b16 v[114:115], v6 offset:35072
    buffer_load_dwordx4 v3, s[4:7], s22 offen offset:128 lds
    v_mfma_f32_32x32x16_bf16 v[12:27], v[136:139], v[96:99], v[12:27]
    s_waitcnt lgkmcnt(4)
    v_mfma_f32_32x32x16_bf16 v[28:43], v[136:139], v[100:103], v[28:43]
    s_waitcnt vmcnt(10) lgkmcnt(0)
    s_barrier
    ds_read_b64_tr_b16 v[92:93], v6 offset:36864
    ds_read_b64_tr_b16 v[94:95], v6 offset:37120
    ds_read_b64_tr_b16 v[96:97], v6 offset:37888
    ds_read_b64_tr_b16 v[98:99], v6 offset:38144
    v_mfma_f32_32x32x16_bf16 v[44:59], v[136:139], v[104:107], v[44:59]
    ds_read_b64_tr_b16 v[100:101], v6 offset:38912
    ds_read_b64_tr_b16 v[102:103], v6 offset:39168
    v_mfma_f32_32x32x16_bf16 v[60:75], v[136:139], v[108:111], v[60:75]
    ds_read_b64_tr_b16 v[104:105], v6 offset:39936
    ds_read_b64_tr_b16 v[106:107], v6 offset:40192
    v_mfma_f32_32x32x16_bf16 v[76:91], v[136:139], v[112:115], v[76:91]
    ds_read_b64_tr_b16 v[108:109], v6 offset:40960
    ds_read_b64_tr_b16 v[110:111], v6 offset:41216
    s_waitcnt lgkmcnt(6)
    v_mfma_f32_32x32x16_bf16 v[12:27], v[140:143], v[92:95], v[12:27]
    ds_read_b64_tr_b16 v[112:113], v6 offset:43008
    ds_read_b64_tr_b16 v[114:115], v6 offset:43264
    v_mfma_f32_32x32x16_bf16 v[28:43], v[140:143], v[96:99], v[28:43]
    ds_read_b64_tr_b16 v[92:93], v6 offset:44032
    ds_read_b64_tr_b16 v[94:95], v6 offset:44288
    s_waitcnt lgkmcnt(6)
    v_mfma_f32_32x32x16_bf16 v[44:59], v[140:143], v[100:103], v[44:59]
    ds_read_b64_tr_b16 v[96:97], v6 offset:45056
    ds_read_b64_tr_b16 v[98:99], v6 offset:45312
    v_mfma_f32_32x32x16_bf16 v[60:75], v[140:143], v[104:107], v[60:75]
    ds_read_b64_tr_b16 v[100:101], v6 offset:46080
    ds_read_b64_tr_b16 v[102:103], v6 offset:46336
    s_waitcnt lgkmcnt(6)
    v_mfma_f32_32x32x16_bf16 v[76:91], v[140:143], v[108:111], v[76:91]
    ds_read_b64_tr_b16 v[104:105], v6 offset:47104
    ds_read_b64_tr_b16 v[106:107], v6 offset:47360
    v_mfma_f32_32x32x16_bf16 v[12:27], v[144:147], v[112:115], v[12:27]
    s_waitcnt lgkmcnt(4)
    v_mfma_f32_32x32x16_bf16 v[28:43], v[144:147], v[92:95], v[28:43]
    s_waitcnt vmcnt(3) lgkmcnt(0)
    s_barrier
    ds_read_b128 v[116:119], v7 offset:0
    ds_read_b128 v[120:123], v8 offset:0
    ds_read_b128 v[124:127], v9 offset:0
    ds_read_b128 v[128:131], v10 offset:0
    ds_read_b64_tr_b16 v[108:109], v6 offset:0
    ds_read_b64_tr_b16 v[110:111], v6 offset:256
    ds_read_b64_tr_b16 v[112:113], v6 offset:1024
    ds_read_b64_tr_b16 v[114:115], v6 offset:1280
    v_mfma_f32_32x32x16_bf16 v[44:59], v[144:147], v[96:99], v[44:59]
    ds_read_b64_tr_b16 v[92:93], v6 offset:2048
    ds_read_b64_tr_b16 v[94:95], v6 offset:2304
    v_mfma_f32_32x32x16_bf16 v[60:75], v[144:147], v[100:103], v[60:75]
    ds_read_b64_tr_b16 v[96:97], v6 offset:3072
    ds_read_b64_tr_b16 v[98:99], v6 offset:3328
    v_mfma_f32_32x32x16_bf16 v[76:91], v[144:147], v[104:107], v[76:91]
    ds_read_b64_tr_b16 v[100:101], v6 offset:4096
    ds_read_b64_tr_b16 v[102:103], v6 offset:4352
    s_waitcnt lgkmcnt(6)
    v_mfma_f32_32x32x16_bf16 v[12:27], v[116:119], v[108:111], v[12:27]
    ds_read_b64_tr_b16 v[104:105], v6 offset:6144
    ds_read_b64_tr_b16 v[106:107], v6 offset:6400
    v_mfma_f32_32x32x16_bf16 v[28:43], v[116:119], v[112:115], v[28:43]
    ds_read_b64_tr_b16 v[108:109], v6 offset:7168
    ds_read_b64_tr_b16 v[110:111], v6 offset:7424
    s_waitcnt lgkmcnt(6)
    v_mfma_f32_32x32x16_bf16 v[44:59], v[116:119], v[92:95], v[44:59]
    ds_read_b64_tr_b16 v[112:113], v6 offset:8192
    ds_read_b64_tr_b16 v[114:115], v6 offset:8448
    v_mfma_f32_32x32x16_bf16 v[60:75], v[116:119], v[96:99], v[60:75]
    ds_read_b64_tr_b16 v[92:93], v6 offset:9216
    ds_read_b64_tr_b16 v[94:95], v6 offset:9472
    s_waitcnt lgkmcnt(6)
    v_mfma_f32_32x32x16_bf16 v[76:91], v[116:119], v[100:103], v[76:91]
    ds_read_b64_tr_b16 v[96:97], v6 offset:10240
    ds_read_b64_tr_b16 v[98:99], v6 offset:10496
    v_mfma_f32_32x32x16_bf16 v[12:27], v[120:123], v[104:107], v[12:27]
    s_waitcnt lgkmcnt(4)
    v_mfma_f32_32x32x16_bf16 v[28:43], v[120:123], v[108:111], v[28:43]
    s_waitcnt vmcnt(0) lgkmcnt(0)
    s_barrier
    ds_read_b64_tr_b16 v[100:101], v6 offset:12288
    ds_read_b64_tr_b16 v[102:103], v6 offset:12544
    ds_read_b64_tr_b16 v[104:105], v6 offset:13312
    ds_read_b64_tr_b16 v[106:107], v6 offset:13568
    v_mfma_f32_32x32x16_bf16 v[44:59], v[120:123], v[112:115], v[44:59]
    ds_read_b64_tr_b16 v[108:109], v6 offset:14336
    ds_read_b64_tr_b16 v[110:111], v6 offset:14592
    v_mfma_f32_32x32x16_bf16 v[60:75], v[120:123], v[92:95], v[60:75]
    ds_read_b64_tr_b16 v[112:113], v6 offset:15360
    ds_read_b64_tr_b16 v[114:115], v6 offset:15616
    v_mfma_f32_32x32x16_bf16 v[76:91], v[120:123], v[96:99], v[76:91]
    ds_read_b64_tr_b16 v[92:93], v6 offset:16384
    ds_read_b64_tr_b16 v[94:95], v6 offset:16640
    s_waitcnt lgkmcnt(6)
    v_mfma_f32_32x32x16_bf16 v[12:27], v[124:127], v[100:103], v[12:27]
    ds_read_b64_tr_b16 v[96:97], v6 offset:18432
    ds_read_b64_tr_b16 v[98:99], v6 offset:18688
    v_mfma_f32_32x32x16_bf16 v[28:43], v[124:127], v[104:107], v[28:43]
    ds_read_b64_tr_b16 v[100:101], v6 offset:19456
    ds_read_b64_tr_b16 v[102:103], v6 offset:19712
    s_waitcnt lgkmcnt(6)
    v_mfma_f32_32x32x16_bf16 v[44:59], v[124:127], v[108:111], v[44:59]
    ds_read_b64_tr_b16 v[104:105], v6 offset:20480
    ds_read_b64_tr_b16 v[106:107], v6 offset:20736
    v_mfma_f32_32x32x16_bf16 v[60:75], v[124:127], v[112:115], v[60:75]
    ds_read_b64_tr_b16 v[108:109], v6 offset:21504
    ds_read_b64_tr_b16 v[110:111], v6 offset:21760
    s_waitcnt lgkmcnt(6)
    v_mfma_f32_32x32x16_bf16 v[76:91], v[124:127], v[92:95], v[76:91]
    ds_read_b64_tr_b16 v[112:113], v6 offset:22528
    ds_read_b64_tr_b16 v[114:115], v6 offset:22784
    v_mfma_f32_32x32x16_bf16 v[12:27], v[128:131], v[96:99], v[12:27]
    s_waitcnt lgkmcnt(4)
    v_mfma_f32_32x32x16_bf16 v[28:43], v[128:131], v[100:103], v[28:43]
    v_mfma_f32_32x32x16_bf16 v[44:59], v[128:131], v[104:107], v[44:59]
    s_waitcnt lgkmcnt(0)
    v_mfma_f32_32x32x16_bf16 v[60:75], v[128:131], v[108:111], v[60:75]
    v_mfma_f32_32x32x16_bf16 v[76:91], v[128:131], v[112:115], v[76:91]
    s_barrier
    s_nop 4
    v_cvt_pk_bf16_f32 v92, v12, v13
    v_cvt_pk_bf16_f32 v93, v14, v15
    v_cvt_pk_bf16_f32 v94, v16, v17
    v_cvt_pk_bf16_f32 v95, v18, v19
    v_cvt_pk_bf16_f32 v96, v20, v21
    v_cvt_pk_bf16_f32 v97, v22, v23
    v_cvt_pk_bf16_f32 v98, v24, v25
    v_cvt_pk_bf16_f32 v99, v26, v27
    ds_write_b128 v184, v[92:95]
    ds_write_b128 v184, v[96:99] offset:640
    v_cvt_pk_bf16_f32 v100, v28, v29
    v_cvt_pk_bf16_f32 v101, v30, v31
    v_cvt_pk_bf16_f32 v102, v32, v33
    v_cvt_pk_bf16_f32 v103, v34, v35
    v_cvt_pk_bf16_f32 v104, v36, v37
    v_cvt_pk_bf16_f32 v105, v38, v39
    v_cvt_pk_bf16_f32 v106, v40, v41
    v_cvt_pk_bf16_f32 v107, v42, v43
    ds_write_b128 v185, v[100:103]
    ds_write_b128 v185, v[104:107] offset:640
    v_cvt_pk_bf16_f32 v108, v44, v45
    v_cvt_pk_bf16_f32 v109, v46, v47
    v_cvt_pk_bf16_f32 v110, v48, v49
    v_cvt_pk_bf16_f32 v111, v50, v51
    v_cvt_pk_bf16_f32 v112, v52, v53
    v_cvt_pk_bf16_f32 v113, v54, v55
    v_cvt_pk_bf16_f32 v114, v56, v57
    v_cvt_pk_bf16_f32 v115, v58, v59
    ds_write_b128 v186, v[108:111]
    ds_write_b128 v186, v[112:115] offset:640
    v_cvt_pk_bf16_f32 v116, v60, v61
    v_cvt_pk_bf16_f32 v117, v62, v63
    v_cvt_pk_bf16_f32 v118, v64, v65
    v_cvt_pk_bf16_f32 v119, v66, v67
    v_cvt_pk_bf16_f32 v120, v68, v69
    v_cvt_pk_bf16_f32 v121, v70, v71
    v_cvt_pk_bf16_f32 v122, v72, v73
    v_cvt_pk_bf16_f32 v123, v74, v75
    ds_write_b128 v187, v[116:119]
    ds_write_b128 v187, v[120:123] offset:640
    v_cvt_pk_bf16_f32 v124, v76, v77
    v_cvt_pk_bf16_f32 v125, v78, v79
    v_cvt_pk_bf16_f32 v126, v80, v81
    v_cvt_pk_bf16_f32 v127, v82, v83
    v_cvt_pk_bf16_f32 v128, v84, v85
    v_cvt_pk_bf16_f32 v129, v86, v87
    v_cvt_pk_bf16_f32 v130, v88, v89
    v_cvt_pk_bf16_f32 v131, v90, v91
    v_cndmask_b32 v124, v124, v190, vcc
    v_cndmask_b32 v125, v125, v190, vcc
    v_cndmask_b32 v126, v126, v190, vcc
    v_cndmask_b32 v127, v127, v190, vcc
    v_cndmask_b32 v128, v128, v190, vcc
    v_cndmask_b32 v129, v129, v190, vcc
    v_cndmask_b32 v130, v130, v190, vcc
    v_cndmask_b32 v131, v131, v190, vcc
    ds_write_b128 v188, v[124:127]
    ds_write_b128 v188, v[128:131] offset:640
    s_mul_i32 s26, s18, 10240
    v_lshlrev_b32 v182, 4, v192
    v_add_u32 v183, s26, v182
    s_lshl_b32 s26, s44, 3
    s_lshl_b32 s27, s18, 1
    s_add_u32 s26, s26, s27
    s_lshl_b32 s26, s26, 4
    s_add_u32 s26, s26, s43
    s_mul_i32 s26, s26, 5120
    s_add_u32 s26, s26, 4718592
    s_waitcnt lgkmcnt(0)
    s_barrier
    ds_read_b128 v[92:95], v183 offset:0
    ds_read_b128 v[96:99], v183 offset:1024
    ds_read_b128 v[100:103], v183 offset:2048
    ds_read_b128 v[104:107], v183 offset:3072
    ds_read_b128 v[108:111], v183 offset:4096
    ds_read_b128 v[112:115], v183 offset:5120
    ds_read_b128 v[116:119], v183 offset:6144
    ds_read_b128 v[120:123], v183 offset:7168
    ds_read_b128 v[124:127], v183 offset:8192
    ds_read_b128 v[128:131], v183 offset:9216
    s_waitcnt lgkmcnt(9)
    buffer_store_dwordx4 v[92:95], v182, s[8:11], s26 offen offset:0 sc1
    s_waitcnt lgkmcnt(8)
    buffer_store_dwordx4 v[96:99], v182, s[8:11], s26 offen offset:1024 sc1
    s_waitcnt lgkmcnt(7)
    buffer_store_dwordx4 v[100:103], v182, s[8:11], s26 offen offset:2048 sc1
    s_waitcnt lgkmcnt(6)
    buffer_store_dwordx4 v[104:107], v182, s[8:11], s26 offen offset:3072 sc1
    s_waitcnt lgkmcnt(5)
    s_add_u32 s26, s26, 4096
    buffer_store_dwordx4 v[108:111], v182, s[8:11], s26 offen offset:0 sc1
    s_add_u32 s26, s26, 77824
    s_waitcnt lgkmcnt(4)
    buffer_store_dwordx4 v[112:115], v182, s[8:11], s26 offen offset:0 sc1
    s_waitcnt lgkmcnt(3)
    buffer_store_dwordx4 v[116:119], v182, s[8:11], s26 offen offset:1024 sc1
    s_waitcnt lgkmcnt(2)
    buffer_store_dwordx4 v[120:123], v182, s[8:11], s26 offen offset:2048 sc1
    s_waitcnt lgkmcnt(1)
    buffer_store_dwordx4 v[124:127], v182, s[8:11], s26 offen offset:3072 sc1
    s_waitcnt lgkmcnt(0)
    s_add_u32 s26, s26, 4096
    buffer_store_dwordx4 v[128:131], v182, s[8:11], s26 offen offset:0 sc1
    s_add_u32 s26, s26, 77824
L_a_sig:
    s_cmp_lg_u32 s18, 0
    s_cbranch_scc1 L_a_att
    s_lshl_b32 s56, s2, 7
    s_add_u32 s56, s56, 12353536
    s_mov_b32 s3, 1
    s_atomic_add s3, s[40:41], s56 glc
    s_branch L_a_att
L_a_side:
    s_cmp_ge_u32 s2, 64
    s_cbranch_scc1 L_f_ni_8
    s_cmp_lg_u32 s18, 0
    s_cbranch_scc1 L_f_ni_8
    s_waitcnt lgkmcnt(0)
    s_mov_b32 s8, s40
    s_and_b32 s9, s41, 0xffff
    s_mov_b32 s10, 0x03000000
    s_mov_b32 s11, 0x00020000
    v_lshlrev_b32 v60, 4, v0
    v_mov_b32 v64, 0
    v_mov_b32 v65, 0
    v_mov_b32 v66, 0
    v_mov_b32 v67, 0
    s_lshr_b32 s26, s2, 2
    s_lshl_b32 s26, s26, 12
    s_add_u32 s26, s26, 12320768
    buffer_store_dwordx4 v[64:67], v60, s[8:11], s26 offen sc1
    buffer_store_dwordx4 v[64:67], v60, s[8:11], s26 offen offset:1024 sc1
    buffer_store_dwordx4 v[64:67], v60, s[8:11], s26 offen offset:2048 sc1
    buffer_store_dwordx4 v[64:67], v60, s[8:11], s26 offen offset:3072 sc1
    s_waitcnt vmcnt(0)
    s_mov_b32 s57, 1
    s_atomic_add s57, s[80:81], 0 glc
    s_waitcnt lgkmcnt(0)
L_f_ni_8:
    s_setprio 3
    s_lshl_b32 s26, s42, 2
    s_add_u32 s26, s26, s44
    s_lshl_b32 s26, s26, 3
    s_lshl_b32 s27, s43, 7
    s_add_u32 s26, s26, s27
    v_lshrrev_b32 v1, 5, v0
    v_add_u32 v1, s26, v1
    v_mul_u32_u24 v3, 1152, v1
    v_and_b32 v32, 31, v0
    v_lshlrev_b32 v4, 4, v32
    v_lshlrev_b32 v5, 2, v32
    v_add_u32 v2, v3, v4
    v_add_u32 v3, v3, v5
    s_waitcnt lgkmcnt(0)
    s_mov_b32 s12, s60
    s_and_b32 s13, s61, 0xffff
    s_mov_b32 s14, 0x00240000
    s_mov_b32 s15, 0x00020000
    s_mov_b32 s4, s76
    s_and_b32 s5, s77, 0xffff
    s_mov_b32 s6, 0x00000480
    s_mov_b32 s7, 0x00020000
    s_mov_b32 s8, s40
    s_and_b32 s9, s41, 0xffff
    s_mov_b32 s10, 0x03000000
    s_mov_b32 s11, 0x00020000
    buffer_load_dwordx4 v[8:11], v2, s[12:15], 0 offen
    buffer_load_dwordx4 v[12:15], v2, s[12:15], 0 offen offset:512
    buffer_load_dword v16, v3, s[12:15], 0 offen offset:1024
    buffer_load_dwordx4 v[20:23], v4, s[4:7], 0 offen
    buffer_load_dwordx4 v[24:27], v4, s[4:7], 0 offen offset:512
    buffer_load_dword v28, v5, s[4:7], 0 offen offset:1024
    s_mov_b32 s52, s68
    s_and_b32 s53, s69, 0xffff
    s_mov_b32 s54, 0x000a2000
    s_mov_b32 s55, 0x00020000
    v_mul_u32_u24 v60, 3641, v0
    v_lshrrev_b32 v60, 16, v60
    v_mul_u32_u24 v61, 864, v60
    v_lshl_add_u32 v61, v0, 4, v61
    v_mov_b32 v72, 0x80000000
    v_cmp_gt_u32 vcc, 12, v60
    s_nop 1
    v_cndmask_b32 v61, v72, v61, vcc
    s_mul_i32 s26, s43, 41472
    s_mul_i32 s27, s44, 288
    s_add_u32 s26, s26, s27
    buffer_load_dwordx4 v[48:51], v61, s[52:55], s26 offen
    s_add_u32 s26, s26, 13824
    buffer_load_dwordx4 v[52:55], v61, s[52:55], s26 offen
    s_add_u32 s26, s26, 13824
    buffer_load_dwordx4 v[56:59], v61, s[52:55], s26 offen
    s_add_u32 s26, s26, 13824
    v_mov_b32 v36, 0
    v_mov_b32 v37, 0
    v_mov_b32 v38, 0
    s_waitcnt vmcnt(3)
    v_lshlrev_b32 v32, 16, v8
    v_and_b32 v33, 0xffff0000, v8
    v_lshlrev_b32 v34, 16, v20
    v_and_b32 v35, 0xffff0000, v20
    v_add_f32 v36, v36, v32
    v_fmac_f32 v37, v32, v32
    v_fmac_f32 v38, v32, v34
    v_add_f32 v36, v36, v33
    v_fmac_f32 v37, v33, v33
    v_fmac_f32 v38, v33, v35
    v_lshlrev_b32 v32, 16, v9
    v_and_b32 v33, 0xffff0000, v9
    v_lshlrev_b32 v34, 16, v21
    v_and_b32 v35, 0xffff0000, v21
    v_add_f32 v36, v36, v32
    v_fmac_f32 v37, v32, v32
    v_fmac_f32 v38, v32, v34
    v_add_f32 v36, v36, v33
    v_fmac_f32 v37, v33, v33
    v_fmac_f32 v38, v33, v35
    v_lshlrev_b32 v32, 16, v10
    v_and_b32 v33, 0xffff0000, v10
    v_lshlrev_b32 v34, 16, v22
    v_and_b32 v35, 0xffff0000, v22
    v_add_f32 v36, v36, v32
    v_fmac_f32 v37, v32, v32
    v_fmac_f32 v38, v32, v34
    v_add_f32 v36, v36, v33
    v_fmac_f32 v37, v33, v33
    v_fmac_f32 v38, v33, v35
    v_lshlrev_b32 v32, 16, v11
    v_and_b32 v33, 0xffff0000, v11
    v_lshlrev_b32 v34, 16, v23
    v_and_b32 v35, 0xffff0000, v23
    v_add_f32 v36, v36, v32
    v_fmac_f32 v37, v32, v32
    v_fmac_f32 v38, v32, v34
    v_add_f32 v36, v36, v33
    v_fmac_f32 v37, v33, v33
    v_fmac_f32 v38, v33, v35
    v_lshlrev_b32 v32, 16, v12
    v_and_b32 v33, 0xffff0000, v12
    v_lshlrev_b32 v34, 16, v24
    v_and_b32 v35, 0xffff0000, v24
    v_add_f32 v36, v36, v32
    v_fmac_f32 v37, v32, v32
    v_fmac_f32 v38, v32, v34
    v_add_f32 v36, v36, v33
    v_fmac_f32 v37, v33, v33
    v_fmac_f32 v38, v33, v35
    v_lshlrev_b32 v32, 16, v13
    v_and_b32 v33, 0xffff0000, v13
    v_lshlrev_b32 v34, 16, v25
    v_and_b32 v35, 0xffff0000, v25
    v_add_f32 v36, v36, v32
    v_fmac_f32 v37, v32, v32
    v_fmac_f32 v38, v32, v34
    v_add_f32 v36, v36, v33
    v_fmac_f32 v37, v33, v33
    v_fmac_f32 v38, v33, v35
    v_lshlrev_b32 v32, 16, v14
    v_and_b32 v33, 0xffff0000, v14
    v_lshlrev_b32 v34, 16, v26
    v_and_b32 v35, 0xffff0000, v26
    v_add_f32 v36, v36, v32
    v_fmac_f32 v37, v32, v32
    v_fmac_f32 v38, v32, v34
    v_add_f32 v36, v36, v33
    v_fmac_f32 v37, v33, v33
    v_fmac_f32 v38, v33, v35
    v_lshlrev_b32 v32, 16, v15
    v_and_b32 v33, 0xffff0000, v15
    v_lshlrev_b32 v34, 16, v27
    v_and_b32 v35, 0xffff0000, v27
    v_add_f32 v36, v36, v32
    v_fmac_f32 v37, v32, v32
    v_fmac_f32 v38, v32, v34
    v_add_f32 v36, v36, v33
    v_fmac_f32 v37, v33, v33
    v_fmac_f32 v38, v33, v35
    v_lshlrev_b32 v32, 16, v16
    v_and_b32 v33, 0xffff0000, v16
    v_lshlrev_b32 v34, 16, v28
    v_and_b32 v35, 0xffff0000, v28
    v_add_f32 v36, v36, v32
    v_fmac_f32 v37, v32, v32
    v_fmac_f32 v38, v32, v34
    v_add_f32 v36, v36, v33
    v_fmac_f32 v37, v33, v33
    v_fmac_f32 v38, v33, v35
    v_add_f32_dpp v36, v36, v36 row_ror:1 row_mask:0xf bank_mask:0xf
    v_add_f32_dpp v37, v37, v37 row_ror:1 row_mask:0xf bank_mask:0xf
    v_add_f32_dpp v38, v38, v38 row_ror:1 row_mask:0xf bank_mask:0xf
    v_add_f32_dpp v36, v36, v36 row_ror:2 row_mask:0xf bank_mask:0xf
    v_add_f32_dpp v37, v37, v37 row_ror:2 row_mask:0xf bank_mask:0xf
    v_add_f32_dpp v38, v38, v38 row_ror:2 row_mask:0xf bank_mask:0xf
    v_add_f32_dpp v36, v36, v36 row_ror:4 row_mask:0xf bank_mask:0xf
    v_add_f32_dpp v37, v37, v37 row_ror:4 row_mask:0xf bank_mask:0xf
    v_add_f32_dpp v38, v38, v38 row_ror:4 row_mask:0xf bank_mask:0xf
    v_add_f32_dpp v36, v36, v36 row_ror:8 row_mask:0xf bank_mask:0xf
    v_add_f32_dpp v37, v37, v37 row_ror:8 row_mask:0xf bank_mask:0xf
    v_add_f32_dpp v38, v38, v38 row_ror:8 row_mask:0xf bank_mask:0xf
    v_mov_b32 v32, v36
    v_mov_b32 v33, v37
    v_mov_b32 v34, v38
    v_permlane16_swap_b32 v36, v32
    v_permlane16_swap_b32 v37, v33
    v_permlane16_swap_b32 v38, v34
    v_add_f32 v36, v36, v32
    v_add_f32 v37, v37, v33
    v_add_f32 v38, v38, v34
    v_mul_f32 v36, 0xbae38e39, v36
    v_mul_f32 v37, 0x3ae38e39, v37
    v_mul_f32 v38, 0xbfb8aa3b, v38
    v_fma_f32 v37, -v36, v36, v37
    v_exp_f32 v38, v38
    v_max_f32 v37, 0, v37
    v_add_f32 v37, 0x3727c5ac, v37
    v_add_f32 v38, 1.0, v38
    v_rsq_f32 v32, v37
    v_rcp_f32 v34, v38
    v_sub_f32 v35, 0, v36
    v_mul_f32 v33, v32, v36
    v_lshlrev_b32 v1, 4, v1
    s_mov_b32 s26, 12058624
    s_mov_b32 exec_lo, 1
    s_mov_b32 exec_hi, 1
    buffer_store_dwordx4 v[32:35], v1, s[8:11], s26 offen sc1
    s_mov_b64 exec, -1
    s_waitcnt vmcnt(1)
    v_lshlrev_b32 v64, 16, v48
    v_and_b32 v65, 0xffff0000, v48
    v_lshlrev_b32 v66, 16, v49
    v_and_b32 v67, 0xffff0000, v49
    v_lshlrev_b32 v68, 16, v50
    v_and_b32 v69, 0xffff0000, v50
    v_lshlrev_b32 v70, 16, v51
    v_and_b32 v71, 0xffff0000, v51
    v_lshlrev_b32 v72, 16, v52
    v_and_b32 v73, 0xffff0000, v52
    v_lshlrev_b32 v74, 16, v53
    v_and_b32 v75, 0xffff0000, v53
    v_lshlrev_b32 v76, 16, v54
    v_and_b32 v77, 0xffff0000, v54
    v_lshlrev_b32 v78, 16, v55
    v_and_b32 v79, 0xffff0000, v55
    v_add_f32 v64, v64, v72
    v_add_f32 v65, v65, v73
    v_add_f32 v66, v66, v74
    v_add_f32 v67, v67, v75
    v_add_f32 v68, v68, v76
    v_add_f32 v69, v69, v77
    v_add_f32 v70, v70, v78
    v_add_f32 v71, v71, v79
    v_lshlrev_b32 v72, 16, v56
    v_and_b32 v73, 0xffff0000, v56
    v_lshlrev_b32 v74, 16, v57
    v_and_b32 v75, 0xffff0000, v57
    v_lshlrev_b32 v76, 16, v58
    v_and_b32 v77, 0xffff0000, v58
    v_lshlrev_b32 v78, 16, v59
    v_and_b32 v79, 0xffff0000, v59
    v_add_f32 v64, v64, v72
    v_add_f32 v65, v65, v73
    v_add_f32 v66, v66, v74
    v_add_f32 v67, v67, v75
    v_add_f32 v68, v68, v76
    v_add_f32 v69, v69, v77
    v_add_f32 v70, v70, v78
    v_add_f32 v71, v71, v79
    v_lshlrev_b32 v60, 5, v0
    ds_write_b128 v60, v[64:67]
    ds_write_b128 v60, v[68:71] offset:16
    v_lshlrev_b32 v60, 2, v0
    s_waitcnt lgkmcnt(0)
    s_barrier
    ds_read_b32 v72, v60 offset:0
    ds_read_b32 v73, v60 offset:576
    ds_read_b32 v74, v60 offset:1152
    ds_read_b32 v75, v60 offset:1728
    ds_read_b32 v76, v60 offset:2304
    ds_read_b32 v77, v60 offset:2880
    ds_read_b32 v78, v60 offset:3456
    ds_read_b32 v79, v60 offset:4032
    ds_read_b32 v80, v60 offset:4608
    ds_read_b32 v81, v60 offset:5184
    ds_read_b32 v82, v60 offset:5760
    ds_read_b32 v83, v60 offset:6336
    s_waitcnt lgkmcnt(0)
    v_add_f32 v72, v72, v73
    v_add_f32 v72, v72, v74
    v_add_f32 v72, v72, v75
    v_add_f32 v72, v72, v76
    v_add_f32 v72, v72, v77
    v_add_f32 v72, v72, v78
    v_add_f32 v72, v72, v79
    v_add_f32 v72, v72, v80
    v_add_f32 v72, v72, v81
    v_add_f32 v72, v72, v82
    v_add_f32 v72, v72, v83
    v_mov_b32 v73, 0x80000000
    v_cmp_gt_u32 vcc, 0x90, v0
    s_nop 1
    v_cndmask_b32 v60, v73, v60, vcc
    s_lshl_b32 s26, s44, 4
    s_add_u32 s26, s26, s43
    s_mul_i32 s26, s26, 576
    s_add_u32 s26, s26, 12386304
    buffer_store_dword v72, v60, s[8:11], s26 offen sc1
    s_cmp_lg_u32 s18, 0
    s_cbranch_scc1 L_f_rd_9
    s_mov_b32 s57, 262144
    v_mov_b32 v91, 0
L_f_rp_10:
    global_load_dword v90, v91, s[80:81] sc1
    s_waitcnt vmcnt(0)
    v_readfirstlane_b32 s58, v90
    s_nop 1
    s_cmp_ge_u32 s58, 16
    s_cbranch_scc1 L_f_rd_9
    s_sleep 8
    s_sub_u32 s57, s57, 1
    s_cmp_gt_i32 s57, 0
    s_cbranch_scc1 L_f_rp_10
L_f_rd_9:
    s_waitcnt vmcnt(0)
    s_barrier
    s_lshl_b32 s56, s43, 7
    s_add_u32 s56, s56, 12344320
    s_lshl_b32 s59, s44, 7
    s_add_u32 s59, s59, 12346368
    s_cmp_lg_u32 s18, 0
    s_cbranch_scc1 L_f_sig_11
    s_mov_b32 s57, 1
    s_atomic_add s57, s[40:41], s56 glc
    s_waitcnt lgkmcnt(0)
L_f_sig_11:
    s_cmp_lg_u32 s18, 0
    s_cbranch_scc1 L_f_sig_12
    s_mov_b32 s57, 1
    s_atomic_add s57, s[40:41], s59 glc
    s_waitcnt lgkmcnt(0)
L_f_sig_12:
L_a_att:
    s_setprio 3
    s_mov_b64 s[24:25], s[40:41]
    v_and_b32 v1, 63, v0
    v_lshrrev_b32 v4, 6, v0
    s_and_b32 s9, s2, 7
    v_readfirstlane_b32 s8, v4
    s_lshl_b32 s9, s9, 2
    s_bfe_u32 s13, s2, 0x20003
    s_add_u32 s9, s9, s13
    s_lshr_b32 s10, s2, 5
    v_lshlrev_b32 v2, 4, v1
    v_cmp_gt_u32 vcc, 32, v1
    v_lshlrev_b32 v4, 2, v1
    v_mov_b32 v5, 0x80000000
    v_cndmask_b32 v3, v5, v4, vcc
    v_and_b32 v6, 0x7c, v4
    v_add_u32 v6, 18432, v6
    v_and_b32 v7, 0x13, v1
    v_and_b32 v4, 4, v1
    v_lshl_or_b32 v7, v4, 1, v7
    v_bfe_u32 v4, v1, 3, 1
    v_lshl_or_b32 v7, v4, 2, v7
    v_min_u32 v7, 19, v7
    v_lshrrev_b32 v4, 5, v1
    v_mul_u32_u24 v4, 320, v4
    v_lshl_add_u32 v7, v7, 4, v4
    v_add_u32 v7, 8192, v7
    v_lshrrev_b32 v4, 5, v1
    v_lshl_add_u32 v6, v4, 10, v6
    s_mul_i32 s18, s8, 5120
    s_lshl_b32 s32, s9, 16
    s_add_u32 s32, s32, 2097152
    s_mul_i32 s33, s9, 81920
    s_add_u32 s33, s33, 4710400
    s_lshl_b32 s34, s9, 13
    s_add_u32 s34, s34, 4456448
    s_add_u32 s13, s18, 0
    s_cmp_lt_u32 s13, 8192
    s_cselect_b32 s19, s32, s33
    s_movk_i32 s26, 10240
    s_cselect_b32 s26, 8192, s26
    s_add_u32 s19, s19, s13
    s_add_u32 s13, s18, 1024
    s_cmp_lt_u32 s13, 8192
    s_cselect_b32 s20, s32, s33
    s_movk_i32 s27, 10240
    s_cselect_b32 s27, 8192, s27
    s_add_u32 s20, s20, s13
    s_add_u32 s13, s18, 2048
    s_cmp_lt_u32 s13, 8192
    s_cselect_b32 s21, s32, s33
    s_movk_i32 s28, 10240
    s_cselect_b32 s28, 8192, s28
    s_add_u32 s21, s21, s13
    s_add_u32 s13, s18, 3072
    s_cmp_lt_u32 s13, 8192
    s_cselect_b32 s22, s32, s33
    s_movk_i32 s29, 10240
    s_cselect_b32 s29, 8192, s29
    s_add_u32 s22, s22, s13
    s_cmp_eq_u32 s8, 3
    s_cselect_b32 s22, s34, s22
    s_cselect_b32 s29, 1024, s29
    s_add_u32 s13, s18, 4096
    s_cmp_lt_u32 s13, 8192
    s_cselect_b32 s23, s32, s33
    s_movk_i32 s30, 10240
    s_cselect_b32 s30, 8192, s30
    s_add_u32 s23, s23, s13
    s_cmp_eq_u32 s8, 3
    s_cselect_b32 s23, 0x4000000, s23
    s_cselect_b32 s30, 0, s30
    s_mov_b32 s4, s24
    s_and_b32 s5, s25, 0xffff
    s_mov_b32 s6, 0x03000000
    s_mov_b32 s7, 0x00020000
    s_lshr_b32 s32, s2, 3
    s_lshl_b32 s32, s32, 2
    s_add_u32 s32, s32, s8
    s_and_b32 s33, s2, 3
    s_lshl_b32 s33, s33, 1
    s_bfe_u32 s34, s2, 0x10002
    s_add_u32 s33, s33, s34
    s_mul_i32 s36, s33, 5184
    s_mul_i32 s34, s32, 41
    s_add_u32 s36, s36, s34
    s_lshl_b32 s36, s36, 7
    s_add_u32 s37, s36, 5248
    s_min_u32 s37, s37, 5308416
    s_mul_i32 s38, s33, 648
    s_mul_i32 s34, s32, 6
    s_add_u32 s38, s38, s34
    s_lshl_b32 s38, s38, 7
    s_add_u32 s39, s38, 768
    s_min_u32 s39, s39, 663552
    s_bfe_u32 s35, s2, 0x10005
    s_add_u32 s35, s35, 5
    v_lshlrev_b32 v11, 7, v1
    s_lshl_b32 s13, s9, 6
    s_lshl_b32 s14, s10, 3
    s_add_u32 s13, s13, s14
    s_lshl_b32 s14, s8, 1
    s_add_u32 s13, s13, s14
    s_lshl_b32 s33, s13, 7
    s_add_u32 s33, s33, 4194304
    s_lshl_b32 s32, s13, 10
    s_mov_b32 s15, 0
    v_mov_b32 v97, 0
    v_mov_b32 v125, 0x3f803f80
    v_mov_b32 v99, 0
    v_mov_b32 v127, 0x3f803f80
    s_bfe_u32 s56, s2, 0x20001
    s_lshl_b32 s56, s56, 2
    s_bfe_u32 s57, s2, 0x20003
    s_add_u32 s56, s56, s57
    s_lshl_b32 s56, s56, 7
    s_add_u32 s56, s56, 12349440
    s_lshr_b32 s58, s2, 5
    s_lshl_b32 s58, s58, 8
    s_add_u32 s58, s58, 12344320
    s_add_u32 s59, s58, 128
    s_waitcnt vmcnt(0) lgkmcnt(0)
    s_barrier
    s_cmp_lg_u32 s8, 0
    s_cbranch_scc1 L_a_ns
    s_cmp_eq_u32 s42, 3
    s_cbranch_scc1 L_a_ns
    s_lshl_b32 s3, s44, 9
    s_add_u32 s3, s3, 12349440
    s_mov_b32 s52, 1
    s_atomic_add s52, s[40:41], s3 glc
    s_add_u32 s3, s3, 128
    s_mov_b32 s53, 1
    s_atomic_add s53, s[40:41], s3 glc
    s_add_u32 s3, s3, 128
    s_mov_b32 s54, 1
    s_atomic_add s54, s[40:41], s3 glc
    s_add_u32 s3, s3, 128
    s_mov_b32 s55, 1
    s_atomic_add s55, s[40:41], s3 glc
    s_add_u32 s3, s3, 128
L_a_ns:
    s_cmp_lg_u32 s8, 0
    s_cbranch_scc1 L_f_pw_13
    s_mov_b32 s57, 262144
L_f_pp_14:
    s_mov_b32 s45, 0
    s_atomic_add s45, s[40:41], s58 glc
    s_mov_b32 s46, 0
    s_atomic_add s46, s[40:41], s59 glc
    s_mov_b32 s47, 0
    s_atomic_add s47, s[40:41], s56 glc
    s_waitcnt lgkmcnt(0)
    s_cmp_lt_u32 s45, 16
    s_cbranch_scc1 L_f_ps_15
    s_cmp_lt_u32 s46, 16
    s_cbranch_scc1 L_f_ps_15
    s_cmp_ge_u32 s47, 48
    s_cbranch_scc1 L_f_pw_13
    s_cmp_lg_u32 s8, 0
    s_cbranch_scc1 L_f_pw_16
    s_mov_b32 s57, 262144
L_f_pp_17:
    s_mov_b32 s45, 0
    s_atomic_add s45, s[40:41], s56 glc
    s_waitcnt lgkmcnt(0)
    s_cmp_ge_u32 s45, 48
    s_cbranch_scc1 L_f_pw_16
L_f_ps_18:
    s_sleep 2
    s_sub_u32 s57, s57, 1
    s_cmp_gt_i32 s57, 0
    s_cbranch_scc1 L_f_pp_17
L_f_pw_16:
    s_branch L_f_pw_13
L_f_ps_15:
    s_sleep 2
    s_sub_u32 s57, s57, 1
    s_cmp_gt_i32 s57, 0
    s_cbranch_scc1 L_f_pp_14
L_f_pw_13:
    s_waitcnt lgkmcnt(0)
    s_barrier
    s_mov_b32 s44, s74
    s_and_b32 s45, s75, 0xffff
    s_mov_b32 s46, 0x00000000
    s_mov_b32 s47, 0x00020000
    s_mov_b32 s52, s64
    s_and_b32 s53, s65, 0xffff
    s_mov_b32 s54, 0x00000000
    s_mov_b32 s55, 0x00020000
    buffer_load_dwordx4 v[88:91], v2, s[4:7], s32 offen offset:0 sc1
    buffer_load_dword v96, v3, s[4:7], s33 offen offset:0 sc1
    buffer_load_dwordx4 v[92:95], v2, s[4:7], s32 offen offset:1024 sc1
    buffer_load_dword v98, v3, s[4:7], s33 offen offset:128 sc1
    v_and_b32 v4, 0x1f0, v2
    s_lshl_b32 s13, s10, 12
    s_lshl_b32 s14, s8, 10
    s_add_u32 s13, s13, s14
    s_add_u32 s13, s13, 12058624
    buffer_load_dword v14, v4, s[4:7], s13 offen offset:8 sc1
    buffer_load_dword v15, v4, s[4:7], s13 offen offset:520 sc1
L_ma_main:
    s_mov_b32 s11, s10
    s_mov_b32 s16, s18
    s_mov_b32 s17, 0
    s_mul_i32 s31, s11, s26
    s_add_u32 m0, s16, 0
    s_add_u32 s31, s31, s19
    buffer_load_dwordx4 v2, s[4:7], s31 offen sc1 lds
    s_mul_i32 s31, s11, s27
    s_add_u32 m0, s16, 1024
    s_add_u32 s31, s31, s20
    buffer_load_dwordx4 v2, s[4:7], s31 offen sc1 lds
    s_mul_i32 s31, s11, s28
    s_add_u32 m0, s16, 2048
    s_add_u32 s31, s31, s21
    buffer_load_dwordx4 v2, s[4:7], s31 offen sc1 lds
    s_mul_i32 s31, s11, s29
    s_add_u32 m0, s16, 3072
    s_add_u32 s31, s31, s22
    buffer_load_dwordx4 v2, s[4:7], s31 offen sc1 lds
    s_mul_i32 s31, s11, s30
    s_add_u32 m0, s16, 4096
    s_add_u32 s31, s31, s23
    buffer_load_dwordx4 v2, s[4:7], s31 offen sc1 lds
    s_add_u32 s11, s11, 1
    s_and_b32 s11, s11, 7
    s_add_u32 s16, s16, 20480
    s_cmp_ge_u32 s16, 61440
    s_cselect_b32 s16, s18, s16
    s_mul_i32 s31, s11, s26
    s_add_u32 m0, s16, 0
    s_add_u32 s31, s31, s19
    buffer_load_dwordx4 v2, s[4:7], s31 offen sc1 lds
    s_mul_i32 s31, s11, s27
    s_add_u32 m0, s16, 1024
    s_add_u32 s31, s31, s20
    buffer_load_dwordx4 v2, s[4:7], s31 offen sc1 lds
    s_mul_i32 s31, s11, s28
    s_add_u32 m0, s16, 2048
    s_add_u32 s31, s31, s21
    buffer_load_dwordx4 v2, s[4:7], s31 offen sc1 lds
    s_mul_i32 s31, s11, s29
    s_add_u32 m0, s16, 3072
    s_add_u32 s31, s31, s22
    buffer_load_dwordx4 v2, s[4:7], s31 offen sc1 lds
    s_mul_i32 s31, s11, s30
    s_add_u32 m0, s16, 4096
    s_add_u32 s31, s31, s23
    buffer_load_dwordx4 v2, s[4:7], s31 offen sc1 lds
    s_add_u32 s11, s11, 1
    s_and_b32 s11, s11, 7
    s_add_u32 s16, s16, 20480
    s_cmp_ge_u32 s16, 61440
    s_cselect_b32 s16, s18, s16
    s_cmp_lg_u32 s8, 3
    s_cbranch_scc1 L_ma_nf2
    s_lshl_b32 s13, s2, 7
    s_add_u32 s13, s13, 12353536
    s_mov_b32 s14, 2
    s_atomic_add s14, s[24:25], s13 glc
    s_waitcnt lgkmcnt(0)
L_ma_nf2:
    v_mov_b32 v16, 0
    v_mov_b32 v17, 0
    v_mov_b32 v18, 0
    v_mov_b32 v19, 0
    v_mov_b32 v20, 0
    v_mov_b32 v21, 0
    v_mov_b32 v22, 0
    v_mov_b32 v23, 0
    v_mov_b32 v24, 0
    v_mov_b32 v25, 0
    v_mov_b32 v26, 0
    v_mov_b32 v27, 0
    v_mov_b32 v28, 0
    v_mov_b32 v29, 0
    v_mov_b32 v30, 0
    v_mov_b32 v31, 0
    v_mov_b32 v32, 0
    v_mov_b32 v33, 0
    v_mov_b32 v34, 0
    v_mov_b32 v35, 0
    v_mov_b32 v36, 0
    v_mov_b32 v37, 0
    v_mov_b32 v38, 0
    v_mov_b32 v39, 0
    v_mov_b32 v40, 0
    v_mov_b32 v41, 0
    v_mov_b32 v42, 0
    v_mov_b32 v43, 0
    v_mov_b32 v44, 0
    v_mov_b32 v45, 0
    v_mov_b32 v46, 0
    v_mov_b32 v47, 0
    v_mov_b32 v84, 0
    v_mov_b32 v120, 0
    v_mov_b32 v85, 0
    v_mov_b32 v121, 0
    v_mov_b32 v86, 0
    v_mov_b32 v122, 0
    v_mov_b32 v87, 0
    v_mov_b32 v123, 0
    v_mov_b32 v4, 61440
    v_mov_b32 v5, 0
    ds_write_b32 v4, v5
    v_add_u32 v8, s17, v2
    v_add_u32 v9, s17, v6
    v_add_u32 v10, s17, v7
    s_add_u32 s17, s17, 20480
    s_cmp_eq_u32 s17, 61440
    s_cselect_b32 s17, 0, s17
    s_waitcnt vmcnt(5) lgkmcnt(0)
    s_barrier
    ds_read_b128 v[100:103], v8 offset:0
    ds_read_b32 v124, v9 offset:0
    ds_read_b128 v[108:111], v10 offset:0
    ds_read_b128 v[112:115], v10 offset:640
    s_mov_b32 s12, 8
    s_waitcnt lgkmcnt(2)
    v_mfma_f32_32x32x16_bf16 v[48:63], v[100:103], v[88:91], 0
    v_mfma_f32_32x32x8_bf16 v[48:63], v[124:125], v[96:97], v[48:63]
    s_setprio 1
    s_nop 7
    .p2align 3
L_ma_loop:
    v_mfma_f32_32x32x16_bf16 v[64:79], v[100:103], v[92:95], 0
    ds_read_b128 v[104:107], v8 offset:1024
    ds_read_b32 v126, v9 offset:128
    v_exp_f32 v48, v48
    v_exp_f32 v49, v49
    v_exp_f32 v50, v50
    v_exp_f32 v51, v51
    v_cvt_pk_bf16_f32 v80, v48, v49
    v_cvt_pk_bf16_f32 v81, v50, v51
    v_mfma_f32_32x32x16_bf16 v[32:47], v[120:123], v[84:87], v[32:47]
    s_setprio 3
    s_mul_i32 s31, s11, s26
    s_add_u32 m0, s16, 0
    s_add_u32 s31, s31, s19
    buffer_load_dwordx4 v2, s[4:7], s31 offen sc1 lds
    s_setprio 1
    v_exp_f32 v52, v52
    v_exp_f32 v53, v53
    v_exp_f32 v54, v54
    v_exp_f32 v55, v55
    v_cvt_pk_bf16_f32 v82, v52, v53
    v_cvt_pk_bf16_f32 v83, v54, v55
    v_mfma_f32_32x32x8_bf16 v[64:79], v[124:125], v[98:99], v[64:79]
    v_exp_f32 v56, v56
    v_exp_f32 v57, v57
    v_exp_f32 v58, v58
    v_exp_f32 v59, v59
    v_cvt_pk_bf16_f32 v84, v56, v57
    v_cvt_pk_bf16_f32 v85, v58, v59
    s_waitcnt lgkmcnt(2)
    v_mfma_f32_32x32x16_bf16 v[16:31], v[108:111], v[80:83], v[16:31]
    v_exp_f32 v60, v60
    v_exp_f32 v61, v61
    v_exp_f32 v62, v62
    v_exp_f32 v63, v63
    v_cvt_pk_bf16_f32 v86, v60, v61
    v_cvt_pk_bf16_f32 v87, v62, v63
    s_waitcnt lgkmcnt(0)
    v_mfma_f32_32x32x16_bf16 v[48:63], v[104:107], v[88:91], 0
    ds_read_b128 v[116:119], v10 offset:1280
    ds_read_b128 v[120:123], v10 offset:1920
    v_exp_f32 v64, v64
    v_exp_f32 v65, v65
    v_exp_f32 v66, v66
    v_exp_f32 v67, v67
    v_cvt_pk_bf16_f32 v80, v64, v65
    v_cvt_pk_bf16_f32 v81, v66, v67
    v_mfma_f32_32x32x16_bf16 v[16:31], v[112:115], v[84:87], v[16:31]
    v_exp_f32 v68, v68
    v_exp_f32 v69, v69
    v_exp_f32 v70, v70
    v_exp_f32 v71, v71
    v_cvt_pk_bf16_f32 v82, v68, v69
    v_cvt_pk_bf16_f32 v83, v70, v71
    v_mfma_f32_32x32x8_bf16 v[48:63], v[126:127], v[96:97], v[48:63]
    v_exp_f32 v72, v72
    v_exp_f32 v73, v73
    v_exp_f32 v74, v74
    v_exp_f32 v75, v75
    v_cvt_pk_bf16_f32 v84, v72, v73
    v_cvt_pk_bf16_f32 v85, v74, v75
    v_mfma_f32_32x32x16_bf16 v[32:47], v[108:111], v[80:83], v[32:47]
    v_exp_f32 v76, v76
    v_exp_f32 v77, v77
    v_exp_f32 v78, v78
    v_exp_f32 v79, v79
    v_cvt_pk_bf16_f32 v86, v76, v77
    v_cvt_pk_bf16_f32 v87, v78, v79
    v_mfma_f32_32x32x16_bf16 v[64:79], v[104:107], v[92:95], 0
    ds_read_b128 v[100:103], v8 offset:2048
    ds_read_b32 v124, v9 offset:256
    v_exp_f32 v48, v48
    v_exp_f32 v49, v49
    v_exp_f32 v50, v50
    v_exp_f32 v51, v51
    v_cvt_pk_bf16_f32 v80, v48, v49
    v_cvt_pk_bf16_f32 v81, v50, v51
    v_mfma_f32_32x32x16_bf16 v[32:47], v[112:115], v[84:87], v[32:47]
    s_setprio 3
    s_mul_i32 s31, s11, s27
    s_add_u32 m0, s16, 1024
    s_add_u32 s31, s31, s20
    buffer_load_dwordx4 v2, s[4:7], s31 offen sc1 lds
    s_setprio 1
    v_exp_f32 v52, v52
    v_exp_f32 v53, v53
    v_exp_f32 v54, v54
    v_exp_f32 v55, v55
    v_cvt_pk_bf16_f32 v82, v52, v53
    v_cvt_pk_bf16_f32 v83, v54, v55
    v_mfma_f32_32x32x8_bf16 v[64:79], v[126:127], v[98:99], v[64:79]
    v_exp_f32 v56, v56
    v_exp_f32 v57, v57
    v_exp_f32 v58, v58
    v_exp_f32 v59, v59
    v_cvt_pk_bf16_f32 v84, v56, v57
    v_cvt_pk_bf16_f32 v85, v58, v59
    s_waitcnt lgkmcnt(2)
    v_mfma_f32_32x32x16_bf16 v[16:31], v[116:119], v[80:83], v[16:31]
    v_exp_f32 v60, v60
    v_exp_f32 v61, v61
    v_exp_f32 v62, v62
    v_exp_f32 v63, v63
    v_cvt_pk_bf16_f32 v86, v60, v61
    v_cvt_pk_bf16_f32 v87, v62, v63
    s_waitcnt lgkmcnt(0)
    v_mfma_f32_32x32x16_bf16 v[48:63], v[100:103], v[88:91], 0
    ds_read_b128 v[108:111], v10 offset:2560
    ds_read_b128 v[112:115], v10 offset:3200
    v_exp_f32 v64, v64
    v_exp_f32 v65, v65
    v_exp_f32 v66, v66
    v_exp_f32 v67, v67
    v_cvt_pk_bf16_f32 v80, v64, v65
    v_cvt_pk_bf16_f32 v81, v66, v67
    v_mfma_f32_32x32x16_bf16 v[16:31], v[120:123], v[84:87], v[16:31]
    v_exp_f32 v68, v68
    v_exp_f32 v69, v69
    v_exp_f32 v70, v70
    v_exp_f32 v71, v71
    v_cvt_pk_bf16_f32 v82, v68, v69
    v_cvt_pk_bf16_f32 v83, v70, v71
    v_mfma_f32_32x32x8_bf16 v[48:63], v[124:125], v[96:97], v[48:63]
    v_exp_f32 v72, v72
    v_exp_f32 v73, v73
    v_exp_f32 v74, v74
    v_exp_f32 v75, v75
    v_cvt_pk_bf16_f32 v84, v72, v73
    v_cvt_pk_bf16_f32 v85, v74, v75
    v_mfma_f32_32x32x16_bf16 v[32:47], v[116:119], v[80:83], v[32:47]
    v_exp_f32 v76, v76
    v_exp_f32 v77, v77
    v_exp_f32 v78, v78
    v_exp_f32 v79, v79
    v_cvt_pk_bf16_f32 v86, v76, v77
    v_cvt_pk_bf16_f32 v87, v78, v79
    v_mfma_f32_32x32x16_bf16 v[64:79], v[100:103], v[92:95], 0
    ds_read_b128 v[104:107], v8 offset:3072
    ds_read_b32 v126, v9 offset:384
    v_exp_f32 v48, v48
    v_exp_f32 v49, v49
    v_exp_f32 v50, v50
    v_exp_f32 v51, v51
    v_cvt_pk_bf16_f32 v80, v48, v49
    v_cvt_pk_bf16_f32 v81, v50, v51
    v_mfma_f32_32x32x16_bf16 v[32:47], v[120:123], v[84:87], v[32:47]
    s_setprio 3
    s_mul_i32 s31, s11, s28
    s_add_u32 m0, s16, 2048
    s_add_u32 s31, s31, s21
    buffer_load_dwordx4 v2, s[4:7], s31 offen sc1 lds
    s_setprio 1
    v_exp_f32 v52, v52
    v_exp_f32 v53, v53
    v_exp_f32 v54, v54
    v_exp_f32 v55, v55
    v_cvt_pk_bf16_f32 v82, v52, v53
    v_cvt_pk_bf16_f32 v83, v54, v55
    v_mfma_f32_32x32x8_bf16 v[64:79], v[124:125], v[98:99], v[64:79]
    v_exp_f32 v56, v56
    v_exp_f32 v57, v57
    v_exp_f32 v58, v58
    v_exp_f32 v59, v59
    v_cvt_pk_bf16_f32 v84, v56, v57
    v_cvt_pk_bf16_f32 v85, v58, v59
    s_waitcnt lgkmcnt(2)
    v_mfma_f32_32x32x16_bf16 v[16:31], v[108:111], v[80:83], v[16:31]
    v_exp_f32 v60, v60
    v_exp_f32 v61, v61
    v_exp_f32 v62, v62
    v_exp_f32 v63, v63
    v_cvt_pk_bf16_f32 v86, v60, v61
    v_cvt_pk_bf16_f32 v87, v62, v63
    s_waitcnt lgkmcnt(0)
    v_mfma_f32_32x32x16_bf16 v[48:63], v[104:107], v[88:91], 0
    ds_read_b128 v[116:119], v10 offset:3840
    ds_read_b128 v[120:123], v10 offset:4480
    v_exp_f32 v64, v64
    v_exp_f32 v65, v65
    v_exp_f32 v66, v66
    v_exp_f32 v67, v67
    v_cvt_pk_bf16_f32 v80, v64, v65
    v_cvt_pk_bf16_f32 v81, v66, v67
    v_mfma_f32_32x32x16_bf16 v[16:31], v[112:115], v[84:87], v[16:31]
    v_exp_f32 v68, v68
    v_exp_f32 v69, v69
    v_exp_f32 v70, v70
    v_exp_f32 v71, v71
    v_cvt_pk_bf16_f32 v82, v68, v69
    v_cvt_pk_bf16_f32 v83, v70, v71
    v_mfma_f32_32x32x8_bf16 v[48:63], v[126:127], v[96:97], v[48:63]
    v_exp_f32 v72, v72
    v_exp_f32 v73, v73
    v_exp_f32 v74, v74
    v_exp_f32 v75, v75
    v_cvt_pk_bf16_f32 v84, v72, v73
    v_cvt_pk_bf16_f32 v85, v74, v75
    v_mfma_f32_32x32x16_bf16 v[32:47], v[108:111], v[80:83], v[32:47]
    v_exp_f32 v76, v76
    v_exp_f32 v77, v77
    v_exp_f32 v78, v78
    v_exp_f32 v79, v79
    v_cvt_pk_bf16_f32 v86, v76, v77
    v_cvt_pk_bf16_f32 v87, v78, v79
    v_mfma_f32_32x32x16_bf16 v[64:79], v[104:107], v[92:95], 0
    ds_read_b128 v[100:103], v8 offset:4096
    ds_read_b32 v124, v9 offset:512
    v_exp_f32 v48, v48
    v_exp_f32 v49, v49
    v_exp_f32 v50, v50
    v_exp_f32 v51, v51
    v_cvt_pk_bf16_f32 v80, v48, v49
    v_cvt_pk_bf16_f32 v81, v50, v51
    v_mfma_f32_32x32x16_bf16 v[32:47], v[112:115], v[84:87], v[32:47]
    s_setprio 3
    s_mul_i32 s31, s11, s29
    s_add_u32 m0, s16, 3072
    s_add_u32 s31, s31, s22
    buffer_load_dwordx4 v2, s[4:7], s31 offen sc1 lds
    s_setprio 1
    v_exp_f32 v52, v52
    v_exp_f32 v53, v53
    v_exp_f32 v54, v54
    v_exp_f32 v55, v55
    v_cvt_pk_bf16_f32 v82, v52, v53
    v_cvt_pk_bf16_f32 v83, v54, v55
    v_mfma_f32_32x32x8_bf16 v[64:79], v[126:127], v[98:99], v[64:79]
    v_exp_f32 v56, v56
    v_exp_f32 v57, v57
    v_exp_f32 v58, v58
    v_exp_f32 v59, v59
    v_cvt_pk_bf16_f32 v84, v56, v57
    v_cvt_pk_bf16_f32 v85, v58, v59
    s_waitcnt lgkmcnt(2)
    v_mfma_f32_32x32x16_bf16 v[16:31], v[116:119], v[80:83], v[16:31]
    v_exp_f32 v60, v60
    v_exp_f32 v61, v61
    v_exp_f32 v62, v62
    v_exp_f32 v63, v63
    v_cvt_pk_bf16_f32 v86, v60, v61
    v_cvt_pk_bf16_f32 v87, v62, v63
    s_waitcnt lgkmcnt(0)
    v_mfma_f32_32x32x16_bf16 v[48:63], v[100:103], v[88:91], 0
    ds_read_b128 v[108:111], v10 offset:5120
    ds_read_b128 v[112:115], v10 offset:5760
    v_exp_f32 v64, v64
    v_exp_f32 v65, v65
    v_exp_f32 v66, v66
    v_exp_f32 v67, v67
    v_cvt_pk_bf16_f32 v80, v64, v65
    v_cvt_pk_bf16_f32 v81, v66, v67
    v_mfma_f32_32x32x16_bf16 v[16:31], v[120:123], v[84:87], v[16:31]
    v_exp_f32 v68, v68
    v_exp_f32 v69, v69
    v_exp_f32 v70, v70
    v_exp_f32 v71, v71
    v_cvt_pk_bf16_f32 v82, v68, v69
    v_cvt_pk_bf16_f32 v83, v70, v71
    v_mfma_f32_32x32x8_bf16 v[48:63], v[124:125], v[96:97], v[48:63]
    v_exp_f32 v72, v72
    v_exp_f32 v73, v73
    v_exp_f32 v74, v74
    v_exp_f32 v75, v75
    v_cvt_pk_bf16_f32 v84, v72, v73
    v_cvt_pk_bf16_f32 v85, v74, v75
    v_mfma_f32_32x32x16_bf16 v[32:47], v[116:119], v[80:83], v[32:47]
    v_exp_f32 v76, v76
    v_exp_f32 v77, v77
    v_exp_f32 v78, v78
    v_exp_f32 v79, v79
    v_cvt_pk_bf16_f32 v86, v76, v77
    v_cvt_pk_bf16_f32 v87, v78, v79
    v_mfma_f32_32x32x16_bf16 v[64:79], v[100:103], v[92:95], 0
    ds_read_b128 v[104:107], v8 offset:5120
    ds_read_b32 v126, v9 offset:640
    v_exp_f32 v48, v48
    v_exp_f32 v49, v49
    v_exp_f32 v50, v50
    v_exp_f32 v51, v51
    v_cvt_pk_bf16_f32 v80, v48, v49
    v_cvt_pk_bf16_f32 v81, v50, v51
    v_mfma_f32_32x32x16_bf16 v[32:47], v[120:123], v[84:87], v[32:47]
    s_setprio 3
    s_mul_i32 s31, s11, s30
    s_add_u32 m0, s16, 4096
    s_add_u32 s31, s31, s23
    buffer_load_dwordx4 v2, s[4:7], s31 offen sc1 lds
    s_setprio 1
    v_exp_f32 v52, v52
    v_exp_f32 v53, v53
    v_exp_f32 v54, v54
    v_exp_f32 v55, v55
    v_cvt_pk_bf16_f32 v82, v52, v53
    v_cvt_pk_bf16_f32 v83, v54, v55
    v_mfma_f32_32x32x8_bf16 v[64:79], v[124:125], v[98:99], v[64:79]
    v_exp_f32 v56, v56
    v_exp_f32 v57, v57
    v_exp_f32 v58, v58
    v_exp_f32 v59, v59
    v_cvt_pk_bf16_f32 v84, v56, v57
    v_cvt_pk_bf16_f32 v85, v58, v59
    s_waitcnt lgkmcnt(2)
    v_mfma_f32_32x32x16_bf16 v[16:31], v[108:111], v[80:83], v[16:31]
    v_exp_f32 v60, v60
    v_exp_f32 v61, v61
    v_exp_f32 v62, v62
    v_exp_f32 v63, v63
    v_cvt_pk_bf16_f32 v86, v60, v61
    v_cvt_pk_bf16_f32 v87, v62, v63
    s_waitcnt lgkmcnt(0)
    v_mfma_f32_32x32x16_bf16 v[48:63], v[104:107], v[88:91], 0
    ds_read_b128 v[116:119], v10 offset:6400
    ds_read_b128 v[120:123], v10 offset:7040
    v_exp_f32 v64, v64
    v_exp_f32 v65, v65
    v_exp_f32 v66, v66
    v_exp_f32 v67, v67
    v_cvt_pk_bf16_f32 v80, v64, v65
    v_cvt_pk_bf16_f32 v81, v66, v67
    v_mfma_f32_32x32x16_bf16 v[16:31], v[112:115], v[84:87], v[16:31]
    v_exp_f32 v68, v68
    v_exp_f32 v69, v69
    v_exp_f32 v70, v70
    v_exp_f32 v71, v71
    v_cvt_pk_bf16_f32 v82, v68, v69
    v_cvt_pk_bf16_f32 v83, v70, v71
    v_mfma_f32_32x32x8_bf16 v[48:63], v[126:127], v[96:97], v[48:63]
    v_exp_f32 v72, v72
    v_exp_f32 v73, v73
    v_exp_f32 v74, v74
    v_exp_f32 v75, v75
    v_cvt_pk_bf16_f32 v84, v72, v73
    v_cvt_pk_bf16_f32 v85, v74, v75
    v_mfma_f32_32x32x16_bf16 v[32:47], v[108:111], v[80:83], v[32:47]
    v_exp_f32 v76, v76
    v_exp_f32 v77, v77
    v_exp_f32 v78, v78
    v_exp_f32 v79, v79
    v_cvt_pk_bf16_f32 v86, v76, v77
    v_cvt_pk_bf16_f32 v87, v78, v79
    v_mfma_f32_32x32x16_bf16 v[64:79], v[104:107], v[92:95], 0
    ds_read_b128 v[100:103], v8 offset:6144
    ds_read_b32 v124, v9 offset:768
    v_exp_f32 v48, v48
    v_exp_f32 v49, v49
    v_exp_f32 v50, v50
    v_exp_f32 v51, v51
    v_cvt_pk_bf16_f32 v80, v48, v49
    v_cvt_pk_bf16_f32 v81, v50, v51
    v_mfma_f32_32x32x16_bf16 v[32:47], v[112:115], v[84:87], v[32:47]
    s_setprio 3
    s_cmp_eq_u32 s12, s35
    s_cselect_b32 s46, s37, 0
    s_cselect_b32 s54, s39, 0
    buffer_load_dword v12, v11, s[44:47], s36 offen
    s_setprio 1
    v_exp_f32 v52, v52
    v_exp_f32 v53, v53
    v_exp_f32 v54, v54
    v_exp_f32 v55, v55
    v_cvt_pk_bf16_f32 v82, v52, v53
    v_cvt_pk_bf16_f32 v83, v54, v55
    v_mfma_f32_32x32x8_bf16 v[64:79], v[126:127], v[98:99], v[64:79]
    v_exp_f32 v56, v56
    v_exp_f32 v57, v57
    v_exp_f32 v58, v58
    v_exp_f32 v59, v59
    v_cvt_pk_bf16_f32 v84, v56, v57
    v_cvt_pk_bf16_f32 v85, v58, v59
    s_waitcnt lgkmcnt(2)
    v_mfma_f32_32x32x16_bf16 v[16:31], v[116:119], v[80:83], v[16:31]
    v_exp_f32 v60, v60
    v_exp_f32 v61, v61
    v_exp_f32 v62, v62
    v_exp_f32 v63, v63
    v_cvt_pk_bf16_f32 v86, v60, v61
    v_cvt_pk_bf16_f32 v87, v62, v63
    s_waitcnt lgkmcnt(0)
    v_mfma_f32_32x32x16_bf16 v[48:63], v[100:103], v[88:91], 0
    ds_read_b128 v[108:111], v10 offset:7680
    ds_read_b128 v[112:115], v10 offset:8320
    v_exp_f32 v64, v64
    v_exp_f32 v65, v65
    v_exp_f32 v66, v66
    v_exp_f32 v67, v67
    v_cvt_pk_bf16_f32 v80, v64, v65
    v_cvt_pk_bf16_f32 v81, v66, v67
    v_mfma_f32_32x32x16_bf16 v[16:31], v[120:123], v[84:87], v[16:31]
    v_exp_f32 v68, v68
    v_exp_f32 v69, v69
    v_exp_f32 v70, v70
    v_exp_f32 v71, v71
    v_cvt_pk_bf16_f32 v82, v68, v69
    v_cvt_pk_bf16_f32 v83, v70, v71
    v_mfma_f32_32x32x8_bf16 v[48:63], v[124:125], v[96:97], v[48:63]
    v_exp_f32 v72, v72
    v_exp_f32 v73, v73
    v_exp_f32 v74, v74
    v_exp_f32 v75, v75
    v_cvt_pk_bf16_f32 v84, v72, v73
    v_cvt_pk_bf16_f32 v85, v74, v75
    v_mfma_f32_32x32x16_bf16 v[32:47], v[116:119], v[80:83], v[32:47]
    v_exp_f32 v76, v76
    v_exp_f32 v77, v77
    v_exp_f32 v78, v78
    v_exp_f32 v79, v79
    v_cvt_pk_bf16_f32 v86, v76, v77
    v_cvt_pk_bf16_f32 v87, v78, v79
    v_mfma_f32_32x32x16_bf16 v[64:79], v[100:103], v[92:95], 0
    ds_read_b128 v[104:107], v8 offset:7168
    ds_read_b32 v126, v9 offset:896
    v_exp_f32 v48, v48
    v_exp_f32 v49, v49
    v_exp_f32 v50, v50
    v_exp_f32 v51, v51
    v_cvt_pk_bf16_f32 v80, v48, v49
    v_cvt_pk_bf16_f32 v81, v50, v51
    v_mfma_f32_32x32x16_bf16 v[32:47], v[120:123], v[84:87], v[32:47]
    s_setprio 3
    buffer_load_dword v12, v11, s[52:55], s38 offen
    s_setprio 1
    v_exp_f32 v52, v52
    v_exp_f32 v53, v53
    v_exp_f32 v54, v54
    v_exp_f32 v55, v55
    v_cvt_pk_bf16_f32 v82, v52, v53
    v_cvt_pk_bf16_f32 v83, v54, v55
    v_mfma_f32_32x32x8_bf16 v[64:79], v[124:125], v[98:99], v[64:79]
    v_exp_f32 v56, v56
    v_exp_f32 v57, v57
    v_exp_f32 v58, v58
    v_exp_f32 v59, v59
    v_cvt_pk_bf16_f32 v84, v56, v57
    v_cvt_pk_bf16_f32 v85, v58, v59
    s_waitcnt lgkmcnt(2)
    v_mfma_f32_32x32x16_bf16 v[16:31], v[108:111], v[80:83], v[16:31]
    v_exp_f32 v60, v60
    v_exp_f32 v61, v61
    v_exp_f32 v62, v62
    v_exp_f32 v63, v63
    v_cvt_pk_bf16_f32 v86, v60, v61
    v_cvt_pk_bf16_f32 v87, v62, v63
    s_waitcnt lgkmcnt(0)
    v_mfma_f32_32x32x16_bf16 v[48:63], v[104:107], v[88:91], 0
    ds_read_b128 v[116:119], v10 offset:8960
    ds_read_b128 v[120:123], v10 offset:9600
    v_exp_f32 v64, v64
    v_exp_f32 v65, v65
    v_exp_f32 v66, v66
    v_exp_f32 v67, v67
    v_cvt_pk_bf16_f32 v80, v64, v65
    v_cvt_pk_bf16_f32 v81, v66, v67
    v_mfma_f32_32x32x16_bf16 v[16:31], v[112:115], v[84:87], v[16:31]
    v_exp_f32 v68, v68
    v_exp_f32 v69, v69
    v_exp_f32 v70, v70
    v_exp_f32 v71, v71
    v_cvt_pk_bf16_f32 v82, v68, v69
    v_cvt_pk_bf16_f32 v83, v70, v71
    v_mfma_f32_32x32x8_bf16 v[48:63], v[126:127], v[96:97], v[48:63]
    s_add_u32 s11, s11, 1
    s_and_b32 s11, s11, 7
    s_add_u32 s16, s16, 20480
    s_cmp_ge_u32 s16, 61440
    s_cselect_b32 s16, s18, s16
    v_exp_f32 v72, v72
    v_exp_f32 v73, v73
    v_exp_f32 v74, v74
    v_exp_f32 v75, v75
    v_cvt_pk_bf16_f32 v84, v72, v73
    v_cvt_pk_bf16_f32 v85, v74, v75
    v_mfma_f32_32x32x16_bf16 v[32:47], v[108:111], v[80:83], v[32:47]
    v_exp_f32 v76, v76
    v_exp_f32 v77, v77
    v_exp_f32 v78, v78
    v_exp_f32 v79, v79
    v_cvt_pk_bf16_f32 v86, v76, v77
    v_cvt_pk_bf16_f32 v87, v78, v79
    v_mfma_f32_32x32x16_bf16 v[64:79], v[104:107], v[92:95], 0
    v_add_u32 v8, s17, v2
    v_add_u32 v9, s17, v6
    s_waitcnt vmcnt(7) lgkmcnt(0)
    s_barrier
    ds_read_b128 v[100:103], v8 offset:0
    ds_read_b32 v124, v9 offset:0
    v_exp_f32 v48, v48
    v_exp_f32 v49, v49
    v_exp_f32 v50, v50
    v_exp_f32 v51, v51
    v_cvt_pk_bf16_f32 v80, v48, v49
    v_cvt_pk_bf16_f32 v81, v50, v51
    v_mfma_f32_32x32x16_bf16 v[32:47], v[112:115], v[84:87], v[32:47]
    v_exp_f32 v52, v52
    v_exp_f32 v53, v53
    v_exp_f32 v54, v54
    v_exp_f32 v55, v55
    v_cvt_pk_bf16_f32 v82, v52, v53
    v_cvt_pk_bf16_f32 v83, v54, v55
    v_mfma_f32_32x32x8_bf16 v[64:79], v[126:127], v[98:99], v[64:79]
    v_exp_f32 v56, v56
    v_exp_f32 v57, v57
    v_exp_f32 v58, v58
    v_exp_f32 v59, v59
    v_cvt_pk_bf16_f32 v84, v56, v57
    v_cvt_pk_bf16_f32 v85, v58, v59
    v_mfma_f32_32x32x16_bf16 v[16:31], v[116:119], v[80:83], v[16:31]
    v_exp_f32 v60, v60
    v_exp_f32 v61, v61
    v_exp_f32 v62, v62
    v_exp_f32 v63, v63
    v_cvt_pk_bf16_f32 v86, v60, v61
    v_cvt_pk_bf16_f32 v87, v62, v63
    s_waitcnt lgkmcnt(0)
    v_mfma_f32_32x32x16_bf16 v[48:63], v[100:103], v[88:91], 0
    v_add_u32 v10, s17, v7
    s_add_u32 s17, s17, 20480
    s_cmp_eq_u32 s17, 61440
    s_cselect_b32 s17, 0, s17
    ds_read_b128 v[108:111], v10 offset:0
    ds_read_b128 v[112:115], v10 offset:640
    v_exp_f32 v64, v64
    v_exp_f32 v65, v65
    v_exp_f32 v66, v66
    v_exp_f32 v67, v67
    v_cvt_pk_bf16_f32 v80, v64, v65
    v_cvt_pk_bf16_f32 v81, v66, v67
    v_mfma_f32_32x32x16_bf16 v[16:31], v[120:123], v[84:87], v[16:31]
    v_exp_f32 v68, v68
    v_exp_f32 v69, v69
    v_exp_f32 v70, v70
    v_exp_f32 v71, v71
    v_cvt_pk_bf16_f32 v82, v68, v69
    v_cvt_pk_bf16_f32 v83, v70, v71
    v_mfma_f32_32x32x8_bf16 v[48:63], v[124:125], v[96:97], v[48:63]
    v_exp_f32 v72, v72
    v_exp_f32 v73, v73
    v_exp_f32 v74, v74
    v_exp_f32 v75, v75
    v_cvt_pk_bf16_f32 v84, v72, v73
    v_cvt_pk_bf16_f32 v85, v74, v75
    v_mfma_f32_32x32x16_bf16 v[32:47], v[116:119], v[80:83], v[32:47]
    s_sub_u32 s12, s12, 1
    s_cmp_lg_u32 s12, 0
    v_exp_f32 v76, v76
    v_exp_f32 v77, v77
    v_exp_f32 v78, v78
    v_exp_f32 v79, v79
    v_cvt_pk_bf16_f32 v86, v76, v77
    v_cvt_pk_bf16_f32 v87, v78, v79
    s_cbranch_scc1 L_ma_loop
    s_nop 0
    v_mfma_f32_32x32x16_bf16 v[32:47], v[120:123], v[84:87], v[32:47]
    s_setprio 3
    s_lshl_b32 s13, s10, 3
    s_lshl_b32 s14, s8, 1
    s_add_u32 s13, s13, s14
    s_mul_i32 s13, s13, 36
    s_add_u32 s14, s13, 32
    s_lshl_b32 s14, s14, 10
    s_lshl_b32 s31, s9, 7
    s_add_u32 s14, s14, s31
    s_add_u32 s14, s14, 12582912
    s_add_u32 s13, s13, s9
    s_lshl_b32 s13, s13, 10
    s_add_u32 s13, s13, 12582912
    s_mov_b64 s[48:49], 0
    s_mov_b32 s32, 0x2f800000
    s_mov_b32 s33, 0x5f800000
    s_mov_b32 s34, 0x207
    s_waitcnt lgkmcnt(0)
    v_mov_b32 v64, v26
    v_mov_b32 v65, v26
    s_nop 1
    v_permlane32_swap_b32 v64, v65
    v_rcp_f32 v66, v64
    v_cmp_nle_f32 vcc, s32, v64
    s_nop 1
    s_or_b64 s[48:49], s[48:49], vcc
    v_cmp_nge_f32 vcc, s33, v64
    s_nop 1
    s_or_b64 s[48:49], s[48:49], vcc
    v_mul_f32 v66, v66, v14
    v_mul_f32 v16, v16, v66
    v_mul_f32 v17, v17, v66
    v_mul_f32 v18, v18, v66
    v_mul_f32 v19, v19, v66
    v_mul_f32 v20, v20, v66
    v_mul_f32 v21, v21, v66
    v_mul_f32 v22, v22, v66
    v_mul_f32 v23, v23, v66
    v_mul_f32 v24, v24, v66
    v_mul_f32 v25, v25, v66
    v_cvt_pk_bf16_f32 v108, v16, v17
    v_cvt_pk_bf16_f32 v109, v18, v19
    v_cvt_pk_bf16_f32 v110, v20, v21
    v_cvt_pk_bf16_f32 v111, v22, v23
    v_cvt_pk_bf16_f32 v112, v24, v25
    buffer_store_dwordx4 v[108:111], v2, s[4:7], s13 offen sc1
    buffer_store_dword v112, v3, s[4:7], s14 offen sc1
    s_add_u32 s13, s13, 36864
    s_add_u32 s14, s14, 36864
    v_mov_b32 v68, v42
    v_mov_b32 v69, v42
    s_nop 1
    v_permlane32_swap_b32 v68, v69
    v_rcp_f32 v70, v68
    v_cmp_nle_f32 vcc, s32, v68
    s_nop 1
    s_or_b64 s[48:49], s[48:49], vcc
    v_cmp_nge_f32 vcc, s33, v68
    s_nop 1
    s_or_b64 s[48:49], s[48:49], vcc
    v_mul_f32 v70, v70, v15
    v_mul_f32 v32, v32, v70
    v_mul_f32 v33, v33, v70
    v_mul_f32 v34, v34, v70
    v_mul_f32 v35, v35, v70
    v_mul_f32 v36, v36, v70
    v_mul_f32 v37, v37, v70
    v_mul_f32 v38, v38, v70
    v_mul_f32 v39, v39, v70
    v_mul_f32 v40, v40, v70
    v_mul_f32 v41, v41, v70
    v_cvt_pk_bf16_f32 v116, v32, v33
    v_cvt_pk_bf16_f32 v117, v34, v35
    v_cvt_pk_bf16_f32 v118, v36, v37
    v_cvt_pk_bf16_f32 v119, v38, v39
    v_cvt_pk_bf16_f32 v120, v40, v41
    buffer_store_dwordx4 v[116:119], v2, s[4:7], s13 offen sc1
    buffer_store_dword v120, v3, s[4:7], s14 offen sc1
    v_sub_f32 v72, v16, v16
    v_fma_f32 v72, v17, 0, v72
    v_fma_f32 v72, v18, 0, v72
    v_fma_f32 v72, v19, 0, v72
    v_fma_f32 v72, v20, 0, v72
    v_fma_f32 v72, v21, 0, v72
    v_fma_f32 v72, v22, 0, v72
    v_fma_f32 v72, v23, 0, v72
    v_fma_f32 v72, v24, 0, v72
    v_fma_f32 v72, v25, 0, v72
    v_fma_f32 v72, v32, 0, v72
    v_fma_f32 v72, v33, 0, v72
    v_fma_f32 v72, v34, 0, v72
    v_fma_f32 v72, v35, 0, v72
    v_fma_f32 v72, v36, 0, v72
    v_fma_f32 v72, v37, 0, v72
    v_fma_f32 v72, v38, 0, v72
    v_fma_f32 v72, v39, 0, v72
    v_fma_f32 v72, v40, 0, v72
    v_fma_f32 v72, v41, 0, v72
    v_cmp_class_f32 vcc, v72, s34
    s_nop 1
    s_or_b64 s[48:49], s[48:49], vcc
    v_mov_b32 v4, 61440
    s_cmp_lg_u32 s15, 0
    s_cbranch_scc1 L_ma_nf
    s_cmp_eq_u64 s[48:49], 0
    s_cbranch_scc1 L_ma_nf
    v_mov_b32 v5, 1
    ds_write_b32 v4, v5
L_ma_nf:
    s_waitcnt vmcnt(0) lgkmcnt(0)
    s_barrier
    ds_read_b32 v5, v4
    s_waitcnt lgkmcnt(0)
    v_readfirstlane_b32 s13, v5
    s_nop 1
    s_cmp_eq_u32 s13, 0
    s_cbranch_scc1 L_ma_done
    s_mov_b32 s15, 1
    s_mov_b32 s12, 64
    s_lshl_b32 s32, s9, 16
    s_add_u32 s32, s32, 2097152
    s_lshl_b32 s33, s9, 13
    s_add_u32 s33, s33, 4456448
    v_mov_b32 v16, 0xff800000
    v_mov_b32 v17, 0xff800000
    s_barrier
L_ma_mx:
    buffer_load_dwordx4 v[100:103], v2, s[4:7], s32 offen sc1
    buffer_load_dword v124, v3, s[4:7], s33 offen sc1
    s_add_u32 s32, s32, 1024
    s_add_u32 s33, s33, 128
    s_waitcnt vmcnt(0)
    v_mfma_f32_32x32x16_bf16 v[48:63], v[100:103], v[88:91], 0
    v_mfma_f32_32x32x8_bf16 v[48:63], v[124:125], v[96:97], v[48:63]
    s_nop 11
    v_max3_f32 v16, v48, v49, v16
    v_max3_f32 v16, v50, v51, v16
    v_max3_f32 v16, v52, v53, v16
    v_max3_f32 v16, v54, v55, v16
    v_max3_f32 v16, v56, v57, v16
    v_max3_f32 v16, v58, v59, v16
    v_max3_f32 v16, v60, v61, v16
    v_max3_f32 v16, v62, v63, v16
    v_mfma_f32_32x32x16_bf16 v[48:63], v[100:103], v[92:95], 0
    v_mfma_f32_32x32x8_bf16 v[48:63], v[124:125], v[98:99], v[48:63]
    s_nop 11
    v_max3_f32 v17, v48, v49, v17
    v_max3_f32 v17, v50, v51, v17
    v_max3_f32 v17, v52, v53, v17
    v_max3_f32 v17, v54, v55, v17
    v_max3_f32 v17, v56, v57, v17
    s_nop 6
    v_max3_f32 v17, v58, v59, v17
    v_max3_f32 v17, v60, v61, v17
    v_max3_f32 v17, v62, v63, v17
    s_sub_u32 s12, s12, 1
    s_cmp_lg_u32 s12, 0
    s_cbranch_scc1 L_ma_mx
    v_cmp_gt_u32 vcc, 32, v1
    v_mov_b32 v48, v16
    s_nop 1
    v_permlane32_swap_b32 v48, v16
    v_max_f32 v16, v16, v48
    v_sub_f32 v16, 0, v16
    v_and_b32 v48, 0xffff0000, v16
    v_sub_f32 v16, v16, v48
    v_and_b32 v49, 0xffff0000, v16
    v_sub_f32 v16, v16, v49
    v_lshrrev_b32 v48, 16, v48
    v_or_b32 v48, v48, v49
    v_lshrrev_b32 v50, 16, v16
    v_cndmask_b32 v97, v50, v48, vcc
    v_mov_b32 v48, v17
    s_nop 1
    v_permlane32_swap_b32 v48, v17
    v_max_f32 v17, v17, v48
    v_sub_f32 v17, 0, v17
    v_and_b32 v48, 0xffff0000, v17
    v_sub_f32 v17, v17, v48
    v_and_b32 v49, 0xffff0000, v17
    v_sub_f32 v17, v17, v49
    v_lshrrev_b32 v48, 16, v48
    v_or_b32 v48, v48, v49
    v_lshrrev_b32 v50, 16, v17
    v_cndmask_b32 v99, v50, v48, vcc
    s_branch L_ma_main
L_ma_done:
    s_cmp_lg_u32 s8, 0
    s_cbranch_scc1 L_ma_sg
    s_lshl_b32 s13, s10, 8
    s_add_u32 s13, s13, 12339200
    s_add_u32 s14, s13, 128
    s_mov_b32 s26, 1
    s_mov_b32 s27, 1
    s_atomic_add s26, s[24:25], s13 glc
    s_atomic_add s27, s[24:25], s14 glc
    s_waitcnt lgkmcnt(0)
L_ma_sg:
    s_endpgm
L_b:
    s_cmp_lg_u32 s42, 3
    s_cbranch_scc1 L_b_side
    s_setprio 2
    s_lshl_b32 s20, s43, 2
    s_add_u32 s20, s20, s18
    s_lshl_b32 s26, s44, 1
    s_add_u32 s21, s43, s26
    s_add_u32 s21, s21, s42
    s_cmp_ge_u32 s21, 18
    s_cselect_b32 s26, 18, 0
    s_sub_u32 s21, s21, s26
    s_cmp_ge_u32 s21, 9
    s_cselect_b32 s26, 9, 0
    s_sub_u32 s21, s21, s26
    s_mul_i32 s25, s44, 288
    s_mul_i32 s21, s21, 21846
    s_lshr_b32 s21, s21, 16
    s_mul_i32 s21, s21, 3
    v_and_b32 v12, 63, v0
    v_lshrrev_b32 v13, 3, v12
    s_lshl_b32 s26, s20, 5
    v_add_u32 v14, s26, v13
    v_mul_u32_u24 v14, 1152, v14
    v_lshrrev_b32 v13, 4, v12
    v_xor_b32 v13, v13, v12
    v_and_b32 v13, 7, v13
    v_lshl_add_u32 v4, v13, 4, v14
    v_xor_b32 v13, 4, v13
    v_lshl_add_u32 v5, v13, 4, v14
    v_add_u32 v5, 9216, v5
    s_lshl_b32 s48, s18, 12
    s_add_u32 s48, s48, 49152
    s_mov_b32 s49, s21
    s_lshl_b32 s21, s21, 1
    s_lshr_b32 s26, s18, 1
    s_and_b32 s27, s18, 1
    s_mul_i32 s28, s18, 3072
    s_lshl_b32 s26, s26, 4
    v_lshrrev_b32 v13, 2, v12
    v_add_u32 v13, s26, v13
    v_mul_u32_u24 v13, 1152, v13
    v_and_b32 v14, 3, v12
    s_mul_i32 s26, s27, 12
    v_add_u32 v14, s26, v14
    v_lshl_add_u32 v1, v14, 4, v13
    v_mov_b32 v13, 0x80000000
    v_cmp_gt_u32 vcc, 14, v14
    s_nop 1
    v_cndmask_b32 v2, v13, v1, vcc
    v_cmp_gt_u32 vcc, 10, v14
    s_nop 1
    v_cndmask_b32 v3, v13, v1, vcc
    s_waitcnt lgkmcnt(0)
    s_mov_b32 s12, s60
    s_and_b32 s13, s61, 0xffff
    s_mov_b32 s14, 0x00240000
    s_mov_b32 s15, 0x00020000
    s_mov_b32 s4, s68
    s_and_b32 s5, s69, 0xffff
    s_mov_b32 s6, 0x000a2000
    s_mov_b32 s7, 0x00020000
    s_lshl_b32 s23, s49, 7
    s_add_u32 s49, s49, 1
    s_cmp_eq_u32 s49, 9
    s_cselect_b32 s49, 0, s49
    s_add_u32 m0, s48, 0
    s_nop 0
    buffer_load_dwordx4 v4, s[12:15], s23 offen lds
    s_add_u32 m0, s48, 1024
    s_nop 0
    buffer_load_dwordx4 v5, s[12:15], s23 offen lds
    s_add_u32 s23, s23, 18432
    s_add_u32 m0, s48, 2048
    s_nop 0
    buffer_load_dwordx4 v4, s[12:15], s23 offen lds
    s_add_u32 m0, s48, 3072
    s_nop 0
    buffer_load_dwordx4 v5, s[12:15], s23 offen lds
    s_mul_i32 s22, s21, 36864
    s_add_u32 s22, s22, s25
    s_add_u32 s21, s21, 1
    s_add_u32 m0, s28, 0
    s_nop 0
    buffer_load_dwordx4 v1, s[4:7], s22 offen offset:0 lds
    s_add_u32 m0, s28, 960
    s_nop 0
    buffer_load_dwordx4 v2, s[4:7], s22 offen offset:64 lds
    s_add_u32 m0, s28, 1920
    s_nop 0
    buffer_load_dwordx4 v3, s[4:7], s22 offen offset:128 lds
    s_mul_i32 s22, s21, 36864
    s_add_u32 s22, s22, s25
    s_add_u32 s21, s21, 1
    s_cmp_eq_u32 s21, 18
    s_cselect_b32 s21, 0, s21
    s_add_u32 m0, s28, 12288
    s_nop 0
    buffer_load_dwordx4 v1, s[4:7], s22 offen offset:0 lds
    s_add_u32 m0, s28, 13248
    s_nop 0
    buffer_load_dwordx4 v2, s[4:7], s22 offen offset:64 lds
    s_add_u32 m0, s28, 14208
    s_nop 0
    buffer_load_dwordx4 v3, s[4:7], s22 offen offset:128 lds
    s_mov_b32 s8, s40
    s_and_b32 s9, s41, 0xffff
    s_mov_b32 s10, 0x03000000
    s_mov_b32 s11, 0x00020000
    v_bfe_u32 v13, v12, 2, 2
    v_lshlrev_b32 v6, 6, v13
    v_bfe_u32 v13, v12, 4, 1
    v_lshl_add_u32 v6, v13, 5, v6
    v_and_b32 v13, 1, v12
    v_lshl_add_u32 v6, v13, 4, v6
    v_bfe_u32 v13, v12, 1, 1
    v_lshl_add_u32 v6, v13, 3, v6
    v_lshrrev_b32 v13, 5, v12
    v_mul_u32_u24 v13, 512, v13
    v_add_u32 v6, v6, v13
    v_and_b32 v13, 31, v12
    v_bfe_u32 v14, v12, 1, 3
    v_lshrrev_b32 v15, 5, v12
    v_xor_b32 v14, v14, v15
    v_lshlrev_b32 v14, 4, v14
    v_lshlrev_b32 v13, 7, v13
    v_add_u32 v13, s48, v13
    v_xor_b32 v7, 0, v14
    v_add_u32 v7, v7, v13
    v_xor_b32 v8, 32, v14
    v_add_u32 v8, v8, v13
    v_xor_b32 v9, 64, v14
    v_add_u32 v9, v9, v13
    v_xor_b32 v10, 96, v14
    v_add_u32 v10, v10, v13
    s_lshl_b32 s23, s49, 7
    s_add_u32 s49, s49, 1
    s_cmp_eq_u32 s49, 9
    s_cselect_b32 s49, 0, s49
    s_add_u32 m0, s48, 16384
    s_nop 0
    buffer_load_dwordx4 v4, s[12:15], s23 offen lds
    s_add_u32 m0, s48, 17408
    s_nop 0
    buffer_load_dwordx4 v5, s[12:15], s23 offen lds
    s_add_u32 s23, s23, 18432
    s_add_u32 m0, s48, 18432
    s_nop 0
    buffer_load_dwordx4 v4, s[12:15], s23 offen lds
    s_add_u32 m0, s48, 19456
    s_nop 0
    buffer_load_dwordx4 v5, s[12:15], s23 offen lds
    s_mul_i32 s22, s21, 36864
    s_add_u32 s22, s22, s25
    s_add_u32 s21, s21, 1
    s_add_u32 m0, s28, 24576
    s_nop 0
    buffer_load_dwordx4 v1, s[4:7], s22 offen offset:0 lds
    s_add_u32 m0, s28, 25536
    s_nop 0
    buffer_load_dwordx4 v2, s[4:7], s22 offen offset:64 lds
    s_add_u32 m0, s28, 26496
    s_nop 0
    buffer_load_dwordx4 v3, s[4:7], s22 offen offset:128 lds
    s_waitcnt vmcnt(10)
    s_barrier
    ds_read_b128 v[116:119], v7 offset:0
    ds_read_b128 v[120:123], v8 offset:0
    ds_read_b128 v[124:127], v9 offset:0
    ds_read_b128 v[128:131], v10 offset:0
    ds_read_b64_tr_b16 v[92:93], v6 offset:0
    ds_read_b64_tr_b16 v[94:95], v6 offset:256
    ds_read_b64_tr_b16 v[96:97], v6 offset:1024
    ds_read_b64_tr_b16 v[98:99], v6 offset:1280
    ds_read_b64_tr_b16 v[100:101], v6 offset:2048
    ds_read_b64_tr_b16 v[102:103], v6 offset:2304
    ds_read_b64_tr_b16 v[104:105], v6 offset:3072
    ds_read_b64_tr_b16 v[106:107], v6 offset:3328
    ds_read_b64_tr_b16 v[108:109], v6 offset:4096
    ds_read_b64_tr_b16 v[110:111], v6 offset:4352
    s_waitcnt lgkmcnt(6)
    v_mfma_f32_32x32x16_bf16 v[12:27], v[92:95], v[116:119], 0
    s_mul_i32 s22, s21, 36864
    s_add_u32 s22, s22, s25
    s_add_u32 s21, s21, 1
    s_cmp_eq_u32 s21, 18
    s_cselect_b32 s21, 0, s21
    s_add_u32 m0, s28, 36864
    ds_read_b64_tr_b16 v[112:113], v6 offset:6144
    ds_read_b64_tr_b16 v[114:115], v6 offset:6400
    buffer_load_dwordx4 v1, s[4:7], s22 offen offset:0 lds
    s_add_u32 m0, s28, 37824
    s_nop 0
    buffer_load_dwordx4 v2, s[4:7], s22 offen offset:64 lds
    v_mfma_f32_32x32x16_bf16 v[28:43], v[96:99], v[116:119], 0
    s_add_u32 m0, s28, 38784
    ds_read_b64_tr_b16 v[92:93], v6 offset:7168
    ds_read_b64_tr_b16 v[94:95], v6 offset:7424
    buffer_load_dwordx4 v3, s[4:7], s22 offen offset:128 lds
    s_waitcnt lgkmcnt(6)
    v_mfma_f32_32x32x16_bf16 v[44:59], v[100:103], v[116:119], 0
    s_lshl_b32 s23, s49, 7
    s_add_u32 s49, s49, 1
    s_cmp_eq_u32 s49, 9
    s_cselect_b32 s49, 0, s49
    s_add_u32 m0, s48, 0
    ds_read_b64_tr_b16 v[96:97], v6 offset:8192
    ds_read_b64_tr_b16 v[98:99], v6 offset:8448
    buffer_load_dwordx4 v4, s[12:15], s23 offen lds
    v_mfma_f32_32x32x16_bf16 v[60:75], v[104:107], v[116:119], 0
    s_add_u32 m0, s48, 1024
    ds_read_b64_tr_b16 v[100:101], v6 offset:9216
    ds_read_b64_tr_b16 v[102:103], v6 offset:9472
    buffer_load_dwordx4 v5, s[12:15], s23 offen lds
    s_waitcnt lgkmcnt(6)
    v_mfma_f32_32x32x16_bf16 v[76:91], v[108:111], v[116:119], 0
    s_add_u32 s23, s23, 18432
    s_add_u32 m0, s48, 2048
    ds_read_b64_tr_b16 v[104:105], v6 offset:10240
    ds_read_b64_tr_b16 v[106:107], v6 offset:10496
    buffer_load_dwordx4 v4, s[12:15], s23 offen lds
    v_mfma_f32_32x32x16_bf16 v[12:27], v[112:115], v[120:123], v[12:27]
    s_add_u32 m0, s48, 3072
    s_nop 0
    buffer_load_dwordx4 v5, s[12:15], s23 offen lds
    s_waitcnt lgkmcnt(4)
    v_mfma_f32_32x32x16_bf16 v[28:43], v[92:95], v[120:123], v[28:43]
    s_waitcnt vmcnt(14) lgkmcnt(0)
    s_barrier
    ds_read_b64_tr_b16 v[108:109], v6 offset:12288
    ds_read_b64_tr_b16 v[110:111], v6 offset:12544
    ds_read_b64_tr_b16 v[112:113], v6 offset:13312
    ds_read_b64_tr_b16 v[114:115], v6 offset:13568
    v_mfma_f32_32x32x16_bf16 v[44:59], v[96:99], v[120:123], v[44:59]
    ds_read_b64_tr_b16 v[92:93], v6 offset:14336
    ds_read_b64_tr_b16 v[94:95], v6 offset:14592
    v_mfma_f32_32x32x16_bf16 v[60:75], v[100:103], v[120:123], v[60:75]
    ds_read_b64_tr_b16 v[96:97], v6 offset:15360
    ds_read_b64_tr_b16 v[98:99], v6 offset:15616
    v_mfma_f32_32x32x16_bf16 v[76:91], v[104:107], v[120:123], v[76:91]
    ds_read_b64_tr_b16 v[100:101], v6 offset:16384
    ds_read_b64_tr_b16 v[102:103], v6 offset:16640
    s_waitcnt lgkmcnt(6)
    v_mfma_f32_32x32x16_bf16 v[12:27], v[108:111], v[124:127], v[12:27]
    s_mul_i32 s22, s21, 36864
    s_add_u32 s22, s22, s25
    s_add_u32 s21, s21, 1
    s_add_u32 m0, s28, 0
    ds_read_b64_tr_b16 v[104:105], v6 offset:18432
    ds_read_b64_tr_b16 v[106:107], v6 offset:18688
    buffer_load_dwordx4 v1, s[4:7], s22 offen offset:0 lds
    v_mfma_f32_32x32x16_bf16 v[28:43], v[112:115], v[124:127], v[28:43]
    ds_read_b64_tr_b16 v[108:109], v6 offset:19456
    ds_read_b64_tr_b16 v[110:111], v6 offset:19712
    s_waitcnt lgkmcnt(6)
    v_mfma_f32_32x32x16_bf16 v[44:59], v[92:95], v[124:127], v[44:59]
    s_add_u32 m0, s28, 960
    ds_read_b64_tr_b16 v[112:113], v6 offset:20480
    ds_read_b64_tr_b16 v[114:115], v6 offset:20736
    buffer_load_dwordx4 v2, s[4:7], s22 offen offset:64 lds
    v_mfma_f32_32x32x16_bf16 v[60:75], v[96:99], v[124:127], v[60:75]
    ds_read_b64_tr_b16 v[92:93], v6 offset:21504
    ds_read_b64_tr_b16 v[94:95], v6 offset:21760
    s_waitcnt lgkmcnt(6)
    v_mfma_f32_32x32x16_bf16 v[76:91], v[100:103], v[124:127], v[76:91]
    s_add_u32 m0, s28, 1920
    ds_read_b64_tr_b16 v[96:97], v6 offset:22528
    ds_read_b64_tr_b16 v[98:99], v6 offset:22784
    buffer_load_dwordx4 v3, s[4:7], s22 offen offset:128 lds
    v_mfma_f32_32x32x16_bf16 v[12:27], v[104:107], v[128:131], v[12:27]
    s_waitcnt lgkmcnt(4)
    v_mfma_f32_32x32x16_bf16 v[28:43], v[108:111], v[128:131], v[28:43]
    s_waitcnt vmcnt(10) lgkmcnt(0)
    s_barrier
    ds_read_b128 v[132:135], v7 offset:16384
    ds_read_b128 v[136:139], v8 offset:16384
    ds_read_b128 v[140:143], v9 offset:16384
    ds_read_b128 v[144:147], v10 offset:16384
    ds_read_b64_tr_b16 v[100:101], v6 offset:24576
    ds_read_b64_tr_b16 v[102:103], v6 offset:24832
    ds_read_b64_tr_b16 v[104:105], v6 offset:25600
    ds_read_b64_tr_b16 v[106:107], v6 offset:25856
    v_mfma_f32_32x32x16_bf16 v[44:59], v[112:115], v[128:131], v[44:59]
    ds_read_b64_tr_b16 v[108:109], v6 offset:26624
    ds_read_b64_tr_b16 v[110:111], v6 offset:26880
    v_mfma_f32_32x32x16_bf16 v[60:75], v[92:95], v[128:131], v[60:75]
    ds_read_b64_tr_b16 v[112:113], v6 offset:27648
    ds_read_b64_tr_b16 v[114:115], v6 offset:27904
    v_mfma_f32_32x32x16_bf16 v[76:91], v[96:99], v[128:131], v[76:91]
    ds_read_b64_tr_b16 v[92:93], v6 offset:28672
    ds_read_b64_tr_b16 v[94:95], v6 offset:28928
    s_waitcnt lgkmcnt(6)
    v_mfma_f32_32x32x16_bf16 v[12:27], v[100:103], v[132:135], v[12:27]
    s_mul_i32 s22, s21, 36864
    s_add_u32 s22, s22, s25
    s_add_u32 s21, s21, 1
    s_cmp_eq_u32 s21, 18
    s_cselect_b32 s21, 0, s21
    s_add_u32 m0, s28, 12288
    ds_read_b64_tr_b16 v[96:97], v6 offset:30720
    ds_read_b64_tr_b16 v[98:99], v6 offset:30976
    buffer_load_dwordx4 v1, s[4:7], s22 offen offset:0 lds
    s_add_u32 m0, s28, 13248
    s_nop 0
    buffer_load_dwordx4 v2, s[4:7], s22 offen offset:64 lds
    v_mfma_f32_32x32x16_bf16 v[28:43], v[104:107], v[132:135], v[28:43]
    s_add_u32 m0, s28, 14208
    ds_read_b64_tr_b16 v[100:101], v6 offset:31744
    ds_read_b64_tr_b16 v[102:103], v6 offset:32000
    buffer_load_dwordx4 v3, s[4:7], s22 offen offset:128 lds
    s_waitcnt lgkmcnt(6)
    v_mfma_f32_32x32x16_bf16 v[44:59], v[108:111], v[132:135], v[44:59]
    s_lshl_b32 s23, s49, 7
    s_add_u32 s49, s49, 1
    s_cmp_eq_u32 s49, 9
    s_cselect_b32 s49, 0, s49
    s_add_u32 m0, s48, 16384
    ds_read_b64_tr_b16 v[104:105], v6 offset:32768
    ds_read_b64_tr_b16 v[106:107], v6 offset:33024
    buffer_load_dwordx4 v4, s[12:15], s23 offen lds
    v_mfma_f32_32x32x16_bf16 v[60:75], v[112:115], v[132:135], v[60:75]
    s_add_u32 m0, s48, 17408
    ds_read_b64_tr_b16 v[108:109], v6 offset:33792
    ds_read_b64_tr_b16 v[110:111], v6 offset:34048
    buffer_load_dwordx4 v5, s[12:15], s23 offen lds
    s_waitcnt lgkmcnt(6)
    v_mfma_f32_32x32x16_bf16 v[76:91], v[92:95], v[132:135], v[76:91]
    s_add_u32 s23, s23, 18432
    s_add_u32 m0, s48, 18432
    ds_read_b64_tr_b16 v[112:113], v6 offset:34816
    ds_read_b64_tr_b16 v[114:115], v6 offset:35072
    buffer_load_dwordx4 v4, s[12:15], s23 offen lds
    v_mfma_f32_32x32x16_bf16 v[12:27], v[96:99], v[136:139], v[12:27]
    s_add_u32 m0, s48, 19456
    s_nop 0
    buffer_load_dwordx4 v5, s[12:15], s23 offen lds
    s_waitcnt lgkmcnt(4)
    v_mfma_f32_32x32x16_bf16 v[28:43], v[100:103], v[136:139], v[28:43]
    s_waitcnt vmcnt(14) lgkmcnt(0)
    s_barrier
    ds_read_b64_tr_b16 v[92:93], v6 offset:36864
    ds_read_b64_tr_b16 v[94:95], v6 offset:37120
    ds_read_b64_tr_b16 v[96:97], v6 offset:37888
    ds_read_b64_tr_b16 v[98:99], v6 offset:38144
    v_mfma_f32_32x32x16_bf16 v[44:59], v[104:107], v[136:139], v[44:59]
    ds_read_b64_tr_b16 v[100:101], v6 offset:38912
    ds_read_b64_tr_b16 v[102:103], v6 offset:39168
    v_mfma_f32_32x32x16_bf16 v[60:75], v[108:111], v[136:139], v[60:75]
    ds_read_b64_tr_b16 v[104:105], v6 offset:39936
    ds_read_b64_tr_b16 v[106:107], v6 offset:40192
    v_mfma_f32_32x32x16_bf16 v[76:91], v[112:115], v[136:139], v[76:91]
    ds_read_b64_tr_b16 v[108:109], v6 offset:40960
    ds_read_b64_tr_b16 v[110:111], v6 offset:41216
    s_waitcnt lgkmcnt(6)
    v_mfma_f32_32x32x16_bf16 v[12:27], v[92:95], v[140:143], v[12:27]
    s_mul_i32 s22, s21, 36864
    s_add_u32 s22, s22, s25
    s_add_u32 s21, s21, 1
    s_add_u32 m0, s28, 24576
    ds_read_b64_tr_b16 v[112:113], v6 offset:43008
    ds_read_b64_tr_b16 v[114:115], v6 offset:43264
    buffer_load_dwordx4 v1, s[4:7], s22 offen offset:0 lds
    v_mfma_f32_32x32x16_bf16 v[28:43], v[96:99], v[140:143], v[28:43]
    s_add_u32 m0, s28, 25536
    ds_read_b64_tr_b16 v[92:93], v6 offset:44032
    ds_read_b64_tr_b16 v[94:95], v6 offset:44288
    buffer_load_dwordx4 v2, s[4:7], s22 offen offset:64 lds
    s_waitcnt lgkmcnt(6)
    v_mfma_f32_32x32x16_bf16 v[44:59], v[100:103], v[140:143], v[44:59]
    ds_read_b64_tr_b16 v[96:97], v6 offset:45056
    ds_read_b64_tr_b16 v[98:99], v6 offset:45312
    v_mfma_f32_32x32x16_bf16 v[60:75], v[104:107], v[140:143], v[60:75]
    s_add_u32 m0, s28, 26496
    ds_read_b64_tr_b16 v[100:101], v6 offset:46080
    ds_read_b64_tr_b16 v[102:103], v6 offset:46336
    buffer_load_dwordx4 v3, s[4:7], s22 offen offset:128 lds
    s_waitcnt lgkmcnt(6)
    v_mfma_f32_32x32x16_bf16 v[76:91], v[108:111], v[140:143], v[76:91]
    v_mov_b32 v181, 0
    ds_read_b64_tr_b16 v[104:105], v6 offset:47104
    ds_read_b64_tr_b16 v[106:107], v6 offset:47360
    global_load_dword v180, v181, s[80:81] sc1
    v_mfma_f32_32x32x16_bf16 v[12:27], v[112:115], v[144:147], v[12:27]
    s_waitcnt lgkmcnt(4)
    v_mfma_f32_32x32x16_bf16 v[28:43], v[92:95], v[144:147], v[28:43]
    s_waitcnt vmcnt(11) lgkmcnt(0)
    s_barrier
    ds_read_b128 v[116:119], v7 offset:0
    ds_read_b128 v[120:123], v8 offset:0
    ds_read_b128 v[124:127], v9 offset:0
    ds_read_b128 v[128:131], v10 offset:0
    ds_read_b64_tr_b16 v[108:109], v6 offset:0
    ds_read_b64_tr_b16 v[110:111], v6 offset:256
    ds_read_b64_tr_b16 v[112:113], v6 offset:1024
    ds_read_b64_tr_b16 v[114:115], v6 offset:1280
    v_mfma_f32_32x32x16_bf16 v[44:59], v[96:99], v[144:147], v[44:59]
    ds_read_b64_tr_b16 v[92:93], v6 offset:2048
    ds_read_b64_tr_b16 v[94:95], v6 offset:2304
    v_mfma_f32_32x32x16_bf16 v[60:75], v[100:103], v[144:147], v[60:75]
    ds_read_b64_tr_b16 v[96:97], v6 offset:3072
    ds_read_b64_tr_b16 v[98:99], v6 offset:3328
    v_mfma_f32_32x32x16_bf16 v[76:91], v[104:107], v[144:147], v[76:91]
    ds_read_b64_tr_b16 v[100:101], v6 offset:4096
    ds_read_b64_tr_b16 v[102:103], v6 offset:4352
    s_waitcnt lgkmcnt(6)
    v_mfma_f32_32x32x16_bf16 v[12:27], v[108:111], v[116:119], v[12:27]
    s_mul_i32 s22, s21, 36864
    s_add_u32 s22, s22, s25
    s_add_u32 s21, s21, 1
    s_cmp_eq_u32 s21, 18
    s_cselect_b32 s21, 0, s21
    s_add_u32 m0, s28, 36864
    ds_read_b64_tr_b16 v[104:105], v6 offset:6144
    ds_read_b64_tr_b16 v[106:107], v6 offset:6400
    buffer_load_dwordx4 v1, s[4:7], s22 offen offset:0 lds
    s_add_u32 m0, s28, 37824
    s_nop 0
    buffer_load_dwordx4 v2, s[4:7], s22 offen offset:64 lds
    v_mfma_f32_32x32x16_bf16 v[28:43], v[112:115], v[116:119], v[28:43]
    s_add_u32 m0, s28, 38784
    ds_read_b64_tr_b16 v[108:109], v6 offset:7168
    ds_read_b64_tr_b16 v[110:111], v6 offset:7424
    buffer_load_dwordx4 v3, s[4:7], s22 offen offset:128 lds
    s_waitcnt lgkmcnt(6)
    v_mfma_f32_32x32x16_bf16 v[44:59], v[92:95], v[116:119], v[44:59]
    s_lshl_b32 s23, s49, 7
    s_add_u32 s49, s49, 1
    s_cmp_eq_u32 s49, 9
    s_cselect_b32 s49, 0, s49
    s_add_u32 m0, s48, 0
    ds_read_b64_tr_b16 v[112:113], v6 offset:8192
    ds_read_b64_tr_b16 v[114:115], v6 offset:8448
    buffer_load_dwordx4 v4, s[12:15], s23 offen lds
    v_mfma_f32_32x32x16_bf16 v[60:75], v[96:99], v[116:119], v[60:75]
    s_add_u32 m0, s48, 1024
    ds_read_b64_tr_b16 v[92:93], v6 offset:9216
    ds_read_b64_tr_b16 v[94:95], v6 offset:9472
    buffer_load_dwordx4 v5, s[12:15], s23 offen lds
    s_waitcnt lgkmcnt(6)
    v_mfma_f32_32x32x16_bf16 v[76:91], v[100:103], v[116:119], v[76:91]
    s_add_u32 s23, s23, 18432
    s_add_u32 m0, s48, 2048
    ds_read_b64_tr_b16 v[96:97], v6 offset:10240
    ds_read_b64_tr_b16 v[98:99], v6 offset:10496
    buffer_load_dwordx4 v4, s[12:15], s23 offen lds
    v_mfma_f32_32x32x16_bf16 v[12:27], v[104:107], v[120:123], v[12:27]
    s_add_u32 m0, s48, 3072
    s_nop 0
    buffer_load_dwordx4 v5, s[12:15], s23 offen lds
    s_waitcnt lgkmcnt(4)
    v_mfma_f32_32x32x16_bf16 v[28:43], v[108:111], v[120:123], v[28:43]
    s_waitcnt vmcnt(15) lgkmcnt(0)
    s_barrier
    ds_read_b64_tr_b16 v[100:101], v6 offset:12288
    ds_read_b64_tr_b16 v[102:103], v6 offset:12544
    ds_read_b64_tr_b16 v[104:105], v6 offset:13312
    ds_read_b64_tr_b16 v[106:107], v6 offset:13568
    v_mfma_f32_32x32x16_bf16 v[44:59], v[112:115], v[120:123], v[44:59]
    ds_read_b64_tr_b16 v[108:109], v6 offset:14336
    ds_read_b64_tr_b16 v[110:111], v6 offset:14592
    v_mfma_f32_32x32x16_bf16 v[60:75], v[92:95], v[120:123], v[60:75]
    ds_read_b64_tr_b16 v[112:113], v6 offset:15360
    ds_read_b64_tr_b16 v[114:115], v6 offset:15616
    v_mfma_f32_32x32x16_bf16 v[76:91], v[96:99], v[120:123], v[76:91]
    ds_read_b64_tr_b16 v[92:93], v6 offset:16384
    ds_read_b64_tr_b16 v[94:95], v6 offset:16640
    s_waitcnt lgkmcnt(6)
    v_mfma_f32_32x32x16_bf16 v[12:27], v[100:103], v[124:127], v[12:27]
    s_mul_i32 s22, s21, 36864
    s_add_u32 s22, s22, s25
    s_add_u32 s21, s21, 1
    s_add_u32 m0, s28, 0
    ds_read_b64_tr_b16 v[96:97], v6 offset:18432
    ds_read_b64_tr_b16 v[98:99], v6 offset:18688
    buffer_load_dwordx4 v1, s[4:7], s22 offen offset:0 lds
    v_mfma_f32_32x32x16_bf16 v[28:43], v[104:107], v[124:127], v[28:43]
    ds_read_b64_tr_b16 v[100:101], v6 offset:19456
    ds_read_b64_tr_b16 v[102:103], v6 offset:19712
    s_waitcnt lgkmcnt(6)
    v_mfma_f32_32x32x16_bf16 v[44:59], v[108:111], v[124:127], v[44:59]
    s_add_u32 m0, s28, 960
    ds_read_b64_tr_b16 v[104:105], v6 offset:20480
    ds_read_b64_tr_b16 v[106:107], v6 offset:20736
    buffer_load_dwordx4 v2, s[4:7], s22 offen offset:64 lds
    v_mfma_f32_32x32x16_bf16 v[60:75], v[112:115], v[124:127], v[60:75]
    ds_read_b64_tr_b16 v[108:109], v6 offset:21504
    ds_read_b64_tr_b16 v[110:111], v6 offset:21760
    s_waitcnt lgkmcnt(6)
    v_mfma_f32_32x32x16_bf16 v[76:91], v[92:95], v[124:127], v[76:91]
    s_add_u32 m0, s28, 1920
    ds_read_b64_tr_b16 v[112:113], v6 offset:22528
    ds_read_b64_tr_b16 v[114:115], v6 offset:22784
    buffer_load_dwordx4 v3, s[4:7], s22 offen offset:128 lds
    v_mfma_f32_32x32x16_bf16 v[12:27], v[96:99], v[128:131], v[12:27]
    s_waitcnt lgkmcnt(4)
    v_mfma_f32_32x32x16_bf16 v[28:43], v[100:103], v[128:131], v[28:43]
    s_waitcnt vmcnt(11) lgkmcnt(0)
    s_barrier
    ds_read_b128 v[132:135], v7 offset:16384
    ds_read_b128 v[136:139], v8 offset:16384
    ds_read_b128 v[140:143], v9 offset:16384
    ds_read_b128 v[144:147], v10 offset:16384
    ds_read_b64_tr_b16 v[92:93], v6 offset:24576
    ds_read_b64_tr_b16 v[94:95], v6 offset:24832
    ds_read_b64_tr_b16 v[96:97], v6 offset:25600
    ds_read_b64_tr_b16 v[98:99], v6 offset:25856
    v_mfma_f32_32x32x16_bf16 v[44:59], v[104:107], v[128:131], v[44:59]
    ds_read_b64_tr_b16 v[100:101], v6 offset:26624
    ds_read_b64_tr_b16 v[102:103], v6 offset:26880
    v_mfma_f32_32x32x16_bf16 v[60:75], v[108:111], v[128:131], v[60:75]
    ds_read_b64_tr_b16 v[104:105], v6 offset:27648
    ds_read_b64_tr_b16 v[106:107], v6 offset:27904
    v_mfma_f32_32x32x16_bf16 v[76:91], v[112:115], v[128:131], v[76:91]
    ds_read_b64_tr_b16 v[108:109], v6 offset:28672
    ds_read_b64_tr_b16 v[110:111], v6 offset:28928
    s_waitcnt lgkmcnt(6)
    v_mfma_f32_32x32x16_bf16 v[12:27], v[92:95], v[132:135], v[12:27]
    s_mul_i32 s22, s21, 36864
    s_add_u32 s22, s22, s25
    s_add_u32 s21, s21, 1
    s_cmp_eq_u32 s21, 18
    s_cselect_b32 s21, 0, s21
    s_add_u32 m0, s28, 12288
    ds_read_b64_tr_b16 v[112:113], v6 offset:30720
    ds_read_b64_tr_b16 v[114:115], v6 offset:30976
    buffer_load_dwordx4 v1, s[4:7], s22 offen offset:0 lds
    s_add_u32 m0, s28, 13248
    s_nop 0
    buffer_load_dwordx4 v2, s[4:7], s22 offen offset:64 lds
    v_mfma_f32_32x32x16_bf16 v[28:43], v[96:99], v[132:135], v[28:43]
    s_add_u32 m0, s28, 14208
    ds_read_b64_tr_b16 v[92:93], v6 offset:31744
    ds_read_b64_tr_b16 v[94:95], v6 offset:32000
    buffer_load_dwordx4 v3, s[4:7], s22 offen offset:128 lds
    s_waitcnt lgkmcnt(6)
    v_mfma_f32_32x32x16_bf16 v[44:59], v[100:103], v[132:135], v[44:59]
    s_lshl_b32 s23, s49, 7
    s_add_u32 s49, s49, 1
    s_cmp_eq_u32 s49, 9
    s_cselect_b32 s49, 0, s49
    s_add_u32 m0, s48, 16384
    ds_read_b64_tr_b16 v[96:97], v6 offset:32768
    ds_read_b64_tr_b16 v[98:99], v6 offset:33024
    buffer_load_dwordx4 v4, s[12:15], s23 offen lds
    v_mfma_f32_32x32x16_bf16 v[60:75], v[104:107], v[132:135], v[60:75]
    s_add_u32 m0, s48, 17408
    ds_read_b64_tr_b16 v[100:101], v6 offset:33792
    ds_read_b64_tr_b16 v[102:103], v6 offset:34048
    buffer_load_dwordx4 v5, s[12:15], s23 offen lds
    s_waitcnt lgkmcnt(6)
    v_mfma_f32_32x32x16_bf16 v[76:91], v[108:111], v[132:135], v[76:91]
    s_add_u32 s23, s23, 18432
    s_add_u32 m0, s48, 18432
    ds_read_b64_tr_b16 v[104:105], v6 offset:34816
    ds_read_b64_tr_b16 v[106:107], v6 offset:35072
    buffer_load_dwordx4 v4, s[12:15], s23 offen lds
    v_mfma_f32_32x32x16_bf16 v[12:27], v[112:115], v[136:139], v[12:27]
    s_add_u32 m0, s48, 19456
    s_nop 0
    buffer_load_dwordx4 v5, s[12:15], s23 offen lds
    s_waitcnt lgkmcnt(4)
    v_mfma_f32_32x32x16_bf16 v[28:43], v[92:95], v[136:139], v[28:43]
    s_waitcnt vmcnt(14) lgkmcnt(0)
    s_barrier
    ds_read_b64_tr_b16 v[108:109], v6 offset:36864
    ds_read_b64_tr_b16 v[110:111], v6 offset:37120
    ds_read_b64_tr_b16 v[112:113], v6 offset:37888
    ds_read_b64_tr_b16 v[114:115], v6 offset:38144
    v_mfma_f32_32x32x16_bf16 v[44:59], v[96:99], v[136:139], v[44:59]
    ds_read_b64_tr_b16 v[92:93], v6 offset:38912
    ds_read_b64_tr_b16 v[94:95], v6 offset:39168
    v_mfma_f32_32x32x16_bf16 v[60:75], v[100:103], v[136:139], v[60:75]
    ds_read_b64_tr_b16 v[96:97], v6 offset:39936
    ds_read_b64_tr_b16 v[98:99], v6 offset:40192
    v_mfma_f32_32x32x16_bf16 v[76:91], v[104:107], v[136:139], v[76:91]
    ds_read_b64_tr_b16 v[100:101], v6 offset:40960
    ds_read_b64_tr_b16 v[102:103], v6 offset:41216
    s_waitcnt lgkmcnt(6)
    v_mfma_f32_32x32x16_bf16 v[12:27], v[108:111], v[140:143], v[12:27]
    s_mul_i32 s22, s21, 36864
    s_add_u32 s22, s22, s25
    s_add_u32 s21, s21, 1
    s_add_u32 m0, s28, 24576
    ds_read_b64_tr_b16 v[104:105], v6 offset:43008
    ds_read_b64_tr_b16 v[106:107], v6 offset:43264
    buffer_load_dwordx4 v1, s[4:7], s22 offen offset:0 lds
    v_mfma_f32_32x32x16_bf16 v[28:43], v[112:115], v[140:143], v[28:43]
    ds_read_b64_tr_b16 v[108:109], v6 offset:44032
    ds_read_b64_tr_b16 v[110:111], v6 offset:44288
    s_waitcnt lgkmcnt(6)
    v_mfma_f32_32x32x16_bf16 v[44:59], v[92:95], v[140:143], v[44:59]
    s_add_u32 m0, s28, 25536
    ds_read_b64_tr_b16 v[112:113], v6 offset:45056
    ds_read_b64_tr_b16 v[114:115], v6 offset:45312
    buffer_load_dwordx4 v2, s[4:7], s22 offen offset:64 lds
    v_mfma_f32_32x32x16_bf16 v[60:75], v[96:99], v[140:143], v[60:75]
    ds_read_b64_tr_b16 v[92:93], v6 offset:46080
    ds_read_b64_tr_b16 v[94:95], v6 offset:46336
    s_waitcnt lgkmcnt(6)
    v_mfma_f32_32x32x16_bf16 v[76:91], v[100:103], v[140:143], v[76:91]
    s_add_u32 m0, s28, 26496
    ds_read_b64_tr_b16 v[96:97], v6 offset:47104
    ds_read_b64_tr_b16 v[98:99], v6 offset:47360
    buffer_load_dwordx4 v3, s[4:7], s22 offen offset:128 lds
    v_mfma_f32_32x32x16_bf16 v[12:27], v[104:107], v[144:147], v[12:27]
    s_waitcnt lgkmcnt(4)
    v_mfma_f32_32x32x16_bf16 v[28:43], v[108:111], v[144:147], v[28:43]
    s_waitcnt vmcnt(10) lgkmcnt(0)
    s_barrier
    ds_read_b128 v[116:119], v7 offset:0
    ds_read_b128 v[120:123], v8 offset:0
    ds_read_b128 v[124:127], v9 offset:0
    ds_read_b128 v[128:131], v10 offset:0
    ds_read_b64_tr_b16 v[100:101], v6 offset:0
    ds_read_b64_tr_b16 v[102:103], v6 offset:256
    ds_read_b64_tr_b16 v[104:105], v6 offset:1024
    ds_read_b64_tr_b16 v[106:107], v6 offset:1280
    v_mfma_f32_32x32x16_bf16 v[44:59], v[112:115], v[144:147], v[44:59]
    ds_read_b64_tr_b16 v[108:109], v6 offset:2048
    ds_read_b64_tr_b16 v[110:111], v6 offset:2304
    v_mfma_f32_32x32x16_bf16 v[60:75], v[92:95], v[144:147], v[60:75]
    ds_read_b64_tr_b16 v[112:113], v6 offset:3072
    ds_read_b64_tr_b16 v[114:115], v6 offset:3328
    v_mfma_f32_32x32x16_bf16 v[76:91], v[96:99], v[144:147], v[76:91]
    ds_read_b64_tr_b16 v[92:93], v6 offset:4096
    ds_read_b64_tr_b16 v[94:95], v6 offset:4352
    s_waitcnt lgkmcnt(6)
    v_mfma_f32_32x32x16_bf16 v[12:27], v[100:103], v[116:119], v[12:27]
    s_mul_i32 s22, s21, 36864
    s_add_u32 s22, s22, s25
    s_add_u32 s21, s21, 1
    s_cmp_eq_u32 s21, 18
    s_cselect_b32 s21, 0, s21
    s_add_u32 m0, s28, 36864
    ds_read_b64_tr_b16 v[96:97], v6 offset:6144
    ds_read_b64_tr_b16 v[98:99], v6 offset:6400
    buffer_load_dwordx4 v1, s[4:7], s22 offen offset:0 lds
    s_add_u32 m0, s28, 37824
    s_nop 0
    buffer_load_dwordx4 v2, s[4:7], s22 offen offset:64 lds
    v_mfma_f32_32x32x16_bf16 v[28:43], v[104:107], v[116:119], v[28:43]
    s_add_u32 m0, s28, 38784
    ds_read_b64_tr_b16 v[100:101], v6 offset:7168
    ds_read_b64_tr_b16 v[102:103], v6 offset:7424
    buffer_load_dwordx4 v3, s[4:7], s22 offen offset:128 lds
    s_waitcnt lgkmcnt(6)
    v_mfma_f32_32x32x16_bf16 v[44:59], v[108:111], v[116:119], v[44:59]
    s_lshl_b32 s23, s49, 7
    s_add_u32 s49, s49, 1
    s_cmp_eq_u32 s49, 9
    s_cselect_b32 s49, 0, s49
    s_add_u32 m0, s48, 0
    ds_read_b64_tr_b16 v[104:105], v6 offset:8192
    ds_read_b64_tr_b16 v[106:107], v6 offset:8448
    buffer_load_dwordx4 v4, s[12:15], s23 offen lds
    v_mfma_f32_32x32x16_bf16 v[60:75], v[112:115], v[116:119], v[60:75]
    s_add_u32 m0, s48, 1024
    ds_read_b64_tr_b16 v[108:109], v6 offset:9216
    ds_read_b64_tr_b16 v[110:111], v6 offset:9472
    buffer_load_dwordx4 v5, s[12:15], s23 offen lds
    s_waitcnt lgkmcnt(6)
    v_mfma_f32_32x32x16_bf16 v[76:91], v[92:95], v[116:119], v[76:91]
    s_add_u32 s23, s23, 18432
    s_add_u32 m0, s48, 2048
    ds_read_b64_tr_b16 v[112:113], v6 offset:10240
    ds_read_b64_tr_b16 v[114:115], v6 offset:10496
    buffer_load_dwordx4 v4, s[12:15], s23 offen lds
    v_mfma_f32_32x32x16_bf16 v[12:27], v[96:99], v[120:123], v[12:27]
    s_add_u32 m0, s48, 3072
    s_nop 0
    buffer_load_dwordx4 v5, s[12:15], s23 offen lds
    s_waitcnt lgkmcnt(4)
    v_mfma_f32_32x32x16_bf16 v[28:43], v[100:103], v[120:123], v[28:43]
    s_waitcnt vmcnt(14) lgkmcnt(0)
    v_readfirstlane_b32 s57, v180
    s_nop 1
    s_cmp_ge_u32 s57, 16
    s_cbranch_scc1 L_f_rk_19
    s_cmp_lg_u32 s18, 0
    s_cbranch_scc1 L_f_rd_20
    s_mov_b32 s57, 262144
    v_mov_b32 v181, 0
L_f_rp_21:
    global_load_dword v180, v181, s[80:81] sc1
    s_waitcnt vmcnt(0)
    v_readfirstlane_b32 s58, v180
    s_nop 1
    s_cmp_ge_u32 s58, 16
    s_cbranch_scc1 L_f_rd_20
    s_sleep 8
    s_sub_u32 s57, s57, 1
    s_cmp_gt_i32 s57, 0
    s_cbranch_scc1 L_f_rp_21
L_f_rd_20:
L_f_rk_19:
    s_barrier
    ds_read_b64_tr_b16 v[92:93], v6 offset:12288
    ds_read_b64_tr_b16 v[94:95], v6 offset:12544
    ds_read_b64_tr_b16 v[96:97], v6 offset:13312
    ds_read_b64_tr_b16 v[98:99], v6 offset:13568
    v_mfma_f32_32x32x16_bf16 v[44:59], v[104:107], v[120:123], v[44:59]
    ds_read_b64_tr_b16 v[100:101], v6 offset:14336
    ds_read_b64_tr_b16 v[102:103], v6 offset:14592
    v_mfma_f32_32x32x16_bf16 v[60:75], v[108:111], v[120:123], v[60:75]
    ds_read_b64_tr_b16 v[104:105], v6 offset:15360
    ds_read_b64_tr_b16 v[106:107], v6 offset:15616
    v_mfma_f32_32x32x16_bf16 v[76:91], v[112:115], v[120:123], v[76:91]
    ds_read_b64_tr_b16 v[108:109], v6 offset:16384
    ds_read_b64_tr_b16 v[110:111], v6 offset:16640
    s_waitcnt lgkmcnt(6)
    v_mfma_f32_32x32x16_bf16 v[12:27], v[92:95], v[124:127], v[12:27]
    s_mul_i32 s22, s21, 36864
    s_add_u32 s22, s22, s25
    s_add_u32 s21, s21, 1
    s_add_u32 m0, s28, 0
    ds_read_b64_tr_b16 v[112:113], v6 offset:18432
    ds_read_b64_tr_b16 v[114:115], v6 offset:18688
    buffer_load_dwordx4 v1, s[4:7], s22 offen offset:0 lds
    v_mfma_f32_32x32x16_bf16 v[28:43], v[96:99], v[124:127], v[28:43]
    ds_read_b64_tr_b16 v[92:93], v6 offset:19456
    ds_read_b64_tr_b16 v[94:95], v6 offset:19712
    s_waitcnt lgkmcnt(6)
    v_mfma_f32_32x32x16_bf16 v[44:59], v[100:103], v[124:127], v[44:59]
    s_add_u32 m0, s28, 960
    ds_read_b64_tr_b16 v[96:97], v6 offset:20480
    ds_read_b64_tr_b16 v[98:99], v6 offset:20736
    buffer_load_dwordx4 v2, s[4:7], s22 offen offset:64 lds
    v_mfma_f32_32x32x16_bf16 v[60:75], v[104:107], v[124:127], v[60:75]
    ds_read_b64_tr_b16 v[100:101], v6 offset:21504
    ds_read_b64_tr_b16 v[102:103], v6 offset:21760
    s_waitcnt lgkmcnt(6)
    v_mfma_f32_32x32x16_bf16 v[76:91], v[108:111], v[124:127], v[76:91]
    s_add_u32 m0, s28, 1920
    ds_read_b64_tr_b16 v[104:105], v6 offset:22528
    ds_read_b64_tr_b16 v[106:107], v6 offset:22784
    buffer_load_dwordx4 v3, s[4:7], s22 offen offset:128 lds
    v_mfma_f32_32x32x16_bf16 v[12:27], v[112:115], v[128:131], v[12:27]
    s_waitcnt lgkmcnt(4)
    v_mfma_f32_32x32x16_bf16 v[28:43], v[92:95], v[128:131], v[28:43]
    s_waitcnt vmcnt(10) lgkmcnt(0)
    s_barrier
    ds_read_b128 v[132:135], v7 offset:16384
    ds_read_b128 v[136:139], v8 offset:16384
    ds_read_b128 v[140:143], v9 offset:16384
    ds_read_b128 v[144:147], v10 offset:16384
    ds_read_b64_tr_b16 v[108:109], v6 offset:24576
    ds_read_b64_tr_b16 v[110:111], v6 offset:24832
    ds_read_b64_tr_b16 v[112:113], v6 offset:25600
    ds_read_b64_tr_b16 v[114:115], v6 offset:25856
    v_mfma_f32_32x32x16_bf16 v[44:59], v[96:99], v[128:131], v[44:59]
    ds_read_b64_tr_b16 v[92:93], v6 offset:26624
    ds_read_b64_tr_b16 v[94:95], v6 offset:26880
    v_mfma_f32_32x32x16_bf16 v[60:75], v[100:103], v[128:131], v[60:75]
    ds_read_b64_tr_b16 v[96:97], v6 offset:27648
    ds_read_b64_tr_b16 v[98:99], v6 offset:27904
    v_mfma_f32_32x32x16_bf16 v[76:91], v[104:107], v[128:131], v[76:91]
    ds_read_b64_tr_b16 v[100:101], v6 offset:28672
    ds_read_b64_tr_b16 v[102:103], v6 offset:28928
    s_waitcnt lgkmcnt(6)
    v_mfma_f32_32x32x16_bf16 v[12:27], v[108:111], v[132:135], v[12:27]
    s_mul_i32 s22, s21, 36864
    s_add_u32 s22, s22, s25
    s_add_u32 s21, s21, 1
    s_cmp_eq_u32 s21, 18
    s_cselect_b32 s21, 0, s21
    s_add_u32 m0, s28, 12288
    ds_read_b64_tr_b16 v[104:105], v6 offset:30720
    ds_read_b64_tr_b16 v[106:107], v6 offset:30976
    buffer_load_dwordx4 v1, s[4:7], s22 offen offset:0 lds
    s_add_u32 m0, s28, 13248
    s_nop 0
    buffer_load_dwordx4 v2, s[4:7], s22 offen offset:64 lds
    v_mfma_f32_32x32x16_bf16 v[28:43], v[112:115], v[132:135], v[28:43]
    s_add_u32 m0, s28, 14208
    ds_read_b64_tr_b16 v[108:109], v6 offset:31744
    ds_read_b64_tr_b16 v[110:111], v6 offset:32000
    buffer_load_dwordx4 v3, s[4:7], s22 offen offset:128 lds
    s_waitcnt lgkmcnt(6)
    v_mfma_f32_32x32x16_bf16 v[44:59], v[92:95], v[132:135], v[44:59]
    s_lshl_b32 s23, s49, 7
    s_add_u32 s49, s49, 1
    s_cmp_eq_u32 s49, 9
    s_cselect_b32 s49, 0, s49
    s_add_u32 m0, s48, 16384
    ds_read_b64_tr_b16 v[112:113], v6 offset:32768
    ds_read_b64_tr_b16 v[114:115], v6 offset:33024
    buffer_load_dwordx4 v4, s[12:15], s23 offen lds
    v_mfma_f32_32x32x16_bf16 v[60:75], v[96:99], v[132:135], v[60:75]
    s_add_u32 m0, s48, 17408
    ds_read_b64_tr_b16 v[92:93], v6 offset:33792
    ds_read_b64_tr_b16 v[94:95], v6 offset:34048
    buffer_load_dwordx4 v5, s[12:15], s23 offen lds
    s_waitcnt lgkmcnt(6)
    v_mfma_f32_32x32x16_bf16 v[76:91], v[100:103], v[132:135], v[76:91]
    s_add_u32 s23, s23, 18432
    s_add_u32 m0, s48, 18432
    ds_read_b64_tr_b16 v[96:97], v6 offset:34816
    ds_read_b64_tr_b16 v[98:99], v6 offset:35072
    buffer_load_dwordx4 v4, s[12:15], s23 offen lds
    v_mfma_f32_32x32x16_bf16 v[12:27], v[104:107], v[136:139], v[12:27]
    s_add_u32 m0, s48, 19456
    s_nop 0
    buffer_load_dwordx4 v5, s[12:15], s23 offen lds
    s_waitcnt lgkmcnt(4)
    v_mfma_f32_32x32x16_bf16 v[28:43], v[108:111], v[136:139], v[28:43]
    s_waitcnt vmcnt(14) lgkmcnt(0)
    s_barrier
    ds_read_b64_tr_b16 v[100:101], v6 offset:36864
    ds_read_b64_tr_b16 v[102:103], v6 offset:37120
    ds_read_b64_tr_b16 v[104:105], v6 offset:37888
    ds_read_b64_tr_b16 v[106:107], v6 offset:38144
    v_mfma_f32_32x32x16_bf16 v[44:59], v[112:115], v[136:139], v[44:59]
    ds_read_b64_tr_b16 v[108:109], v6 offset:38912
    ds_read_b64_tr_b16 v[110:111], v6 offset:39168
    v_mfma_f32_32x32x16_bf16 v[60:75], v[92:95], v[136:139], v[60:75]
    ds_read_b64_tr_b16 v[112:113], v6 offset:39936
    ds_read_b64_tr_b16 v[114:115], v6 offset:40192
    v_mfma_f32_32x32x16_bf16 v[76:91], v[96:99], v[136:139], v[76:91]
    ds_read_b64_tr_b16 v[92:93], v6 offset:40960
    ds_read_b64_tr_b16 v[94:95], v6 offset:41216
    s_waitcnt lgkmcnt(6)
    v_mfma_f32_32x32x16_bf16 v[12:27], v[100:103], v[140:143], v[12:27]
    s_mul_i32 s22, s21, 36864
    s_add_u32 s22, s22, s25
    s_add_u32 s21, s21, 1
    s_add_u32 m0, s28, 24576
    ds_read_b64_tr_b16 v[96:97], v6 offset:43008
    ds_read_b64_tr_b16 v[98:99], v6 offset:43264
    buffer_load_dwordx4 v1, s[4:7], s22 offen offset:0 lds
    v_mfma_f32_32x32x16_bf16 v[28:43], v[104:107], v[140:143], v[28:43]
    ds_read_b64_tr_b16 v[100:101], v6 offset:44032
    ds_read_b64_tr_b16 v[102:103], v6 offset:44288
    s_waitcnt lgkmcnt(6)
    v_mfma_f32_32x32x16_bf16 v[44:59], v[108:111], v[140:143], v[44:59]
    s_add_u32 m0, s28, 25536
    ds_read_b64_tr_b16 v[104:105], v6 offset:45056
    ds_read_b64_tr_b16 v[106:107], v6 offset:45312
    buffer_load_dwordx4 v2, s[4:7], s22 offen offset:64 lds
    v_mfma_f32_32x32x16_bf16 v[60:75], v[112:115], v[140:143], v[60:75]
    ds_read_b64_tr_b16 v[108:109], v6 offset:46080
    ds_read_b64_tr_b16 v[110:111], v6 offset:46336
    s_waitcnt lgkmcnt(6)
    v_mfma_f32_32x32x16_bf16 v[76:91], v[92:95], v[140:143], v[76:91]
    s_add_u32 m0, s28, 26496
    ds_read_b64_tr_b16 v[112:113], v6 offset:47104
    ds_read_b64_tr_b16 v[114:115], v6 offset:47360
    buffer_load_dwordx4 v3, s[4:7], s22 offen offset:128 lds
    v_mfma_f32_32x32x16_bf16 v[12:27], v[96:99], v[144:147], v[12:27]
    s_waitcnt lgkmcnt(4)
    v_mfma_f32_32x32x16_bf16 v[28:43], v[100:103], v[144:147], v[28:43]
    s_waitcnt vmcnt(10) lgkmcnt(0)
    s_mov_b32 s54, 16
    s_mov_b32 s55, 16
    s_cmp_lg_u32 s18, 0
    s_cbranch_scc1 L_f_pa_22
    s_lshl_b32 s56, s43, 7
    s_add_u32 s56, s56, 12344320
    s_lshl_b32 s59, s44, 7
    s_add_u32 s59, s59, 12346368
    s_mov_b32 s54, 0
    s_mov_b32 s55, 0
    s_atomic_add s54, s[40:41], s56 glc
    s_atomic_add s55, s[40:41], s59 glc
L_f_pa_22:
    s_barrier
    ds_read_b128 v[116:119], v7 offset:0
    ds_read_b128 v[120:123], v8 offset:0
    ds_read_b128 v[124:127], v9 offset:0
    ds_read_b128 v[128:131], v10 offset:0
    ds_read_b64_tr_b16 v[92:93], v6 offset:0
    ds_read_b64_tr_b16 v[94:95], v6 offset:256
    ds_read_b64_tr_b16 v[96:97], v6 offset:1024
    ds_read_b64_tr_b16 v[98:99], v6 offset:1280
    v_mfma_f32_32x32x16_bf16 v[44:59], v[104:107], v[144:147], v[44:59]
    ds_read_b64_tr_b16 v[100:101], v6 offset:2048
    ds_read_b64_tr_b16 v[102:103], v6 offset:2304
    v_mfma_f32_32x32x16_bf16 v[60:75], v[108:111], v[144:147], v[60:75]
    ds_read_b64_tr_b16 v[104:105], v6 offset:3072
    ds_read_b64_tr_b16 v[106:107], v6 offset:3328
    v_mfma_f32_32x32x16_bf16 v[76:91], v[112:115], v[144:147], v[76:91]
    ds_read_b64_tr_b16 v[108:109], v6 offset:4096
    ds_read_b64_tr_b16 v[110:111], v6 offset:4352
    s_waitcnt lgkmcnt(6)
    v_mfma_f32_32x32x16_bf16 v[12:27], v[92:95], v[116:119], v[12:27]
    s_mul_i32 s22, s21, 36864
    s_add_u32 s22, s22, s25
    s_add_u32 s21, s21, 1
    s_cmp_eq_u32 s21, 18
    s_cselect_b32 s21, 0, s21
    s_add_u32 m0, s28, 36864
    ds_read_b64_tr_b16 v[112:113], v6 offset:6144
    ds_read_b64_tr_b16 v[114:115], v6 offset:6400
    buffer_load_dwordx4 v1, s[4:7], s22 offen offset:0 lds
    s_add_u32 m0, s28, 37824
    s_nop 0
    buffer_load_dwordx4 v2, s[4:7], s22 offen offset:64 lds
    v_mfma_f32_32x32x16_bf16 v[28:43], v[96:99], v[116:119], v[28:43]
    s_add_u32 m0, s28, 38784
    ds_read_b64_tr_b16 v[92:93], v6 offset:7168
    ds_read_b64_tr_b16 v[94:95], v6 offset:7424
    buffer_load_dwordx4 v3, s[4:7], s22 offen offset:128 lds
    s_waitcnt lgkmcnt(6)
    v_mfma_f32_32x32x16_bf16 v[44:59], v[100:103], v[116:119], v[44:59]
    s_lshl_b32 s23, s49, 7
    s_add_u32 s49, s49, 1
    s_cmp_eq_u32 s49, 9
    s_cselect_b32 s49, 0, s49
    s_add_u32 m0, s48, 0
    ds_read_b64_tr_b16 v[96:97], v6 offset:8192
    ds_read_b64_tr_b16 v[98:99], v6 offset:8448
    buffer_load_dwordx4 v4, s[12:15], s23 offen lds
    v_mfma_f32_32x32x16_bf16 v[60:75], v[104:107], v[116:119], v[60:75]
    s_add_u32 m0, s48, 1024
    ds_read_b64_tr_b16 v[100:101], v6 offset:9216
    ds_read_b64_tr_b16 v[102:103], v6 offset:9472
    buffer_load_dwordx4 v5, s[12:15], s23 offen lds
    s_waitcnt lgkmcnt(6)
    v_mfma_f32_32x32x16_bf16 v[76:91], v[108:111], v[116:119], v[76:91]
    s_add_u32 s23, s23, 18432
    s_add_u32 m0, s48, 2048
    ds_read_b64_tr_b16 v[104:105], v6 offset:10240
    ds_read_b64_tr_b16 v[106:107], v6 offset:10496
    buffer_load_dwordx4 v4, s[12:15], s23 offen lds
    v_mfma_f32_32x32x16_bf16 v[12:27], v[112:115], v[120:123], v[12:27]
    s_add_u32 m0, s48, 3072
    s_nop 0
    buffer_load_dwordx4 v5, s[12:15], s23 offen lds
    s_waitcnt lgkmcnt(4)
    v_mfma_f32_32x32x16_bf16 v[28:43], v[92:95], v[120:123], v[28:43]
    s_waitcnt vmcnt(14) lgkmcnt(0)
    s_barrier
    ds_read_b64_tr_b16 v[108:109], v6 offset:12288
    ds_read_b64_tr_b16 v[110:111], v6 offset:12544
    ds_read_b64_tr_b16 v[112:113], v6 offset:13312
    ds_read_b64_tr_b16 v[114:115], v6 offset:13568
    v_mfma_f32_32x32x16_bf16 v[44:59], v[96:99], v[120:123], v[44:59]
    ds_read_b64_tr_b16 v[92:93], v6 offset:14336
    ds_read_b64_tr_b16 v[94:95], v6 offset:14592
    v_mfma_f32_32x32x16_bf16 v[60:75], v[100:103], v[120:123], v[60:75]
    ds_read_b64_tr_b16 v[96:97], v6 offset:15360
    ds_read_b64_tr_b16 v[98:99], v6 offset:15616
    v_mfma_f32_32x32x16_bf16 v[76:91], v[104:107], v[120:123], v[76:91]
    ds_read_b64_tr_b16 v[100:101], v6 offset:16384
    ds_read_b64_tr_b16 v[102:103], v6 offset:16640
    s_waitcnt lgkmcnt(6)
    v_mfma_f32_32x32x16_bf16 v[12:27], v[108:111], v[124:127], v[12:27]
    s_mul_i32 s22, s21, 36864
    s_add_u32 s22, s22, s25
    s_add_u32 s21, s21, 1
    s_add_u32 m0, s28, 0
    ds_read_b64_tr_b16 v[104:105], v6 offset:18432
    ds_read_b64_tr_b16 v[106:107], v6 offset:18688
    buffer_load_dwordx4 v1, s[4:7], s22 offen offset:0 lds
    v_mfma_f32_32x32x16_bf16 v[28:43], v[112:115], v[124:127], v[28:43]
    ds_read_b64_tr_b16 v[108:109], v6 offset:19456
    ds_read_b64_tr_b16 v[110:111], v6 offset:19712
    s_waitcnt lgkmcnt(6)
    v_mfma_f32_32x32x16_bf16 v[44:59], v[92:95], v[124:127], v[44:59]
    s_add_u32 m0, s28, 960
    ds_read_b64_tr_b16 v[112:113], v6 offset:20480
    ds_read_b64_tr_b16 v[114:115], v6 offset:20736
    buffer_load_dwordx4 v2, s[4:7], s22 offen offset:64 lds
    v_mfma_f32_32x32x16_bf16 v[60:75], v[96:99], v[124:127], v[60:75]
    ds_read_b64_tr_b16 v[92:93], v6 offset:21504
    ds_read_b64_tr_b16 v[94:95], v6 offset:21760
    s_waitcnt lgkmcnt(6)
    v_mfma_f32_32x32x16_bf16 v[76:91], v[100:103], v[124:127], v[76:91]
    s_add_u32 m0, s28, 1920
    ds_read_b64_tr_b16 v[96:97], v6 offset:22528
    ds_read_b64_tr_b16 v[98:99], v6 offset:22784
    buffer_load_dwordx4 v3, s[4:7], s22 offen offset:128 lds
    v_mfma_f32_32x32x16_bf16 v[12:27], v[104:107], v[128:131], v[12:27]
    s_waitcnt lgkmcnt(4)
    v_mfma_f32_32x32x16_bf16 v[28:43], v[108:111], v[128:131], v[28:43]
    s_waitcnt vmcnt(10) lgkmcnt(0)
    s_min_u32 s54, s54, s55
    s_cmp_ge_u32 s54, 16
    s_cbranch_scc1 L_f_pb_23
    s_cmp_lg_u32 s18, 0
    s_cbranch_scc1 L_f_pw_24
    s_mov_b32 s57, 262144
L_f_pp_25:
    s_mov_b32 s45, 0
    s_atomic_add s45, s[40:41], s56 glc
    s_mov_b32 s46, 0
    s_atomic_add s46, s[40:41], s59 glc
    s_waitcnt lgkmcnt(0)
    s_cmp_lt_u32 s45, 16
    s_cbranch_scc1 L_f_ps_26
    s_cmp_ge_u32 s46, 16
    s_cbranch_scc1 L_f_pw_24
L_f_ps_26:
    s_sleep 2
    s_sub_u32 s57, s57, 1
    s_cmp_gt_i32 s57, 0
    s_cbranch_scc1 L_f_pp_25
L_f_pw_24:
L_f_pb_23:
    s_barrier
    ds_read_b128 v[132:135], v7 offset:16384
    ds_read_b128 v[136:139], v8 offset:16384
    ds_read_b128 v[140:143], v9 offset:16384
    ds_read_b128 v[144:147], v10 offset:16384
    ds_read_b64_tr_b16 v[100:101], v6 offset:24576
    ds_read_b64_tr_b16 v[102:103], v6 offset:24832
    ds_read_b64_tr_b16 v[104:105], v6 offset:25600
    ds_read_b64_tr_b16 v[106:107], v6 offset:25856
    v_mfma_f32_32x32x16_bf16 v[44:59], v[112:115], v[128:131], v[44:59]
    ds_read_b64_tr_b16 v[108:109], v6 offset:26624
    ds_read_b64_tr_b16 v[110:111], v6 offset:26880
    v_mfma_f32_32x32x16_bf16 v[60:75], v[92:95], v[128:131], v[60:75]
    ds_read_b64_tr_b16 v[112:113], v6 offset:27648
    ds_read_b64_tr_b16 v[114:115], v6 offset:27904
    v_mfma_f32_32x32x16_bf16 v[76:91], v[96:99], v[128:131], v[76:91]
    ds_read_b64_tr_b16 v[92:93], v6 offset:28672
    ds_read_b64_tr_b16 v[94:95], v6 offset:28928
    s_waitcnt lgkmcnt(6)
    v_mfma_f32_32x32x16_bf16 v[12:27], v[100:103], v[132:135], v[12:27]
    s_mul_i32 s22, s21, 36864
    s_add_u32 s22, s22, s25
    s_add_u32 s21, s21, 1
    s_cmp_eq_u32 s21, 18
    s_cselect_b32 s21, 0, s21
    s_add_u32 m0, s28, 12288
    ds_read_b64_tr_b16 v[96:97], v6 offset:30720
    ds_read_b64_tr_b16 v[98:99], v6 offset:30976
    buffer_load_dwordx4 v1, s[4:7], s22 offen offset:0 lds
    s_add_u32 m0, s28, 13248
    s_nop 0
    buffer_load_dwordx4 v2, s[4:7], s22 offen offset:64 lds
    v_mfma_f32_32x32x16_bf16 v[28:43], v[104:107], v[132:135], v[28:43]
    s_add_u32 m0, s28, 14208
    ds_read_b64_tr_b16 v[100:101], v6 offset:31744
    ds_read_b64_tr_b16 v[102:103], v6 offset:32000
    buffer_load_dwordx4 v3, s[4:7], s22 offen offset:128 lds
    s_waitcnt lgkmcnt(6)
    v_mfma_f32_32x32x16_bf16 v[44:59], v[108:111], v[132:135], v[44:59]
    v_and_b32 v220, 31, v0
    v_lshlrev_b32 v220, 4, v220
    s_lshl_b32 s56, s20, 9
    s_add_u32 s56, s56, 12058624
    ds_read_b64_tr_b16 v[104:105], v6 offset:32768
    ds_read_b64_tr_b16 v[106:107], v6 offset:33024
    buffer_load_dwordx2 v[216:217], v220, s[8:11], s56 offen sc1
    v_lshlrev_b32 v221, 2, v0
    s_mul_i32 s56, s44, 9216
    s_add_u32 s56, s56, 12386304
    buffer_load_dword v184, v221, s[8:11], s56 offen offset:0 sc1
    v_mfma_f32_32x32x16_bf16 v[60:75], v[112:115], v[132:135], v[60:75]
    ds_read_b64_tr_b16 v[108:109], v6 offset:33792
    ds_read_b64_tr_b16 v[110:111], v6 offset:34048
    buffer_load_dword v185, v221, s[8:11], s56 offen offset:576 sc1
    s_waitcnt lgkmcnt(6)
    v_mfma_f32_32x32x16_bf16 v[76:91], v[92:95], v[132:135], v[76:91]
    ds_read_b64_tr_b16 v[112:113], v6 offset:34816
    ds_read_b64_tr_b16 v[114:115], v6 offset:35072
    buffer_load_dword v186, v221, s[8:11], s56 offen offset:1152 sc1
    buffer_load_dword v187, v221, s[8:11], s56 offen offset:1728 sc1
    v_mfma_f32_32x32x16_bf16 v[12:27], v[96:99], v[136:139], v[12:27]
    s_add_u32 s56, s56, 2304
    buffer_load_dword v188, v221, s[8:11], s56 offen offset:0 sc1
    s_waitcnt lgkmcnt(4)
    v_mfma_f32_32x32x16_bf16 v[28:43], v[100:103], v[136:139], v[28:43]
    s_waitcnt vmcnt(16) lgkmcnt(0)
    s_barrier
    ds_read_b64_tr_b16 v[92:93], v6 offset:36864
    ds_read_b64_tr_b16 v[94:95], v6 offset:37120
    ds_read_b64_tr_b16 v[96:97], v6 offset:37888
    ds_read_b64_tr_b16 v[98:99], v6 offset:38144
    v_mfma_f32_32x32x16_bf16 v[44:59], v[104:107], v[136:139], v[44:59]
    ds_read_b64_tr_b16 v[100:101], v6 offset:38912
    ds_read_b64_tr_b16 v[102:103], v6 offset:39168
    v_mfma_f32_32x32x16_bf16 v[60:75], v[108:111], v[136:139], v[60:75]
    ds_read_b64_tr_b16 v[104:105], v6 offset:39936
    ds_read_b64_tr_b16 v[106:107], v6 offset:40192
    v_mfma_f32_32x32x16_bf16 v[76:91], v[112:115], v[136:139], v[76:91]
    ds_read_b64_tr_b16 v[108:109], v6 offset:40960
    ds_read_b64_tr_b16 v[110:111], v6 offset:41216
    s_waitcnt lgkmcnt(6)
    v_mfma_f32_32x32x16_bf16 v[12:27], v[92:95], v[140:143], v[12:27]
    ds_read_b64_tr_b16 v[112:113], v6 offset:43008
    ds_read_b64_tr_b16 v[114:115], v6 offset:43264
    buffer_load_dword v189, v221, s[8:11], s56 offen offset:576 sc1
    v_mfma_f32_32x32x16_bf16 v[28:43], v[96:99], v[140:143], v[28:43]
    ds_read_b64_tr_b16 v[92:93], v6 offset:44032
    ds_read_b64_tr_b16 v[94:95], v6 offset:44288
    buffer_load_dword v190, v221, s[8:11], s56 offen offset:1152 sc1
    s_waitcnt lgkmcnt(6)
    v_mfma_f32_32x32x16_bf16 v[44:59], v[100:103], v[140:143], v[44:59]
    ds_read_b64_tr_b16 v[96:97], v6 offset:45056
    ds_read_b64_tr_b16 v[98:99], v6 offset:45312
    buffer_load_dword v191, v221, s[8:11], s56 offen offset:1728 sc1
    v_mfma_f32_32x32x16_bf16 v[60:75], v[104:107], v[140:143], v[60:75]
    s_add_u32 s56, s56, 2304
    ds_read_b64_tr_b16 v[100:101], v6 offset:46080
    ds_read_b64_tr_b16 v[102:103], v6 offset:46336
    buffer_load_dword v192, v221, s[8:11], s56 offen offset:0 sc1
    s_waitcnt lgkmcnt(6)
    v_mfma_f32_32x32x16_bf16 v[76:91], v[108:111], v[140:143], v[76:91]
    ds_read_b64_tr_b16 v[104:105], v6 offset:47104
    ds_read_b64_tr_b16 v[106:107], v6 offset:47360
    buffer_load_dword v193, v221, s[8:11], s56 offen offset:576 sc1
    v_mfma_f32_32x32x16_bf16 v[12:27], v[112:115], v[144:147], v[12:27]
    buffer_load_dword v194, v221, s[8:11], s56 offen offset:1152 sc1
    s_waitcnt lgkmcnt(4)
    v_mfma_f32_32x32x16_bf16 v[28:43], v[92:95], v[144:147], v[28:43]
    s_waitcnt vmcnt(15) lgkmcnt(0)
    s_barrier
    ds_read_b128 v[116:119], v7 offset:0
    ds_read_b128 v[120:123], v8 offset:0
    ds_read_b128 v[124:127], v9 offset:0
    ds_read_b128 v[128:131], v10 offset:0
    ds_read_b64_tr_b16 v[108:109], v6 offset:0
    ds_read_b64_tr_b16 v[110:111], v6 offset:256
    ds_read_b64_tr_b16 v[112:113], v6 offset:1024
    ds_read_b64_tr_b16 v[114:115], v6 offset:1280
    v_mfma_f32_32x32x16_bf16 v[44:59], v[96:99], v[144:147], v[44:59]
    ds_read_b64_tr_b16 v[92:93], v6 offset:2048
    ds_read_b64_tr_b16 v[94:95], v6 offset:2304
    v_mfma_f32_32x32x16_bf16 v[60:75], v[100:103], v[144:147], v[60:75]
    ds_read_b64_tr_b16 v[96:97], v6 offset:3072
    ds_read_b64_tr_b16 v[98:99], v6 offset:3328
    v_mfma_f32_32x32x16_bf16 v[76:91], v[104:107], v[144:147], v[76:91]
    ds_read_b64_tr_b16 v[100:101], v6 offset:4096
    ds_read_b64_tr_b16 v[102:103], v6 offset:4352
    s_waitcnt lgkmcnt(6)
    v_mfma_f32_32x32x16_bf16 v[12:27], v[108:111], v[116:119], v[12:27]
    ds_read_b64_tr_b16 v[104:105], v6 offset:6144
    ds_read_b64_tr_b16 v[106:107], v6 offset:6400
    buffer_load_dword v195, v221, s[8:11], s56 offen offset:1728 sc1
    v_mfma_f32_32x32x16_bf16 v[28:43], v[112:115], v[116:119], v[28:43]
    s_add_u32 s56, s56, 2304
    ds_read_b64_tr_b16 v[108:109], v6 offset:7168
    ds_read_b64_tr_b16 v[110:111], v6 offset:7424
    buffer_load_dword v196, v221, s[8:11], s56 offen offset:0 sc1
    s_waitcnt lgkmcnt(6)
    v_mfma_f32_32x32x16_bf16 v[44:59], v[92:95], v[116:119], v[44:59]
    ds_read_b64_tr_b16 v[112:113], v6 offset:8192
    ds_read_b64_tr_b16 v[114:115], v6 offset:8448
    buffer_load_dword v197, v221, s[8:11], s56 offen offset:576 sc1
    v_mfma_f32_32x32x16_bf16 v[60:75], v[96:99], v[116:119], v[60:75]
    ds_read_b64_tr_b16 v[92:93], v6 offset:9216
    ds_read_b64_tr_b16 v[94:95], v6 offset:9472
    buffer_load_dword v198, v221, s[8:11], s56 offen offset:1152 sc1
    s_waitcnt lgkmcnt(6)
    v_mfma_f32_32x32x16_bf16 v[76:91], v[100:103], v[116:119], v[76:91]
    ds_read_b64_tr_b16 v[96:97], v6 offset:10240
    ds_read_b64_tr_b16 v[98:99], v6 offset:10496
    buffer_load_dword v199, v221, s[8:11], s56 offen offset:1728 sc1
    v_mfma_f32_32x32x16_bf16 v[12:27], v[104:107], v[120:123], v[12:27]
    s_waitcnt lgkmcnt(4)
    v_mfma_f32_32x32x16_bf16 v[28:43], v[108:111], v[120:123], v[28:43]
    s_waitcnt vmcnt(17) lgkmcnt(0)
    s_barrier
    ds_read_b64_tr_b16 v[100:101], v6 offset:12288
    ds_read_b64_tr_b16 v[102:103], v6 offset:12544
    ds_read_b64_tr_b16 v[104:105], v6 offset:13312
    ds_read_b64_tr_b16 v[106:107], v6 offset:13568
    v_mfma_f32_32x32x16_bf16 v[44:59], v[112:115], v[120:123], v[44:59]
    ds_read_b64_tr_b16 v[108:109], v6 offset:14336
    ds_read_b64_tr_b16 v[110:111], v6 offset:14592
    v_mfma_f32_32x32x16_bf16 v[60:75], v[92:95], v[120:123], v[60:75]
    ds_read_b64_tr_b16 v[112:113], v6 offset:15360
    ds_read_b64_tr_b16 v[114:115], v6 offset:15616
    v_mfma_f32_32x32x16_bf16 v[76:91], v[96:99], v[120:123], v[76:91]
    ds_read_b64_tr_b16 v[92:93], v6 offset:16384
    ds_read_b64_tr_b16 v[94:95], v6 offset:16640
    s_waitcnt lgkmcnt(6)
    v_mfma_f32_32x32x16_bf16 v[12:27], v[100:103], v[124:127], v[12:27]
    ds_read_b64_tr_b16 v[96:97], v6 offset:18432
    ds_read_b64_tr_b16 v[98:99], v6 offset:18688
    v_mfma_f32_32x32x16_bf16 v[28:43], v[104:107], v[124:127], v[28:43]
    ds_read_b64_tr_b16 v[100:101], v6 offset:19456
    ds_read_b64_tr_b16 v[102:103], v6 offset:19712
    s_waitcnt lgkmcnt(6)
    v_mfma_f32_32x32x16_bf16 v[44:59], v[108:111], v[124:127], v[44:59]
    ds_read_b64_tr_b16 v[104:105], v6 offset:20480
    ds_read_b64_tr_b16 v[106:107], v6 offset:20736
    v_mfma_f32_32x32x16_bf16 v[60:75], v[112:115], v[124:127], v[60:75]
    ds_read_b64_tr_b16 v[108:109], v6 offset:21504
    ds_read_b64_tr_b16 v[110:111], v6 offset:21760
    s_waitcnt lgkmcnt(6)
    v_mfma_f32_32x32x16_bf16 v[76:91], v[92:95], v[124:127], v[76:91]
    ds_read_b64_tr_b16 v[112:113], v6 offset:22528
    ds_read_b64_tr_b16 v[114:115], v6 offset:22784
    v_mfma_f32_32x32x16_bf16 v[12:27], v[96:99], v[128:131], v[12:27]
    s_waitcnt lgkmcnt(4)
    v_mfma_f32_32x32x16_bf16 v[28:43], v[100:103], v[128:131], v[28:43]
    v_mfma_f32_32x32x16_bf16 v[44:59], v[104:107], v[128:131], v[44:59]
    s_waitcnt lgkmcnt(0)
    v_mfma_f32_32x32x16_bf16 v[60:75], v[108:111], v[128:131], v[60:75]
    v_mfma_f32_32x32x16_bf16 v[76:91], v[112:115], v[128:131], v[76:91]
    s_waitcnt vmcnt(0)
    v_add_f32 v184, v184, v192
    v_add_f32 v185, v185, v193
    v_add_f32 v186, v186, v194
    v_add_f32 v187, v187, v195
    v_add_f32 v188, v188, v196
    v_add_f32 v189, v189, v197
    v_add_f32 v190, v190, v198
    v_add_f32 v191, v191, v199
    v_add_f32 v184, v184, v188
    v_add_f32 v185, v185, v189
    v_add_f32 v186, v186, v190
    v_add_f32 v187, v187, v191
    v_add_f32 v184, v184, v186
    v_add_f32 v185, v185, v187
    v_add_f32 v184, v184, v185
    ds_write_b32 v221, v184 offset:24576
    v_and_b32 v224, 63, v0
    v_lshlrev_b32 v222, 4, v224
    s_mul_i32 s26, s20, 36
    s_mul_i32 s27, s44, 9
    s_add_u32 s26, s26, s27
    s_lshl_b32 s26, s26, 10
    s_add_u32 s26, s26, 7340032
    v_mov_b32 v218, 0xc0135761
    s_mov_b32 s30, 0xbdd2d3e8
    v_lshrrev_b32 v223, 5, v224
    v_lshlrev_b32 v223, 5, v223
    s_waitcnt lgkmcnt(0)
    s_barrier
    ds_read_b128 v[200:203], v223 offset:24576
    ds_read_b128 v[204:207], v223 offset:24592
    ds_read_b128 v[208:211], v223 offset:24640
    ds_read_b128 v[212:215], v223 offset:24656
    ds_read_b128 v[92:95], v223 offset:24704
    ds_read_b128 v[96:99], v223 offset:24720
    ds_read_b128 v[100:103], v223 offset:24768
    ds_read_b128 v[104:107], v223 offset:24784
    s_waitcnt lgkmcnt(4)
    v_pk_mul_f32 v[200:201], v[200:201], v[216:217] op_sel:[0,1] op_sel_hi:[1,1]
    v_pk_mul_f32 v[202:203], v[202:203], v[216:217] op_sel:[0,1] op_sel_hi:[1,1]
    v_pk_mul_f32 v[204:205], v[204:205], v[216:217] op_sel:[0,1] op_sel_hi:[1,1]
    v_pk_mul_f32 v[206:207], v[206:207], v[216:217] op_sel:[0,1] op_sel_hi:[1,1]
    v_pk_mul_f32 v[208:209], v[208:209], v[216:217] op_sel:[0,1] op_sel_hi:[1,1]
    v_pk_mul_f32 v[210:211], v[210:211], v[216:217] op_sel:[0,1] op_sel_hi:[1,1]
    v_pk_mul_f32 v[212:213], v[212:213], v[216:217] op_sel:[0,1] op_sel_hi:[1,1]
    v_pk_mul_f32 v[214:215], v[214:215], v[216:217] op_sel:[0,1] op_sel_hi:[1,1]
    v_pk_fma_f32 v[12:13], v[12:13], v[216:217], v[200:201] op_sel_hi:[1,0,1]
    v_pk_fma_f32 v[14:15], v[14:15], v[216:217], v[202:203] op_sel_hi:[1,0,1]
    v_pk_fma_f32 v[16:17], v[16:17], v[216:217], v[204:205] op_sel_hi:[1,0,1]
    v_pk_fma_f32 v[18:19], v[18:19], v[216:217], v[206:207] op_sel_hi:[1,0,1]
    v_pk_fma_f32 v[20:21], v[20:21], v[216:217], v[208:209] op_sel_hi:[1,0,1]
    v_pk_fma_f32 v[22:23], v[22:23], v[216:217], v[210:211] op_sel_hi:[1,0,1]
    v_pk_fma_f32 v[24:25], v[24:25], v[216:217], v[212:213] op_sel_hi:[1,0,1]
    v_pk_fma_f32 v[26:27], v[26:27], v[216:217], v[214:215] op_sel_hi:[1,0,1]
    v_pk_mul_f32 v[148:149], v[12:13], v[12:13]
    v_pk_mul_f32 v[150:151], v[14:15], v[14:15]
    v_pk_mul_f32 v[152:153], v[16:17], v[16:17]
    v_pk_mul_f32 v[154:155], v[18:19], v[18:19]
    v_pk_mul_f32 v[156:157], v[20:21], v[20:21]
    v_pk_mul_f32 v[158:159], v[22:23], v[22:23]
    v_pk_mul_f32 v[160:161], v[24:25], v[24:25]
    v_pk_mul_f32 v[162:163], v[26:27], v[26:27]
    v_pk_fma_f32 v[148:149], v[148:149], s[30:31], v[218:219] op_sel_hi:[1,0,0]
    v_pk_fma_f32 v[150:151], v[150:151], s[30:31], v[218:219] op_sel_hi:[1,0,0]
    v_pk_fma_f32 v[152:153], v[152:153], s[30:31], v[218:219] op_sel_hi:[1,0,0]
    v_pk_fma_f32 v[154:155], v[154:155], s[30:31], v[218:219] op_sel_hi:[1,0,0]
    v_pk_fma_f32 v[156:157], v[156:157], s[30:31], v[218:219] op_sel_hi:[1,0,0]
    v_pk_fma_f32 v[158:159], v[158:159], s[30:31], v[218:219] op_sel_hi:[1,0,0]
    v_pk_fma_f32 v[160:161], v[160:161], s[30:31], v[218:219] op_sel_hi:[1,0,0]
    v_pk_fma_f32 v[162:163], v[162:163], s[30:31], v[218:219] op_sel_hi:[1,0,0]
    v_pk_mul_f32 v[148:149], v[148:149], v[12:13]
    v_pk_mul_f32 v[150:151], v[150:151], v[14:15]
    v_pk_mul_f32 v[152:153], v[152:153], v[16:17]
    v_pk_mul_f32 v[154:155], v[154:155], v[18:19]
    v_pk_mul_f32 v[156:157], v[156:157], v[20:21]
    v_pk_mul_f32 v[158:159], v[158:159], v[22:23]
    v_pk_mul_f32 v[160:161], v[160:161], v[24:25]
    v_pk_mul_f32 v[162:163], v[162:163], v[26:27]
    v_exp_f32 v148, v148
    v_exp_f32 v149, v149
    v_exp_f32 v150, v150
    v_exp_f32 v151, v151
    v_exp_f32 v152, v152
    v_exp_f32 v153, v153
    v_exp_f32 v154, v154
    v_exp_f32 v155, v155
    v_exp_f32 v156, v156
    v_exp_f32 v157, v157
    v_exp_f32 v158, v158
    v_exp_f32 v159, v159
    v_exp_f32 v160, v160
    v_exp_f32 v161, v161
    v_exp_f32 v162, v162
    v_exp_f32 v163, v163
    v_pk_add_f32 v[148:149], v[148:149], 1.0 op_sel_hi:[1,0]
    v_pk_add_f32 v[150:151], v[150:151], 1.0 op_sel_hi:[1,0]
    v_pk_add_f32 v[152:153], v[152:153], 1.0 op_sel_hi:[1,0]
    v_pk_add_f32 v[154:155], v[154:155], 1.0 op_sel_hi:[1,0]
    v_pk_add_f32 v[156:157], v[156:157], 1.0 op_sel_hi:[1,0]
    v_pk_add_f32 v[158:159], v[158:159], 1.0 op_sel_hi:[1,0]
    v_pk_add_f32 v[160:161], v[160:161], 1.0 op_sel_hi:[1,0]
    v_pk_add_f32 v[162:163], v[162:163], 1.0 op_sel_hi:[1,0]
    v_rcp_f32 v148, v148
    v_rcp_f32 v149, v149
    v_rcp_f32 v150, v150
    v_rcp_f32 v151, v151
    v_rcp_f32 v152, v152
    v_rcp_f32 v153, v153
    v_rcp_f32 v154, v154
    v_rcp_f32 v155, v155
    v_rcp_f32 v156, v156
    v_rcp_f32 v157, v157
    v_rcp_f32 v158, v158
    v_rcp_f32 v159, v159
    v_rcp_f32 v160, v160
    v_rcp_f32 v161, v161
    v_rcp_f32 v162, v162
    v_rcp_f32 v163, v163
    v_pk_mul_f32 v[148:149], v[148:149], v[12:13]
    v_pk_mul_f32 v[150:151], v[150:151], v[14:15]
    v_pk_mul_f32 v[152:153], v[152:153], v[16:17]
    v_pk_mul_f32 v[154:155], v[154:155], v[18:19]
    v_pk_mul_f32 v[156:157], v[156:157], v[20:21]
    v_pk_mul_f32 v[158:159], v[158:159], v[22:23]
    v_pk_mul_f32 v[160:161], v[160:161], v[24:25]
    v_pk_mul_f32 v[162:163], v[162:163], v[26:27]
    v_cvt_pk_bf16_f32 v164, v148, v149
    v_cvt_pk_bf16_f32 v165, v150, v151
    v_cvt_pk_bf16_f32 v166, v152, v153
    v_cvt_pk_bf16_f32 v167, v154, v155
    v_cvt_pk_bf16_f32 v168, v156, v157
    v_cvt_pk_bf16_f32 v169, v158, v159
    v_cvt_pk_bf16_f32 v170, v160, v161
    v_cvt_pk_bf16_f32 v171, v162, v163
    buffer_store_dwordx4 v[164:167], v222, s[8:11], s26 offen offset:0 sc1
    buffer_store_dwordx4 v[168:171], v222, s[8:11], s26 offen offset:1024 sc1
    s_add_u32 s26, s26, 2048
    ds_read_b128 v[200:203], v223 offset:24832
    ds_read_b128 v[204:207], v223 offset:24848
    ds_read_b128 v[208:211], v223 offset:24896
    ds_read_b128 v[212:215], v223 offset:24912
    s_waitcnt lgkmcnt(4)
    v_pk_mul_f32 v[92:93], v[92:93], v[216:217] op_sel:[0,1] op_sel_hi:[1,1]
    v_pk_mul_f32 v[94:95], v[94:95], v[216:217] op_sel:[0,1] op_sel_hi:[1,1]
    v_pk_mul_f32 v[96:97], v[96:97], v[216:217] op_sel:[0,1] op_sel_hi:[1,1]
    v_pk_mul_f32 v[98:99], v[98:99], v[216:217] op_sel:[0,1] op_sel_hi:[1,1]
    v_pk_mul_f32 v[100:101], v[100:101], v[216:217] op_sel:[0,1] op_sel_hi:[1,1]
    v_pk_mul_f32 v[102:103], v[102:103], v[216:217] op_sel:[0,1] op_sel_hi:[1,1]
    v_pk_mul_f32 v[104:105], v[104:105], v[216:217] op_sel:[0,1] op_sel_hi:[1,1]
    v_pk_mul_f32 v[106:107], v[106:107], v[216:217] op_sel:[0,1] op_sel_hi:[1,1]
    v_pk_fma_f32 v[28:29], v[28:29], v[216:217], v[92:93] op_sel_hi:[1,0,1]
    v_pk_fma_f32 v[30:31], v[30:31], v[216:217], v[94:95] op_sel_hi:[1,0,1]
    v_pk_fma_f32 v[32:33], v[32:33], v[216:217], v[96:97] op_sel_hi:[1,0,1]
    v_pk_fma_f32 v[34:35], v[34:35], v[216:217], v[98:99] op_sel_hi:[1,0,1]
    v_pk_fma_f32 v[36:37], v[36:37], v[216:217], v[100:101] op_sel_hi:[1,0,1]
    v_pk_fma_f32 v[38:39], v[38:39], v[216:217], v[102:103] op_sel_hi:[1,0,1]
    v_pk_fma_f32 v[40:41], v[40:41], v[216:217], v[104:105] op_sel_hi:[1,0,1]
    v_pk_fma_f32 v[42:43], v[42:43], v[216:217], v[106:107] op_sel_hi:[1,0,1]
    v_pk_mul_f32 v[148:149], v[28:29], v[28:29]
    v_pk_mul_f32 v[150:151], v[30:31], v[30:31]
    v_pk_mul_f32 v[152:153], v[32:33], v[32:33]
    v_pk_mul_f32 v[154:155], v[34:35], v[34:35]
    v_pk_mul_f32 v[156:157], v[36:37], v[36:37]
    v_pk_mul_f32 v[158:159], v[38:39], v[38:39]
    v_pk_mul_f32 v[160:161], v[40:41], v[40:41]
    v_pk_mul_f32 v[162:163], v[42:43], v[42:43]
    v_pk_fma_f32 v[148:149], v[148:149], s[30:31], v[218:219] op_sel_hi:[1,0,0]
    v_pk_fma_f32 v[150:151], v[150:151], s[30:31], v[218:219] op_sel_hi:[1,0,0]
    v_pk_fma_f32 v[152:153], v[152:153], s[30:31], v[218:219] op_sel_hi:[1,0,0]
    v_pk_fma_f32 v[154:155], v[154:155], s[30:31], v[218:219] op_sel_hi:[1,0,0]
    v_pk_fma_f32 v[156:157], v[156:157], s[30:31], v[218:219] op_sel_hi:[1,0,0]
    v_pk_fma_f32 v[158:159], v[158:159], s[30:31], v[218:219] op_sel_hi:[1,0,0]
    v_pk_fma_f32 v[160:161], v[160:161], s[30:31], v[218:219] op_sel_hi:[1,0,0]
    v_pk_fma_f32 v[162:163], v[162:163], s[30:31], v[218:219] op_sel_hi:[1,0,0]
    v_pk_mul_f32 v[148:149], v[148:149], v[28:29]
    v_pk_mul_f32 v[150:151], v[150:151], v[30:31]
    v_pk_mul_f32 v[152:153], v[152:153], v[32:33]
    v_pk_mul_f32 v[154:155], v[154:155], v[34:35]
    v_pk_mul_f32 v[156:157], v[156:157], v[36:37]
    v_pk_mul_f32 v[158:159], v[158:159], v[38:39]
    v_pk_mul_f32 v[160:161], v[160:161], v[40:41]
    v_pk_mul_f32 v[162:163], v[162:163], v[42:43]
    v_exp_f32 v148, v148
    v_exp_f32 v149, v149
    v_exp_f32 v150, v150
    v_exp_f32 v151, v151
    v_exp_f32 v152, v152
    v_exp_f32 v153, v153
    v_exp_f32 v154, v154
    v_exp_f32 v155, v155
    v_exp_f32 v156, v156
    v_exp_f32 v157, v157
    v_exp_f32 v158, v158
    v_exp_f32 v159, v159
    v_exp_f32 v160, v160
    v_exp_f32 v161, v161
    v_exp_f32 v162, v162
    v_exp_f32 v163, v163
    v_pk_add_f32 v[148:149], v[148:149], 1.0 op_sel_hi:[1,0]
    v_pk_add_f32 v[150:151], v[150:151], 1.0 op_sel_hi:[1,0]
    v_pk_add_f32 v[152:153], v[152:153], 1.0 op_sel_hi:[1,0]
    v_pk_add_f32 v[154:155], v[154:155], 1.0 op_sel_hi:[1,0]
    v_pk_add_f32 v[156:157], v[156:157], 1.0 op_sel_hi:[1,0]
    v_pk_add_f32 v[158:159], v[158:159], 1.0 op_sel_hi:[1,0]
    v_pk_add_f32 v[160:161], v[160:161], 1.0 op_sel_hi:[1,0]
    v_pk_add_f32 v[162:163], v[162:163], 1.0 op_sel_hi:[1,0]
    v_rcp_f32 v148, v148
    v_rcp_f32 v149, v149
    v_rcp_f32 v150, v150
    v_rcp_f32 v151, v151
    v_rcp_f32 v152, v152
    v_rcp_f32 v153, v153
    v_rcp_f32 v154, v154
    v_rcp_f32 v155, v155
    v_rcp_f32 v156, v156
    v_rcp_f32 v157, v157
    v_rcp_f32 v158, v158
    v_rcp_f32 v159, v159
    v_rcp_f32 v160, v160
    v_rcp_f32 v161, v161
    v_rcp_f32 v162, v162
    v_rcp_f32 v163, v163
    v_pk_mul_f32 v[148:149], v[148:149], v[28:29]
    v_pk_mul_f32 v[150:151], v[150:151], v[30:31]
    v_pk_mul_f32 v[152:153], v[152:153], v[32:33]
    v_pk_mul_f32 v[154:155], v[154:155], v[34:35]
    v_pk_mul_f32 v[156:157], v[156:157], v[36:37]
    v_pk_mul_f32 v[158:159], v[158:159], v[38:39]
    v_pk_mul_f32 v[160:161], v[160:161], v[40:41]
    v_pk_mul_f32 v[162:163], v[162:163], v[42:43]
    v_cvt_pk_bf16_f32 v172, v148, v149
    v_cvt_pk_bf16_f32 v173, v150, v151
    v_cvt_pk_bf16_f32 v174, v152, v153
    v_cvt_pk_bf16_f32 v175, v154, v155
    v_cvt_pk_bf16_f32 v176, v156, v157
    v_cvt_pk_bf16_f32 v177, v158, v159
    v_cvt_pk_bf16_f32 v178, v160, v161
    v_cvt_pk_bf16_f32 v179, v162, v163
    buffer_store_dwordx4 v[172:175], v222, s[8:11], s26 offen offset:0 sc1
    buffer_store_dwordx4 v[176:179], v222, s[8:11], s26 offen offset:1024 sc1
    s_add_u32 s26, s26, 2048
    ds_read_b128 v[92:95], v223 offset:24960
    ds_read_b128 v[96:99], v223 offset:24976
    ds_read_b128 v[100:103], v223 offset:25024
    ds_read_b128 v[104:107], v223 offset:25040
    s_waitcnt lgkmcnt(4)
    v_pk_mul_f32 v[200:201], v[200:201], v[216:217] op_sel:[0,1] op_sel_hi:[1,1]
    v_pk_mul_f32 v[202:203], v[202:203], v[216:217] op_sel:[0,1] op_sel_hi:[1,1]
    v_pk_mul_f32 v[204:205], v[204:205], v[216:217] op_sel:[0,1] op_sel_hi:[1,1]
    v_pk_mul_f32 v[206:207], v[206:207], v[216:217] op_sel:[0,1] op_sel_hi:[1,1]
    v_pk_mul_f32 v[208:209], v[208:209], v[216:217] op_sel:[0,1] op_sel_hi:[1,1]
    v_pk_mul_f32 v[210:211], v[210:211], v[216:217] op_sel:[0,1] op_sel_hi:[1,1]
    v_pk_mul_f32 v[212:213], v[212:213], v[216:217] op_sel:[0,1] op_sel_hi:[1,1]
    v_pk_mul_f32 v[214:215], v[214:215], v[216:217] op_sel:[0,1] op_sel_hi:[1,1]
    v_pk_fma_f32 v[44:45], v[44:45], v[216:217], v[200:201] op_sel_hi:[1,0,1]
    v_pk_fma_f32 v[46:47], v[46:47], v[216:217], v[202:203] op_sel_hi:[1,0,1]
    v_pk_fma_f32 v[48:49], v[48:49], v[216:217], v[204:205] op_sel_hi:[1,0,1]
    v_pk_fma_f32 v[50:51], v[50:51], v[216:217], v[206:207] op_sel_hi:[1,0,1]
    v_pk_fma_f32 v[52:53], v[52:53], v[216:217], v[208:209] op_sel_hi:[1,0,1]
    v_pk_fma_f32 v[54:55], v[54:55], v[216:217], v[210:211] op_sel_hi:[1,0,1]
    v_pk_fma_f32 v[56:57], v[56:57], v[216:217], v[212:213] op_sel_hi:[1,0,1]
    v_pk_fma_f32 v[58:59], v[58:59], v[216:217], v[214:215] op_sel_hi:[1,0,1]
    v_pk_mul_f32 v[148:149], v[44:45], v[44:45]
    v_pk_mul_f32 v[150:151], v[46:47], v[46:47]
    v_pk_mul_f32 v[152:153], v[48:49], v[48:49]
    v_pk_mul_f32 v[154:155], v[50:51], v[50:51]
    v_pk_mul_f32 v[156:157], v[52:53], v[52:53]
    v_pk_mul_f32 v[158:159], v[54:55], v[54:55]
    v_pk_mul_f32 v[160:161], v[56:57], v[56:57]
    v_pk_mul_f32 v[162:163], v[58:59], v[58:59]
    v_pk_fma_f32 v[148:149], v[148:149], s[30:31], v[218:219] op_sel_hi:[1,0,0]
    v_pk_fma_f32 v[150:151], v[150:151], s[30:31], v[218:219] op_sel_hi:[1,0,0]
    v_pk_fma_f32 v[152:153], v[152:153], s[30:31], v[218:219] op_sel_hi:[1,0,0]
    v_pk_fma_f32 v[154:155], v[154:155], s[30:31], v[218:219] op_sel_hi:[1,0,0]
    v_pk_fma_f32 v[156:157], v[156:157], s[30:31], v[218:219] op_sel_hi:[1,0,0]
    v_pk_fma_f32 v[158:159], v[158:159], s[30:31], v[218:219] op_sel_hi:[1,0,0]
    v_pk_fma_f32 v[160:161], v[160:161], s[30:31], v[218:219] op_sel_hi:[1,0,0]
    v_pk_fma_f32 v[162:163], v[162:163], s[30:31], v[218:219] op_sel_hi:[1,0,0]
    v_pk_mul_f32 v[148:149], v[148:149], v[44:45]
    v_pk_mul_f32 v[150:151], v[150:151], v[46:47]
    v_pk_mul_f32 v[152:153], v[152:153], v[48:49]
    v_pk_mul_f32 v[154:155], v[154:155], v[50:51]
    v_pk_mul_f32 v[156:157], v[156:157], v[52:53]
    v_pk_mul_f32 v[158:159], v[158:159], v[54:55]
    v_pk_mul_f32 v[160:161], v[160:161], v[56:57]
    v_pk_mul_f32 v[162:163], v[162:163], v[58:59]
    v_exp_f32 v148, v148
    v_exp_f32 v149, v149
    v_exp_f32 v150, v150
    v_exp_f32 v151, v151
    v_exp_f32 v152, v152
    v_exp_f32 v153, v153
    v_exp_f32 v154, v154
    v_exp_f32 v155, v155
    v_exp_f32 v156, v156
    v_exp_f32 v157, v157
    v_exp_f32 v158, v158
    v_exp_f32 v159, v159
    v_exp_f32 v160, v160
    v_exp_f32 v161, v161
    v_exp_f32 v162, v162
    v_exp_f32 v163, v163
    v_pk_add_f32 v[148:149], v[148:149], 1.0 op_sel_hi:[1,0]
    v_pk_add_f32 v[150:151], v[150:151], 1.0 op_sel_hi:[1,0]
    v_pk_add_f32 v[152:153], v[152:153], 1.0 op_sel_hi:[1,0]
    v_pk_add_f32 v[154:155], v[154:155], 1.0 op_sel_hi:[1,0]
    v_pk_add_f32 v[156:157], v[156:157], 1.0 op_sel_hi:[1,0]
    v_pk_add_f32 v[158:159], v[158:159], 1.0 op_sel_hi:[1,0]
    v_pk_add_f32 v[160:161], v[160:161], 1.0 op_sel_hi:[1,0]
    v_pk_add_f32 v[162:163], v[162:163], 1.0 op_sel_hi:[1,0]
    v_rcp_f32 v148, v148
    v_rcp_f32 v149, v149
    v_rcp_f32 v150, v150
    v_rcp_f32 v151, v151
    v_rcp_f32 v152, v152
    v_rcp_f32 v153, v153
    v_rcp_f32 v154, v154
    v_rcp_f32 v155, v155
    v_rcp_f32 v156, v156
    v_rcp_f32 v157, v157
    v_rcp_f32 v158, v158
    v_rcp_f32 v159, v159
    v_rcp_f32 v160, v160
    v_rcp_f32 v161, v161
    v_rcp_f32 v162, v162
    v_rcp_f32 v163, v163
    v_pk_mul_f32 v[148:149], v[148:149], v[44:45]
    v_pk_mul_f32 v[150:151], v[150:151], v[46:47]
    v_pk_mul_f32 v[152:153], v[152:153], v[48:49]
    v_pk_mul_f32 v[154:155], v[154:155], v[50:51]
    v_pk_mul_f32 v[156:157], v[156:157], v[52:53]
    v_pk_mul_f32 v[158:159], v[158:159], v[54:55]
    v_pk_mul_f32 v[160:161], v[160:161], v[56:57]
    v_pk_mul_f32 v[162:163], v[162:163], v[58:59]
    v_cvt_pk_bf16_f32 v164, v148, v149
    v_cvt_pk_bf16_f32 v165, v150, v151
    v_cvt_pk_bf16_f32 v166, v152, v153
    v_cvt_pk_bf16_f32 v167, v154, v155
    v_cvt_pk_bf16_f32 v168, v156, v157
    v_cvt_pk_bf16_f32 v169, v158, v159
    v_cvt_pk_bf16_f32 v170, v160, v161
    v_cvt_pk_bf16_f32 v171, v162, v163
    buffer_store_dwordx4 v[164:167], v222, s[8:11], s26 offen offset:0 sc1
    buffer_store_dwordx4 v[168:171], v222, s[8:11], s26 offen offset:1024 sc1
    s_add_u32 s26, s26, 2048
    ds_read_b128 v[200:203], v223 offset:25088
    ds_read_b128 v[204:207], v223 offset:25104
    s_waitcnt lgkmcnt(2)
    v_pk_mul_f32 v[92:93], v[92:93], v[216:217] op_sel:[0,1] op_sel_hi:[1,1]
    v_pk_mul_f32 v[94:95], v[94:95], v[216:217] op_sel:[0,1] op_sel_hi:[1,1]
    v_pk_mul_f32 v[96:97], v[96:97], v[216:217] op_sel:[0,1] op_sel_hi:[1,1]
    v_pk_mul_f32 v[98:99], v[98:99], v[216:217] op_sel:[0,1] op_sel_hi:[1,1]
    v_pk_mul_f32 v[100:101], v[100:101], v[216:217] op_sel:[0,1] op_sel_hi:[1,1]
    v_pk_mul_f32 v[102:103], v[102:103], v[216:217] op_sel:[0,1] op_sel_hi:[1,1]
    v_pk_mul_f32 v[104:105], v[104:105], v[216:217] op_sel:[0,1] op_sel_hi:[1,1]
    v_pk_mul_f32 v[106:107], v[106:107], v[216:217] op_sel:[0,1] op_sel_hi:[1,1]
    v_pk_fma_f32 v[60:61], v[60:61], v[216:217], v[92:93] op_sel_hi:[1,0,1]
    v_pk_fma_f32 v[62:63], v[62:63], v[216:217], v[94:95] op_sel_hi:[1,0,1]
    v_pk_fma_f32 v[64:65], v[64:65], v[216:217], v[96:97] op_sel_hi:[1,0,1]
    v_pk_fma_f32 v[66:67], v[66:67], v[216:217], v[98:99] op_sel_hi:[1,0,1]
    v_pk_fma_f32 v[68:69], v[68:69], v[216:217], v[100:101] op_sel_hi:[1,0,1]
    v_pk_fma_f32 v[70:71], v[70:71], v[216:217], v[102:103] op_sel_hi:[1,0,1]
    v_pk_fma_f32 v[72:73], v[72:73], v[216:217], v[104:105] op_sel_hi:[1,0,1]
    v_pk_fma_f32 v[74:75], v[74:75], v[216:217], v[106:107] op_sel_hi:[1,0,1]
    v_pk_mul_f32 v[148:149], v[60:61], v[60:61]
    v_pk_mul_f32 v[150:151], v[62:63], v[62:63]
    v_pk_mul_f32 v[152:153], v[64:65], v[64:65]
    v_pk_mul_f32 v[154:155], v[66:67], v[66:67]
    v_pk_mul_f32 v[156:157], v[68:69], v[68:69]
    v_pk_mul_f32 v[158:159], v[70:71], v[70:71]
    v_pk_mul_f32 v[160:161], v[72:73], v[72:73]
    v_pk_mul_f32 v[162:163], v[74:75], v[74:75]
    v_pk_fma_f32 v[148:149], v[148:149], s[30:31], v[218:219] op_sel_hi:[1,0,0]
    v_pk_fma_f32 v[150:151], v[150:151], s[30:31], v[218:219] op_sel_hi:[1,0,0]
    v_pk_fma_f32 v[152:153], v[152:153], s[30:31], v[218:219] op_sel_hi:[1,0,0]
    v_pk_fma_f32 v[154:155], v[154:155], s[30:31], v[218:219] op_sel_hi:[1,0,0]
    v_pk_fma_f32 v[156:157], v[156:157], s[30:31], v[218:219] op_sel_hi:[1,0,0]
    v_pk_fma_f32 v[158:159], v[158:159], s[30:31], v[218:219] op_sel_hi:[1,0,0]
    v_pk_fma_f32 v[160:161], v[160:161], s[30:31], v[218:219] op_sel_hi:[1,0,0]
    v_pk_fma_f32 v[162:163], v[162:163], s[30:31], v[218:219] op_sel_hi:[1,0,0]
    v_pk_mul_f32 v[148:149], v[148:149], v[60:61]
    v_pk_mul_f32 v[150:151], v[150:151], v[62:63]
    v_pk_mul_f32 v[152:153], v[152:153], v[64:65]
    v_pk_mul_f32 v[154:155], v[154:155], v[66:67]
    v_pk_mul_f32 v[156:157], v[156:157], v[68:69]
    v_pk_mul_f32 v[158:159], v[158:159], v[70:71]
    v_pk_mul_f32 v[160:161], v[160:161], v[72:73]
    v_pk_mul_f32 v[162:163], v[162:163], v[74:75]
    v_exp_f32 v148, v148
    v_exp_f32 v149, v149
    v_exp_f32 v150, v150
    v_exp_f32 v151, v151
    v_exp_f32 v152, v152
    v_exp_f32 v153, v153
    v_exp_f32 v154, v154
    v_exp_f32 v155, v155
    v_exp_f32 v156, v156
    v_exp_f32 v157, v157
    v_exp_f32 v158, v158
    v_exp_f32 v159, v159
    v_exp_f32 v160, v160
    v_exp_f32 v161, v161
    v_exp_f32 v162, v162
    v_exp_f32 v163, v163
    v_pk_add_f32 v[148:149], v[148:149], 1.0 op_sel_hi:[1,0]
    v_pk_add_f32 v[150:151], v[150:151], 1.0 op_sel_hi:[1,0]
    v_pk_add_f32 v[152:153], v[152:153], 1.0 op_sel_hi:[1,0]
    v_pk_add_f32 v[154:155], v[154:155], 1.0 op_sel_hi:[1,0]
    v_pk_add_f32 v[156:157], v[156:157], 1.0 op_sel_hi:[1,0]
    v_pk_add_f32 v[158:159], v[158:159], 1.0 op_sel_hi:[1,0]
    v_pk_add_f32 v[160:161], v[160:161], 1.0 op_sel_hi:[1,0]
    v_pk_add_f32 v[162:163], v[162:163], 1.0 op_sel_hi:[1,0]
    v_rcp_f32 v148, v148
    v_rcp_f32 v149, v149
    v_rcp_f32 v150, v150
    v_rcp_f32 v151, v151
    v_rcp_f32 v152, v152
    v_rcp_f32 v153, v153
    v_rcp_f32 v154, v154
    v_rcp_f32 v155, v155
    v_rcp_f32 v156, v156
    v_rcp_f32 v157, v157
    v_rcp_f32 v158, v158
    v_rcp_f32 v159, v159
    v_rcp_f32 v160, v160
    v_rcp_f32 v161, v161
    v_rcp_f32 v162, v162
    v_rcp_f32 v163, v163
    v_pk_mul_f32 v[148:149], v[148:149], v[60:61]
    v_pk_mul_f32 v[150:151], v[150:151], v[62:63]
    v_pk_mul_f32 v[152:153], v[152:153], v[64:65]
    v_pk_mul_f32 v[154:155], v[154:155], v[66:67]
    v_pk_mul_f32 v[156:157], v[156:157], v[68:69]
    v_pk_mul_f32 v[158:159], v[158:159], v[70:71]
    v_pk_mul_f32 v[160:161], v[160:161], v[72:73]
    v_pk_mul_f32 v[162:163], v[162:163], v[74:75]
    v_cvt_pk_bf16_f32 v172, v148, v149
    v_cvt_pk_bf16_f32 v173, v150, v151
    v_cvt_pk_bf16_f32 v174, v152, v153
    v_cvt_pk_bf16_f32 v175, v154, v155
    v_cvt_pk_bf16_f32 v176, v156, v157
    v_cvt_pk_bf16_f32 v177, v158, v159
    v_cvt_pk_bf16_f32 v178, v160, v161
    v_cvt_pk_bf16_f32 v179, v162, v163
    buffer_store_dwordx4 v[172:175], v222, s[8:11], s26 offen offset:0 sc1
    buffer_store_dwordx4 v[176:179], v222, s[8:11], s26 offen offset:1024 sc1
    s_add_u32 s26, s26, 2048
    s_waitcnt lgkmcnt(0)
    v_pk_mul_f32 v[200:201], v[200:201], v[216:217] op_sel:[0,1] op_sel_hi:[1,1]
    v_pk_mul_f32 v[202:203], v[202:203], v[216:217] op_sel:[0,1] op_sel_hi:[1,1]
    v_pk_mul_f32 v[204:205], v[204:205], v[216:217] op_sel:[0,1] op_sel_hi:[1,1]
    v_pk_mul_f32 v[206:207], v[206:207], v[216:217] op_sel:[0,1] op_sel_hi:[1,1]
    v_pk_fma_f32 v[76:77], v[76:77], v[216:217], v[200:201] op_sel_hi:[1,0,1]
    v_pk_fma_f32 v[78:79], v[78:79], v[216:217], v[202:203] op_sel_hi:[1,0,1]
    v_pk_fma_f32 v[80:81], v[80:81], v[216:217], v[204:205] op_sel_hi:[1,0,1]
    v_pk_fma_f32 v[82:83], v[82:83], v[216:217], v[206:207] op_sel_hi:[1,0,1]
    v_pk_mul_f32 v[148:149], v[76:77], v[76:77]
    v_pk_mul_f32 v[150:151], v[78:79], v[78:79]
    v_pk_mul_f32 v[152:153], v[80:81], v[80:81]
    v_pk_mul_f32 v[154:155], v[82:83], v[82:83]
    v_pk_fma_f32 v[148:149], v[148:149], s[30:31], v[218:219] op_sel_hi:[1,0,0]
    v_pk_fma_f32 v[150:151], v[150:151], s[30:31], v[218:219] op_sel_hi:[1,0,0]
    v_pk_fma_f32 v[152:153], v[152:153], s[30:31], v[218:219] op_sel_hi:[1,0,0]
    v_pk_fma_f32 v[154:155], v[154:155], s[30:31], v[218:219] op_sel_hi:[1,0,0]
    v_pk_mul_f32 v[148:149], v[148:149], v[76:77]
    v_pk_mul_f32 v[150:151], v[150:151], v[78:79]
    v_pk_mul_f32 v[152:153], v[152:153], v[80:81]
    v_pk_mul_f32 v[154:155], v[154:155], v[82:83]
    v_exp_f32 v148, v148
    v_exp_f32 v149, v149
    v_exp_f32 v150, v150
    v_exp_f32 v151, v151
    v_exp_f32 v152, v152
    v_exp_f32 v153, v153
    v_exp_f32 v154, v154
    v_exp_f32 v155, v155
    v_pk_add_f32 v[148:149], v[148:149], 1.0 op_sel_hi:[1,0]
    v_pk_add_f32 v[150:151], v[150:151], 1.0 op_sel_hi:[1,0]
    v_pk_add_f32 v[152:153], v[152:153], 1.0 op_sel_hi:[1,0]
    v_pk_add_f32 v[154:155], v[154:155], 1.0 op_sel_hi:[1,0]
    v_rcp_f32 v148, v148
    v_rcp_f32 v149, v149
    v_rcp_f32 v150, v150
    v_rcp_f32 v151, v151
    v_rcp_f32 v152, v152
    v_rcp_f32 v153, v153
    v_rcp_f32 v154, v154
    v_rcp_f32 v155, v155
    v_pk_mul_f32 v[148:149], v[148:149], v[76:77]
    v_pk_mul_f32 v[150:151], v[150:151], v[78:79]
    v_pk_mul_f32 v[152:153], v[152:153], v[80:81]
    v_pk_mul_f32 v[154:155], v[154:155], v[82:83]
    v_cvt_pk_bf16_f32 v164, v148, v149
    v_cvt_pk_bf16_f32 v165, v150, v151
    v_cvt_pk_bf16_f32 v166, v152, v153
    v_cvt_pk_bf16_f32 v167, v154, v155
    buffer_store_dwordx4 v[164:167], v222, s[8:11], s26 offen offset:0 sc1
    s_add_u32 s26, s26, 2048
    s_lshl_b32 s56, s43, 7
    s_add_u32 s56, s56, 12347392
    s_waitcnt vmcnt(0)
    s_barrier
    s_cmp_lg_u32 s18, 0
    s_cbranch_scc1 L_f_sig_27
    s_mov_b32 s57, 1
    s_atomic_add s57, s[40:41], s56 glc
    s_waitcnt lgkmcnt(0)
L_f_sig_27:
    s_branch L_b_w2
L_b_side:
    s_setprio 3
    s_lshl_b32 s26, s42, 2
    s_add_u32 s26, s26, s44
    s_lshl_b32 s26, s26, 3
    s_lshl_b32 s27, s43, 7
    s_add_u32 s26, s26, s27
    v_lshrrev_b32 v1, 5, v0
    v_add_u32 v1, s26, v1
    v_mul_u32_u24 v3, 1152, v1
    v_and_b32 v32, 31, v0
    v_lshlrev_b32 v4, 4, v32
    v_lshlrev_b32 v5, 2, v32
    v_add_u32 v2, v3, v4
    v_add_u32 v3, v3, v5
    s_waitcnt lgkmcnt(0)
    s_mov_b32 s12, s60
    s_and_b32 s13, s61, 0xffff
    s_mov_b32 s14, 0x00240000
    s_mov_b32 s15, 0x00020000
    s_mov_b32 s4, s76
    s_and_b32 s5, s77, 0xffff
    s_mov_b32 s6, 0x00000480
    s_mov_b32 s7, 0x00020000
    s_mov_b32 s8, s40
    s_and_b32 s9, s41, 0xffff
    s_mov_b32 s10, 0x03000000
    s_mov_b32 s11, 0x00020000
    buffer_load_dwordx4 v[8:11], v2, s[12:15], 0 offen
    buffer_load_dwordx4 v[12:15], v2, s[12:15], 0 offen offset:512
    buffer_load_dword v16, v3, s[12:15], 0 offen offset:1024
    buffer_load_dwordx4 v[20:23], v4, s[4:7], 0 offen
    buffer_load_dwordx4 v[24:27], v4, s[4:7], 0 offen offset:512
    buffer_load_dword v28, v5, s[4:7], 0 offen offset:1024
    s_bfe_u32 s26, s2, 0x60002
    s_mul_i32 s26, s26, 3
    s_add_u32 s26, s26, s42
    s_mul_i32 s26, s26, 3456
    v_lshlrev_b32 v60, 7, v0
    s_mov_b32 s52, s70
    s_and_b32 s53, s71, 0xffff
    s_mov_b32 s54, 0x000a2000
    s_mov_b32 s55, 0x00020000
    s_add_u32 s54, s26, 3456
    buffer_load_dword v61, v60, s[52:55], s26 offen
    v_mov_b32 v36, 0
    v_mov_b32 v37, 0
    v_mov_b32 v38, 0
    s_waitcnt vmcnt(1)
    v_lshlrev_b32 v32, 16, v8
    v_and_b32 v33, 0xffff0000, v8
    v_lshlrev_b32 v34, 16, v20
    v_and_b32 v35, 0xffff0000, v20
    v_add_f32 v36, v36, v32
    v_fmac_f32 v37, v32, v32
    v_fmac_f32 v38, v32, v34
    v_add_f32 v36, v36, v33
    v_fmac_f32 v37, v33, v33
    v_fmac_f32 v38, v33, v35
    v_lshlrev_b32 v32, 16, v9
    v_and_b32 v33, 0xffff0000, v9
    v_lshlrev_b32 v34, 16, v21
    v_and_b32 v35, 0xffff0000, v21
    v_add_f32 v36, v36, v32
    v_fmac_f32 v37, v32, v32
    v_fmac_f32 v38, v32, v34
    v_add_f32 v36, v36, v33
    v_fmac_f32 v37, v33, v33
    v_fmac_f32 v38, v33, v35
    v_lshlrev_b32 v32, 16, v10
    v_and_b32 v33, 0xffff0000, v10
    v_lshlrev_b32 v34, 16, v22
    v_and_b32 v35, 0xffff0000, v22
    v_add_f32 v36, v36, v32
    v_fmac_f32 v37, v32, v32
    v_fmac_f32 v38, v32, v34
    v_add_f32 v36, v36, v33
    v_fmac_f32 v37, v33, v33
    v_fmac_f32 v38, v33, v35
    v_lshlrev_b32 v32, 16, v11
    v_and_b32 v33, 0xffff0000, v11
    v_lshlrev_b32 v34, 16, v23
    v_and_b32 v35, 0xffff0000, v23
    v_add_f32 v36, v36, v32
    v_fmac_f32 v37, v32, v32
    v_fmac_f32 v38, v32, v34
    v_add_f32 v36, v36, v33
    v_fmac_f32 v37, v33, v33
    v_fmac_f32 v38, v33, v35
    v_lshlrev_b32 v32, 16, v12
    v_and_b32 v33, 0xffff0000, v12
    v_lshlrev_b32 v34, 16, v24
    v_and_b32 v35, 0xffff0000, v24
    v_add_f32 v36, v36, v32
    v_fmac_f32 v37, v32, v32
    v_fmac_f32 v38, v32, v34
    v_add_f32 v36, v36, v33
    v_fmac_f32 v37, v33, v33
    v_fmac_f32 v38, v33, v35
    v_lshlrev_b32 v32, 16, v13
    v_and_b32 v33, 0xffff0000, v13
    v_lshlrev_b32 v34, 16, v25
    v_and_b32 v35, 0xffff0000, v25
    v_add_f32 v36, v36, v32
    v_fmac_f32 v37, v32, v32
    v_fmac_f32 v38, v32, v34
    v_add_f32 v36, v36, v33
    v_fmac_f32 v37, v33, v33
    v_fmac_f32 v38, v33, v35
    v_lshlrev_b32 v32, 16, v14
    v_and_b32 v33, 0xffff0000, v14
    v_lshlrev_b32 v34, 16, v26
    v_and_b32 v35, 0xffff0000, v26
    v_add_f32 v36, v36, v32
    v_fmac_f32 v37, v32, v32
    v_fmac_f32 v38, v32, v34
    v_add_f32 v36, v36, v33
    v_fmac_f32 v37, v33, v33
    v_fmac_f32 v38, v33, v35
    v_lshlrev_b32 v32, 16, v15
    v_and_b32 v33, 0xffff0000, v15
    v_lshlrev_b32 v34, 16, v27
    v_and_b32 v35, 0xffff0000, v27
    v_add_f32 v36, v36, v32
    v_fmac_f32 v37, v32, v32
    v_fmac_f32 v38, v32, v34
    v_add_f32 v36, v36, v33
    v_fmac_f32 v37, v33, v33
    v_fmac_f32 v38, v33, v35
    v_lshlrev_b32 v32, 16, v16
    v_and_b32 v33, 0xffff0000, v16
    v_lshlrev_b32 v34, 16, v28
    v_and_b32 v35, 0xffff0000, v28
    v_add_f32 v36, v36, v32
    v_fmac_f32 v37, v32, v32
    v_fmac_f32 v38, v32, v34
    v_add_f32 v36, v36, v33
    v_fmac_f32 v37, v33, v33
    v_fmac_f32 v38, v33, v35
    v_add_f32_dpp v36, v36, v36 row_ror:1 row_mask:0xf bank_mask:0xf
    v_add_f32_dpp v37, v37, v37 row_ror:1 row_mask:0xf bank_mask:0xf
    v_add_f32_dpp v38, v38, v38 row_ror:1 row_mask:0xf bank_mask:0xf
    v_add_f32_dpp v36, v36, v36 row_ror:2 row_mask:0xf bank_mask:0xf
    v_add_f32_dpp v37, v37, v37 row_ror:2 row_mask:0xf bank_mask:0xf
    v_add_f32_dpp v38, v38, v38 row_ror:2 row_mask:0xf bank_mask:0xf
    v_add_f32_dpp v36, v36, v36 row_ror:4 row_mask:0xf bank_mask:0xf
    v_add_f32_dpp v37, v37, v37 row_ror:4 row_mask:0xf bank_mask:0xf
    v_add_f32_dpp v38, v38, v38 row_ror:4 row_mask:0xf bank_mask:0xf
    v_add_f32_dpp v36, v36, v36 row_ror:8 row_mask:0xf bank_mask:0xf
    v_add_f32_dpp v37, v37, v37 row_ror:8 row_mask:0xf bank_mask:0xf
    v_add_f32_dpp v38, v38, v38 row_ror:8 row_mask:0xf bank_mask:0xf
    v_mov_b32 v32, v36
    v_mov_b32 v33, v37
    v_mov_b32 v34, v38
    v_permlane16_swap_b32 v36, v32
    v_permlane16_swap_b32 v37, v33
    v_permlane16_swap_b32 v38, v34
    v_add_f32 v36, v36, v32
    v_add_f32 v37, v37, v33
    v_add_f32 v38, v38, v34
    v_mul_f32 v36, 0xbae38e39, v36
    v_mul_f32 v37, 0x3ae38e39, v37
    v_mul_f32 v38, 0xbfb8aa3b, v38
    v_fma_f32 v37, -v36, v36, v37
    v_exp_f32 v38, v38
    v_max_f32 v37, 0, v37
    v_add_f32 v37, 0x3727c5ac, v37
    v_add_f32 v38, 1.0, v38
    v_rsq_f32 v32, v37
    v_rcp_f32 v34, v38
    v_sub_f32 v35, 0, v36
    v_mul_f32 v33, v32, v36
    v_lshlrev_b32 v1, 4, v1
    s_mov_b32 s26, 12058624
    s_mov_b32 exec_lo, 1
    s_mov_b32 exec_hi, 1
    buffer_store_dwordx4 v[32:35], v1, s[8:11], s26 offen sc1
    s_mov_b64 exec, -1
    s_cmp_lg_u32 s18, 0
    s_cbranch_scc1 L_f_rd_28
    s_mov_b32 s57, 262144
    v_mov_b32 v91, 0
L_f_rp_29:
    global_load_dword v90, v91, s[80:81] sc1
    s_waitcnt vmcnt(0)
    v_readfirstlane_b32 s58, v90
    s_nop 1
    s_cmp_ge_u32 s58, 16
    s_cbranch_scc1 L_f_rd_28
    s_sleep 8
    s_sub_u32 s57, s57, 1
    s_cmp_gt_i32 s57, 0
    s_cbranch_scc1 L_f_rp_29
L_f_rd_28:
    s_waitcnt vmcnt(0)
    s_barrier
    s_lshl_b32 s56, s43, 7
    s_add_u32 s56, s56, 12344320
    s_cmp_lg_u32 s18, 0
    s_cbranch_scc1 L_f_sig_30
    s_mov_b32 s57, 1
    s_atomic_add s57, s[40:41], s56 glc
    s_waitcnt lgkmcnt(0)
L_f_sig_30:
    s_setprio 0
    s_and_b32 s56, s2, 255
    s_lshl_b32 s56, s56, 7
    s_add_u32 s56, s56, 12353536
    s_cmp_lg_u32 s18, 0
    s_cbranch_scc1 L_f_pw_31
    s_mov_b32 s57, 262144
L_f_pp_32:
    s_mov_b32 s45, 0
    s_atomic_add s45, s[40:41], s56 glc
    s_waitcnt lgkmcnt(0)
    s_cmp_ge_u32 s45, 1
    s_cbranch_scc1 L_f_pw_31
L_f_ps_33:
    s_sleep 2
    s_sub_u32 s57, s57, 1
    s_cmp_gt_i32 s57, 0
    s_cbranch_scc1 L_f_pp_32
L_f_pw_31:
    s_barrier
L_b_w2:
    s_setprio 2
    s_mov_b64 s[36:37], s[60:61]
    s_mov_b64 s[38:39], s[70:71]
    s_bfe_u32 s26, s2, 0x10002
    s_bfe_u32 s16, s2, 0x30003
    s_lshl_b32 s26, s26, 3
    s_add_u32 s16, s16, s26
    s_and_b32 s17, s2, 3
    s_lshl_b32 s17, s17, 2
    s_bfe_u32 s26, s2, 0x20006
    s_add_u32 s17, s17, s26
    s_bfe_u32 s27, s2, 0x50003
    s_bfe_u32 s26, s2, 0x10002
    s_and_b32 s50, s2, 3
    s_mul_i32 s52, s26, 3
    s_add_u32 s52, s52, s50
    s_lshl_b32 s53, s26, 5
    s_add_u32 s53, s53, 48
    s_lshl_b32 s54, s52, 3
    s_sub_u32 s54, s54, 24
    s_cmp_eq_u32 s50, 3
    s_cselect_b32 s53, s53, s54
    s_cselect_b32 s54, 0, 24
    s_add_u32 s53, s53, s27
    s_mul_i32 s52, s52, 24
    s_add_u32 s52, s52, s27
    s_mul_i32 s50, s52, 7282
    s_lshr_b32 s50, s50, 16
    s_mul_i32 s51, s50, 9
    s_sub_u32 s51, s52, s51
    s_cmp_ge_u32 s27, s54
    s_cselect_b32 s51, s53, s51
    s_cbranch_scc1 L_b_cs
    s_mov_b32 s12, s36
    s_and_b32 s13, s37, 0xffff
    s_mov_b32 s14, 0x00240000
    s_mov_b32 s15, 0x00020000
    s_mov_b32 s4, s38
    s_and_b32 s5, s39, 0xffff
    s_mov_b32 s6, 0x000a2000
    s_mov_b32 s7, 0x00020000
    s_cmp_ge_u32 s51, 9
    s_cselect_b32 s26, 1, 0
    s_cselect_b32 s27, 9, 0
    s_add_u32 s50, s50, s26
    s_sub_u32 s51, s51, s27
    s_lshl_b32 s20, s50, 2
    s_add_u32 s20, s20, s18
    s_min_u32 s21, s51, 8
    s_lshl_b32 s25, s51, 7
    s_mul_i32 s24, s20, 36864
    s_add_u32 s24, s24, 7340032
    v_and_b32 v12, 63, v0
    v_and_b32 v14, 3, v0
    s_mov_b32 s49, s21
    s_mul_i32 s28, s18, 2048
    v_lshlrev_b32 v1, 4, v12
    s_lshl_b32 s26, s20, 5
    v_and_b32 v13, 31, v0
    v_add_u32 v13, s26, v13
    s_movk_i32 s27, 2048
    v_add_u32 v2, -1, v13
    v_cmp_gt_u32 vcc, s27, v2
    v_lshrrev_b32 v15, 5, v2
    v_mul_u32_u24 v15, 36864, v15
    v_and_b32 v2, 31, v2
    v_lshl_add_u32 v2, v2, 4, v15
    v_and_b32 v15, 0x200, v1
    v_add_u32 v2, v2, v15
    v_add_u32 v2, 0, v2
    v_mov_b32 v15, 0x80000000
    v_cndmask_b32 v2, v15, v2, vcc
    v_add_u32 v3, 1, v13
    v_cmp_gt_u32 vcc, s27, v3
    v_lshrrev_b32 v15, 5, v3
    v_mul_u32_u24 v15, 36864, v15
    v_and_b32 v3, 31, v3
    v_lshl_add_u32 v3, v3, 4, v15
    v_and_b32 v15, 0x200, v1
    v_add_u32 v3, v3, v15
    v_add_u32 v3, 9216, v3
    v_mov_b32 v15, 0x80000000
    v_cndmask_b32 v3, v15, v3, vcc
    v_add_u32 v4, -2, v13
    v_cmp_gt_u32 vcc, s27, v4
    v_lshrrev_b32 v15, 5, v4
    v_mul_u32_u24 v15, 36864, v15
    v_and_b32 v4, 31, v4
    v_lshl_add_u32 v4, v4, 4, v15
    v_and_b32 v15, 0x200, v1
    v_add_u32 v4, v4, v15
    v_add_u32 v4, 18432, v4
    v_mov_b32 v15, 0x80000000
    v_cndmask_b32 v4, v15, v4, vcc
    v_add_u32 v5, 2, v13
    v_cmp_gt_u32 vcc, s27, v5
    v_lshrrev_b32 v15, 5, v5
    v_mul_u32_u24 v15, 36864, v15
    v_and_b32 v5, 31, v5
    v_lshl_add_u32 v5, v5, 4, v15
    v_and_b32 v15, 0x200, v1
    v_add_u32 v5, v5, v15
    v_add_u32 v5, 27648, v5
    v_mov_b32 v15, 0x80000000
    v_cndmask_b32 v5, v15, v5, vcc
    v_lshrrev_b32 v13, 2, v12
    s_mul_i32 s26, s18, 144
    v_add_u32 v13, s26, v13
    v_mul_u32_u24 v13, 1152, v13
    v_lshl_add_u32 v6, v14, 4, v13
    s_mul_i32 s22, s21, 18432
    s_add_u32 s22, s22, s25
    s_add_u32 s21, s21, 1
    s_cmp_eq_u32 s21, 9
    s_cselect_b32 s21, 0, s21
    s_add_u32 m0, s28, 0
    s_nop 0
    buffer_load_dwordx4 v6, s[4:7], s22 offen offset:0 lds
    s_add_u32 m0, s28, 960
    s_nop 0
    buffer_load_dwordx4 v6, s[4:7], s22 offen offset:64 lds
    s_mul_i32 s22, s21, 18432
    s_add_u32 s22, s22, s25
    s_add_u32 s21, s21, 1
    s_cmp_eq_u32 s21, 9
    s_cselect_b32 s21, 0, s21
    s_add_u32 m0, s28, 8192
    s_nop 0
    buffer_load_dwordx4 v6, s[4:7], s22 offen offset:0 lds
    s_add_u32 m0, s28, 9152
    s_nop 0
    buffer_load_dwordx4 v6, s[4:7], s22 offen offset:64 lds
    s_mul_i32 s22, s21, 18432
    s_add_u32 s22, s22, s25
    s_add_u32 s21, s21, 1
    s_cmp_eq_u32 s21, 9
    s_cselect_b32 s21, 0, s21
    s_add_u32 m0, s28, 16384
    s_nop 0
    buffer_load_dwordx4 v6, s[4:7], s22 offen offset:0 lds
    s_add_u32 m0, s28, 17344
    s_nop 0
    buffer_load_dwordx4 v6, s[4:7], s22 offen offset:64 lds
    s_mul_i32 s22, s21, 18432
    s_add_u32 s22, s22, s25
    s_add_u32 s21, s21, 1
    s_cmp_eq_u32 s21, 9
    s_cselect_b32 s21, 0, s21
    s_add_u32 m0, s28, 24576
    s_nop 0
    buffer_load_dwordx4 v6, s[4:7], s22 offen offset:0 lds
    s_add_u32 m0, s28, 25536
    s_nop 0
    buffer_load_dwordx4 v6, s[4:7], s22 offen offset:64 lds
    s_mul_i32 s22, s21, 18432
    s_add_u32 s22, s22, s25
    s_add_u32 s21, s21, 1
    s_cmp_eq_u32 s21, 9
    s_cselect_b32 s21, 0, s21
    s_add_u32 m0, s28, 32768
    s_nop 0
    buffer_load_dwordx4 v6, s[4:7], s22 offen offset:0 lds
    s_add_u32 m0, s28, 33728
    s_nop 0
    buffer_load_dwordx4 v6, s[4:7], s22 offen offset:64 lds
    s_mul_i32 s22, s21, 18432
    s_add_u32 s22, s22, s25
    s_add_u32 s21, s21, 1
    s_cmp_eq_u32 s21, 9
    s_cselect_b32 s21, 0, s21
    s_add_u32 m0, s28, 40960
    s_nop 0
    buffer_load_dwordx4 v6, s[4:7], s22 offen offset:0 lds
    s_add_u32 m0, s28, 41920
    s_nop 0
    buffer_load_dwordx4 v6, s[4:7], s22 offen offset:64 lds
    s_mul_i32 s22, s21, 18432
    s_add_u32 s22, s22, s25
    s_add_u32 s21, s21, 1
    s_cmp_eq_u32 s21, 9
    s_cselect_b32 s21, 0, s21
    s_add_u32 m0, s28, 49152
    s_nop 0
    buffer_load_dwordx4 v6, s[4:7], s22 offen offset:0 lds
    s_add_u32 m0, s28, 50112
    s_nop 0
    buffer_load_dwordx4 v6, s[4:7], s22 offen offset:64 lds
    s_mul_i32 s22, s21, 18432
    s_add_u32 s22, s22, s25
    s_add_u32 s21, s21, 1
    s_cmp_eq_u32 s21, 9
    s_cselect_b32 s21, 0, s21
    s_add_u32 m0, s28, 57344
    s_nop 0
    buffer_load_dwordx4 v6, s[4:7], s22 offen offset:0 lds
    s_add_u32 m0, s28, 58304
    s_nop 0
    buffer_load_dwordx4 v6, s[4:7], s22 offen offset:64 lds
    s_mul_i32 s22, s21, 18432
    s_add_u32 s22, s22, s25
    s_add_u32 s21, s21, 1
    s_cmp_eq_u32 s21, 9
    s_cselect_b32 s21, 0, s21
    s_add_u32 m0, s28, 65536
    s_nop 0
    buffer_load_dwordx4 v6, s[4:7], s22 offen offset:0 lds
    s_add_u32 m0, s28, 66496
    s_nop 0
    buffer_load_dwordx4 v6, s[4:7], s22 offen offset:64 lds
    v_bfe_u32 v13, v12, 2, 2
    v_lshlrev_b32 v7, 6, v13
    v_bfe_u32 v13, v12, 4, 1
    v_lshl_add_u32 v7, v13, 5, v7
    v_and_b32 v13, 1, v12
    v_lshl_add_u32 v7, v13, 4, v7
    v_bfe_u32 v13, v12, 1, 1
    v_lshl_add_u32 v7, v13, 3, v7
    v_lshrrev_b32 v13, 5, v12
    v_mul_u32_u24 v13, 512, v13
    v_add_u32 v7, v7, v13
    v_add_u32 v8, 40960, v7
    v_and_b32 v164, 31, v0
    s_lshl_b32 s26, s20, 5
    v_add_u32 v164, s26, v164
    v_mul_u32_u24 v165, 1152, v164
    v_bfe_u32 v166, v0, 5, 1
    v_lshl_add_u32 v165, v166, 4, v165
    buffer_load_dwordx4 v[148:151], v165, s[12:15], s25 offen offset:0
    buffer_load_dwordx4 v[152:155], v165, s[12:15], s25 offen offset:32
    buffer_load_dwordx4 v[156:159], v165, s[12:15], s25 offen offset:64
    buffer_load_dwordx4 v[160:163], v165, s[12:15], s25 offen offset:96
    s_lshl_b32 s52, s50, 7
    s_add_u32 s53, s52, 128
    s_and_b32 s53, s53, 2047
    s_sub_u32 s54, s52, 128
    s_and_b32 s54, s54, 2047
    s_add_u32 s52, s52, 12347392
    s_add_u32 s53, s53, 12347392
    s_add_u32 s54, s54, 12347392
    s_cmp_lg_u32 s18, 0
    s_cbranch_scc1 L_f_pw_34
    s_mov_b32 s57, 262144
L_f_pp_35:
    s_mov_b32 s45, 0
    s_atomic_add s45, s[40:41], s52 glc
    s_mov_b32 s46, 0
    s_atomic_add s46, s[40:41], s53 glc
    s_mov_b32 s47, 0
    s_atomic_add s47, s[40:41], s54 glc
    s_waitcnt lgkmcnt(0)
    s_cmp_lt_u32 s45, 4
    s_cbranch_scc1 L_f_ps_36
    s_cmp_lt_u32 s46, 4
    s_cbranch_scc1 L_f_ps_36
    s_cmp_ge_u32 s47, 4
    s_cbranch_scc1 L_f_pw_34
L_f_ps_36:
    s_sleep 2
    s_sub_u32 s57, s57, 1
    s_cmp_gt_i32 s57, 0
    s_cbranch_scc1 L_f_pp_35
L_f_pw_34:
    s_barrier
    s_lshl_b32 s23, s49, 10
    s_add_u32 s23, s23, 7340032
    s_add_u32 s49, s49, 1
    s_cmp_eq_u32 s49, 9
    s_cselect_b32 s49, 0, s49
    buffer_load_dwordx4 v[68:71], v2, s[8:11], s23 offen sc1
    buffer_load_dwordx4 v[72:75], v3, s[8:11], s23 offen sc1
    buffer_load_dwordx4 v[76:79], v4, s[8:11], s23 offen sc1
    buffer_load_dwordx4 v[80:83], v5, s[8:11], s23 offen sc1
    s_lshl_b32 s23, s49, 10
    s_add_u32 s23, s23, 7340032
    s_add_u32 s49, s49, 1
    s_cmp_eq_u32 s49, 9
    s_cselect_b32 s49, 0, s49
    buffer_load_dwordx4 v[84:87], v2, s[8:11], s23 offen sc1
    buffer_load_dwordx4 v[88:91], v3, s[8:11], s23 offen sc1
    buffer_load_dwordx4 v[92:95], v4, s[8:11], s23 offen sc1
    buffer_load_dwordx4 v[96:99], v5, s[8:11], s23 offen sc1
    s_waitcnt vmcnt(4)
    s_barrier
    ds_read_b64_tr_b16 v[44:45], v7 offset:0
    ds_read_b64_tr_b16 v[46:47], v7 offset:256
    ds_read_b64_tr_b16 v[48:49], v7 offset:1024
    ds_read_b64_tr_b16 v[50:51], v7 offset:1280
    ds_read_b64_tr_b16 v[52:53], v7 offset:2048
    ds_read_b64_tr_b16 v[54:55], v7 offset:2304
    ds_read_b64_tr_b16 v[56:57], v7 offset:3072
    ds_read_b64_tr_b16 v[58:59], v7 offset:3328
    ds_read_b64_tr_b16 v[60:61], v7 offset:4096
    ds_read_b64_tr_b16 v[62:63], v7 offset:4352
    s_waitcnt lgkmcnt(6)
    v_mfma_f32_32x32x16_bf16 v[12:27], v[44:47], v[68:71], 0
    s_lshl_b32 s23, s49, 10
    s_add_u32 s23, s23, 7340032
    s_add_u32 s49, s49, 1
    s_cmp_eq_u32 s49, 9
    s_cselect_b32 s49, 0, s49
    ds_read_b64_tr_b16 v[64:65], v7 offset:5120
    ds_read_b64_tr_b16 v[66:67], v7 offset:5376
    buffer_load_dwordx4 v[100:103], v2, s[8:11], s23 offen sc1
    buffer_load_dwordx4 v[104:107], v3, s[8:11], s23 offen sc1
    v_mfma_f32_32x32x16_bf16 v[28:43], v[48:51], v[68:71], 0
    ds_read_b64_tr_b16 v[44:45], v7 offset:6144
    ds_read_b64_tr_b16 v[46:47], v7 offset:6400
    buffer_load_dwordx4 v[108:111], v4, s[8:11], s23 offen sc1
    s_waitcnt lgkmcnt(6)
    v_mfma_f32_32x32x16_bf16 v[12:27], v[52:55], v[72:75], v[12:27]
    ds_read_b64_tr_b16 v[48:49], v7 offset:7168
    ds_read_b64_tr_b16 v[50:51], v7 offset:7424
    buffer_load_dwordx4 v[112:115], v5, s[8:11], s23 offen sc1
    s_lshl_b32 s23, s49, 10
    s_add_u32 s23, s23, 7340032
    s_add_u32 s49, s49, 1
    s_cmp_eq_u32 s49, 9
    s_cselect_b32 s49, 0, s49
    buffer_load_dwordx4 v[116:119], v2, s[8:11], s23 offen sc1
    v_mfma_f32_32x32x16_bf16 v[28:43], v[56:59], v[72:75], v[28:43]
    ds_read_b64_tr_b16 v[52:53], v7 offset:8192
    ds_read_b64_tr_b16 v[54:55], v7 offset:8448
    buffer_load_dwordx4 v[120:123], v3, s[8:11], s23 offen sc1
    s_waitcnt lgkmcnt(6)
    v_mfma_f32_32x32x16_bf16 v[12:27], v[60:63], v[76:79], v[12:27]
    ds_read_b64_tr_b16 v[56:57], v7 offset:9216
    ds_read_b64_tr_b16 v[58:59], v7 offset:9472
    buffer_load_dwordx4 v[124:127], v4, s[8:11], s23 offen sc1
    buffer_load_dwordx4 v[128:131], v5, s[8:11], s23 offen sc1
    v_mfma_f32_32x32x16_bf16 v[28:43], v[64:67], v[76:79], v[28:43]
    s_lshl_b32 s23, s49, 10
    s_add_u32 s23, s23, 7340032
    s_add_u32 s49, s49, 1
    s_cmp_eq_u32 s49, 9
    s_cselect_b32 s49, 0, s49
    ds_read_b64_tr_b16 v[60:61], v7 offset:10240
    ds_read_b64_tr_b16 v[62:63], v7 offset:10496
    buffer_load_dwordx4 v[132:135], v2, s[8:11], s23 offen sc1
    s_waitcnt lgkmcnt(6)
    v_mfma_f32_32x32x16_bf16 v[12:27], v[44:47], v[80:83], v[12:27]
    ds_read_b64_tr_b16 v[64:65], v7 offset:11264
    ds_read_b64_tr_b16 v[66:67], v7 offset:11520
    buffer_load_dwordx4 v[136:139], v3, s[8:11], s23 offen sc1
    buffer_load_dwordx4 v[140:143], v4, s[8:11], s23 offen sc1
    v_mfma_f32_32x32x16_bf16 v[28:43], v[48:51], v[80:83], v[28:43]
    ds_read_b64_tr_b16 v[44:45], v7 offset:12288
    ds_read_b64_tr_b16 v[46:47], v7 offset:12544
    buffer_load_dwordx4 v[144:147], v5, s[8:11], s23 offen sc1
    s_waitcnt vmcnt(12)
    s_waitcnt lgkmcnt(6)
    v_mfma_f32_32x32x16_bf16 v[12:27], v[52:55], v[84:87], v[12:27]
    s_lshl_b32 s23, s49, 10
    s_add_u32 s23, s23, 7340032
    s_add_u32 s49, s49, 1
    s_cmp_eq_u32 s49, 9
    s_cselect_b32 s49, 0, s49
    ds_read_b64_tr_b16 v[48:49], v7 offset:13312
    ds_read_b64_tr_b16 v[50:51], v7 offset:13568
    buffer_load_dwordx4 v[68:71], v2, s[8:11], s23 offen sc1
    v_mfma_f32_32x32x16_bf16 v[28:43], v[56:59], v[84:87], v[28:43]
    ds_read_b64_tr_b16 v[52:53], v7 offset:14336
    ds_read_b64_tr_b16 v[54:55], v7 offset:14592
    s_waitcnt lgkmcnt(6)
    v_mfma_f32_32x32x16_bf16 v[12:27], v[60:63], v[88:91], v[12:27]
    ds_read_b64_tr_b16 v[56:57], v7 offset:15360
    ds_read_b64_tr_b16 v[58:59], v7 offset:15616
    buffer_load_dwordx4 v[72:75], v3, s[8:11], s23 offen sc1
    v_mfma_f32_32x32x16_bf16 v[28:43], v[64:67], v[88:91], v[28:43]
    ds_read_b64_tr_b16 v[60:61], v7 offset:16384
    ds_read_b64_tr_b16 v[62:63], v7 offset:16640
    s_waitcnt lgkmcnt(6)
    v_mfma_f32_32x32x16_bf16 v[12:27], v[44:47], v[92:95], v[12:27]
    ds_read_b64_tr_b16 v[64:65], v7 offset:17408
    ds_read_b64_tr_b16 v[66:67], v7 offset:17664
    buffer_load_dwordx4 v[76:79], v4, s[8:11], s23 offen sc1
    v_mfma_f32_32x32x16_bf16 v[28:43], v[48:51], v[92:95], v[28:43]
    ds_read_b64_tr_b16 v[44:45], v7 offset:18432
    ds_read_b64_tr_b16 v[46:47], v7 offset:18688
    s_waitcnt lgkmcnt(6)
    v_mfma_f32_32x32x16_bf16 v[12:27], v[52:55], v[96:99], v[12:27]
    ds_read_b64_tr_b16 v[48:49], v7 offset:19456
    ds_read_b64_tr_b16 v[50:51], v7 offset:19712
    buffer_load_dwordx4 v[80:83], v5, s[8:11], s23 offen sc1
    v_mfma_f32_32x32x16_bf16 v[28:43], v[56:59], v[96:99], v[28:43]
    ds_read_b64_tr_b16 v[52:53], v7 offset:20480
    ds_read_b64_tr_b16 v[54:55], v7 offset:20736
    s_waitcnt vmcnt(12)
    s_waitcnt lgkmcnt(6)
    v_mfma_f32_32x32x16_bf16 v[12:27], v[60:63], v[100:103], v[12:27]
    s_lshl_b32 s23, s49, 10
    s_add_u32 s23, s23, 7340032
    s_add_u32 s49, s49, 1
    s_cmp_eq_u32 s49, 9
    s_cselect_b32 s49, 0, s49
    ds_read_b64_tr_b16 v[56:57], v7 offset:21504
    ds_read_b64_tr_b16 v[58:59], v7 offset:21760
    buffer_load_dwordx4 v[84:87], v2, s[8:11], s23 offen sc1
    v_mfma_f32_32x32x16_bf16 v[28:43], v[64:67], v[100:103], v[28:43]
    ds_read_b64_tr_b16 v[60:61], v7 offset:22528
    ds_read_b64_tr_b16 v[62:63], v7 offset:22784
    s_waitcnt lgkmcnt(6)
    v_mfma_f32_32x32x16_bf16 v[12:27], v[44:47], v[104:107], v[12:27]
    ds_read_b64_tr_b16 v[64:65], v7 offset:23552
    ds_read_b64_tr_b16 v[66:67], v7 offset:23808
    buffer_load_dwordx4 v[88:91], v3, s[8:11], s23 offen sc1
    v_mfma_f32_32x32x16_bf16 v[28:43], v[48:51], v[104:107], v[28:43]
    ds_read_b64_tr_b16 v[44:45], v7 offset:24576
    ds_read_b64_tr_b16 v[46:47], v7 offset:24832
    s_waitcnt lgkmcnt(6)
    v_mfma_f32_32x32x16_bf16 v[12:27], v[52:55], v[108:111], v[12:27]
    ds_read_b64_tr_b16 v[48:49], v7 offset:25600
    ds_read_b64_tr_b16 v[50:51], v7 offset:25856
    buffer_load_dwordx4 v[92:95], v4, s[8:11], s23 offen sc1
    v_mfma_f32_32x32x16_bf16 v[28:43], v[56:59], v[108:111], v[28:43]
    ds_read_b64_tr_b16 v[52:53], v7 offset:26624
    ds_read_b64_tr_b16 v[54:55], v7 offset:26880
    s_waitcnt lgkmcnt(6)
    v_mfma_f32_32x32x16_bf16 v[12:27], v[60:63], v[112:115], v[12:27]
    ds_read_b64_tr_b16 v[56:57], v7 offset:27648
    ds_read_b64_tr_b16 v[58:59], v7 offset:27904
    buffer_load_dwordx4 v[96:99], v5, s[8:11], s23 offen sc1
    v_mfma_f32_32x32x16_bf16 v[28:43], v[64:67], v[112:115], v[28:43]
    ds_read_b64_tr_b16 v[60:61], v7 offset:28672
    ds_read_b64_tr_b16 v[62:63], v7 offset:28928
    s_waitcnt vmcnt(12)
    s_waitcnt lgkmcnt(6)
    v_mfma_f32_32x32x16_bf16 v[12:27], v[44:47], v[116:119], v[12:27]
    s_lshl_b32 s23, s49, 10
    s_add_u32 s23, s23, 7340032
    s_add_u32 s49, s49, 1
    s_cmp_eq_u32 s49, 9
    s_cselect_b32 s49, 0, s49
    ds_read_b64_tr_b16 v[64:65], v7 offset:29696
    ds_read_b64_tr_b16 v[66:67], v7 offset:29952
    buffer_load_dwordx4 v[100:103], v2, s[8:11], s23 offen sc1
    v_mfma_f32_32x32x16_bf16 v[28:43], v[48:51], v[116:119], v[28:43]
    ds_read_b64_tr_b16 v[44:45], v7 offset:30720
    ds_read_b64_tr_b16 v[46:47], v7 offset:30976
    s_waitcnt lgkmcnt(6)
    v_mfma_f32_32x32x16_bf16 v[12:27], v[52:55], v[120:123], v[12:27]
    ds_read_b64_tr_b16 v[48:49], v7 offset:31744
    ds_read_b64_tr_b16 v[50:51], v7 offset:32000
    buffer_load_dwordx4 v[104:107], v3, s[8:11], s23 offen sc1
    v_mfma_f32_32x32x16_bf16 v[28:43], v[56:59], v[120:123], v[28:43]
    ds_read_b64_tr_b16 v[52:53], v7 offset:32768
    ds_read_b64_tr_b16 v[54:55], v7 offset:33024
    s_waitcnt lgkmcnt(6)
    v_mfma_f32_32x32x16_bf16 v[12:27], v[60:63], v[124:127], v[12:27]
    ds_read_b64_tr_b16 v[56:57], v7 offset:33792
    ds_read_b64_tr_b16 v[58:59], v7 offset:34048
    buffer_load_dwordx4 v[108:111], v4, s[8:11], s23 offen sc1
    v_mfma_f32_32x32x16_bf16 v[28:43], v[64:67], v[124:127], v[28:43]
    ds_read_b64_tr_b16 v[60:61], v7 offset:34816
    ds_read_b64_tr_b16 v[62:63], v7 offset:35072
    s_waitcnt lgkmcnt(6)
    v_mfma_f32_32x32x16_bf16 v[12:27], v[44:47], v[128:131], v[12:27]
    ds_read_b64_tr_b16 v[64:65], v7 offset:35840
    ds_read_b64_tr_b16 v[66:67], v7 offset:36096
    buffer_load_dwordx4 v[112:115], v5, s[8:11], s23 offen sc1
    v_mfma_f32_32x32x16_bf16 v[28:43], v[48:51], v[128:131], v[28:43]
    ds_read_b64_tr_b16 v[44:45], v7 offset:36864
    ds_read_b64_tr_b16 v[46:47], v7 offset:37120
    s_waitcnt vmcnt(12)
    s_waitcnt lgkmcnt(6)
    v_mfma_f32_32x32x16_bf16 v[12:27], v[52:55], v[132:135], v[12:27]
    s_lshl_b32 s23, s49, 10
    s_add_u32 s23, s23, 7340032
    s_add_u32 s49, s49, 1
    s_cmp_eq_u32 s49, 9
    s_cselect_b32 s49, 0, s49
    ds_read_b64_tr_b16 v[48:49], v7 offset:37888
    ds_read_b64_tr_b16 v[50:51], v7 offset:38144
    buffer_load_dwordx4 v[116:119], v2, s[8:11], s23 offen sc1
    v_mfma_f32_32x32x16_bf16 v[28:43], v[56:59], v[132:135], v[28:43]
    ds_read_b64_tr_b16 v[52:53], v7 offset:38912
    ds_read_b64_tr_b16 v[54:55], v7 offset:39168
    s_waitcnt lgkmcnt(6)
    v_mfma_f32_32x32x16_bf16 v[12:27], v[60:63], v[136:139], v[12:27]
    ds_read_b64_tr_b16 v[56:57], v7 offset:39936
    ds_read_b64_tr_b16 v[58:59], v7 offset:40192
    buffer_load_dwordx4 v[120:123], v3, s[8:11], s23 offen sc1
    v_mfma_f32_32x32x16_bf16 v[28:43], v[64:67], v[136:139], v[28:43]
    ds_read_b64_tr_b16 v[60:61], v8 offset:0
    ds_read_b64_tr_b16 v[62:63], v8 offset:256
    s_waitcnt lgkmcnt(6)
    v_mfma_f32_32x32x16_bf16 v[12:27], v[44:47], v[140:143], v[12:27]
    ds_read_b64_tr_b16 v[64:65], v8 offset:1024
    ds_read_b64_tr_b16 v[66:67], v8 offset:1280
    buffer_load_dwordx4 v[124:127], v4, s[8:11], s23 offen sc1
    v_mfma_f32_32x32x16_bf16 v[28:43], v[48:51], v[140:143], v[28:43]
    ds_read_b64_tr_b16 v[44:45], v8 offset:2048
    ds_read_b64_tr_b16 v[46:47], v8 offset:2304
    s_waitcnt lgkmcnt(6)
    v_mfma_f32_32x32x16_bf16 v[12:27], v[52:55], v[144:147], v[12:27]
    ds_read_b64_tr_b16 v[48:49], v8 offset:3072
    ds_read_b64_tr_b16 v[50:51], v8 offset:3328
    buffer_load_dwordx4 v[128:131], v5, s[8:11], s23 offen sc1
    v_mfma_f32_32x32x16_bf16 v[28:43], v[56:59], v[144:147], v[28:43]
    ds_read_b64_tr_b16 v[52:53], v8 offset:4096
    ds_read_b64_tr_b16 v[54:55], v8 offset:4352
    s_waitcnt vmcnt(12)
    s_waitcnt lgkmcnt(6)
    v_mfma_f32_32x32x16_bf16 v[12:27], v[60:63], v[68:71], v[12:27]
    ds_read_b64_tr_b16 v[56:57], v8 offset:5120
    ds_read_b64_tr_b16 v[58:59], v8 offset:5376
    v_mfma_f32_32x32x16_bf16 v[28:43], v[64:67], v[68:71], v[28:43]
    ds_read_b64_tr_b16 v[60:61], v8 offset:6144
    ds_read_b64_tr_b16 v[62:63], v8 offset:6400
    s_waitcnt lgkmcnt(6)
    v_mfma_f32_32x32x16_bf16 v[12:27], v[44:47], v[72:75], v[12:27]
    ds_read_b64_tr_b16 v[64:65], v8 offset:7168
    ds_read_b64_tr_b16 v[66:67], v8 offset:7424
    v_mfma_f32_32x32x16_bf16 v[28:43], v[48:51], v[72:75], v[28:43]
    ds_read_b64_tr_b16 v[44:45], v8 offset:8192
    ds_read_b64_tr_b16 v[46:47], v8 offset:8448
    s_waitcnt lgkmcnt(6)
    v_mfma_f32_32x32x16_bf16 v[12:27], v[52:55], v[76:79], v[12:27]
    ds_read_b64_tr_b16 v[48:49], v8 offset:9216
    ds_read_b64_tr_b16 v[50:51], v8 offset:9472
    v_mfma_f32_32x32x16_bf16 v[28:43], v[56:59], v[76:79], v[28:43]
    ds_read_b64_tr_b16 v[52:53], v8 offset:10240
    ds_read_b64_tr_b16 v[54:55], v8 offset:10496
    s_waitcnt lgkmcnt(6)
    v_mfma_f32_32x32x16_bf16 v[12:27], v[60:63], v[80:83], v[12:27]
    ds_read_b64_tr_b16 v[56:57], v8 offset:11264
    ds_read_b64_tr_b16 v[58:59], v8 offset:11520
    v_mfma_f32_32x32x16_bf16 v[28:43], v[64:67], v[80:83], v[28:43]
    ds_read_b64_tr_b16 v[60:61], v8 offset:12288
    ds_read_b64_tr_b16 v[62:63], v8 offset:12544
    s_waitcnt vmcnt(8)
    s_waitcnt lgkmcnt(6)
    v_mfma_f32_32x32x16_bf16 v[12:27], v[44:47], v[84:87], v[12:27]
    ds_read_b64_tr_b16 v[64:65], v8 offset:13312
    ds_read_b64_tr_b16 v[66:67], v8 offset:13568
    v_mfma_f32_32x32x16_bf16 v[28:43], v[48:51], v[84:87], v[28:43]
    ds_read_b64_tr_b16 v[44:45], v8 offset:14336
    ds_read_b64_tr_b16 v[46:47], v8 offset:14592
    s_waitcnt lgkmcnt(6)
    v_mfma_f32_32x32x16_bf16 v[12:27], v[52:55], v[88:91], v[12:27]
    ds_read_b64_tr_b16 v[48:49], v8 offset:15360
    ds_read_b64_tr_b16 v[50:51], v8 offset:15616
    v_mfma_f32_32x32x16_bf16 v[28:43], v[56:59], v[88:91], v[28:43]
    ds_read_b64_tr_b16 v[52:53], v8 offset:16384
    ds_read_b64_tr_b16 v[54:55], v8 offset:16640
    s_waitcnt lgkmcnt(6)
    v_mfma_f32_32x32x16_bf16 v[12:27], v[60:63], v[92:95], v[12:27]
    ds_read_b64_tr_b16 v[56:57], v8 offset:17408
    ds_read_b64_tr_b16 v[58:59], v8 offset:17664
    v_mfma_f32_32x32x16_bf16 v[28:43], v[64:67], v[92:95], v[28:43]
    ds_read_b64_tr_b16 v[60:61], v8 offset:18432
    ds_read_b64_tr_b16 v[62:63], v8 offset:18688
    s_waitcnt lgkmcnt(6)
    v_mfma_f32_32x32x16_bf16 v[12:27], v[44:47], v[96:99], v[12:27]
    ds_read_b64_tr_b16 v[64:65], v8 offset:19456
    ds_read_b64_tr_b16 v[66:67], v8 offset:19712
    v_mfma_f32_32x32x16_bf16 v[28:43], v[48:51], v[96:99], v[28:43]
    ds_read_b64_tr_b16 v[44:45], v8 offset:20480
    ds_read_b64_tr_b16 v[46:47], v8 offset:20736
    s_waitcnt vmcnt(4)
    s_waitcnt lgkmcnt(6)
    v_mfma_f32_32x32x16_bf16 v[12:27], v[52:55], v[100:103], v[12:27]
    ds_read_b64_tr_b16 v[48:49], v8 offset:21504
    ds_read_b64_tr_b16 v[50:51], v8 offset:21760
    v_mfma_f32_32x32x16_bf16 v[28:43], v[56:59], v[100:103], v[28:43]
    ds_read_b64_tr_b16 v[52:53], v8 offset:22528
    ds_read_b64_tr_b16 v[54:55], v8 offset:22784
    s_waitcnt lgkmcnt(6)
    v_mfma_f32_32x32x16_bf16 v[12:27], v[60:63], v[104:107], v[12:27]
    ds_read_b64_tr_b16 v[56:57], v8 offset:23552
    ds_read_b64_tr_b16 v[58:59], v8 offset:23808
    v_mfma_f32_32x32x16_bf16 v[28:43], v[64:67], v[104:107], v[28:43]
    ds_read_b64_tr_b16 v[60:61], v8 offset:24576
    ds_read_b64_tr_b16 v[62:63], v8 offset:24832
    s_waitcnt lgkmcnt(6)
    v_mfma_f32_32x32x16_bf16 v[12:27], v[44:47], v[108:111], v[12:27]
    ds_read_b64_tr_b16 v[64:65], v8 offset:25600
    ds_read_b64_tr_b16 v[66:67], v8 offset:25856
    v_mfma_f32_32x32x16_bf16 v[28:43], v[48:51], v[108:111], v[28:43]
    ds_read_b64_tr_b16 v[44:45], v8 offset:26624
    ds_read_b64_tr_b16 v[46:47], v8 offset:26880
    s_waitcnt lgkmcnt(6)
    v_mfma_f32_32x32x16_bf16 v[12:27], v[52:55], v[112:115], v[12:27]
    ds_read_b64_tr_b16 v[48:49], v8 offset:27648
    ds_read_b64_tr_b16 v[50:51], v8 offset:27904
    v_mfma_f32_32x32x16_bf16 v[28:43], v[56:59], v[112:115], v[28:43]
    ds_read_b64_tr_b16 v[52:53], v8 offset:28672
    ds_read_b64_tr_b16 v[54:55], v8 offset:28928
    s_waitcnt vmcnt(0)
    s_waitcnt lgkmcnt(6)
    v_mfma_f32_32x32x16_bf16 v[12:27], v[60:63], v[116:119], v[12:27]
    ds_read_b64_tr_b16 v[56:57], v8 offset:29696
    ds_read_b64_tr_b16 v[58:59], v8 offset:29952
    v_mfma_f32_32x32x16_bf16 v[28:43], v[64:67], v[116:119], v[28:43]
    ds_read_b64_tr_b16 v[60:61], v8 offset:30720
    ds_read_b64_tr_b16 v[62:63], v8 offset:30976
    s_waitcnt lgkmcnt(6)
    v_mfma_f32_32x32x16_bf16 v[12:27], v[44:47], v[120:123], v[12:27]
    ds_read_b64_tr_b16 v[64:65], v8 offset:31744
    ds_read_b64_tr_b16 v[66:67], v8 offset:32000
    v_mfma_f32_32x32x16_bf16 v[28:43], v[48:51], v[120:123], v[28:43]
    s_waitcnt lgkmcnt(4)
    v_mfma_f32_32x32x16_bf16 v[12:27], v[52:55], v[124:127], v[12:27]
    v_mfma_f32_32x32x16_bf16 v[28:43], v[56:59], v[124:127], v[28:43]
    s_waitcnt lgkmcnt(0)
    v_mfma_f32_32x32x16_bf16 v[12:27], v[60:63], v[128:131], v[12:27]
    v_mfma_f32_32x32x16_bf16 v[28:43], v[64:67], v[128:131], v[28:43]
    v_mov_b32 v168, 0
    v_mov_b32 v169, 0
    s_lshl_b32 s26, s51, 12
    s_add_u32 s26, s26, s24
    s_add_u32 s26, s26, 2359296
    v_lshlrev_b32 v164, 3, v164
    s_lshl_b32 s27, s51, 14
    s_add_u32 s27, s27, 14942208
    s_waitcnt vmcnt(0)
    v_lshlrev_b32 v166, 16, v148
    v_and_b32 v167, 0xffff0000, v148
    v_add_f32 v12, v12, v166
    v_add_f32 v13, v13, v167
    v_cvt_pk_bf16_f32 v148, v12, v13
    v_lshlrev_b32 v166, 16, v149
    v_and_b32 v167, 0xffff0000, v149
    v_add_f32 v14, v14, v166
    v_add_f32 v15, v15, v167
    v_cvt_pk_bf16_f32 v149, v14, v15
    v_lshlrev_b32 v166, 16, v150
    v_and_b32 v167, 0xffff0000, v150
    v_add_f32 v16, v16, v166
    v_add_f32 v17, v17, v167
    v_cvt_pk_bf16_f32 v150, v16, v17
    v_lshlrev_b32 v166, 16, v151
    v_and_b32 v167, 0xffff0000, v151
    v_add_f32 v18, v18, v166
    v_add_f32 v19, v19, v167
    v_cvt_pk_bf16_f32 v151, v18, v19
    buffer_store_dwordx4 v[148:151], v1, s[8:11], s26 offen offset:0 sc1
    v_lshlrev_b32 v166, 16, v152
    v_and_b32 v167, 0xffff0000, v152
    v_add_f32 v20, v20, v166
    v_add_f32 v21, v21, v167
    v_cvt_pk_bf16_f32 v152, v20, v21
    v_lshlrev_b32 v166, 16, v153
    v_and_b32 v167, 0xffff0000, v153
    v_add_f32 v22, v22, v166
    v_add_f32 v23, v23, v167
    v_cvt_pk_bf16_f32 v153, v22, v23
    v_lshlrev_b32 v166, 16, v154
    v_and_b32 v167, 0xffff0000, v154
    v_add_f32 v24, v24, v166
    v_add_f32 v25, v25, v167
    v_cvt_pk_bf16_f32 v154, v24, v25
    v_lshlrev_b32 v166, 16, v155
    v_and_b32 v167, 0xffff0000, v155
    v_add_f32 v26, v26, v166
    v_add_f32 v27, v27, v167
    v_cvt_pk_bf16_f32 v155, v26, v27
    buffer_store_dwordx4 v[152:155], v1, s[8:11], s26 offen offset:1024 sc1
    v_lshlrev_b32 v166, 16, v156
    v_and_b32 v167, 0xffff0000, v156
    v_add_f32 v28, v28, v166
    v_add_f32 v29, v29, v167
    v_cvt_pk_bf16_f32 v156, v28, v29
    v_lshlrev_b32 v166, 16, v157
    v_and_b32 v167, 0xffff0000, v157
    v_add_f32 v30, v30, v166
    v_add_f32 v31, v31, v167
    v_cvt_pk_bf16_f32 v157, v30, v31
    v_lshlrev_b32 v166, 16, v158
    v_and_b32 v167, 0xffff0000, v158
    v_add_f32 v32, v32, v166
    v_add_f32 v33, v33, v167
    v_cvt_pk_bf16_f32 v158, v32, v33
    v_lshlrev_b32 v166, 16, v159
    v_and_b32 v167, 0xffff0000, v159
    v_add_f32 v34, v34, v166
    v_add_f32 v35, v35, v167
    v_cvt_pk_bf16_f32 v159, v34, v35
    buffer_store_dwordx4 v[156:159], v1, s[8:11], s26 offen offset:2048 sc1
    v_lshlrev_b32 v166, 16, v160
    v_and_b32 v167, 0xffff0000, v160
    v_add_f32 v36, v36, v166
    v_add_f32 v37, v37, v167
    v_cvt_pk_bf16_f32 v160, v36, v37
    v_lshlrev_b32 v166, 16, v161
    v_and_b32 v167, 0xffff0000, v161
    v_add_f32 v38, v38, v166
    v_add_f32 v39, v39, v167
    v_cvt_pk_bf16_f32 v161, v38, v39
    v_lshlrev_b32 v166, 16, v162
    v_and_b32 v167, 0xffff0000, v162
    v_add_f32 v40, v40, v166
    v_add_f32 v41, v41, v167
    v_cvt_pk_bf16_f32 v162, v40, v41
    v_lshlrev_b32 v166, 16, v163
    v_and_b32 v167, 0xffff0000, v163
    v_add_f32 v42, v42, v166
    v_add_f32 v43, v43, v167
    v_cvt_pk_bf16_f32 v163, v42, v43
    buffer_store_dwordx4 v[160:163], v1, s[8:11], s26 offen offset:3072 sc1
    v_add_f32 v168, v168, v12
    v_fmac_f32 v169, v12, v12
    v_add_f32 v168, v168, v13
    v_fmac_f32 v169, v13, v13
    v_add_f32 v168, v168, v14
    v_fmac_f32 v169, v14, v14
    v_add_f32 v168, v168, v15
    v_fmac_f32 v169, v15, v15
    v_add_f32 v168, v168, v16
    v_fmac_f32 v169, v16, v16
    v_add_f32 v168, v168, v17
    v_fmac_f32 v169, v17, v17
    v_add_f32 v168, v168, v18
    v_fmac_f32 v169, v18, v18
    v_add_f32 v168, v168, v19
    v_fmac_f32 v169, v19, v19
    v_add_f32 v168, v168, v20
    v_fmac_f32 v169, v20, v20
    v_add_f32 v168, v168, v21
    v_fmac_f32 v169, v21, v21
    v_add_f32 v168, v168, v22
    v_fmac_f32 v169, v22, v22
    v_add_f32 v168, v168, v23
    v_fmac_f32 v169, v23, v23
    v_add_f32 v168, v168, v24
    v_fmac_f32 v169, v24, v24
    v_add_f32 v168, v168, v25
    v_fmac_f32 v169, v25, v25
    v_add_f32 v168, v168, v26
    v_fmac_f32 v169, v26, v26
    v_add_f32 v168, v168, v27
    v_fmac_f32 v169, v27, v27
    v_add_f32 v168, v168, v28
    v_fmac_f32 v169, v28, v28
    v_add_f32 v168, v168, v29
    v_fmac_f32 v169, v29, v29
    v_add_f32 v168, v168, v30
    v_fmac_f32 v169, v30, v30
    v_add_f32 v168, v168, v31
    v_fmac_f32 v169, v31, v31
    v_add_f32 v168, v168, v32
    v_fmac_f32 v169, v32, v32
    v_add_f32 v168, v168, v33
    v_fmac_f32 v169, v33, v33
    v_add_f32 v168, v168, v34
    v_fmac_f32 v169, v34, v34
    v_add_f32 v168, v168, v35
    v_fmac_f32 v169, v35, v35
    v_add_f32 v168, v168, v36
    v_fmac_f32 v169, v36, v36
    v_add_f32 v168, v168, v37
    v_fmac_f32 v169, v37, v37
    v_add_f32 v168, v168, v38
    v_fmac_f32 v169, v38, v38
    v_add_f32 v168, v168, v39
    v_fmac_f32 v169, v39, v39
    v_add_f32 v168, v168, v40
    v_fmac_f32 v169, v40, v40
    v_add_f32 v168, v168, v41
    v_fmac_f32 v169, v41, v41
    v_add_f32 v168, v168, v42
    v_fmac_f32 v169, v42, v42
    v_add_f32 v168, v168, v43
    v_fmac_f32 v169, v43, v43
    v_mov_b32 v166, v168
    s_nop 1
    v_permlane32_swap_b32 v168, v166
    v_add_f32 v168, v168, v166
    v_mov_b32 v167, v169
    s_nop 1
    v_permlane32_swap_b32 v169, v167
    v_add_f32 v169, v169, v167
    s_mov_b32 exec_hi, 0
    buffer_store_dwordx2 v[168:169], v164, s[8:11], s27 offen sc1
    s_mov_b64 exec, -1
    s_lshl_b32 s3, s50, 7
    s_add_u32 s3, s3, 12320768
    s_barrier
    s_branch L_b_w3
L_b_cs:
    s_and_b32 s56, s2, 255
    s_lshl_b32 s56, s56, 7
    s_add_u32 s56, s56, 12353536
    s_lshl_b32 s59, s51, 1
    v_lshrrev_b32 v1, 3, v0
    v_mul_u32_u24 v1, 9216, v1
    v_and_b32 v2, 7, v0
    v_lshl_add_u32 v1, v2, 4, v1
    s_mov_b32 s4, s72
    s_and_b32 s5, s73, 0xffff
    s_mov_b32 s6, 0x00510000
    s_mov_b32 s7, 0x00020000
    s_cmp_lg_u32 s18, 0
    s_cbranch_scc1 L_f_pw_39
    s_mov_b32 s57, 262144
L_f_pp_40:
    s_mov_b32 s45, 0
    s_atomic_add s45, s[40:41], s56 glc
    s_waitcnt lgkmcnt(0)
    s_cmp_ge_u32 s45, 2
    s_cbranch_scc1 L_f_pw_39
L_f_ps_41:
    s_sleep 2
    s_sub_u32 s57, s57, 1
    s_cmp_gt_i32 s57, 0
    s_cbranch_scc1 L_f_pp_40
L_f_pw_39:
    s_barrier
    s_cmp_ge_u32 s59, 216
    s_cbranch_scc1 L_f_se_38
    s_mul_i32 s52, s59, 21846
    s_lshr_b32 s52, s52, 16
    s_mul_i32 s26, s52, 3
    s_sub_u32 s53, s59, s26
    s_lshl_b32 s26, s52, 7
    s_mul_i32 s27, s53, 1769472
    s_add_u32 s26, s26, s27
    s_add_u32 s59, s59, 1
    buffer_load_dwordx4 v[4:7], v1, s[4:7], s26 offen
    s_add_u32 s26, s26, 294912
    buffer_load_dwordx4 v[8:11], v1, s[4:7], s26 offen
    s_add_u32 s26, s26, 294912
    buffer_load_dwordx4 v[12:15], v1, s[4:7], s26 offen
    s_add_u32 s26, s26, 294912
    buffer_load_dwordx4 v[16:19], v1, s[4:7], s26 offen
    s_add_u32 s26, s26, 294912
    buffer_load_dwordx4 v[20:23], v1, s[4:7], s26 offen
    s_add_u32 s26, s26, 294912
    buffer_load_dwordx4 v[24:27], v1, s[4:7], s26 offen
    s_add_u32 s26, s26, 294912
    s_mul_i32 s54, s59, 21846
    s_lshr_b32 s54, s54, 16
    s_mul_i32 s26, s54, 3
    s_sub_u32 s55, s59, s26
    s_lshl_b32 s26, s54, 7
    s_mul_i32 s27, s55, 1769472
    s_add_u32 s26, s26, s27
    s_add_u32 s59, s59, 1
    buffer_load_dwordx4 v[28:31], v1, s[4:7], s26 offen
    s_add_u32 s26, s26, 294912
    buffer_load_dwordx4 v[32:35], v1, s[4:7], s26 offen
    s_add_u32 s26, s26, 294912
    buffer_load_dwordx4 v[36:39], v1, s[4:7], s26 offen
    s_add_u32 s26, s26, 294912
    buffer_load_dwordx4 v[40:43], v1, s[4:7], s26 offen
    s_add_u32 s26, s26, 294912
    buffer_load_dwordx4 v[44:47], v1, s[4:7], s26 offen
    s_add_u32 s26, s26, 294912
    buffer_load_dwordx4 v[48:51], v1, s[4:7], s26 offen
    s_add_u32 s26, s26, 294912
    v_lshlrev_b32 v3, 5, v0
    s_waitcnt vmcnt(11)
    v_lshlrev_b32 v52, 16, v4
    v_and_b32 v53, 0xffff0000, v4
    v_lshlrev_b32 v54, 16, v5
    v_and_b32 v55, 0xffff0000, v5
    v_lshlrev_b32 v56, 16, v6
    v_and_b32 v57, 0xffff0000, v6
    v_lshlrev_b32 v58, 16, v7
    v_and_b32 v59, 0xffff0000, v7
    s_waitcnt vmcnt(10)
    v_lshlrev_b32 v68, 16, v8
    v_and_b32 v69, 0xffff0000, v8
    v_lshlrev_b32 v70, 16, v9
    v_and_b32 v71, 0xffff0000, v9
    v_lshlrev_b32 v72, 16, v10
    v_and_b32 v73, 0xffff0000, v10
    v_lshlrev_b32 v74, 16, v11
    v_and_b32 v75, 0xffff0000, v11
    v_add_f32 v52, v52, v68
    v_add_f32 v53, v53, v69
    v_add_f32 v54, v54, v70
    v_add_f32 v55, v55, v71
    v_add_f32 v56, v56, v72
    v_add_f32 v57, v57, v73
    v_add_f32 v58, v58, v74
    v_add_f32 v59, v59, v75
    s_waitcnt vmcnt(9)
    v_lshlrev_b32 v68, 16, v12
    v_and_b32 v69, 0xffff0000, v12
    v_lshlrev_b32 v70, 16, v13
    v_and_b32 v71, 0xffff0000, v13
    v_lshlrev_b32 v72, 16, v14
    v_and_b32 v73, 0xffff0000, v14
    v_lshlrev_b32 v74, 16, v15
    v_and_b32 v75, 0xffff0000, v15
    v_add_f32 v52, v52, v68
    v_add_f32 v53, v53, v69
    v_add_f32 v54, v54, v70
    v_add_f32 v55, v55, v71
    v_add_f32 v56, v56, v72
    v_add_f32 v57, v57, v73
    v_add_f32 v58, v58, v74
    v_add_f32 v59, v59, v75
    s_waitcnt vmcnt(8)
    v_lshlrev_b32 v68, 16, v16
    v_and_b32 v69, 0xffff0000, v16
    v_lshlrev_b32 v70, 16, v17
    v_and_b32 v71, 0xffff0000, v17
    v_lshlrev_b32 v72, 16, v18
    v_and_b32 v73, 0xffff0000, v18
    v_lshlrev_b32 v74, 16, v19
    v_and_b32 v75, 0xffff0000, v19
    v_add_f32 v52, v52, v68
    v_add_f32 v53, v53, v69
    v_add_f32 v54, v54, v70
    v_add_f32 v55, v55, v71
    v_add_f32 v56, v56, v72
    v_add_f32 v57, v57, v73
    v_add_f32 v58, v58, v74
    v_add_f32 v59, v59, v75
    s_waitcnt vmcnt(7)
    v_lshlrev_b32 v68, 16, v20
    v_and_b32 v69, 0xffff0000, v20
    v_lshlrev_b32 v70, 16, v21
    v_and_b32 v71, 0xffff0000, v21
    v_lshlrev_b32 v72, 16, v22
    v_and_b32 v73, 0xffff0000, v22
    v_lshlrev_b32 v74, 16, v23
    v_and_b32 v75, 0xffff0000, v23
    v_add_f32 v52, v52, v68
    v_add_f32 v53, v53, v69
    v_add_f32 v54, v54, v70
    v_add_f32 v55, v55, v71
    v_add_f32 v56, v56, v72
    v_add_f32 v57, v57, v73
    v_add_f32 v58, v58, v74
    v_add_f32 v59, v59, v75
    s_waitcnt vmcnt(6)
    v_lshlrev_b32 v68, 16, v24
    v_and_b32 v69, 0xffff0000, v24
    v_lshlrev_b32 v70, 16, v25
    v_and_b32 v71, 0xffff0000, v25
    v_lshlrev_b32 v72, 16, v26
    v_and_b32 v73, 0xffff0000, v26
    v_lshlrev_b32 v74, 16, v27
    v_and_b32 v75, 0xffff0000, v27
    v_add_f32 v52, v52, v68
    v_add_f32 v53, v53, v69
    v_add_f32 v54, v54, v70
    v_add_f32 v55, v55, v71
    v_add_f32 v56, v56, v72
    v_add_f32 v57, v57, v73
    v_add_f32 v58, v58, v74
    v_add_f32 v59, v59, v75
    ds_write_b128 v3, v[52:55] offset:0
    ds_write_b128 v3, v[56:59] offset:16
    s_waitcnt vmcnt(5)
    v_lshlrev_b32 v60, 16, v28
    v_and_b32 v61, 0xffff0000, v28
    v_lshlrev_b32 v62, 16, v29
    v_and_b32 v63, 0xffff0000, v29
    v_lshlrev_b32 v64, 16, v30
    v_and_b32 v65, 0xffff0000, v30
    v_lshlrev_b32 v66, 16, v31
    v_and_b32 v67, 0xffff0000, v31
    s_waitcnt vmcnt(4)
    v_lshlrev_b32 v68, 16, v32
    v_and_b32 v69, 0xffff0000, v32
    v_lshlrev_b32 v70, 16, v33
    v_and_b32 v71, 0xffff0000, v33
    v_lshlrev_b32 v72, 16, v34
    v_and_b32 v73, 0xffff0000, v34
    v_lshlrev_b32 v74, 16, v35
    v_and_b32 v75, 0xffff0000, v35
    v_add_f32 v60, v60, v68
    v_add_f32 v61, v61, v69
    v_add_f32 v62, v62, v70
    v_add_f32 v63, v63, v71
    v_add_f32 v64, v64, v72
    v_add_f32 v65, v65, v73
    v_add_f32 v66, v66, v74
    v_add_f32 v67, v67, v75
    s_waitcnt vmcnt(3)
    v_lshlrev_b32 v68, 16, v36
    v_and_b32 v69, 0xffff0000, v36
    v_lshlrev_b32 v70, 16, v37
    v_and_b32 v71, 0xffff0000, v37
    v_lshlrev_b32 v72, 16, v38
    v_and_b32 v73, 0xffff0000, v38
    v_lshlrev_b32 v74, 16, v39
    v_and_b32 v75, 0xffff0000, v39
    v_add_f32 v60, v60, v68
    v_add_f32 v61, v61, v69
    v_add_f32 v62, v62, v70
    v_add_f32 v63, v63, v71
    v_add_f32 v64, v64, v72
    v_add_f32 v65, v65, v73
    v_add_f32 v66, v66, v74
    v_add_f32 v67, v67, v75
    s_waitcnt vmcnt(2)
    v_lshlrev_b32 v68, 16, v40
    v_and_b32 v69, 0xffff0000, v40
    v_lshlrev_b32 v70, 16, v41
    v_and_b32 v71, 0xffff0000, v41
    v_lshlrev_b32 v72, 16, v42
    v_and_b32 v73, 0xffff0000, v42
    v_lshlrev_b32 v74, 16, v43
    v_and_b32 v75, 0xffff0000, v43
    v_add_f32 v60, v60, v68
    v_add_f32 v61, v61, v69
    v_add_f32 v62, v62, v70
    v_add_f32 v63, v63, v71
    v_add_f32 v64, v64, v72
    v_add_f32 v65, v65, v73
    v_add_f32 v66, v66, v74
    v_add_f32 v67, v67, v75
    s_waitcnt vmcnt(1)
    v_lshlrev_b32 v68, 16, v44
    v_and_b32 v69, 0xffff0000, v44
    v_lshlrev_b32 v70, 16, v45
    v_and_b32 v71, 0xffff0000, v45
    v_lshlrev_b32 v72, 16, v46
    v_and_b32 v73, 0xffff0000, v46
    v_lshlrev_b32 v74, 16, v47
    v_and_b32 v75, 0xffff0000, v47
    v_add_f32 v60, v60, v68
    v_add_f32 v61, v61, v69
    v_add_f32 v62, v62, v70
    v_add_f32 v63, v63, v71
    v_add_f32 v64, v64, v72
    v_add_f32 v65, v65, v73
    v_add_f32 v66, v66, v74
    v_add_f32 v67, v67, v75
    s_waitcnt vmcnt(0)
    v_lshlrev_b32 v68, 16, v48
    v_and_b32 v69, 0xffff0000, v48
    v_lshlrev_b32 v70, 16, v49
    v_and_b32 v71, 0xffff0000, v49
    v_lshlrev_b32 v72, 16, v50
    v_and_b32 v73, 0xffff0000, v50
    v_lshlrev_b32 v74, 16, v51
    v_and_b32 v75, 0xffff0000, v51
    v_add_f32 v60, v60, v68
    v_add_f32 v61, v61, v69
    v_add_f32 v62, v62, v70
    v_add_f32 v63, v63, v71
    v_add_f32 v64, v64, v72
    v_add_f32 v65, v65, v73
    v_add_f32 v66, v66, v74
    v_add_f32 v67, v67, v75
    ds_write_b128 v3, v[60:63] offset:8192
    ds_write_b128 v3, v[64:67] offset:8208
    v_and_b32 v3, 63, v0
    v_lshlrev_b32 v3, 2, v3
    s_lshl_b32 s26, s18, 13
    v_add_u32 v3, s26, v3
    s_waitcnt lgkmcnt(0)
    s_barrier
    s_cmp_ge_u32 s18, 2
    s_cbranch_scc1 L_f_sd_37
    ds_read_b32 v4, v3 offset:0
    ds_read_b32 v5, v3 offset:256
    ds_read_b32 v6, v3 offset:512
    ds_read_b32 v7, v3 offset:768
    ds_read_b32 v8, v3 offset:1024
    ds_read_b32 v9, v3 offset:1280
    ds_read_b32 v10, v3 offset:1536
    ds_read_b32 v11, v3 offset:1792
    ds_read_b32 v12, v3 offset:2048
    ds_read_b32 v13, v3 offset:2304
    ds_read_b32 v14, v3 offset:2560
    ds_read_b32 v15, v3 offset:2816
    ds_read_b32 v16, v3 offset:3072
    ds_read_b32 v17, v3 offset:3328
    ds_read_b32 v18, v3 offset:3584
    ds_read_b32 v19, v3 offset:3840
    ds_read_b32 v20, v3 offset:4096
    ds_read_b32 v21, v3 offset:4352
    ds_read_b32 v22, v3 offset:4608
    ds_read_b32 v23, v3 offset:4864
    ds_read_b32 v24, v3 offset:5120
    ds_read_b32 v25, v3 offset:5376
    ds_read_b32 v26, v3 offset:5632
    ds_read_b32 v27, v3 offset:5888
    ds_read_b32 v28, v3 offset:6144
    ds_read_b32 v29, v3 offset:6400
    ds_read_b32 v30, v3 offset:6656
    ds_read_b32 v31, v3 offset:6912
    ds_read_b32 v32, v3 offset:7168
    ds_read_b32 v33, v3 offset:7424
    ds_read_b32 v34, v3 offset:7680
    ds_read_b32 v35, v3 offset:7936
    s_cmp_eq_u32 s18, 0
    s_cselect_b32 s52, s52, s54
    s_cselect_b32 s53, s53, s55
    s_waitcnt lgkmcnt(0)
    v_add_f32 v4, v4, v20
    v_add_f32 v5, v5, v21
    v_add_f32 v6, v6, v22
    v_add_f32 v7, v7, v23
    v_add_f32 v8, v8, v24
    v_add_f32 v9, v9, v25
    v_add_f32 v10, v10, v26
    v_add_f32 v11, v11, v27
    v_add_f32 v12, v12, v28
    v_add_f32 v13, v13, v29
    v_add_f32 v14, v14, v30
    v_add_f32 v15, v15, v31
    v_add_f32 v16, v16, v32
    v_add_f32 v17, v17, v33
    v_add_f32 v18, v18, v34
    v_add_f32 v19, v19, v35
    v_add_f32 v4, v4, v12
    v_add_f32 v5, v5, v13
    v_add_f32 v6, v6, v14
    v_add_f32 v7, v7, v15
    v_add_f32 v8, v8, v16
    v_add_f32 v9, v9, v17
    v_add_f32 v10, v10, v18
    v_add_f32 v11, v11, v19
    v_add_f32 v4, v4, v8
    v_add_f32 v5, v5, v9
    v_add_f32 v6, v6, v10
    v_add_f32 v7, v7, v11
    v_add_f32 v4, v4, v6
    v_add_f32 v5, v5, v7
    v_add_f32 v4, v4, v5
    v_and_b32 v68, 0xffff0000, v4
    v_sub_f32 v4, v4, v68
    v_cvt_pk_bf16_f32 v52, v68, v68
    v_cvt_pk_bf16_f32 v53, v4, v4
    v_mov_b32 v54, 0
    v_mov_b32 v55, 0
    v_and_b32 v1, 0x13, v0
    v_and_b32 v2, 4, v0
    v_lshl_or_b32 v1, v2, 1, v1
    v_bfe_u32 v2, v0, 3, 1
    v_lshl_or_b32 v1, v2, 2, v1
    v_lshlrev_b32 v1, 4, v1
    v_bfe_u32 v2, v0, 5, 1
    v_lshl_add_u32 v1, v2, 10, v1
    s_lshl_b32 s26, s52, 11
    s_add_u32 s26, s26, 15204352
    s_lshl_b32 s27, s53, 3
    s_cmp_eq_u32 s53, 2
    s_cselect_b32 s27, 512, s27
    s_add_u32 s26, s26, s27
    buffer_store_dwordx2 v[52:53], v1, s[8:11], s26 offen sc1
    s_cmp_lg_u32 s53, 2
    s_cbranch_scc1 L_f_nz_42
    buffer_store_dwordx2 v[54:55], v1, s[8:11], s26 offen offset:8 sc1
L_f_nz_42:
    s_mul_i32 s56, s52, 3641
    s_lshr_b32 s56, s56, 16
    s_lshl_b32 s56, s56, 7
    s_add_u32 s56, s56, 12343296
    s_waitcnt vmcnt(0)
    s_mov_b32 s57, 1
    s_atomic_add s57, s[40:41], s56 glc
    s_waitcnt lgkmcnt(0)
L_f_sd_37:
    s_barrier
L_f_se_38:
    s_mov_b32 s3, 12343808
L_b_w3:
    s_mov_b64 s[38:39], s[72:73]
    s_setprio 3
    s_mov_b32 s4, s38
    s_and_b32 s5, s39, 0xffff
    s_mov_b32 s6, 0x00510000
    s_mov_b32 s7, 0x00020000
    v_and_b32 v10, 63, v0
    s_lshl_b32 s20, s16, 2
    s_add_u32 s20, s20, s18
    v_lshlrev_b32 v1, 4, v10
    s_and_b32 s50, s16, 3
    s_bfe_u32 s51, s16, 0x10002
    s_and_b32 s26, s17, 3
    s_add_u32 s51, s51, s26
    s_cmp_ge_u32 s51, 3
    s_cselect_b32 s26, 3, 0
    s_sub_u32 s51, s51, s26
    s_mul_i32 s42, s51, 1769472
    s_add_u32 s43, s42, 1769472
    s_cmp_eq_u32 s51, 2
    s_cselect_b32 s43, 0, s43
    s_add_u32 s44, s43, 1769472
    s_cmp_eq_u32 s51, 1
    s_cselect_b32 s44, 0, s44
    v_bfe_u32 v11, v10, 2, 2
    v_lshrrev_b32 v12, 5, v10
    v_lshl_add_u32 v11, v12, 2, v11
    s_mul_i32 s26, s18, 48
    v_add_u32 v11, s26, v11
    v_mul_u32_u24 v2, 9216, v11
    v_bfe_u32 v11, v10, 4, 1
    v_lshl_add_u32 v2, v11, 6, v2
    v_and_b32 v12, 3, v10
    v_lshl_add_u32 v2, v12, 4, v2
    v_lshrrev_b32 v11, 2, v10
    v_add_u32 v11, s26, v11
    v_mul_u32_u24 v3, 9216, v11
    v_lshl_add_u32 v3, v12, 4, v3
    s_mul_i32 s25, s17, 576
    s_and_b32 s48, s17, 1
    s_cselect_b32 s49, 0, 8
    s_mul_i32 s28, s18, 6144
    s_mul_i32 s29, s18, 3072
    v_bfe_u32 v11, v10, 2, 2
    v_lshlrev_b32 v4, 6, v11
    v_bfe_u32 v11, v10, 4, 1
    v_lshl_add_u32 v4, v11, 5, v4
    v_and_b32 v11, 1, v10
    v_lshl_add_u32 v4, v11, 4, v4
    v_bfe_u32 v11, v10, 1, 1
    v_lshl_add_u32 v4, v11, 3, v4
    v_lshrrev_b32 v11, 5, v10
    v_mul_u32_u24 v11, 1024, v11
    v_add_u32 v4, v4, v11
    v_add_u32 v5, 49152, v4
    s_add_u32 s52, s50, 0
    s_and_b32 s52, s52, 3
    s_lshl_b32 s52, s52, 1
    s_add_u32 s52, s52, s48
    s_lshl_b32 s52, s52, 6
    s_add_u32 s52, s52, s25
    s_add_u32 s53, s42, s52
    s_add_u32 m0, s28, 0
    s_nop 0
    buffer_load_dwordx4 v2, s[4:7], s53 offen lds
    s_add_u32 s53, s53, 73728
    s_add_u32 m0, s28, 1024
    s_nop 0
    buffer_load_dwordx4 v2, s[4:7], s53 offen lds
    s_add_u32 s53, s53, 73728
    s_add_u32 m0, s28, 2048
    s_nop 0
    buffer_load_dwordx4 v2, s[4:7], s53 offen lds
    s_add_u32 s53, s53, 73728
    s_add_u32 m0, s28, 3072
    s_nop 0
    buffer_load_dwordx4 v2, s[4:7], s53 offen lds
    s_add_u32 s53, s53, 73728
    s_add_u32 m0, s28, 4096
    s_nop 0
    buffer_load_dwordx4 v2, s[4:7], s53 offen lds
    s_add_u32 s53, s53, 73728
    s_add_u32 m0, s28, 5120
    s_nop 0
    buffer_load_dwordx4 v2, s[4:7], s53 offen lds
    s_waitcnt vmcnt(6)
    s_barrier
    s_cmp_lg_u32 s18, 0
    s_cbranch_scc1 L_f_sig_43
    s_mov_b32 s57, 1
    s_atomic_add s57, s[40:41], s3 glc
    s_waitcnt lgkmcnt(0)
L_f_sig_43:
    s_add_u32 s53, s43, s52
    s_add_u32 m0, s28, 24576
    s_nop 0
    buffer_load_dwordx4 v2, s[4:7], s53 offen lds
    s_add_u32 s53, s53, 73728
    s_add_u32 m0, s28, 25600
    s_nop 0
    buffer_load_dwordx4 v2, s[4:7], s53 offen lds
    s_add_u32 s53, s53, 73728
    s_add_u32 m0, s28, 26624
    s_nop 0
    buffer_load_dwordx4 v2, s[4:7], s53 offen lds
    s_add_u32 s53, s53, 73728
    s_add_u32 m0, s28, 27648
    s_nop 0
    buffer_load_dwordx4 v2, s[4:7], s53 offen lds
    s_add_u32 s53, s53, 73728
    s_add_u32 m0, s28, 28672
    s_nop 0
    buffer_load_dwordx4 v2, s[4:7], s53 offen lds
    s_add_u32 s53, s53, 73728
    s_add_u32 m0, s28, 29696
    s_nop 0
    buffer_load_dwordx4 v2, s[4:7], s53 offen lds
    s_add_u32 s53, s44, s52
    s_add_u32 m0, s28, 49152
    s_nop 0
    buffer_load_dwordx4 v2, s[4:7], s53 offen lds
    s_add_u32 s53, s53, 73728
    s_add_u32 m0, s28, 50176
    s_nop 0
    buffer_load_dwordx4 v2, s[4:7], s53 offen lds
    s_add_u32 s53, s53, 73728
    s_add_u32 m0, s28, 51200
    s_nop 0
    buffer_load_dwordx4 v2, s[4:7], s53 offen lds
    s_add_u32 s53, s53, 73728
    s_add_u32 m0, s28, 52224
    s_nop 0
    buffer_load_dwordx4 v2, s[4:7], s53 offen lds
    s_add_u32 s53, s53, 73728
    s_add_u32 m0, s28, 53248
    s_nop 0
    buffer_load_dwordx4 v2, s[4:7], s53 offen lds
    s_add_u32 s53, s53, 73728
    s_add_u32 m0, s28, 54272
    s_nop 0
    buffer_load_dwordx4 v2, s[4:7], s53 offen lds
    v_and_b32 v11, 31, v0
    v_lshlrev_b32 v11, 3, v11
    s_lshl_b32 s34, s20, 8
    s_add_u32 s34, s34, 14942208
    s_mul_i32 s55, s17, 9216
    s_add_u32 s55, s55, 15204352
    s_mul_i32 s24, s20, 36864
    s_add_u32 s24, s24, 9699328
    s_mul_i32 s54, s20, 288
    s_mul_i32 s26, s17, 18
    s_add_u32 s54, s54, s26
    s_lshl_b32 s54, s54, 10
    s_add_u32 s54, s54, 16777216
    s_lshl_b32 s56, s16, 7
    s_add_u32 s56, s56, 12320768
    s_and_b32 s59, s2, 3
    s_lshl_b32 s59, s59, 7
    s_add_u32 s59, s59, 12343296
    s_cmp_lg_u32 s18, 0
    s_cbranch_scc1 L_f_pw_44
    s_mov_b32 s57, 262144
L_f_pp_45:
    s_mov_b32 s45, 0
    s_atomic_add s45, s[40:41], s56 glc
    s_waitcnt lgkmcnt(0)
    s_cmp_ge_u32 s45, 9
    s_cbranch_scc1 L_f_pw_44
L_f_ps_46:
    s_sleep 2
    s_sub_u32 s57, s57, 1
    s_cmp_gt_i32 s57, 0
    s_cbranch_scc1 L_f_pp_45
L_f_pw_44:
    s_mov_b32 s58, 54
    s_cmp_lg_u32 s18, 0
    s_cbranch_scc1 L_f_ca_47
    s_mov_b32 s58, 0
    s_atomic_add s58, s[40:41], s59 glc
L_f_ca_47:
    s_waitcnt vmcnt(12)
    s_barrier
    s_add_u32 s23, s51, 0
    s_mul_i32 s23, s23, 12288
    s_add_u32 s23, s23, s24
    buffer_load_dwordx4 v[112:115], v1, s[8:11], s23 offen offset:0 sc1
    buffer_load_dwordx4 v[116:119], v1, s[8:11], s23 offen offset:1024 sc1
    buffer_load_dwordx4 v[120:123], v1, s[8:11], s23 offen offset:2048 sc1
    buffer_load_dwordx4 v[124:127], v1, s[8:11], s23 offen offset:3072 sc1
    s_add_u32 s23, s23, 4096
    buffer_load_dwordx4 v[128:131], v1, s[8:11], s23 offen offset:0 sc1
    buffer_load_dwordx4 v[132:135], v1, s[8:11], s23 offen offset:1024 sc1
    buffer_load_dwordx4 v[136:139], v1, s[8:11], s23 offen offset:2048 sc1
    buffer_load_dwordx4 v[140:143], v1, s[8:11], s23 offen offset:3072 sc1
    s_setprio 2
    ds_read_b64_tr_b16 v[88:89], v4 offset:0
    ds_read_b64_tr_b16 v[90:91], v4 offset:512
    ds_read_b64_tr_b16 v[92:93], v4 offset:256
    ds_read_b64_tr_b16 v[94:95], v4 offset:768
    ds_read_b64_tr_b16 v[96:97], v4 offset:2048
    ds_read_b64_tr_b16 v[98:99], v4 offset:2560
    ds_read_b64_tr_b16 v[100:101], v4 offset:2304
    ds_read_b64_tr_b16 v[102:103], v4 offset:2816
    ds_read_b64_tr_b16 v[104:105], v4 offset:4096
    ds_read_b64_tr_b16 v[106:107], v4 offset:4608
    s_waitcnt vmcnt(7) lgkmcnt(6)
    v_mfma_f32_32x32x16_bf16 v[24:39], v[88:91], v[112:115], 0
    s_add_u32 s23, s23, 4096
    ds_read_b64_tr_b16 v[108:109], v4 offset:4352
    ds_read_b64_tr_b16 v[110:111], v4 offset:4864
    buffer_load_dwordx4 v[144:147], v1, s[8:11], s23 offen offset:0 sc1
    v_mfma_f32_32x32x16_bf16 v[40:55], v[92:95], v[112:115], 0
    ds_read_b64_tr_b16 v[88:89], v4 offset:6144
    ds_read_b64_tr_b16 v[90:91], v4 offset:6656
    buffer_load_dwordx4 v[148:151], v1, s[8:11], s23 offen offset:1024 sc1
    s_waitcnt vmcnt(8) lgkmcnt(6)
    v_mfma_f32_32x32x16_bf16 v[24:39], v[96:99], v[116:119], v[24:39]
    ds_read_b64_tr_b16 v[92:93], v4 offset:6400
    ds_read_b64_tr_b16 v[94:95], v4 offset:6912
    buffer_load_dwordx4 v[152:155], v1, s[8:11], s23 offen offset:2048 sc1
    v_mfma_f32_32x32x16_bf16 v[40:55], v[100:103], v[116:119], v[40:55]
    ds_read_b64_tr_b16 v[96:97], v4 offset:8192
    ds_read_b64_tr_b16 v[98:99], v4 offset:8704
    buffer_load_dwordx4 v[156:159], v1, s[8:11], s23 offen offset:3072 sc1
    s_waitcnt vmcnt(9) lgkmcnt(6)
    v_mfma_f32_32x32x16_bf16 v[24:39], v[104:107], v[120:123], v[24:39]
    s_add_u32 s23, s51, 1
    s_cmp_ge_u32 s23, 3
    s_cselect_b32 s27, 3, 0
    s_sub_u32 s23, s23, s27
    s_mul_i32 s23, s23, 12288
    s_add_u32 s23, s23, s24
    ds_read_b64_tr_b16 v[100:101], v4 offset:8448
    ds_read_b64_tr_b16 v[102:103], v4 offset:8960
    buffer_load_dwordx4 v[160:163], v1, s[8:11], s23 offen offset:0 sc1
    v_mfma_f32_32x32x16_bf16 v[40:55], v[108:111], v[120:123], v[40:55]
    ds_read_b64_tr_b16 v[104:105], v4 offset:10240
    ds_read_b64_tr_b16 v[106:107], v4 offset:10752
    buffer_load_dwordx4 v[164:167], v1, s[8:11], s23 offen offset:1024 sc1
    s_waitcnt vmcnt(10) lgkmcnt(6)
    v_mfma_f32_32x32x16_bf16 v[24:39], v[88:91], v[124:127], v[24:39]
    ds_read_b64_tr_b16 v[108:109], v4 offset:10496
    ds_read_b64_tr_b16 v[110:111], v4 offset:11008
    buffer_load_dwordx4 v[168:171], v1, s[8:11], s23 offen offset:2048 sc1
    v_mfma_f32_32x32x16_bf16 v[40:55], v[92:95], v[124:127], v[40:55]
    ds_read_b64_tr_b16 v[88:89], v4 offset:12288
    ds_read_b64_tr_b16 v[90:91], v4 offset:12800
    buffer_load_dwordx4 v[172:175], v1, s[8:11], s23 offen offset:3072 sc1
    s_waitcnt vmcnt(11) lgkmcnt(6)
    v_mfma_f32_32x32x16_bf16 v[24:39], v[96:99], v[128:131], v[24:39]
    s_add_u32 s23, s23, 4096
    ds_read_b64_tr_b16 v[92:93], v4 offset:12544
    ds_read_b64_tr_b16 v[94:95], v4 offset:13056
    buffer_load_dwordx4 v[176:179], v1, s[8:11], s23 offen offset:0 sc1
    v_mfma_f32_32x32x16_bf16 v[40:55], v[100:103], v[128:131], v[40:55]
    ds_read_b64_tr_b16 v[96:97], v4 offset:14336
    ds_read_b64_tr_b16 v[98:99], v4 offset:14848
    buffer_load_dwordx2 v[56:57], v11, s[8:11], s34 offen sc1
    s_waitcnt vmcnt(12) lgkmcnt(6)
    v_mfma_f32_32x32x16_bf16 v[24:39], v[104:107], v[132:135], v[24:39]
    s_add_u32 s34, s34, 16384
    ds_read_b64_tr_b16 v[100:101], v4 offset:14592
    ds_read_b64_tr_b16 v[102:103], v4 offset:15104
    buffer_load_dwordx2 v[58:59], v11, s[8:11], s34 offen sc1
    v_mfma_f32_32x32x16_bf16 v[40:55], v[108:111], v[132:135], v[40:55]
    s_add_u32 s34, s34, 16384
    ds_read_b64_tr_b16 v[104:105], v4 offset:16384
    ds_read_b64_tr_b16 v[106:107], v4 offset:16896
    buffer_load_dwordx2 v[60:61], v11, s[8:11], s34 offen sc1
    s_waitcnt vmcnt(13) lgkmcnt(6)
    v_mfma_f32_32x32x16_bf16 v[24:39], v[88:91], v[136:139], v[24:39]
    s_add_u32 s34, s34, 16384
    ds_read_b64_tr_b16 v[108:109], v4 offset:16640
    ds_read_b64_tr_b16 v[110:111], v4 offset:17152
    buffer_load_dwordx2 v[62:63], v11, s[8:11], s34 offen sc1
    v_mfma_f32_32x32x16_bf16 v[40:55], v[92:95], v[136:139], v[40:55]
    s_add_u32 s34, s34, 16384
    ds_read_b64_tr_b16 v[88:89], v4 offset:18432
    ds_read_b64_tr_b16 v[90:91], v4 offset:18944
    buffer_load_dwordx2 v[64:65], v11, s[8:11], s34 offen sc1
    s_waitcnt vmcnt(14) lgkmcnt(6)
    v_mfma_f32_32x32x16_bf16 v[24:39], v[96:99], v[140:143], v[24:39]
    s_add_u32 s34, s34, 16384
    ds_read_b64_tr_b16 v[92:93], v4 offset:18688
    ds_read_b64_tr_b16 v[94:95], v4 offset:19200
    buffer_load_dwordx2 v[66:67], v11, s[8:11], s34 offen sc1
    v_mfma_f32_32x32x16_bf16 v[40:55], v[100:103], v[140:143], v[40:55]
    s_add_u32 s34, s34, 16384
    ds_read_b64_tr_b16 v[96:97], v4 offset:20480
    ds_read_b64_tr_b16 v[98:99], v4 offset:20992
    buffer_load_dwordx2 v[68:69], v11, s[8:11], s34 offen sc1
    s_waitcnt vmcnt(15) lgkmcnt(6)
    v_mfma_f32_32x32x16_bf16 v[24:39], v[104:107], v[144:147], v[24:39]
    s_add_u32 s34, s34, 16384
    ds_read_b64_tr_b16 v[100:101], v4 offset:20736
    ds_read_b64_tr_b16 v[102:103], v4 offset:21248
    buffer_load_dwordx2 v[70:71], v11, s[8:11], s34 offen sc1
    v_mfma_f32_32x32x16_bf16 v[40:55], v[108:111], v[144:147], v[40:55]
    s_add_u32 s34, s34, 16384
    ds_read_b64_tr_b16 v[104:105], v4 offset:22528
    ds_read_b64_tr_b16 v[106:107], v4 offset:23040
    buffer_load_dwordx2 v[72:73], v11, s[8:11], s34 offen sc1
    s_waitcnt vmcnt(16) lgkmcnt(6)
    v_mfma_f32_32x32x16_bf16 v[24:39], v[88:91], v[148:151], v[24:39]
    v_lshlrev_b32 v12, 1, v11
    s_lshl_b32 s34, s20, 9
    s_add_u32 s34, s34, 12058624
    ds_read_b64_tr_b16 v[108:109], v4 offset:22784
    ds_read_b64_tr_b16 v[110:111], v4 offset:23296
    buffer_load_dword v74, v12, s[8:11], s34 offen offset:8 sc1
    v_mfma_f32_32x32x16_bf16 v[40:55], v[92:95], v[148:151], v[40:55]
    buffer_load_dwordx4 v[180:183], v1, s[8:11], s23 offen offset:1024 sc1
    s_waitcnt vmcnt(17) lgkmcnt(4)
    v_mfma_f32_32x32x16_bf16 v[24:39], v[96:99], v[152:155], v[24:39]
    s_waitcnt vmcnt(34) lgkmcnt(0)
    s_cmp_ge_u32 s58, 54
    s_cbranch_scc1 L_f_cb_48
    s_cmp_lg_u32 s18, 0
    s_cbranch_scc1 L_f_pw_49
    s_mov_b32 s57, 262144
L_f_pp_50:
    s_mov_b32 s45, 0
    s_atomic_add s45, s[40:41], s59 glc
    s_waitcnt lgkmcnt(0)
    s_cmp_ge_u32 s45, 54
    s_cbranch_scc1 L_f_pw_49
L_f_ps_51:
    s_sleep 2
    s_sub_u32 s57, s57, 1
    s_cmp_gt_i32 s57, 0
    s_cbranch_scc1 L_f_pp_50
L_f_pw_49:
L_f_cb_48:
    s_barrier
    ds_read_b64_tr_b16 v[88:89], v4 offset:24576
    ds_read_b64_tr_b16 v[90:91], v4 offset:25088
    ds_read_b64_tr_b16 v[92:93], v4 offset:24832
    ds_read_b64_tr_b16 v[94:95], v4 offset:25344
    buffer_load_dwordx4 v[184:187], v1, s[8:11], s23 offen offset:2048 sc1
    v_mfma_f32_32x32x16_bf16 v[40:55], v[100:103], v[152:155], v[40:55]
    ds_read_b64_tr_b16 v[96:97], v4 offset:26624
    ds_read_b64_tr_b16 v[98:99], v4 offset:27136
    buffer_load_dwordx4 v[188:191], v1, s[8:11], s23 offen offset:3072 sc1
    s_waitcnt vmcnt(18)
    v_mfma_f32_32x32x16_bf16 v[24:39], v[104:107], v[156:159], v[24:39]
    s_add_u32 s23, s23, 4096
    ds_read_b64_tr_b16 v[100:101], v4 offset:26880
    ds_read_b64_tr_b16 v[102:103], v4 offset:27392
    buffer_load_dwordx4 v[192:195], v1, s[8:11], s23 offen offset:0 sc1
    v_mfma_f32_32x32x16_bf16 v[40:55], v[108:111], v[156:159], v[40:55]
    ds_read_b64_tr_b16 v[104:105], v4 offset:28672
    ds_read_b64_tr_b16 v[106:107], v4 offset:29184
    buffer_load_dwordx4 v[196:199], v1, s[8:11], s23 offen offset:1024 sc1
    s_waitcnt vmcnt(19) lgkmcnt(6)
    v_mfma_f32_32x32x16_bf16 v[24:39], v[88:91], v[160:163], v[24:39]
    s_add_u32 s26, s50, 0
    s_and_b32 s26, s26, 3
    s_lshl_b32 s26, s26, 1
    s_add_u32 s26, s26, s48
    s_lshl_b32 s26, s26, 10
    s_add_u32 s26, s26, s55
    ds_read_b64_tr_b16 v[108:109], v4 offset:28928
    ds_read_b64_tr_b16 v[110:111], v4 offset:29440
    buffer_load_dwordx4 v[18:21], v1, s[8:11], s26 offen offset:0 sc1
    v_mfma_f32_32x32x16_bf16 v[40:55], v[92:95], v[160:163], v[40:55]
    ds_read_b64_tr_b16 v[88:89], v4 offset:30720
    ds_read_b64_tr_b16 v[90:91], v4 offset:31232
    buffer_load_dwordx4 v[200:203], v1, s[8:11], s23 offen offset:2048 sc1
    s_waitcnt vmcnt(20) lgkmcnt(6)
    v_mfma_f32_32x32x16_bf16 v[24:39], v[96:99], v[164:167], v[24:39]
    s_add_u32 s52, s50, 1
    s_and_b32 s52, s52, 3
    s_lshl_b32 s52, s52, 1
    s_add_u32 s52, s52, s48
    s_lshl_b32 s52, s52, 6
    s_add_u32 s52, s52, s25
    s_add_u32 s53, s42, s52
    s_add_u32 m0, s28, 0
    ds_read_b64_tr_b16 v[92:93], v4 offset:30976
    ds_read_b64_tr_b16 v[94:95], v4 offset:31488
    buffer_load_dwordx4 v2, s[4:7], s53 offen lds
    v_mfma_f32_32x32x16_bf16 v[40:55], v[100:103], v[164:167], v[40:55]
    ds_read_b64_tr_b16 v[96:97], v4 offset:32768
    ds_read_b64_tr_b16 v[98:99], v4 offset:33280
    buffer_load_dwordx4 v[204:207], v1, s[8:11], s23 offen offset:3072 sc1
    s_waitcnt vmcnt(21) lgkmcnt(6)
    v_mfma_f32_32x32x16_bf16 v[24:39], v[104:107], v[168:171], v[24:39]
    s_add_u32 s23, s51, 2
    s_cmp_ge_u32 s23, 3
    s_cselect_b32 s27, 3, 0
    s_sub_u32 s23, s23, s27
    s_mul_i32 s23, s23, 12288
    s_add_u32 s23, s23, s24
    ds_read_b64_tr_b16 v[100:101], v4 offset:33024
    ds_read_b64_tr_b16 v[102:103], v4 offset:33536
    buffer_load_dwordx4 v[208:211], v1, s[8:11], s23 offen offset:0 sc1
    v_mfma_f32_32x32x16_bf16 v[40:55], v[108:111], v[168:171], v[40:55]
    s_add_u32 s53, s53, 73728
    s_add_u32 m0, s28, 1024
    ds_read_b64_tr_b16 v[104:105], v4 offset:34816
    ds_read_b64_tr_b16 v[106:107], v4 offset:35328
    buffer_load_dwordx4 v2, s[4:7], s53 offen lds
    s_waitcnt vmcnt(22) lgkmcnt(6)
    v_mfma_f32_32x32x16_bf16 v[24:39], v[88:91], v[172:175], v[24:39]
    ds_read_b64_tr_b16 v[108:109], v4 offset:35072
    ds_read_b64_tr_b16 v[110:111], v4 offset:35584
    buffer_load_dwordx4 v[212:215], v1, s[8:11], s23 offen offset:1024 sc1
    v_mfma_f32_32x32x16_bf16 v[40:55], v[92:95], v[172:175], v[40:55]
    ds_read_b64_tr_b16 v[88:89], v4 offset:36864
    ds_read_b64_tr_b16 v[90:91], v4 offset:37376
    buffer_load_dwordx4 v[216:219], v1, s[8:11], s23 offen offset:2048 sc1
    s_waitcnt vmcnt(23) lgkmcnt(6)
    v_mfma_f32_32x32x16_bf16 v[24:39], v[96:99], v[176:179], v[24:39]
    s_add_u32 s53, s53, 73728
    s_add_u32 m0, s28, 2048
    ds_read_b64_tr_b16 v[92:93], v4 offset:37120
    ds_read_b64_tr_b16 v[94:95], v4 offset:37632
    buffer_load_dwordx4 v2, s[4:7], s53 offen lds
    v_mfma_f32_32x32x16_bf16 v[40:55], v[100:103], v[176:179], v[40:55]
    ds_read_b64_tr_b16 v[96:97], v4 offset:38912
    ds_read_b64_tr_b16 v[98:99], v4 offset:39424
    buffer_load_dwordx4 v[220:223], v1, s[8:11], s23 offen offset:3072 sc1
    s_waitcnt vmcnt(14) lgkmcnt(6)
    v_mfma_f32_32x32x16_bf16 v[24:39], v[104:107], v[180:183], v[24:39]
    s_add_u32 s53, s53, 73728
    s_add_u32 m0, s28, 3072
    ds_read_b64_tr_b16 v[100:101], v4 offset:39168
    ds_read_b64_tr_b16 v[102:103], v4 offset:39680
    buffer_load_dwordx4 v2, s[4:7], s53 offen lds
    v_mfma_f32_32x32x16_bf16 v[40:55], v[108:111], v[180:183], v[40:55]
    s_add_u32 s23, s23, 4096
    ds_read_b64_tr_b16 v[104:105], v4 offset:40960
    ds_read_b64_tr_b16 v[106:107], v4 offset:41472
    buffer_load_dwordx4 v[224:227], v1, s[8:11], s23 offen offset:0 sc1
    s_waitcnt vmcnt(17)
    v_add_f32 v56, v56, v58
    v_add_f32 v57, v57, v59
    v_add_f32 v56, v56, v60
    v_add_f32 v57, v57, v61
    v_add_f32 v56, v56, v62
    v_add_f32 v57, v57, v63
    v_add_f32 v56, v56, v64
    v_add_f32 v57, v57, v65
    v_add_f32 v56, v56, v66
    v_add_f32 v57, v57, v67
    v_add_f32 v56, v56, v68
    v_add_f32 v57, v57, v69
    v_add_f32 v56, v56, v70
    v_add_f32 v57, v57, v71
    v_add_f32 v56, v56, v72
    v_add_f32 v57, v57, v73
    v_mul_f32 v56, 0xbae38e39, v56
    v_mul_f32 v57, 0x3ae38e39, v57
    v_fma_f32 v57, -v56, v56, v57
    v_max_f32 v57, 0, v57
    v_add_f32 v57, 0x3727c5ac, v57
    v_rsq_f32 v58, v57
    v_sqrt_f32 v8, v57
    v_sub_f32 v74, 1.0, v74
    v_max_f32 v74, 0x0da24260, v74
    v_rcp_f32 v74, v74
    s_nop 0
    v_mul_f32 v8, v8, v74
    v_and_b32 v60, 0xffff0000, v56
    v_sub_f32 v56, v56, v60
    v_mul_f32 v6, 0xc0135761, v58
    v_mul_f32 v7, v58, v58
    v_mul_f32 v7, v7, v58
    v_mul_f32 v7, 0xbdd2d3e8, v7
    v_cvt_pk_bf16_f32 v14, v60, v56
    v_cvt_pk_bf16_f32 v15, v60, v56
    v_cvt_pk_bf16_f32 v16, v60, v56
    v_cvt_pk_bf16_f32 v17, v60, v56
    s_waitcnt vmcnt(15) lgkmcnt(6)
    v_mfma_f32_32x32x16_bf16 v[24:39], v[88:91], v[184:187], v[24:39]
    ds_read_b64_tr_b16 v[108:109], v4 offset:41216
    ds_read_b64_tr_b16 v[110:111], v4 offset:41728
    buffer_load_dwordx4 v[228:231], v1, s[8:11], s23 offen offset:1024 sc1
    v_mfma_f32_32x32x16_bf16 v[40:55], v[92:95], v[184:187], v[40:55]
    s_add_u32 s53, s53, 73728
    s_add_u32 m0, s28, 4096
    ds_read_b64_tr_b16 v[88:89], v4 offset:43008
    ds_read_b64_tr_b16 v[90:91], v4 offset:43520
    buffer_load_dwordx4 v2, s[4:7], s53 offen lds
    s_waitcnt vmcnt(16) lgkmcnt(6)
    v_mfma_f32_32x32x16_bf16 v[24:39], v[96:99], v[188:191], v[24:39]
    ds_read_b64_tr_b16 v[92:93], v4 offset:43264
    ds_read_b64_tr_b16 v[94:95], v4 offset:43776
    buffer_load_dwordx4 v[232:235], v1, s[8:11], s23 offen offset:2048 sc1
    v_mfma_f32_32x32x16_bf16 v[40:55], v[100:103], v[188:191], v[40:55]
    ds_read_b64_tr_b16 v[96:97], v4 offset:45056
    ds_read_b64_tr_b16 v[98:99], v4 offset:45568
    buffer_load_dwordx4 v[236:239], v1, s[8:11], s23 offen offset:3072 sc1
    s_waitcnt vmcnt(17) lgkmcnt(6)
    v_mfma_f32_32x32x16_bf16 v[24:39], v[104:107], v[192:195], v[24:39]
    s_waitcnt vmcnt(15)
    v_mfma_f32_32x32x16_bf16 v[24:39], v[18:21], v[14:17], v[24:39]
    s_add_u32 s53, s53, 73728
    s_add_u32 m0, s28, 5120
    ds_read_b64_tr_b16 v[100:101], v4 offset:45312
    ds_read_b64_tr_b16 v[102:103], v4 offset:45824
    buffer_load_dwordx4 v2, s[4:7], s53 offen lds
    v_mfma_f32_32x32x16_bf16 v[40:55], v[108:111], v[192:195], v[40:55]
    s_add_u32 s23, s23, 4096
    ds_read_b64_tr_b16 v[104:105], v4 offset:47104
    ds_read_b64_tr_b16 v[106:107], v4 offset:47616
    buffer_load_dwordx4 v[240:243], v1, s[8:11], s23 offen offset:0 sc1
    s_waitcnt vmcnt(18) lgkmcnt(6)
    v_mfma_f32_32x32x16_bf16 v[24:39], v[88:91], v[196:199], v[24:39]
    ds_read_b64_tr_b16 v[108:109], v4 offset:47360
    ds_read_b64_tr_b16 v[110:111], v4 offset:47872
    buffer_load_dwordx4 v[244:247], v1, s[8:11], s23 offen offset:1024 sc1
    v_mfma_f32_32x32x16_bf16 v[40:55], v[92:95], v[196:199], v[40:55]
    buffer_load_dwordx4 v[248:251], v1, s[8:11], s23 offen offset:2048 sc1
    s_waitcnt vmcnt(18) lgkmcnt(4)
    v_mfma_f32_32x32x16_bf16 v[24:39], v[96:99], v[200:203], v[24:39]
    s_waitcnt vmcnt(52) lgkmcnt(0)
    s_barrier
    ds_read_b64_tr_b16 v[88:89], v5 offset:0
    ds_read_b64_tr_b16 v[90:91], v5 offset:512
    ds_read_b64_tr_b16 v[92:93], v5 offset:256
    ds_read_b64_tr_b16 v[94:95], v5 offset:768
    buffer_load_dwordx4 v[252:255], v1, s[8:11], s23 offen offset:3072 sc1
    v_mfma_f32_32x32x16_bf16 v[40:55], v[100:103], v[200:203], v[40:55]
    ds_read_b64_tr_b16 v[96:97], v5 offset:2048
    ds_read_b64_tr_b16 v[98:99], v5 offset:2560
    s_waitcnt vmcnt(17)
    v_mfma_f32_32x32x16_bf16 v[24:39], v[104:107], v[204:207], v[24:39]
    ds_read_b64_tr_b16 v[100:101], v5 offset:2304
    ds_read_b64_tr_b16 v[102:103], v5 offset:2816
    v_mfma_f32_32x32x16_bf16 v[40:55], v[108:111], v[204:207], v[40:55]
    ds_read_b64_tr_b16 v[104:105], v5 offset:4096
    ds_read_b64_tr_b16 v[106:107], v5 offset:4608
    s_waitcnt vmcnt(16) lgkmcnt(6)
    v_mfma_f32_32x32x16_bf16 v[24:39], v[88:91], v[208:211], v[24:39]
    s_add_u32 s26, s50, 0
    s_and_b32 s26, s26, 3
    s_lshl_b32 s26, s26, 1
    s_add_u32 s26, s26, s48
    s_lshl_b32 s26, s26, 10
    s_add_u32 s26, s26, s55
    ds_read_b64_tr_b16 v[108:109], v5 offset:4352
    ds_read_b64_tr_b16 v[110:111], v5 offset:4864
    buffer_load_dwordx4 v[18:21], v1, s[8:11], s26 offen offset:1024 sc1
    v_mfma_f32_32x32x16_bf16 v[40:55], v[92:95], v[208:211], v[40:55]
    ds_read_b64_tr_b16 v[88:89], v5 offset:6144
    ds_read_b64_tr_b16 v[90:91], v5 offset:6656
    s_waitcnt vmcnt(15) lgkmcnt(6)
    v_mfma_f32_32x32x16_bf16 v[24:39], v[96:99], v[212:215], v[24:39]
    s_add_u32 s53, s43, s52
    s_add_u32 m0, s28, 24576
    ds_read_b64_tr_b16 v[92:93], v5 offset:6400
    ds_read_b64_tr_b16 v[94:95], v5 offset:6912
    buffer_load_dwordx4 v2, s[4:7], s53 offen lds
    v_mfma_f32_32x32x16_bf16 v[40:55], v[100:103], v[212:215], v[40:55]
    ds_read_b64_tr_b16 v[96:97], v5 offset:8192
    ds_read_b64_tr_b16 v[98:99], v5 offset:8704
    s_waitcnt vmcnt(15) lgkmcnt(6)
    v_mfma_f32_32x32x16_bf16 v[24:39], v[104:107], v[216:219], v[24:39]
    ds_read_b64_tr_b16 v[100:101], v5 offset:8448
    ds_read_b64_tr_b16 v[102:103], v5 offset:8960
    v_mfma_f32_32x32x16_bf16 v[40:55], v[108:111], v[216:219], v[40:55]
    s_add_u32 s53, s53, 73728
    s_add_u32 m0, s28, 25600
    ds_read_b64_tr_b16 v[104:105], v5 offset:10240
    ds_read_b64_tr_b16 v[106:107], v5 offset:10752
    buffer_load_dwordx4 v2, s[4:7], s53 offen lds
    s_waitcnt vmcnt(14) lgkmcnt(6)
    v_mfma_f32_32x32x16_bf16 v[24:39], v[88:91], v[220:223], v[24:39]
    ds_read_b64_tr_b16 v[108:109], v5 offset:10496
    ds_read_b64_tr_b16 v[110:111], v5 offset:11008
    v_mfma_f32_32x32x16_bf16 v[40:55], v[92:95], v[220:223], v[40:55]
    ds_read_b64_tr_b16 v[88:89], v5 offset:12288
    ds_read_b64_tr_b16 v[90:91], v5 offset:12800
    s_waitcnt vmcnt(12) lgkmcnt(6)
    v_mfma_f32_32x32x16_bf16 v[24:39], v[96:99], v[224:227], v[24:39]
    s_add_u32 s53, s53, 73728
    s_add_u32 m0, s28, 26624
    ds_read_b64_tr_b16 v[92:93], v5 offset:12544
    ds_read_b64_tr_b16 v[94:95], v5 offset:13056
    buffer_load_dwordx4 v2, s[4:7], s53 offen lds
    v_mfma_f32_32x32x16_bf16 v[40:55], v[100:103], v[224:227], v[40:55]
    ds_read_b64_tr_b16 v[96:97], v5 offset:14336
    ds_read_b64_tr_b16 v[98:99], v5 offset:14848
    s_waitcnt vmcnt(12) lgkmcnt(6)
    v_mfma_f32_32x32x16_bf16 v[24:39], v[104:107], v[228:231], v[24:39]
    s_add_u32 s53, s53, 73728
    s_add_u32 m0, s28, 27648
    ds_read_b64_tr_b16 v[100:101], v5 offset:14592
    ds_read_b64_tr_b16 v[102:103], v5 offset:15104
    buffer_load_dwordx4 v2, s[4:7], s53 offen lds
    v_mfma_f32_32x32x16_bf16 v[40:55], v[108:111], v[228:231], v[40:55]
    ds_read_b64_tr_b16 v[104:105], v5 offset:16384
    ds_read_b64_tr_b16 v[106:107], v5 offset:16896
    s_waitcnt vmcnt(11) lgkmcnt(6)
    v_mfma_f32_32x32x16_bf16 v[24:39], v[88:91], v[232:235], v[24:39]
    ds_read_b64_tr_b16 v[108:109], v5 offset:16640
    ds_read_b64_tr_b16 v[110:111], v5 offset:17152
    v_mfma_f32_32x32x16_bf16 v[40:55], v[92:95], v[232:235], v[40:55]
    s_add_u32 s53, s53, 73728
    s_add_u32 m0, s28, 28672
    ds_read_b64_tr_b16 v[88:89], v5 offset:18432
    ds_read_b64_tr_b16 v[90:91], v5 offset:18944
    buffer_load_dwordx4 v2, s[4:7], s53 offen lds
    s_waitcnt vmcnt(11) lgkmcnt(6)
    v_mfma_f32_32x32x16_bf16 v[24:39], v[96:99], v[236:239], v[24:39]
    ds_read_b64_tr_b16 v[92:93], v5 offset:18688
    ds_read_b64_tr_b16 v[94:95], v5 offset:19200
    v_mfma_f32_32x32x16_bf16 v[40:55], v[100:103], v[236:239], v[40:55]
    ds_read_b64_tr_b16 v[96:97], v5 offset:20480
    ds_read_b64_tr_b16 v[98:99], v5 offset:20992
    s_waitcnt vmcnt(9) lgkmcnt(6)
    v_mfma_f32_32x32x16_bf16 v[24:39], v[104:107], v[240:243], v[24:39]
    s_add_u32 s53, s53, 73728
    s_add_u32 m0, s28, 29696
    ds_read_b64_tr_b16 v[100:101], v5 offset:20736
    ds_read_b64_tr_b16 v[102:103], v5 offset:21248
    buffer_load_dwordx4 v2, s[4:7], s53 offen lds
    v_mfma_f32_32x32x16_bf16 v[40:55], v[108:111], v[240:243], v[40:55]
    s_waitcnt vmcnt(6)
    v_mfma_f32_32x32x16_bf16 v[40:55], v[18:21], v[14:17], v[40:55]
    ds_read_b64_tr_b16 v[104:105], v5 offset:22528
    ds_read_b64_tr_b16 v[106:107], v5 offset:23040
    s_waitcnt vmcnt(9) lgkmcnt(6)
    v_mfma_f32_32x32x16_bf16 v[24:39], v[88:91], v[244:247], v[24:39]
    ds_read_b64_tr_b16 v[108:109], v5 offset:22784
    ds_read_b64_tr_b16 v[110:111], v5 offset:23296
    v_mfma_f32_32x32x16_bf16 v[40:55], v[92:95], v[244:247], v[40:55]
    s_waitcnt vmcnt(8) lgkmcnt(4)
    v_mfma_f32_32x32x16_bf16 v[24:39], v[96:99], v[248:251], v[24:39]
    s_waitcnt vmcnt(11) lgkmcnt(0)
    s_barrier
    ds_read_b64_tr_b16 v[88:89], v4 offset:0
    ds_read_b64_tr_b16 v[90:91], v4 offset:512
    ds_read_b64_tr_b16 v[92:93], v4 offset:256
    ds_read_b64_tr_b16 v[94:95], v4 offset:768
    v_mfma_f32_32x32x16_bf16 v[40:55], v[100:103], v[248:251], v[40:55]
    ds_read_b64_tr_b16 v[96:97], v4 offset:2048
    ds_read_b64_tr_b16 v[98:99], v4 offset:2560
    s_waitcnt vmcnt(7)
    v_mfma_f32_32x32x16_bf16 v[24:39], v[104:107], v[252:255], v[24:39]
    ds_read_b64_tr_b16 v[100:101], v4 offset:2304
    ds_read_b64_tr_b16 v[102:103], v4 offset:2816
    v_mfma_f32_32x32x16_bf16 v[40:55], v[108:111], v[252:255], v[40:55]
    ds_read_b64_tr_b16 v[104:105], v4 offset:4096
    ds_read_b64_tr_b16 v[106:107], v4 offset:4608
    s_waitcnt lgkmcnt(6)
    v_mfma_f32_32x32x16_bf16 v[56:71], v[88:91], v[112:115], 0
    s_add_u32 s53, s44, s52
    s_add_u32 m0, s28, 49152
    ds_read_b64_tr_b16 v[108:109], v4 offset:4352
    ds_read_b64_tr_b16 v[110:111], v4 offset:4864
    buffer_load_dwordx4 v2, s[4:7], s53 offen lds
    v_mfma_f32_32x32x16_bf16 v[72:87], v[92:95], v[112:115], 0
    ds_read_b64_tr_b16 v[88:89], v4 offset:6144
    ds_read_b64_tr_b16 v[90:91], v4 offset:6656
    s_waitcnt lgkmcnt(6)
    v_mfma_f32_32x32x16_bf16 v[56:71], v[96:99], v[116:119], v[56:71]
    ds_read_b64_tr_b16 v[92:93], v4 offset:6400
    ds_read_b64_tr_b16 v[94:95], v4 offset:6912
    s_add_u32 s27, s50, 0
    s_and_b32 s27, s27, 3
    s_lshl_b32 s27, s27, 1
    s_add_u32 s27, s27, s48
    s_lshl_b32 s27, s27, 11
    v_mfma_f32_32x32x16_bf16 v[72:87], v[100:103], v[116:119], v[72:87]
    s_add_u32 s53, s53, 73728
    s_add_u32 m0, s28, 50176
    ds_read_b64_tr_b16 v[96:97], v4 offset:8192
    ds_read_b64_tr_b16 v[98:99], v4 offset:8704
    buffer_load_dwordx4 v2, s[4:7], s53 offen lds
    s_add_u32 s27, s27, s54
    v_mul_f32 v10, v24, v24
    v_mul_f32 v11, v25, v25
    v_mul_f32 v12, v26, v26
    v_mul_f32 v13, v27, v27
    s_waitcnt lgkmcnt(6)
    v_mfma_f32_32x32x16_bf16 v[56:71], v[104:107], v[120:123], v[56:71]
    ds_read_b64_tr_b16 v[100:101], v4 offset:8448
    ds_read_b64_tr_b16 v[102:103], v4 offset:8960
    v_fma_f32 v10, v10, v7, v6
    v_fma_f32 v11, v11, v7, v6
    v_fma_f32 v12, v12, v7, v6
    v_fma_f32 v13, v13, v7, v6
    v_mfma_f32_32x32x16_bf16 v[72:87], v[108:111], v[120:123], v[72:87]
    ds_read_b64_tr_b16 v[104:105], v4 offset:10240
    ds_read_b64_tr_b16 v[106:107], v4 offset:10752
    v_mul_f32 v10, v10, v24
    v_mul_f32 v11, v11, v25
    v_mul_f32 v12, v12, v26
    v_mul_f32 v13, v13, v27
    v_exp_f32 v10, v10
    s_waitcnt lgkmcnt(6)
    v_mfma_f32_32x32x16_bf16 v[56:71], v[88:91], v[124:127], v[56:71]
    s_add_u32 s53, s53, 73728
    s_add_u32 m0, s28, 51200
    ds_read_b64_tr_b16 v[108:109], v4 offset:10496
    ds_read_b64_tr_b16 v[110:111], v4 offset:11008
    buffer_load_dwordx4 v2, s[4:7], s53 offen lds
    v_exp_f32 v11, v11
    v_exp_f32 v12, v12
    v_mfma_f32_32x32x16_bf16 v[72:87], v[92:95], v[124:127], v[72:87]
    ds_read_b64_tr_b16 v[88:89], v4 offset:12288
    ds_read_b64_tr_b16 v[90:91], v4 offset:12800
    v_exp_f32 v13, v13
    v_fma_f32 v10, v10, v8, v8
    v_fma_f32 v11, v11, v8, v8
    s_waitcnt lgkmcnt(6)
    v_mfma_f32_32x32x16_bf16 v[56:71], v[96:99], v[128:131], v[56:71]
    ds_read_b64_tr_b16 v[92:93], v4 offset:12544
    ds_read_b64_tr_b16 v[94:95], v4 offset:13056
    v_fma_f32 v12, v12, v8, v8
    v_fma_f32 v13, v13, v8, v8
    v_rcp_f32 v10, v10
    v_rcp_f32 v11, v11
    v_mfma_f32_32x32x16_bf16 v[72:87], v[100:103], v[128:131], v[72:87]
    s_add_u32 s53, s53, 73728
    s_add_u32 m0, s28, 52224
    ds_read_b64_tr_b16 v[96:97], v4 offset:14336
    ds_read_b64_tr_b16 v[98:99], v4 offset:14848
    buffer_load_dwordx4 v2, s[4:7], s53 offen lds
    v_rcp_f32 v12, v12
    v_rcp_f32 v13, v13
    s_waitcnt lgkmcnt(6)
    v_mfma_f32_32x32x16_bf16 v[56:71], v[104:107], v[132:135], v[56:71]
    ds_read_b64_tr_b16 v[100:101], v4 offset:14592
    ds_read_b64_tr_b16 v[102:103], v4 offset:15104
    v_mul_f32 v10, v10, v24
    v_mul_f32 v11, v11, v25
    v_mul_f32 v12, v12, v26
    v_mul_f32 v13, v13, v27
    v_mfma_f32_32x32x16_bf16 v[72:87], v[108:111], v[132:135], v[72:87]
    ds_read_b64_tr_b16 v[104:105], v4 offset:16384
    ds_read_b64_tr_b16 v[106:107], v4 offset:16896
    v_cvt_pk_bf16_f32 v24, v10, v11
    v_cvt_pk_bf16_f32 v25, v12, v13
    v_mul_f32 v10, v28, v28
    v_mul_f32 v11, v29, v29
    v_mul_f32 v12, v30, v30
    s_waitcnt lgkmcnt(6)
    v_mfma_f32_32x32x16_bf16 v[56:71], v[88:91], v[136:139], v[56:71]
    s_add_u32 s53, s53, 73728
    s_add_u32 m0, s28, 53248
    ds_read_b64_tr_b16 v[108:109], v4 offset:16640
    ds_read_b64_tr_b16 v[110:111], v4 offset:17152
    buffer_load_dwordx4 v2, s[4:7], s53 offen lds
    v_mul_f32 v13, v31, v31
    v_fma_f32 v10, v10, v7, v6
    v_fma_f32 v11, v11, v7, v6
    v_fma_f32 v12, v12, v7, v6
    v_mfma_f32_32x32x16_bf16 v[72:87], v[92:95], v[136:139], v[72:87]
    ds_read_b64_tr_b16 v[88:89], v4 offset:18432
    ds_read_b64_tr_b16 v[90:91], v4 offset:18944
    v_fma_f32 v13, v13, v7, v6
    v_mul_f32 v10, v10, v28
    v_mul_f32 v11, v11, v29
    v_mul_f32 v12, v12, v30
    v_mul_f32 v13, v13, v31
    s_waitcnt lgkmcnt(6)
    v_mfma_f32_32x32x16_bf16 v[56:71], v[96:99], v[140:143], v[56:71]
    ds_read_b64_tr_b16 v[92:93], v4 offset:18688
    ds_read_b64_tr_b16 v[94:95], v4 offset:19200
    v_exp_f32 v10, v10
    v_exp_f32 v11, v11
    v_exp_f32 v12, v12
    v_mfma_f32_32x32x16_bf16 v[72:87], v[100:103], v[140:143], v[72:87]
    s_add_u32 s53, s53, 73728
    s_add_u32 m0, s28, 54272
    ds_read_b64_tr_b16 v[96:97], v4 offset:20480
    ds_read_b64_tr_b16 v[98:99], v4 offset:20992
    buffer_load_dwordx4 v2, s[4:7], s53 offen lds
    v_exp_f32 v13, v13
    v_fma_f32 v10, v10, v8, v8
    s_waitcnt lgkmcnt(6)
    v_mfma_f32_32x32x16_bf16 v[56:71], v[104:107], v[144:147], v[56:71]
    ds_read_b64_tr_b16 v[100:101], v4 offset:20736
    ds_read_b64_tr_b16 v[102:103], v4 offset:21248
    v_fma_f32 v11, v11, v8, v8
    v_fma_f32 v12, v12, v8, v8
    v_fma_f32 v13, v13, v8, v8
    v_rcp_f32 v10, v10
    v_mfma_f32_32x32x16_bf16 v[72:87], v[108:111], v[144:147], v[72:87]
    ds_read_b64_tr_b16 v[104:105], v4 offset:22528
    ds_read_b64_tr_b16 v[106:107], v4 offset:23040
    v_rcp_f32 v11, v11
    v_rcp_f32 v12, v12
    s_waitcnt lgkmcnt(6)
    v_mfma_f32_32x32x16_bf16 v[56:71], v[88:91], v[148:151], v[56:71]
    ds_read_b64_tr_b16 v[108:109], v4 offset:22784
    ds_read_b64_tr_b16 v[110:111], v4 offset:23296
    v_rcp_f32 v13, v13
    v_mul_f32 v10, v10, v28
    v_mul_f32 v11, v11, v29
    v_mul_f32 v12, v12, v30
    v_mfma_f32_32x32x16_bf16 v[72:87], v[92:95], v[148:151], v[72:87]
    v_mul_f32 v13, v13, v31
    v_cvt_pk_bf16_f32 v26, v10, v11
    v_cvt_pk_bf16_f32 v27, v12, v13
    buffer_store_dwordx4 v[24:27], v1, s[8:11], s27 offen offset:0 sc1
    v_mul_f32 v10, v32, v32
    s_waitcnt lgkmcnt(4)
    v_mfma_f32_32x32x16_bf16 v[56:71], v[96:99], v[152:155], v[56:71]
    s_waitcnt vmcnt(7) lgkmcnt(0)
    s_barrier
    ds_read_b64_tr_b16 v[88:89], v4 offset:24576
    ds_read_b64_tr_b16 v[90:91], v4 offset:25088
    ds_read_b64_tr_b16 v[92:93], v4 offset:24832
    ds_read_b64_tr_b16 v[94:95], v4 offset:25344
    v_mul_f32 v11, v33, v33
    v_mul_f32 v12, v34, v34
    v_mul_f32 v13, v35, v35
    v_fma_f32 v10, v10, v7, v6
    v_mfma_f32_32x32x16_bf16 v[72:87], v[100:103], v[152:155], v[72:87]
    ds_read_b64_tr_b16 v[96:97], v4 offset:26624
    ds_read_b64_tr_b16 v[98:99], v4 offset:27136
    v_fma_f32 v11, v11, v7, v6
    v_fma_f32 v12, v12, v7, v6
    v_fma_f32 v13, v13, v7, v6
    v_mul_f32 v10, v10, v32
    v_mul_f32 v11, v11, v33
    v_mfma_f32_32x32x16_bf16 v[56:71], v[104:107], v[156:159], v[56:71]
    ds_read_b64_tr_b16 v[100:101], v4 offset:26880
    ds_read_b64_tr_b16 v[102:103], v4 offset:27392
    v_mul_f32 v12, v12, v34
    v_mul_f32 v13, v13, v35
    v_exp_f32 v10, v10
    v_mfma_f32_32x32x16_bf16 v[72:87], v[108:111], v[156:159], v[72:87]
    ds_read_b64_tr_b16 v[104:105], v4 offset:28672
    ds_read_b64_tr_b16 v[106:107], v4 offset:29184
    v_exp_f32 v11, v11
    v_exp_f32 v12, v12
    v_exp_f32 v13, v13
    s_waitcnt lgkmcnt(6)
    v_mfma_f32_32x32x16_bf16 v[56:71], v[88:91], v[160:163], v[56:71]
    s_add_u32 s26, s50, 1
    s_and_b32 s26, s26, 3
    s_lshl_b32 s26, s26, 1
    s_add_u32 s26, s26, s48
    s_lshl_b32 s26, s26, 10
    s_add_u32 s26, s26, s55
    ds_read_b64_tr_b16 v[108:109], v4 offset:28928
    ds_read_b64_tr_b16 v[110:111], v4 offset:29440
    buffer_load_dwordx4 v[18:21], v1, s[8:11], s26 offen offset:0 sc1
    v_fma_f32 v10, v10, v8, v8
    v_fma_f32 v11, v11, v8, v8
    v_fma_f32 v12, v12, v8, v8
    v_fma_f32 v13, v13, v8, v8
    v_mfma_f32_32x32x16_bf16 v[72:87], v[92:95], v[160:163], v[72:87]
    ds_read_b64_tr_b16 v[88:89], v4 offset:30720
    ds_read_b64_tr_b16 v[90:91], v4 offset:31232
    v_rcp_f32 v10, v10
    v_rcp_f32 v11, v11
    s_waitcnt lgkmcnt(6)
    v_mfma_f32_32x32x16_bf16 v[56:71], v[96:99], v[164:167], v[56:71]
    s_add_u32 s52, s50, 2
    s_and_b32 s52, s52, 3
    s_lshl_b32 s52, s52, 1
    s_add_u32 s52, s52, s48
    s_lshl_b32 s52, s52, 6
    s_add_u32 s52, s52, s25
    s_add_u32 s53, s42, s52
    s_add_u32 m0, s28, 0
    ds_read_b64_tr_b16 v[92:93], v4 offset:30976
    ds_read_b64_tr_b16 v[94:95], v4 offset:31488
    buffer_load_dwordx4 v2, s[4:7], s53 offen lds
    v_rcp_f32 v12, v12
    v_rcp_f32 v13, v13
    v_mul_f32 v10, v10, v32
    v_mfma_f32_32x32x16_bf16 v[72:87], v[100:103], v[164:167], v[72:87]
    ds_read_b64_tr_b16 v[96:97], v4 offset:32768
    ds_read_b64_tr_b16 v[98:99], v4 offset:33280
    v_mul_f32 v11, v11, v33
    v_mul_f32 v12, v12, v34
    v_mul_f32 v13, v13, v35
    v_cvt_pk_bf16_f32 v32, v10, v11
    v_cvt_pk_bf16_f32 v33, v12, v13
    s_waitcnt lgkmcnt(6)
    v_mfma_f32_32x32x16_bf16 v[56:71], v[104:107], v[168:171], v[56:71]
    ds_read_b64_tr_b16 v[100:101], v4 offset:33024
    ds_read_b64_tr_b16 v[102:103], v4 offset:33536
    v_mul_f32 v10, v36, v36
    v_mul_f32 v11, v37, v37
    v_mul_f32 v12, v38, v38
    v_mul_f32 v13, v39, v39
    v_mfma_f32_32x32x16_bf16 v[72:87], v[108:111], v[168:171], v[72:87]
    s_add_u32 s53, s53, 73728
    s_add_u32 m0, s28, 1024
    ds_read_b64_tr_b16 v[104:105], v4 offset:34816
    ds_read_b64_tr_b16 v[106:107], v4 offset:35328
    buffer_load_dwordx4 v2, s[4:7], s53 offen lds
    v_fma_f32 v10, v10, v7, v6
    v_fma_f32 v11, v11, v7, v6
    v_fma_f32 v12, v12, v7, v6
    v_fma_f32 v13, v13, v7, v6
    v_mul_f32 v10, v10, v36
    s_waitcnt lgkmcnt(6)
    v_mfma_f32_32x32x16_bf16 v[56:71], v[88:91], v[172:175], v[56:71]
    ds_read_b64_tr_b16 v[108:109], v4 offset:35072
    ds_read_b64_tr_b16 v[110:111], v4 offset:35584
    v_mul_f32 v11, v11, v37
    v_mul_f32 v12, v12, v38
    v_mul_f32 v13, v13, v39
    v_exp_f32 v10, v10
    v_mfma_f32_32x32x16_bf16 v[72:87], v[92:95], v[172:175], v[72:87]
    ds_read_b64_tr_b16 v[88:89], v4 offset:36864
    ds_read_b64_tr_b16 v[90:91], v4 offset:37376
    v_exp_f32 v11, v11
    v_exp_f32 v12, v12
    s_waitcnt lgkmcnt(6)
    v_mfma_f32_32x32x16_bf16 v[56:71], v[96:99], v[176:179], v[56:71]
    s_add_u32 s53, s53, 73728
    s_add_u32 m0, s28, 2048
    ds_read_b64_tr_b16 v[92:93], v4 offset:37120
    ds_read_b64_tr_b16 v[94:95], v4 offset:37632
    buffer_load_dwordx4 v2, s[4:7], s53 offen lds
    v_exp_f32 v13, v13
    v_fma_f32 v10, v10, v8, v8
    v_fma_f32 v11, v11, v8, v8
    v_fma_f32 v12, v12, v8, v8
    v_mfma_f32_32x32x16_bf16 v[72:87], v[100:103], v[176:179], v[72:87]
    ds_read_b64_tr_b16 v[96:97], v4 offset:38912
    ds_read_b64_tr_b16 v[98:99], v4 offset:39424
    v_fma_f32 v13, v13, v8, v8
    v_rcp_f32 v10, v10
    v_rcp_f32 v11, v11
    s_waitcnt lgkmcnt(6)
    v_mfma_f32_32x32x16_bf16 v[56:71], v[104:107], v[180:183], v[56:71]
    s_add_u32 s53, s53, 73728
    s_add_u32 m0, s28, 3072
    ds_read_b64_tr_b16 v[100:101], v4 offset:39168
    ds_read_b64_tr_b16 v[102:103], v4 offset:39680
    buffer_load_dwordx4 v2, s[4:7], s53 offen lds
    v_rcp_f32 v12, v12
    v_rcp_f32 v13, v13
    v_mfma_f32_32x32x16_bf16 v[72:87], v[108:111], v[180:183], v[72:87]
    ds_read_b64_tr_b16 v[104:105], v4 offset:40960
    ds_read_b64_tr_b16 v[106:107], v4 offset:41472
    v_mul_f32 v10, v10, v36
    v_mul_f32 v11, v11, v37
    v_mul_f32 v12, v12, v38
    v_mul_f32 v13, v13, v39
    s_waitcnt lgkmcnt(6)
    v_mfma_f32_32x32x16_bf16 v[56:71], v[88:91], v[184:187], v[56:71]
    ds_read_b64_tr_b16 v[108:109], v4 offset:41216
    ds_read_b64_tr_b16 v[110:111], v4 offset:41728
    v_cvt_pk_bf16_f32 v34, v10, v11
    v_cvt_pk_bf16_f32 v35, v12, v13
    buffer_store_dwordx4 v[32:35], v1, s[8:11], s27 offen offset:1024 sc1
    v_mul_f32 v10, v40, v40
    v_mul_f32 v11, v41, v41
    v_mfma_f32_32x32x16_bf16 v[72:87], v[92:95], v[184:187], v[72:87]
    s_add_u32 s53, s53, 73728
    s_add_u32 m0, s28, 4096
    ds_read_b64_tr_b16 v[88:89], v4 offset:43008
    ds_read_b64_tr_b16 v[90:91], v4 offset:43520
    buffer_load_dwordx4 v2, s[4:7], s53 offen lds
    v_mul_f32 v12, v42, v42
    v_mul_f32 v13, v43, v43
    v_fma_f32 v10, v10, v7, v6
    v_fma_f32 v11, v11, v7, v6
    v_fma_f32 v12, v12, v7, v6
    s_waitcnt lgkmcnt(6)
    v_mfma_f32_32x32x16_bf16 v[56:71], v[96:99], v[188:191], v[56:71]
    ds_read_b64_tr_b16 v[92:93], v4 offset:43264
    ds_read_b64_tr_b16 v[94:95], v4 offset:43776
    v_fma_f32 v13, v13, v7, v6
    v_mul_f32 v10, v10, v40
    v_mul_f32 v11, v11, v41
    v_mul_f32 v12, v12, v42
    v_mfma_f32_32x32x16_bf16 v[72:87], v[100:103], v[188:191], v[72:87]
    ds_read_b64_tr_b16 v[96:97], v4 offset:45056
    ds_read_b64_tr_b16 v[98:99], v4 offset:45568
    v_mul_f32 v13, v13, v43
    v_exp_f32 v10, v10
    v_exp_f32 v11, v11
    s_waitcnt lgkmcnt(6)
    v_mfma_f32_32x32x16_bf16 v[56:71], v[104:107], v[192:195], v[56:71]
    s_waitcnt vmcnt(6)
    v_mfma_f32_32x32x16_bf16 v[56:71], v[18:21], v[14:17], v[56:71]
    s_add_u32 s53, s53, 73728
    s_add_u32 m0, s28, 5120
    ds_read_b64_tr_b16 v[100:101], v4 offset:45312
    ds_read_b64_tr_b16 v[102:103], v4 offset:45824
    buffer_load_dwordx4 v2, s[4:7], s53 offen lds
    v_exp_f32 v12, v12
    v_exp_f32 v13, v13
    v_fma_f32 v10, v10, v8, v8
    v_mfma_f32_32x32x16_bf16 v[72:87], v[108:111], v[192:195], v[72:87]
    ds_read_b64_tr_b16 v[104:105], v4 offset:47104
    ds_read_b64_tr_b16 v[106:107], v4 offset:47616
    v_fma_f32 v11, v11, v8, v8
    v_fma_f32 v12, v12, v8, v8
    v_fma_f32 v13, v13, v8, v8
    v_rcp_f32 v10, v10
    s_waitcnt lgkmcnt(6)
    v_mfma_f32_32x32x16_bf16 v[56:71], v[88:91], v[196:199], v[56:71]
    ds_read_b64_tr_b16 v[108:109], v4 offset:47360
    ds_read_b64_tr_b16 v[110:111], v4 offset:47872
    v_rcp_f32 v11, v11
    v_rcp_f32 v12, v12
    v_mfma_f32_32x32x16_bf16 v[72:87], v[92:95], v[196:199], v[72:87]
    v_rcp_f32 v13, v13
    v_mul_f32 v10, v10, v40
    v_mul_f32 v11, v11, v41
    s_waitcnt lgkmcnt(4)
    v_mfma_f32_32x32x16_bf16 v[56:71], v[96:99], v[200:203], v[56:71]
    s_waitcnt vmcnt(9) lgkmcnt(0)
    s_barrier
    ds_read_b64_tr_b16 v[88:89], v5 offset:0
    ds_read_b64_tr_b16 v[90:91], v5 offset:512
    ds_read_b64_tr_b16 v[92:93], v5 offset:256
    ds_read_b64_tr_b16 v[94:95], v5 offset:768
    v_mul_f32 v12, v12, v42
    v_mul_f32 v13, v13, v43
    v_cvt_pk_bf16_f32 v40, v10, v11
    v_cvt_pk_bf16_f32 v41, v12, v13
    v_mul_f32 v10, v44, v44
    v_mfma_f32_32x32x16_bf16 v[72:87], v[100:103], v[200:203], v[72:87]
    ds_read_b64_tr_b16 v[96:97], v5 offset:2048
    ds_read_b64_tr_b16 v[98:99], v5 offset:2560
    v_mul_f32 v11, v45, v45
    v_mul_f32 v12, v46, v46
    v_mul_f32 v13, v47, v47
    v_fma_f32 v10, v10, v7, v6
    v_fma_f32 v11, v11, v7, v6
    v_mfma_f32_32x32x16_bf16 v[56:71], v[104:107], v[204:207], v[56:71]
    ds_read_b64_tr_b16 v[100:101], v5 offset:2304
    ds_read_b64_tr_b16 v[102:103], v5 offset:2816
    v_fma_f32 v12, v12, v7, v6
    v_fma_f32 v13, v13, v7, v6
    v_mul_f32 v10, v10, v44
    v_mul_f32 v11, v11, v45
    v_mfma_f32_32x32x16_bf16 v[72:87], v[108:111], v[204:207], v[72:87]
    ds_read_b64_tr_b16 v[104:105], v5 offset:4096
    ds_read_b64_tr_b16 v[106:107], v5 offset:4608
    v_mul_f32 v12, v12, v46
    v_mul_f32 v13, v13, v47
    v_exp_f32 v10, v10
    v_exp_f32 v11, v11
    s_waitcnt lgkmcnt(6)
    v_mfma_f32_32x32x16_bf16 v[56:71], v[88:91], v[208:211], v[56:71]
    s_add_u32 s26, s50, 1
    s_and_b32 s26, s26, 3
    s_lshl_b32 s26, s26, 1
    s_add_u32 s26, s26, s48
    s_lshl_b32 s26, s26, 10
    s_add_u32 s26, s26, s55
    ds_read_b64_tr_b16 v[108:109], v5 offset:4352
    ds_read_b64_tr_b16 v[110:111], v5 offset:4864
    buffer_load_dwordx4 v[18:21], v1, s[8:11], s26 offen offset:1024 sc1
    v_exp_f32 v12, v12
    v_exp_f32 v13, v13
    v_mfma_f32_32x32x16_bf16 v[72:87], v[92:95], v[208:211], v[72:87]
    ds_read_b64_tr_b16 v[88:89], v5 offset:6144
    ds_read_b64_tr_b16 v[90:91], v5 offset:6656
    v_fma_f32 v10, v10, v8, v8
    v_fma_f32 v11, v11, v8, v8
    v_fma_f32 v12, v12, v8, v8
    v_fma_f32 v13, v13, v8, v8
    s_waitcnt lgkmcnt(6)
    v_mfma_f32_32x32x16_bf16 v[56:71], v[96:99], v[212:215], v[56:71]
    s_add_u32 s53, s43, s52
    s_add_u32 m0, s28, 24576
    ds_read_b64_tr_b16 v[92:93], v5 offset:6400
    ds_read_b64_tr_b16 v[94:95], v5 offset:6912
    buffer_load_dwordx4 v2, s[4:7], s53 offen lds
    v_rcp_f32 v10, v10
    v_rcp_f32 v11, v11
    v_rcp_f32 v12, v12
    v_mfma_f32_32x32x16_bf16 v[72:87], v[100:103], v[212:215], v[72:87]
    ds_read_b64_tr_b16 v[96:97], v5 offset:8192
    ds_read_b64_tr_b16 v[98:99], v5 offset:8704
    v_rcp_f32 v13, v13
    v_mul_f32 v10, v10, v44
    s_waitcnt lgkmcnt(6)
    v_mfma_f32_32x32x16_bf16 v[56:71], v[104:107], v[216:219], v[56:71]
    ds_read_b64_tr_b16 v[100:101], v5 offset:8448
    ds_read_b64_tr_b16 v[102:103], v5 offset:8960
    v_mul_f32 v11, v11, v45
    v_mul_f32 v12, v12, v46
    v_mul_f32 v13, v13, v47
    v_cvt_pk_bf16_f32 v42, v10, v11
    v_cvt_pk_bf16_f32 v43, v12, v13
    v_mfma_f32_32x32x16_bf16 v[72:87], v[108:111], v[216:219], v[72:87]
    s_add_u32 s53, s53, 73728
    s_add_u32 m0, s28, 25600
    ds_read_b64_tr_b16 v[104:105], v5 offset:10240
    ds_read_b64_tr_b16 v[106:107], v5 offset:10752
    buffer_load_dwordx4 v2, s[4:7], s53 offen lds
    buffer_store_dwordx4 v[40:43], v1, s[8:11], s27 offen offset:2048 sc1
    v_mul_f32 v10, v48, v48
    v_mul_f32 v11, v49, v49
    v_mul_f32 v12, v50, v50
    v_mul_f32 v13, v51, v51
    s_waitcnt lgkmcnt(6)
    v_mfma_f32_32x32x16_bf16 v[56:71], v[88:91], v[220:223], v[56:71]
    ds_read_b64_tr_b16 v[108:109], v5 offset:10496
    ds_read_b64_tr_b16 v[110:111], v5 offset:11008
    v_fma_f32 v10, v10, v7, v6
    v_fma_f32 v11, v11, v7, v6
    v_fma_f32 v12, v12, v7, v6
    v_fma_f32 v13, v13, v7, v6
    v_mfma_f32_32x32x16_bf16 v[72:87], v[92:95], v[220:223], v[72:87]
    ds_read_b64_tr_b16 v[88:89], v5 offset:12288
    ds_read_b64_tr_b16 v[90:91], v5 offset:12800
    v_mul_f32 v10, v10, v48
    v_mul_f32 v11, v11, v49
    v_mul_f32 v12, v12, v50
    v_mul_f32 v13, v13, v51
    v_exp_f32 v10, v10
    s_waitcnt lgkmcnt(6)
    v_mfma_f32_32x32x16_bf16 v[56:71], v[96:99], v[224:227], v[56:71]
    s_add_u32 s53, s53, 73728
    s_add_u32 m0, s28, 26624
    ds_read_b64_tr_b16 v[92:93], v5 offset:12544
    ds_read_b64_tr_b16 v[94:95], v5 offset:13056
    buffer_load_dwordx4 v2, s[4:7], s53 offen lds
    v_exp_f32 v11, v11
    v_exp_f32 v12, v12
    v_mfma_f32_32x32x16_bf16 v[72:87], v[100:103], v[224:227], v[72:87]
    ds_read_b64_tr_b16 v[96:97], v5 offset:14336
    ds_read_b64_tr_b16 v[98:99], v5 offset:14848
    v_exp_f32 v13, v13
    v_fma_f32 v10, v10, v8, v8
    v_fma_f32 v11, v11, v8, v8
    s_waitcnt lgkmcnt(6)
    v_mfma_f32_32x32x16_bf16 v[56:71], v[104:107], v[228:231], v[56:71]
    s_add_u32 s53, s53, 73728
    s_add_u32 m0, s28, 27648
    ds_read_b64_tr_b16 v[100:101], v5 offset:14592
    ds_read_b64_tr_b16 v[102:103], v5 offset:15104
    buffer_load_dwordx4 v2, s[4:7], s53 offen lds
    v_fma_f32 v12, v12, v8, v8
    v_fma_f32 v13, v13, v8, v8
    v_rcp_f32 v10, v10
    v_rcp_f32 v11, v11
    v_mfma_f32_32x32x16_bf16 v[72:87], v[108:111], v[228:231], v[72:87]
    ds_read_b64_tr_b16 v[104:105], v5 offset:16384
    ds_read_b64_tr_b16 v[106:107], v5 offset:16896
    v_rcp_f32 v12, v12
    v_rcp_f32 v13, v13
    s_waitcnt lgkmcnt(6)
    v_mfma_f32_32x32x16_bf16 v[56:71], v[88:91], v[232:235], v[56:71]
    ds_read_b64_tr_b16 v[108:109], v5 offset:16640
    ds_read_b64_tr_b16 v[110:111], v5 offset:17152
    v_mul_f32 v10, v10, v48
    v_mul_f32 v11, v11, v49
    v_mul_f32 v12, v12, v50
    v_mul_f32 v13, v13, v51
    v_mfma_f32_32x32x16_bf16 v[72:87], v[92:95], v[232:235], v[72:87]
    s_add_u32 s53, s53, 73728
    s_add_u32 m0, s28, 28672
    ds_read_b64_tr_b16 v[88:89], v5 offset:18432
    ds_read_b64_tr_b16 v[90:91], v5 offset:18944
    buffer_load_dwordx4 v2, s[4:7], s53 offen lds
    v_cvt_pk_bf16_f32 v48, v10, v11
    v_cvt_pk_bf16_f32 v49, v12, v13
    v_mul_f32 v10, v52, v52
    v_mul_f32 v11, v53, v53
    v_mul_f32 v12, v54, v54
    s_waitcnt lgkmcnt(6)
    v_mfma_f32_32x32x16_bf16 v[56:71], v[96:99], v[236:239], v[56:71]
    ds_read_b64_tr_b16 v[92:93], v5 offset:18688
    ds_read_b64_tr_b16 v[94:95], v5 offset:19200
    v_mul_f32 v13, v55, v55
    v_fma_f32 v10, v10, v7, v6
    v_fma_f32 v11, v11, v7, v6
    v_fma_f32 v12, v12, v7, v6
    v_mfma_f32_32x32x16_bf16 v[72:87], v[100:103], v[236:239], v[72:87]
    ds_read_b64_tr_b16 v[96:97], v5 offset:20480
    ds_read_b64_tr_b16 v[98:99], v5 offset:20992
    v_fma_f32 v13, v13, v7, v6
    v_mul_f32 v10, v10, v52
    v_mul_f32 v11, v11, v53
    v_mul_f32 v12, v12, v54
    v_mul_f32 v13, v13, v55
    s_waitcnt lgkmcnt(6)
    v_mfma_f32_32x32x16_bf16 v[56:71], v[104:107], v[240:243], v[56:71]
    s_add_u32 s53, s53, 73728
    s_add_u32 m0, s28, 29696
    ds_read_b64_tr_b16 v[100:101], v5 offset:20736
    ds_read_b64_tr_b16 v[102:103], v5 offset:21248
    buffer_load_dwordx4 v2, s[4:7], s53 offen lds
    v_exp_f32 v10, v10
    v_exp_f32 v11, v11
    v_mfma_f32_32x32x16_bf16 v[72:87], v[108:111], v[240:243], v[72:87]
    s_waitcnt vmcnt(7)
    v_mfma_f32_32x32x16_bf16 v[72:87], v[18:21], v[14:17], v[72:87]
    ds_read_b64_tr_b16 v[104:105], v5 offset:22528
    ds_read_b64_tr_b16 v[106:107], v5 offset:23040
    v_exp_f32 v12, v12
    v_exp_f32 v13, v13
    v_fma_f32 v10, v10, v8, v8
    s_waitcnt lgkmcnt(6)
    v_mfma_f32_32x32x16_bf16 v[56:71], v[88:91], v[244:247], v[56:71]
    ds_read_b64_tr_b16 v[108:109], v5 offset:22784
    ds_read_b64_tr_b16 v[110:111], v5 offset:23296
    v_fma_f32 v11, v11, v8, v8
    v_fma_f32 v12, v12, v8, v8
    v_fma_f32 v13, v13, v8, v8
    v_rcp_f32 v10, v10
    v_mfma_f32_32x32x16_bf16 v[72:87], v[92:95], v[244:247], v[72:87]
    v_rcp_f32 v11, v11
    v_rcp_f32 v12, v12
    s_waitcnt lgkmcnt(4)
    v_mfma_f32_32x32x16_bf16 v[56:71], v[96:99], v[248:251], v[56:71]
    s_waitcnt vmcnt(8) lgkmcnt(0)
    s_barrier
    ds_read_b64_tr_b16 v[88:89], v4 offset:0
    ds_read_b64_tr_b16 v[90:91], v4 offset:512
    ds_read_b64_tr_b16 v[92:93], v4 offset:256
    ds_read_b64_tr_b16 v[94:95], v4 offset:768
    v_rcp_f32 v13, v13
    v_mul_f32 v10, v10, v52
    v_mul_f32 v11, v11, v53
    v_mul_f32 v12, v12, v54
    v_mfma_f32_32x32x16_bf16 v[72:87], v[100:103], v[248:251], v[72:87]
    ds_read_b64_tr_b16 v[96:97], v4 offset:2048
    ds_read_b64_tr_b16 v[98:99], v4 offset:2560
    v_mul_f32 v13, v13, v55
    v_cvt_pk_bf16_f32 v50, v10, v11
    v_cvt_pk_bf16_f32 v51, v12, v13
    buffer_store_dwordx4 v[48:51], v1, s[8:11], s27 offen offset:3072 sc1
    v_mfma_f32_32x32x16_bf16 v[56:71], v[104:107], v[252:255], v[56:71]
    ds_read_b64_tr_b16 v[100:101], v4 offset:2304
    ds_read_b64_tr_b16 v[102:103], v4 offset:2816
    v_mfma_f32_32x32x16_bf16 v[72:87], v[108:111], v[252:255], v[72:87]
    ds_read_b64_tr_b16 v[104:105], v4 offset:4096
    ds_read_b64_tr_b16 v[106:107], v4 offset:4608
    s_waitcnt lgkmcnt(6)
    v_mfma_f32_32x32x16_bf16 v[24:39], v[88:91], v[112:115], 0
    s_add_u32 s53, s44, s52
    s_add_u32 m0, s28, 49152
    ds_read_b64_tr_b16 v[108:109], v4 offset:4352
    ds_read_b64_tr_b16 v[110:111], v4 offset:4864
    buffer_load_dwordx4 v2, s[4:7], s53 offen lds
    v_mfma_f32_32x32x16_bf16 v[40:55], v[92:95], v[112:115], 0
    ds_read_b64_tr_b16 v[88:89], v4 offset:6144
    ds_read_b64_tr_b16 v[90:91], v4 offset:6656
    s_waitcnt lgkmcnt(6)
    v_mfma_f32_32x32x16_bf16 v[24:39], v[96:99], v[116:119], v[24:39]
    ds_read_b64_tr_b16 v[92:93], v4 offset:6400
    ds_read_b64_tr_b16 v[94:95], v4 offset:6912
    s_add_u32 s27, s50, 1
    s_and_b32 s27, s27, 3
    s_lshl_b32 s27, s27, 1
    s_add_u32 s27, s27, s48
    s_lshl_b32 s27, s27, 11
    v_mfma_f32_32x32x16_bf16 v[40:55], v[100:103], v[116:119], v[40:55]
    s_add_u32 s53, s53, 73728
    s_add_u32 m0, s28, 50176
    ds_read_b64_tr_b16 v[96:97], v4 offset:8192
    ds_read_b64_tr_b16 v[98:99], v4 offset:8704
    buffer_load_dwordx4 v2, s[4:7], s53 offen lds
    s_add_u32 s27, s27, s54
    v_mul_f32 v10, v56, v56
    v_mul_f32 v11, v57, v57
    v_mul_f32 v12, v58, v58
    v_mul_f32 v13, v59, v59
    s_waitcnt lgkmcnt(6)
    v_mfma_f32_32x32x16_bf16 v[24:39], v[104:107], v[120:123], v[24:39]
    ds_read_b64_tr_b16 v[100:101], v4 offset:8448
    ds_read_b64_tr_b16 v[102:103], v4 offset:8960
    v_fma_f32 v10, v10, v7, v6
    v_fma_f32 v11, v11, v7, v6
    v_fma_f32 v12, v12, v7, v6
    v_fma_f32 v13, v13, v7, v6
    v_mfma_f32_32x32x16_bf16 v[40:55], v[108:111], v[120:123], v[40:55]
    ds_read_b64_tr_b16 v[104:105], v4 offset:10240
    ds_read_b64_tr_b16 v[106:107], v4 offset:10752
    v_mul_f32 v10, v10, v56
    v_mul_f32 v11, v11, v57
    v_mul_f32 v12, v12, v58
    v_mul_f32 v13, v13, v59
    v_exp_f32 v10, v10
    s_waitcnt lgkmcnt(6)
    v_mfma_f32_32x32x16_bf16 v[24:39], v[88:91], v[124:127], v[24:39]
    s_add_u32 s53, s53, 73728
    s_add_u32 m0, s28, 51200
    ds_read_b64_tr_b16 v[108:109], v4 offset:10496
    ds_read_b64_tr_b16 v[110:111], v4 offset:11008
    buffer_load_dwordx4 v2, s[4:7], s53 offen lds
    v_exp_f32 v11, v11
    v_exp_f32 v12, v12
    v_mfma_f32_32x32x16_bf16 v[40:55], v[92:95], v[124:127], v[40:55]
    ds_read_b64_tr_b16 v[88:89], v4 offset:12288
    ds_read_b64_tr_b16 v[90:91], v4 offset:12800
    v_exp_f32 v13, v13
    v_fma_f32 v10, v10, v8, v8
    v_fma_f32 v11, v11, v8, v8
    s_waitcnt lgkmcnt(6)
    v_mfma_f32_32x32x16_bf16 v[24:39], v[96:99], v[128:131], v[24:39]
    ds_read_b64_tr_b16 v[92:93], v4 offset:12544
    ds_read_b64_tr_b16 v[94:95], v4 offset:13056
    v_fma_f32 v12, v12, v8, v8
    v_fma_f32 v13, v13, v8, v8
    v_rcp_f32 v10, v10
    v_rcp_f32 v11, v11
    v_mfma_f32_32x32x16_bf16 v[40:55], v[100:103], v[128:131], v[40:55]
    s_add_u32 s53, s53, 73728
    s_add_u32 m0, s28, 52224
    ds_read_b64_tr_b16 v[96:97], v4 offset:14336
    ds_read_b64_tr_b16 v[98:99], v4 offset:14848
    buffer_load_dwordx4 v2, s[4:7], s53 offen lds
    v_rcp_f32 v12, v12
    v_rcp_f32 v13, v13
    s_waitcnt lgkmcnt(6)
    v_mfma_f32_32x32x16_bf16 v[24:39], v[104:107], v[132:135], v[24:39]
    ds_read_b64_tr_b16 v[100:101], v4 offset:14592
    ds_read_b64_tr_b16 v[102:103], v4 offset:15104
    v_mul_f32 v10, v10, v56
    v_mul_f32 v11, v11, v57
    v_mul_f32 v12, v12, v58
    v_mul_f32 v13, v13, v59
    v_mfma_f32_32x32x16_bf16 v[40:55], v[108:111], v[132:135], v[40:55]
    ds_read_b64_tr_b16 v[104:105], v4 offset:16384
    ds_read_b64_tr_b16 v[106:107], v4 offset:16896
    v_cvt_pk_bf16_f32 v56, v10, v11
    v_cvt_pk_bf16_f32 v57, v12, v13
    v_mul_f32 v10, v60, v60
    v_mul_f32 v11, v61, v61
    v_mul_f32 v12, v62, v62
    s_waitcnt lgkmcnt(6)
    v_mfma_f32_32x32x16_bf16 v[24:39], v[88:91], v[136:139], v[24:39]
    s_add_u32 s53, s53, 73728
    s_add_u32 m0, s28, 53248
    ds_read_b64_tr_b16 v[108:109], v4 offset:16640
    ds_read_b64_tr_b16 v[110:111], v4 offset:17152
    buffer_load_dwordx4 v2, s[4:7], s53 offen lds
    v_mul_f32 v13, v63, v63
    v_fma_f32 v10, v10, v7, v6
    v_fma_f32 v11, v11, v7, v6
    v_fma_f32 v12, v12, v7, v6
    v_mfma_f32_32x32x16_bf16 v[40:55], v[92:95], v[136:139], v[40:55]
    ds_read_b64_tr_b16 v[88:89], v4 offset:18432
    ds_read_b64_tr_b16 v[90:91], v4 offset:18944
    v_fma_f32 v13, v13, v7, v6
    v_mul_f32 v10, v10, v60
    v_mul_f32 v11, v11, v61
    v_mul_f32 v12, v12, v62
    v_mul_f32 v13, v13, v63
    s_waitcnt lgkmcnt(6)
    v_mfma_f32_32x32x16_bf16 v[24:39], v[96:99], v[140:143], v[24:39]
    ds_read_b64_tr_b16 v[92:93], v4 offset:18688
    ds_read_b64_tr_b16 v[94:95], v4 offset:19200
    v_exp_f32 v10, v10
    v_exp_f32 v11, v11
    v_exp_f32 v12, v12
    v_mfma_f32_32x32x16_bf16 v[40:55], v[100:103], v[140:143], v[40:55]
    s_add_u32 s53, s53, 73728
    s_add_u32 m0, s28, 54272
    ds_read_b64_tr_b16 v[96:97], v4 offset:20480
    ds_read_b64_tr_b16 v[98:99], v4 offset:20992
    buffer_load_dwordx4 v2, s[4:7], s53 offen lds
    v_exp_f32 v13, v13
    v_fma_f32 v10, v10, v8, v8
    s_waitcnt lgkmcnt(6)
    v_mfma_f32_32x32x16_bf16 v[24:39], v[104:107], v[144:147], v[24:39]
    ds_read_b64_tr_b16 v[100:101], v4 offset:20736
    ds_read_b64_tr_b16 v[102:103], v4 offset:21248
    v_fma_f32 v11, v11, v8, v8
    v_fma_f32 v12, v12, v8, v8
    v_fma_f32 v13, v13, v8, v8
    v_rcp_f32 v10, v10
    v_mfma_f32_32x32x16_bf16 v[40:55], v[108:111], v[144:147], v[40:55]
    ds_read_b64_tr_b16 v[104:105], v4 offset:22528
    ds_read_b64_tr_b16 v[106:107], v4 offset:23040
    v_rcp_f32 v11, v11
    v_rcp_f32 v12, v12
    s_waitcnt lgkmcnt(6)
    v_mfma_f32_32x32x16_bf16 v[24:39], v[88:91], v[148:151], v[24:39]
    ds_read_b64_tr_b16 v[108:109], v4 offset:22784
    ds_read_b64_tr_b16 v[110:111], v4 offset:23296
    v_rcp_f32 v13, v13
    v_mul_f32 v10, v10, v60
    v_mul_f32 v11, v11, v61
    v_mul_f32 v12, v12, v62
    v_mfma_f32_32x32x16_bf16 v[40:55], v[92:95], v[148:151], v[40:55]
    v_mul_f32 v13, v13, v63
    v_cvt_pk_bf16_f32 v58, v10, v11
    v_cvt_pk_bf16_f32 v59, v12, v13
    buffer_store_dwordx4 v[56:59], v1, s[8:11], s27 offen offset:0 sc1
    v_mul_f32 v10, v64, v64
    s_waitcnt lgkmcnt(4)
    v_mfma_f32_32x32x16_bf16 v[24:39], v[96:99], v[152:155], v[24:39]
    s_waitcnt vmcnt(8) lgkmcnt(0)
    s_barrier
    ds_read_b64_tr_b16 v[88:89], v4 offset:24576
    ds_read_b64_tr_b16 v[90:91], v4 offset:25088
    ds_read_b64_tr_b16 v[92:93], v4 offset:24832
    ds_read_b64_tr_b16 v[94:95], v4 offset:25344
    v_mul_f32 v11, v65, v65
    v_mul_f32 v12, v66, v66
    v_mul_f32 v13, v67, v67
    v_fma_f32 v10, v10, v7, v6
    v_mfma_f32_32x32x16_bf16 v[40:55], v[100:103], v[152:155], v[40:55]
    ds_read_b64_tr_b16 v[96:97], v4 offset:26624
    ds_read_b64_tr_b16 v[98:99], v4 offset:27136
    v_fma_f32 v11, v11, v7, v6
    v_fma_f32 v12, v12, v7, v6
    v_fma_f32 v13, v13, v7, v6
    v_mul_f32 v10, v10, v64
    v_mul_f32 v11, v11, v65
    v_mfma_f32_32x32x16_bf16 v[24:39], v[104:107], v[156:159], v[24:39]
    ds_read_b64_tr_b16 v[100:101], v4 offset:26880
    ds_read_b64_tr_b16 v[102:103], v4 offset:27392
    v_mul_f32 v12, v12, v66
    v_mul_f32 v13, v13, v67
    v_exp_f32 v10, v10
    v_mfma_f32_32x32x16_bf16 v[40:55], v[108:111], v[156:159], v[40:55]
    ds_read_b64_tr_b16 v[104:105], v4 offset:28672
    ds_read_b64_tr_b16 v[106:107], v4 offset:29184
    v_exp_f32 v11, v11
    v_exp_f32 v12, v12
    v_exp_f32 v13, v13
    s_waitcnt lgkmcnt(6)
    v_mfma_f32_32x32x16_bf16 v[24:39], v[88:91], v[160:163], v[24:39]
    s_add_u32 s26, s50, 2
    s_and_b32 s26, s26, 3
    s_lshl_b32 s26, s26, 1
    s_add_u32 s26, s26, s48
    s_lshl_b32 s26, s26, 10
    s_add_u32 s26, s26, s55
    ds_read_b64_tr_b16 v[108:109], v4 offset:28928
    ds_read_b64_tr_b16 v[110:111], v4 offset:29440
    buffer_load_dwordx4 v[18:21], v1, s[8:11], s26 offen offset:0 sc1
    v_fma_f32 v10, v10, v8, v8
    v_fma_f32 v11, v11, v8, v8
    v_fma_f32 v12, v12, v8, v8
    v_fma_f32 v13, v13, v8, v8
    v_mfma_f32_32x32x16_bf16 v[40:55], v[92:95], v[160:163], v[40:55]
    ds_read_b64_tr_b16 v[88:89], v4 offset:30720
    ds_read_b64_tr_b16 v[90:91], v4 offset:31232
    v_rcp_f32 v10, v10
    v_rcp_f32 v11, v11
    s_waitcnt lgkmcnt(6)
    v_mfma_f32_32x32x16_bf16 v[24:39], v[96:99], v[164:167], v[24:39]
    s_add_u32 s52, s50, 3
    s_and_b32 s52, s52, 3
    s_lshl_b32 s52, s52, 1
    s_add_u32 s52, s52, s48
    s_lshl_b32 s52, s52, 6
    s_add_u32 s52, s52, s25
    s_add_u32 s53, s42, s52
    s_add_u32 m0, s28, 0
    ds_read_b64_tr_b16 v[92:93], v4 offset:30976
    ds_read_b64_tr_b16 v[94:95], v4 offset:31488
    buffer_load_dwordx4 v2, s[4:7], s53 offen lds
    v_rcp_f32 v12, v12
    v_rcp_f32 v13, v13
    v_mul_f32 v10, v10, v64
    v_mfma_f32_32x32x16_bf16 v[40:55], v[100:103], v[164:167], v[40:55]
    ds_read_b64_tr_b16 v[96:97], v4 offset:32768
    ds_read_b64_tr_b16 v[98:99], v4 offset:33280
    v_mul_f32 v11, v11, v65
    v_mul_f32 v12, v12, v66
    v_mul_f32 v13, v13, v67
    v_cvt_pk_bf16_f32 v64, v10, v11
    v_cvt_pk_bf16_f32 v65, v12, v13
    s_waitcnt lgkmcnt(6)
    v_mfma_f32_32x32x16_bf16 v[24:39], v[104:107], v[168:171], v[24:39]
    ds_read_b64_tr_b16 v[100:101], v4 offset:33024
    ds_read_b64_tr_b16 v[102:103], v4 offset:33536
    v_mul_f32 v10, v68, v68
    v_mul_f32 v11, v69, v69
    v_mul_f32 v12, v70, v70
    v_mul_f32 v13, v71, v71
    v_mfma_f32_32x32x16_bf16 v[40:55], v[108:111], v[168:171], v[40:55]
    s_add_u32 s53, s53, 73728
    s_add_u32 m0, s28, 1024
    ds_read_b64_tr_b16 v[104:105], v4 offset:34816
    ds_read_b64_tr_b16 v[106:107], v4 offset:35328
    buffer_load_dwordx4 v2, s[4:7], s53 offen lds
    v_fma_f32 v10, v10, v7, v6
    v_fma_f32 v11, v11, v7, v6
    v_fma_f32 v12, v12, v7, v6
    v_fma_f32 v13, v13, v7, v6
    v_mul_f32 v10, v10, v68
    s_waitcnt lgkmcnt(6)
    v_mfma_f32_32x32x16_bf16 v[24:39], v[88:91], v[172:175], v[24:39]
    ds_read_b64_tr_b16 v[108:109], v4 offset:35072
    ds_read_b64_tr_b16 v[110:111], v4 offset:35584
    v_mul_f32 v11, v11, v69
    v_mul_f32 v12, v12, v70
    v_mul_f32 v13, v13, v71
    v_exp_f32 v10, v10
    v_mfma_f32_32x32x16_bf16 v[40:55], v[92:95], v[172:175], v[40:55]
    ds_read_b64_tr_b16 v[88:89], v4 offset:36864
    ds_read_b64_tr_b16 v[90:91], v4 offset:37376
    v_exp_f32 v11, v11
    v_exp_f32 v12, v12
    s_waitcnt lgkmcnt(6)
    v_mfma_f32_32x32x16_bf16 v[24:39], v[96:99], v[176:179], v[24:39]
    s_add_u32 s53, s53, 73728
    s_add_u32 m0, s28, 2048
    ds_read_b64_tr_b16 v[92:93], v4 offset:37120
    ds_read_b64_tr_b16 v[94:95], v4 offset:37632
    buffer_load_dwordx4 v2, s[4:7], s53 offen lds
    v_exp_f32 v13, v13
    v_fma_f32 v10, v10, v8, v8
    v_fma_f32 v11, v11, v8, v8
    v_fma_f32 v12, v12, v8, v8
    v_mfma_f32_32x32x16_bf16 v[40:55], v[100:103], v[176:179], v[40:55]
    ds_read_b64_tr_b16 v[96:97], v4 offset:38912
    ds_read_b64_tr_b16 v[98:99], v4 offset:39424
    v_fma_f32 v13, v13, v8, v8
    v_rcp_f32 v10, v10
    v_rcp_f32 v11, v11
    s_waitcnt lgkmcnt(6)
    v_mfma_f32_32x32x16_bf16 v[24:39], v[104:107], v[180:183], v[24:39]
    s_add_u32 s53, s53, 73728
    s_add_u32 m0, s28, 3072
    ds_read_b64_tr_b16 v[100:101], v4 offset:39168
    ds_read_b64_tr_b16 v[102:103], v4 offset:39680
    buffer_load_dwordx4 v2, s[4:7], s53 offen lds
    v_rcp_f32 v12, v12
    v_rcp_f32 v13, v13
    v_mfma_f32_32x32x16_bf16 v[40:55], v[108:111], v[180:183], v[40:55]
    ds_read_b64_tr_b16 v[104:105], v4 offset:40960
    ds_read_b64_tr_b16 v[106:107], v4 offset:41472
    v_mul_f32 v10, v10, v68
    v_mul_f32 v11, v11, v69
    v_mul_f32 v12, v12, v70
    v_mul_f32 v13, v13, v71
    s_waitcnt lgkmcnt(6)
    v_mfma_f32_32x32x16_bf16 v[24:39], v[88:91], v[184:187], v[24:39]
    ds_read_b64_tr_b16 v[108:109], v4 offset:41216
    ds_read_b64_tr_b16 v[110:111], v4 offset:41728
    v_cvt_pk_bf16_f32 v66, v10, v11
    v_cvt_pk_bf16_f32 v67, v12, v13
    buffer_store_dwordx4 v[64:67], v1, s[8:11], s27 offen offset:1024 sc1
    v_mul_f32 v10, v72, v72
    v_mul_f32 v11, v73, v73
    v_mfma_f32_32x32x16_bf16 v[40:55], v[92:95], v[184:187], v[40:55]
    s_add_u32 s53, s53, 73728
    s_add_u32 m0, s28, 4096
    ds_read_b64_tr_b16 v[88:89], v4 offset:43008
    ds_read_b64_tr_b16 v[90:91], v4 offset:43520
    buffer_load_dwordx4 v2, s[4:7], s53 offen lds
    v_mul_f32 v12, v74, v74
    v_mul_f32 v13, v75, v75
    v_fma_f32 v10, v10, v7, v6
    v_fma_f32 v11, v11, v7, v6
    v_fma_f32 v12, v12, v7, v6
    s_waitcnt lgkmcnt(6)
    v_mfma_f32_32x32x16_bf16 v[24:39], v[96:99], v[188:191], v[24:39]
    ds_read_b64_tr_b16 v[92:93], v4 offset:43264
    ds_read_b64_tr_b16 v[94:95], v4 offset:43776
    v_fma_f32 v13, v13, v7, v6
    v_mul_f32 v10, v10, v72
    v_mul_f32 v11, v11, v73
    v_mul_f32 v12, v12, v74
    v_mfma_f32_32x32x16_bf16 v[40:55], v[100:103], v[188:191], v[40:55]
    ds_read_b64_tr_b16 v[96:97], v4 offset:45056
    ds_read_b64_tr_b16 v[98:99], v4 offset:45568
    v_mul_f32 v13, v13, v75
    v_exp_f32 v10, v10
    v_exp_f32 v11, v11
    s_waitcnt lgkmcnt(6)
    v_mfma_f32_32x32x16_bf16 v[24:39], v[104:107], v[192:195], v[24:39]
    s_waitcnt vmcnt(6)
    v_mfma_f32_32x32x16_bf16 v[24:39], v[18:21], v[14:17], v[24:39]
    s_add_u32 s53, s53, 73728
    s_add_u32 m0, s28, 5120
    ds_read_b64_tr_b16 v[100:101], v4 offset:45312
    ds_read_b64_tr_b16 v[102:103], v4 offset:45824
    buffer_load_dwordx4 v2, s[4:7], s53 offen lds
    v_exp_f32 v12, v12
    v_exp_f32 v13, v13
    v_fma_f32 v10, v10, v8, v8
    v_mfma_f32_32x32x16_bf16 v[40:55], v[108:111], v[192:195], v[40:55]
    ds_read_b64_tr_b16 v[104:105], v4 offset:47104
    ds_read_b64_tr_b16 v[106:107], v4 offset:47616
    v_fma_f32 v11, v11, v8, v8
    v_fma_f32 v12, v12, v8, v8
    v_fma_f32 v13, v13, v8, v8
    v_rcp_f32 v10, v10
    s_waitcnt lgkmcnt(6)
    v_mfma_f32_32x32x16_bf16 v[24:39], v[88:91], v[196:199], v[24:39]
    ds_read_b64_tr_b16 v[108:109], v4 offset:47360
    ds_read_b64_tr_b16 v[110:111], v4 offset:47872
    v_rcp_f32 v11, v11
    v_rcp_f32 v12, v12
    v_mfma_f32_32x32x16_bf16 v[40:55], v[92:95], v[196:199], v[40:55]
    v_rcp_f32 v13, v13
    v_mul_f32 v10, v10, v72
    v_mul_f32 v11, v11, v73
    s_waitcnt lgkmcnt(4)
    v_mfma_f32_32x32x16_bf16 v[24:39], v[96:99], v[200:203], v[24:39]
    s_waitcnt vmcnt(9) lgkmcnt(0)
    s_barrier
    ds_read_b64_tr_b16 v[88:89], v5 offset:0
    ds_read_b64_tr_b16 v[90:91], v5 offset:512
    ds_read_b64_tr_b16 v[92:93], v5 offset:256
    ds_read_b64_tr_b16 v[94:95], v5 offset:768
    v_mul_f32 v12, v12, v74
    v_mul_f32 v13, v13, v75
    v_cvt_pk_bf16_f32 v72, v10, v11
    v_cvt_pk_bf16_f32 v73, v12, v13
    v_mul_f32 v10, v76, v76
    v_mfma_f32_32x32x16_bf16 v[40:55], v[100:103], v[200:203], v[40:55]
    ds_read_b64_tr_b16 v[96:97], v5 offset:2048
    ds_read_b64_tr_b16 v[98:99], v5 offset:2560
    v_mul_f32 v11, v77, v77
    v_mul_f32 v12, v78, v78
    v_mul_f32 v13, v79, v79
    v_fma_f32 v10, v10, v7, v6
    v_fma_f32 v11, v11, v7, v6
    v_mfma_f32_32x32x16_bf16 v[24:39], v[104:107], v[204:207], v[24:39]
    ds_read_b64_tr_b16 v[100:101], v5 offset:2304
    ds_read_b64_tr_b16 v[102:103], v5 offset:2816
    v_fma_f32 v12, v12, v7, v6
    v_fma_f32 v13, v13, v7, v6
    v_mul_f32 v10, v10, v76
    v_mul_f32 v11, v11, v77
    v_mfma_f32_32x32x16_bf16 v[40:55], v[108:111], v[204:207], v[40:55]
    ds_read_b64_tr_b16 v[104:105], v5 offset:4096
    ds_read_b64_tr_b16 v[106:107], v5 offset:4608
    v_mul_f32 v12, v12, v78
    v_mul_f32 v13, v13, v79
    v_exp_f32 v10, v10
    v_exp_f32 v11, v11
    s_waitcnt lgkmcnt(6)
    v_mfma_f32_32x32x16_bf16 v[24:39], v[88:91], v[208:211], v[24:39]
    s_add_u32 s26, s50, 2
    s_and_b32 s26, s26, 3
    s_lshl_b32 s26, s26, 1
    s_add_u32 s26, s26, s48
    s_lshl_b32 s26, s26, 10
    s_add_u32 s26, s26, s55
    ds_read_b64_tr_b16 v[108:109], v5 offset:4352
    ds_read_b64_tr_b16 v[110:111], v5 offset:4864
    buffer_load_dwordx4 v[18:21], v1, s[8:11], s26 offen offset:1024 sc1
    v_exp_f32 v12, v12
    v_exp_f32 v13, v13
    v_mfma_f32_32x32x16_bf16 v[40:55], v[92:95], v[208:211], v[40:55]
    ds_read_b64_tr_b16 v[88:89], v5 offset:6144
    ds_read_b64_tr_b16 v[90:91], v5 offset:6656
    v_fma_f32 v10, v10, v8, v8
    v_fma_f32 v11, v11, v8, v8
    v_fma_f32 v12, v12, v8, v8
    v_fma_f32 v13, v13, v8, v8
    s_waitcnt lgkmcnt(6)
    v_mfma_f32_32x32x16_bf16 v[24:39], v[96:99], v[212:215], v[24:39]
    s_add_u32 s53, s43, s52
    s_add_u32 m0, s28, 24576
    ds_read_b64_tr_b16 v[92:93], v5 offset:6400
    ds_read_b64_tr_b16 v[94:95], v5 offset:6912
    buffer_load_dwordx4 v2, s[4:7], s53 offen lds
    v_rcp_f32 v10, v10
    v_rcp_f32 v11, v11
    v_rcp_f32 v12, v12
    v_mfma_f32_32x32x16_bf16 v[40:55], v[100:103], v[212:215], v[40:55]
    ds_read_b64_tr_b16 v[96:97], v5 offset:8192
    ds_read_b64_tr_b16 v[98:99], v5 offset:8704
    v_rcp_f32 v13, v13
    v_mul_f32 v10, v10, v76
    s_waitcnt lgkmcnt(6)
    v_mfma_f32_32x32x16_bf16 v[24:39], v[104:107], v[216:219], v[24:39]
    ds_read_b64_tr_b16 v[100:101], v5 offset:8448
    ds_read_b64_tr_b16 v[102:103], v5 offset:8960
    v_mul_f32 v11, v11, v77
    v_mul_f32 v12, v12, v78
    v_mul_f32 v13, v13, v79
    v_cvt_pk_bf16_f32 v74, v10, v11
    v_cvt_pk_bf16_f32 v75, v12, v13
    v_mfma_f32_32x32x16_bf16 v[40:55], v[108:111], v[216:219], v[40:55]
    s_add_u32 s53, s53, 73728
    s_add_u32 m0, s28, 25600
    ds_read_b64_tr_b16 v[104:105], v5 offset:10240
    ds_read_b64_tr_b16 v[106:107], v5 offset:10752
    buffer_load_dwordx4 v2, s[4:7], s53 offen lds
    buffer_store_dwordx4 v[72:75], v1, s[8:11], s27 offen offset:2048 sc1
    v_mul_f32 v10, v80, v80
    v_mul_f32 v11, v81, v81
    v_mul_f32 v12, v82, v82
    v_mul_f32 v13, v83, v83
    s_waitcnt lgkmcnt(6)
    v_mfma_f32_32x32x16_bf16 v[24:39], v[88:91], v[220:223], v[24:39]
    ds_read_b64_tr_b16 v[108:109], v5 offset:10496
    ds_read_b64_tr_b16 v[110:111], v5 offset:11008
    v_fma_f32 v10, v10, v7, v6
    v_fma_f32 v11, v11, v7, v6
    v_fma_f32 v12, v12, v7, v6
    v_fma_f32 v13, v13, v7, v6
    v_mfma_f32_32x32x16_bf16 v[40:55], v[92:95], v[220:223], v[40:55]
    ds_read_b64_tr_b16 v[88:89], v5 offset:12288
    ds_read_b64_tr_b16 v[90:91], v5 offset:12800
    v_mul_f32 v10, v10, v80
    v_mul_f32 v11, v11, v81
    v_mul_f32 v12, v12, v82
    v_mul_f32 v13, v13, v83
    v_exp_f32 v10, v10
    s_waitcnt lgkmcnt(6)
    v_mfma_f32_32x32x16_bf16 v[24:39], v[96:99], v[224:227], v[24:39]
    s_add_u32 s53, s53, 73728
    s_add_u32 m0, s28, 26624
    ds_read_b64_tr_b16 v[92:93], v5 offset:12544
    ds_read_b64_tr_b16 v[94:95], v5 offset:13056
    buffer_load_dwordx4 v2, s[4:7], s53 offen lds
    v_exp_f32 v11, v11
    v_exp_f32 v12, v12
    v_mfma_f32_32x32x16_bf16 v[40:55], v[100:103], v[224:227], v[40:55]
    ds_read_b64_tr_b16 v[96:97], v5 offset:14336
    ds_read_b64_tr_b16 v[98:99], v5 offset:14848
    v_exp_f32 v13, v13
    v_fma_f32 v10, v10, v8, v8
    v_fma_f32 v11, v11, v8, v8
    s_waitcnt lgkmcnt(6)
    v_mfma_f32_32x32x16_bf16 v[24:39], v[104:107], v[228:231], v[24:39]
    s_add_u32 s53, s53, 73728
    s_add_u32 m0, s28, 27648
    ds_read_b64_tr_b16 v[100:101], v5 offset:14592
    ds_read_b64_tr_b16 v[102:103], v5 offset:15104
    buffer_load_dwordx4 v2, s[4:7], s53 offen lds
    v_fma_f32 v12, v12, v8, v8
    v_fma_f32 v13, v13, v8, v8
    v_rcp_f32 v10, v10
    v_rcp_f32 v11, v11
    v_mfma_f32_32x32x16_bf16 v[40:55], v[108:111], v[228:231], v[40:55]
    ds_read_b64_tr_b16 v[104:105], v5 offset:16384
    ds_read_b64_tr_b16 v[106:107], v5 offset:16896
    v_rcp_f32 v12, v12
    v_rcp_f32 v13, v13
    s_waitcnt lgkmcnt(6)
    v_mfma_f32_32x32x16_bf16 v[24:39], v[88:91], v[232:235], v[24:39]
    ds_read_b64_tr_b16 v[108:109], v5 offset:16640
    ds_read_b64_tr_b16 v[110:111], v5 offset:17152
    v_mul_f32 v10, v10, v80
    v_mul_f32 v11, v11, v81
    v_mul_f32 v12, v12, v82
    v_mul_f32 v13, v13, v83
    v_mfma_f32_32x32x16_bf16 v[40:55], v[92:95], v[232:235], v[40:55]
    s_add_u32 s53, s53, 73728
    s_add_u32 m0, s28, 28672
    ds_read_b64_tr_b16 v[88:89], v5 offset:18432
    ds_read_b64_tr_b16 v[90:91], v5 offset:18944
    buffer_load_dwordx4 v2, s[4:7], s53 offen lds
    v_cvt_pk_bf16_f32 v80, v10, v11
    v_cvt_pk_bf16_f32 v81, v12, v13
    v_mul_f32 v10, v84, v84
    v_mul_f32 v11, v85, v85
    v_mul_f32 v12, v86, v86
    s_waitcnt lgkmcnt(6)
    v_mfma_f32_32x32x16_bf16 v[24:39], v[96:99], v[236:239], v[24:39]
    ds_read_b64_tr_b16 v[92:93], v5 offset:18688
    ds_read_b64_tr_b16 v[94:95], v5 offset:19200
    v_mul_f32 v13, v87, v87
    v_fma_f32 v10, v10, v7, v6
    v_fma_f32 v11, v11, v7, v6
    v_fma_f32 v12, v12, v7, v6
    v_mfma_f32_32x32x16_bf16 v[40:55], v[100:103], v[236:239], v[40:55]
    ds_read_b64_tr_b16 v[96:97], v5 offset:20480
    ds_read_b64_tr_b16 v[98:99], v5 offset:20992
    v_fma_f32 v13, v13, v7, v6
    v_mul_f32 v10, v10, v84
    v_mul_f32 v11, v11, v85
    v_mul_f32 v12, v12, v86
    v_mul_f32 v13, v13, v87
    s_waitcnt lgkmcnt(6)
    v_mfma_f32_32x32x16_bf16 v[24:39], v[104:107], v[240:243], v[24:39]
    s_add_u32 s53, s53, 73728
    s_add_u32 m0, s28, 29696
    ds_read_b64_tr_b16 v[100:101], v5 offset:20736
    ds_read_b64_tr_b16 v[102:103], v5 offset:21248
    buffer_load_dwordx4 v2, s[4:7], s53 offen lds
    v_exp_f32 v10, v10
    v_exp_f32 v11, v11
    v_mfma_f32_32x32x16_bf16 v[40:55], v[108:111], v[240:243], v[40:55]
    s_waitcnt vmcnt(7)
    v_mfma_f32_32x32x16_bf16 v[40:55], v[18:21], v[14:17], v[40:55]
    ds_read_b64_tr_b16 v[104:105], v5 offset:22528
    ds_read_b64_tr_b16 v[106:107], v5 offset:23040
    v_exp_f32 v12, v12
    v_exp_f32 v13, v13
    v_fma_f32 v10, v10, v8, v8
    s_waitcnt lgkmcnt(6)
    v_mfma_f32_32x32x16_bf16 v[24:39], v[88:91], v[244:247], v[24:39]
    ds_read_b64_tr_b16 v[108:109], v5 offset:22784
    ds_read_b64_tr_b16 v[110:111], v5 offset:23296
    v_fma_f32 v11, v11, v8, v8
    v_fma_f32 v12, v12, v8, v8
    v_fma_f32 v13, v13, v8, v8
    v_rcp_f32 v10, v10
    v_mfma_f32_32x32x16_bf16 v[40:55], v[92:95], v[244:247], v[40:55]
    v_rcp_f32 v11, v11
    v_rcp_f32 v12, v12
    s_waitcnt lgkmcnt(4)
    v_mfma_f32_32x32x16_bf16 v[24:39], v[96:99], v[248:251], v[24:39]
    s_waitcnt vmcnt(8) lgkmcnt(0)
    s_barrier
    ds_read_b64_tr_b16 v[88:89], v4 offset:0
    ds_read_b64_tr_b16 v[90:91], v4 offset:512
    ds_read_b64_tr_b16 v[92:93], v4 offset:256
    ds_read_b64_tr_b16 v[94:95], v4 offset:768
    v_rcp_f32 v13, v13
    v_mul_f32 v10, v10, v84
    v_mul_f32 v11, v11, v85
    v_mul_f32 v12, v12, v86
    v_mfma_f32_32x32x16_bf16 v[40:55], v[100:103], v[248:251], v[40:55]
    ds_read_b64_tr_b16 v[96:97], v4 offset:2048
    ds_read_b64_tr_b16 v[98:99], v4 offset:2560
    v_mul_f32 v13, v13, v87
    v_cvt_pk_bf16_f32 v82, v10, v11
    v_cvt_pk_bf16_f32 v83, v12, v13
    buffer_store_dwordx4 v[80:83], v1, s[8:11], s27 offen offset:3072 sc1
    v_mfma_f32_32x32x16_bf16 v[24:39], v[104:107], v[252:255], v[24:39]
    ds_read_b64_tr_b16 v[100:101], v4 offset:2304
    ds_read_b64_tr_b16 v[102:103], v4 offset:2816
    v_mfma_f32_32x32x16_bf16 v[40:55], v[108:111], v[252:255], v[40:55]
    ds_read_b64_tr_b16 v[104:105], v4 offset:4096
    ds_read_b64_tr_b16 v[106:107], v4 offset:4608
    s_waitcnt lgkmcnt(6)
    v_mfma_f32_32x32x16_bf16 v[56:71], v[88:91], v[112:115], 0
    s_add_u32 s53, s44, s52
    s_add_u32 m0, s28, 49152
    ds_read_b64_tr_b16 v[108:109], v4 offset:4352
    ds_read_b64_tr_b16 v[110:111], v4 offset:4864
    buffer_load_dwordx4 v2, s[4:7], s53 offen lds
    v_mfma_f32_32x32x16_bf16 v[72:87], v[92:95], v[112:115], 0
    ds_read_b64_tr_b16 v[88:89], v4 offset:6144
    ds_read_b64_tr_b16 v[90:91], v4 offset:6656
    s_waitcnt lgkmcnt(6)
    v_mfma_f32_32x32x16_bf16 v[56:71], v[96:99], v[116:119], v[56:71]
    ds_read_b64_tr_b16 v[92:93], v4 offset:6400
    ds_read_b64_tr_b16 v[94:95], v4 offset:6912
    s_add_u32 s27, s50, 2
    s_and_b32 s27, s27, 3
    s_lshl_b32 s27, s27, 1
    s_add_u32 s27, s27, s48
    s_lshl_b32 s27, s27, 11
    v_mfma_f32_32x32x16_bf16 v[72:87], v[100:103], v[116:119], v[72:87]
    s_add_u32 s53, s53, 73728
    s_add_u32 m0, s28, 50176
    ds_read_b64_tr_b16 v[96:97], v4 offset:8192
    ds_read_b64_tr_b16 v[98:99], v4 offset:8704
    buffer_load_dwordx4 v2, s[4:7], s53 offen lds
    s_add_u32 s27, s27, s54
    v_mul_f32 v10, v24, v24
    v_mul_f32 v11, v25, v25
    v_mul_f32 v12, v26, v26
    v_mul_f32 v13, v27, v27
    s_waitcnt lgkmcnt(6)
    v_mfma_f32_32x32x16_bf16 v[56:71], v[104:107], v[120:123], v[56:71]
    ds_read_b64_tr_b16 v[100:101], v4 offset:8448
    ds_read_b64_tr_b16 v[102:103], v4 offset:8960
    v_fma_f32 v10, v10, v7, v6
    v_fma_f32 v11, v11, v7, v6
    v_fma_f32 v12, v12, v7, v6
    v_fma_f32 v13, v13, v7, v6
    v_mfma_f32_32x32x16_bf16 v[72:87], v[108:111], v[120:123], v[72:87]
    ds_read_b64_tr_b16 v[104:105], v4 offset:10240
    ds_read_b64_tr_b16 v[106:107], v4 offset:10752
    v_mul_f32 v10, v10, v24
    v_mul_f32 v11, v11, v25
    v_mul_f32 v12, v12, v26
    v_mul_f32 v13, v13, v27
    v_exp_f32 v10, v10
    s_waitcnt lgkmcnt(6)
    v_mfma_f32_32x32x16_bf16 v[56:71], v[88:91], v[124:127], v[56:71]
    s_add_u32 s53, s53, 73728
    s_add_u32 m0, s28, 51200
    ds_read_b64_tr_b16 v[108:109], v4 offset:10496
    ds_read_b64_tr_b16 v[110:111], v4 offset:11008
    buffer_load_dwordx4 v2, s[4:7], s53 offen lds
    v_exp_f32 v11, v11
    v_exp_f32 v12, v12
    v_mfma_f32_32x32x16_bf16 v[72:87], v[92:95], v[124:127], v[72:87]
    ds_read_b64_tr_b16 v[88:89], v4 offset:12288
    ds_read_b64_tr_b16 v[90:91], v4 offset:12800
    v_exp_f32 v13, v13
    v_fma_f32 v10, v10, v8, v8
    v_fma_f32 v11, v11, v8, v8
    s_waitcnt lgkmcnt(6)
    v_mfma_f32_32x32x16_bf16 v[56:71], v[96:99], v[128:131], v[56:71]
    ds_read_b64_tr_b16 v[92:93], v4 offset:12544
    ds_read_b64_tr_b16 v[94:95], v4 offset:13056
    v_fma_f32 v12, v12, v8, v8
    v_fma_f32 v13, v13, v8, v8
    v_rcp_f32 v10, v10
    v_rcp_f32 v11, v11
    v_mfma_f32_32x32x16_bf16 v[72:87], v[100:103], v[128:131], v[72:87]
    s_add_u32 s53, s53, 73728
    s_add_u32 m0, s28, 52224
    ds_read_b64_tr_b16 v[96:97], v4 offset:14336
    ds_read_b64_tr_b16 v[98:99], v4 offset:14848
    buffer_load_dwordx4 v2, s[4:7], s53 offen lds
    v_rcp_f32 v12, v12
    v_rcp_f32 v13, v13
    s_waitcnt lgkmcnt(6)
    v_mfma_f32_32x32x16_bf16 v[56:71], v[104:107], v[132:135], v[56:71]
    ds_read_b64_tr_b16 v[100:101], v4 offset:14592
    ds_read_b64_tr_b16 v[102:103], v4 offset:15104
    v_mul_f32 v10, v10, v24
    v_mul_f32 v11, v11, v25
    v_mul_f32 v12, v12, v26
    v_mul_f32 v13, v13, v27
    v_mfma_f32_32x32x16_bf16 v[72:87], v[108:111], v[132:135], v[72:87]
    ds_read_b64_tr_b16 v[104:105], v4 offset:16384
    ds_read_b64_tr_b16 v[106:107], v4 offset:16896
    v_cvt_pk_bf16_f32 v24, v10, v11
    v_cvt_pk_bf16_f32 v25, v12, v13
    v_mul_f32 v10, v28, v28
    v_mul_f32 v11, v29, v29
    v_mul_f32 v12, v30, v30
    s_waitcnt lgkmcnt(6)
    v_mfma_f32_32x32x16_bf16 v[56:71], v[88:91], v[136:139], v[56:71]
    s_add_u32 s53, s53, 73728
    s_add_u32 m0, s28, 53248
    ds_read_b64_tr_b16 v[108:109], v4 offset:16640
    ds_read_b64_tr_b16 v[110:111], v4 offset:17152
    buffer_load_dwordx4 v2, s[4:7], s53 offen lds
    v_mul_f32 v13, v31, v31
    v_fma_f32 v10, v10, v7, v6
    v_fma_f32 v11, v11, v7, v6
    v_fma_f32 v12, v12, v7, v6
    v_mfma_f32_32x32x16_bf16 v[72:87], v[92:95], v[136:139], v[72:87]
    ds_read_b64_tr_b16 v[88:89], v4 offset:18432
    ds_read_b64_tr_b16 v[90:91], v4 offset:18944
    v_fma_f32 v13, v13, v7, v6
    v_mul_f32 v10, v10, v28
    v_mul_f32 v11, v11, v29
    v_mul_f32 v12, v12, v30
    v_mul_f32 v13, v13, v31
    s_waitcnt lgkmcnt(6)
    v_mfma_f32_32x32x16_bf16 v[56:71], v[96:99], v[140:143], v[56:71]
    ds_read_b64_tr_b16 v[92:93], v4 offset:18688
    ds_read_b64_tr_b16 v[94:95], v4 offset:19200
    v_exp_f32 v10, v10
    v_exp_f32 v11, v11
    v_exp_f32 v12, v12
    v_mfma_f32_32x32x16_bf16 v[72:87], v[100:103], v[140:143], v[72:87]
    s_add_u32 s53, s53, 73728
    s_add_u32 m0, s28, 54272
    ds_read_b64_tr_b16 v[96:97], v4 offset:20480
    ds_read_b64_tr_b16 v[98:99], v4 offset:20992
    buffer_load_dwordx4 v2, s[4:7], s53 offen lds
    v_exp_f32 v13, v13
    v_fma_f32 v10, v10, v8, v8
    s_waitcnt lgkmcnt(6)
    v_mfma_f32_32x32x16_bf16 v[56:71], v[104:107], v[144:147], v[56:71]
    ds_read_b64_tr_b16 v[100:101], v4 offset:20736
    ds_read_b64_tr_b16 v[102:103], v4 offset:21248
    v_fma_f32 v11, v11, v8, v8
    v_fma_f32 v12, v12, v8, v8
    v_fma_f32 v13, v13, v8, v8
    v_rcp_f32 v10, v10
    v_mfma_f32_32x32x16_bf16 v[72:87], v[108:111], v[144:147], v[72:87]
    ds_read_b64_tr_b16 v[104:105], v4 offset:22528
    ds_read_b64_tr_b16 v[106:107], v4 offset:23040
    v_rcp_f32 v11, v11
    v_rcp_f32 v12, v12
    s_waitcnt lgkmcnt(6)
    v_mfma_f32_32x32x16_bf16 v[56:71], v[88:91], v[148:151], v[56:71]
    ds_read_b64_tr_b16 v[108:109], v4 offset:22784
    ds_read_b64_tr_b16 v[110:111], v4 offset:23296
    v_rcp_f32 v13, v13
    v_mul_f32 v10, v10, v28
    v_mul_f32 v11, v11, v29
    v_mul_f32 v12, v12, v30
    v_mfma_f32_32x32x16_bf16 v[72:87], v[92:95], v[148:151], v[72:87]
    v_mul_f32 v13, v13, v31
    v_cvt_pk_bf16_f32 v26, v10, v11
    v_cvt_pk_bf16_f32 v27, v12, v13
    buffer_store_dwordx4 v[24:27], v1, s[8:11], s27 offen offset:0 sc1
    v_mul_f32 v10, v32, v32
    s_waitcnt lgkmcnt(4)
    v_mfma_f32_32x32x16_bf16 v[56:71], v[96:99], v[152:155], v[56:71]
    s_waitcnt vmcnt(8) lgkmcnt(0)
    s_barrier
    ds_read_b64_tr_b16 v[88:89], v4 offset:24576
    ds_read_b64_tr_b16 v[90:91], v4 offset:25088
    ds_read_b64_tr_b16 v[92:93], v4 offset:24832
    ds_read_b64_tr_b16 v[94:95], v4 offset:25344
    v_mul_f32 v11, v33, v33
    v_mul_f32 v12, v34, v34
    v_mul_f32 v13, v35, v35
    v_fma_f32 v10, v10, v7, v6
    v_mfma_f32_32x32x16_bf16 v[72:87], v[100:103], v[152:155], v[72:87]
    ds_read_b64_tr_b16 v[96:97], v4 offset:26624
    ds_read_b64_tr_b16 v[98:99], v4 offset:27136
    v_fma_f32 v11, v11, v7, v6
    v_fma_f32 v12, v12, v7, v6
    v_fma_f32 v13, v13, v7, v6
    v_mul_f32 v10, v10, v32
    v_mul_f32 v11, v11, v33
    v_mfma_f32_32x32x16_bf16 v[56:71], v[104:107], v[156:159], v[56:71]
    ds_read_b64_tr_b16 v[100:101], v4 offset:26880
    ds_read_b64_tr_b16 v[102:103], v4 offset:27392
    v_mul_f32 v12, v12, v34
    v_mul_f32 v13, v13, v35
    v_exp_f32 v10, v10
    v_mfma_f32_32x32x16_bf16 v[72:87], v[108:111], v[156:159], v[72:87]
    ds_read_b64_tr_b16 v[104:105], v4 offset:28672
    ds_read_b64_tr_b16 v[106:107], v4 offset:29184
    v_exp_f32 v11, v11
    v_exp_f32 v12, v12
    v_exp_f32 v13, v13
    s_waitcnt lgkmcnt(6)
    v_mfma_f32_32x32x16_bf16 v[56:71], v[88:91], v[160:163], v[56:71]
    s_add_u32 s26, s50, 3
    s_and_b32 s26, s26, 3
    s_lshl_b32 s26, s26, 1
    s_add_u32 s26, s26, s48
    s_lshl_b32 s26, s26, 10
    s_add_u32 s26, s26, s55
    ds_read_b64_tr_b16 v[108:109], v4 offset:28928
    ds_read_b64_tr_b16 v[110:111], v4 offset:29440
    buffer_load_dwordx4 v[18:21], v1, s[8:11], s26 offen offset:0 sc1
    v_fma_f32 v10, v10, v8, v8
    v_fma_f32 v11, v11, v8, v8
    v_fma_f32 v12, v12, v8, v8
    v_fma_f32 v13, v13, v8, v8
    v_mfma_f32_32x32x16_bf16 v[72:87], v[92:95], v[160:163], v[72:87]
    ds_read_b64_tr_b16 v[88:89], v4 offset:30720
    ds_read_b64_tr_b16 v[90:91], v4 offset:31232
    v_rcp_f32 v10, v10
    v_rcp_f32 v11, v11
    s_waitcnt lgkmcnt(6)
    v_mfma_f32_32x32x16_bf16 v[56:71], v[96:99], v[164:167], v[56:71]
    ds_read_b64_tr_b16 v[92:93], v4 offset:30976
    ds_read_b64_tr_b16 v[94:95], v4 offset:31488
    v_rcp_f32 v12, v12
    v_rcp_f32 v13, v13
    v_mul_f32 v10, v10, v32
    v_mfma_f32_32x32x16_bf16 v[72:87], v[100:103], v[164:167], v[72:87]
    ds_read_b64_tr_b16 v[96:97], v4 offset:32768
    ds_read_b64_tr_b16 v[98:99], v4 offset:33280
    v_mul_f32 v11, v11, v33
    v_mul_f32 v12, v12, v34
    v_mul_f32 v13, v13, v35
    v_cvt_pk_bf16_f32 v32, v10, v11
    v_cvt_pk_bf16_f32 v33, v12, v13
    s_waitcnt lgkmcnt(6)
    v_mfma_f32_32x32x16_bf16 v[56:71], v[104:107], v[168:171], v[56:71]
    s_lshl_b32 s52, s49, 6
    s_add_u32 s52, s52, s25
    s_add_u32 s53, s42, s52
    s_add_u32 m0, s29, 0
    ds_read_b64_tr_b16 v[100:101], v4 offset:33024
    ds_read_b64_tr_b16 v[102:103], v4 offset:33536
    buffer_load_dwordx4 v3, s[4:7], s53 offen lds
    v_mul_f32 v10, v36, v36
    v_mul_f32 v11, v37, v37
    v_mul_f32 v12, v38, v38
    v_mul_f32 v13, v39, v39
    v_mfma_f32_32x32x16_bf16 v[72:87], v[108:111], v[168:171], v[72:87]
    ds_read_b64_tr_b16 v[104:105], v4 offset:34816
    ds_read_b64_tr_b16 v[106:107], v4 offset:35328
    v_fma_f32 v10, v10, v7, v6
    v_fma_f32 v11, v11, v7, v6
    v_fma_f32 v12, v12, v7, v6
    v_fma_f32 v13, v13, v7, v6
    v_mul_f32 v10, v10, v36
    s_waitcnt lgkmcnt(6)
    v_mfma_f32_32x32x16_bf16 v[56:71], v[88:91], v[172:175], v[56:71]
    ds_read_b64_tr_b16 v[108:109], v4 offset:35072
    ds_read_b64_tr_b16 v[110:111], v4 offset:35584
    v_mul_f32 v11, v11, v37
    v_mul_f32 v12, v12, v38
    v_mul_f32 v13, v13, v39
    v_exp_f32 v10, v10
    v_mfma_f32_32x32x16_bf16 v[72:87], v[92:95], v[172:175], v[72:87]
    ds_read_b64_tr_b16 v[88:89], v4 offset:36864
    ds_read_b64_tr_b16 v[90:91], v4 offset:37376
    v_exp_f32 v11, v11
    v_exp_f32 v12, v12
    s_waitcnt lgkmcnt(6)
    v_mfma_f32_32x32x16_bf16 v[56:71], v[96:99], v[176:179], v[56:71]
    ds_read_b64_tr_b16 v[92:93], v4 offset:37120
    ds_read_b64_tr_b16 v[94:95], v4 offset:37632
    v_exp_f32 v13, v13
    v_fma_f32 v10, v10, v8, v8
    v_fma_f32 v11, v11, v8, v8
    v_fma_f32 v12, v12, v8, v8
    v_mfma_f32_32x32x16_bf16 v[72:87], v[100:103], v[176:179], v[72:87]
    s_add_u32 s53, s53, 147456
    s_add_u32 m0, s29, 1024
    ds_read_b64_tr_b16 v[96:97], v4 offset:38912
    ds_read_b64_tr_b16 v[98:99], v4 offset:39424
    buffer_load_dwordx4 v3, s[4:7], s53 offen lds
    v_fma_f32 v13, v13, v8, v8
    v_rcp_f32 v10, v10
    v_rcp_f32 v11, v11
    s_waitcnt lgkmcnt(6)
    v_mfma_f32_32x32x16_bf16 v[56:71], v[104:107], v[180:183], v[56:71]
    ds_read_b64_tr_b16 v[100:101], v4 offset:39168
    ds_read_b64_tr_b16 v[102:103], v4 offset:39680
    v_rcp_f32 v12, v12
    v_rcp_f32 v13, v13
    v_mfma_f32_32x32x16_bf16 v[72:87], v[108:111], v[180:183], v[72:87]
    ds_read_b64_tr_b16 v[104:105], v4 offset:40960
    ds_read_b64_tr_b16 v[106:107], v4 offset:41472
    v_mul_f32 v10, v10, v36
    v_mul_f32 v11, v11, v37
    v_mul_f32 v12, v12, v38
    v_mul_f32 v13, v13, v39
    s_waitcnt lgkmcnt(6)
    v_mfma_f32_32x32x16_bf16 v[56:71], v[88:91], v[184:187], v[56:71]
    ds_read_b64_tr_b16 v[108:109], v4 offset:41216
    ds_read_b64_tr_b16 v[110:111], v4 offset:41728
    v_cvt_pk_bf16_f32 v34, v10, v11
    v_cvt_pk_bf16_f32 v35, v12, v13
    buffer_store_dwordx4 v[32:35], v1, s[8:11], s27 offen offset:1024 sc1
    v_mul_f32 v10, v40, v40
    v_mul_f32 v11, v41, v41
    v_mfma_f32_32x32x16_bf16 v[72:87], v[92:95], v[184:187], v[72:87]
    ds_read_b64_tr_b16 v[88:89], v4 offset:43008
    ds_read_b64_tr_b16 v[90:91], v4 offset:43520
    v_mul_f32 v12, v42, v42
    v_mul_f32 v13, v43, v43
    v_fma_f32 v10, v10, v7, v6
    v_fma_f32 v11, v11, v7, v6
    v_fma_f32 v12, v12, v7, v6
    s_waitcnt lgkmcnt(6)
    v_mfma_f32_32x32x16_bf16 v[56:71], v[96:99], v[188:191], v[56:71]
    s_add_u32 s53, s53, 147456
    s_add_u32 m0, s29, 2048
    ds_read_b64_tr_b16 v[92:93], v4 offset:43264
    ds_read_b64_tr_b16 v[94:95], v4 offset:43776
    buffer_load_dwordx4 v3, s[4:7], s53 offen lds
    v_fma_f32 v13, v13, v7, v6
    v_mul_f32 v10, v10, v40
    v_mul_f32 v11, v11, v41
    v_mul_f32 v12, v12, v42
    v_mfma_f32_32x32x16_bf16 v[72:87], v[100:103], v[188:191], v[72:87]
    ds_read_b64_tr_b16 v[96:97], v4 offset:45056
    ds_read_b64_tr_b16 v[98:99], v4 offset:45568
    v_mul_f32 v13, v13, v43
    v_exp_f32 v10, v10
    v_exp_f32 v11, v11
    s_waitcnt lgkmcnt(6)
    v_mfma_f32_32x32x16_bf16 v[56:71], v[104:107], v[192:195], v[56:71]
    s_waitcnt vmcnt(4)
    v_mfma_f32_32x32x16_bf16 v[56:71], v[18:21], v[14:17], v[56:71]
    ds_read_b64_tr_b16 v[100:101], v4 offset:45312
    ds_read_b64_tr_b16 v[102:103], v4 offset:45824
    v_exp_f32 v12, v12
    v_exp_f32 v13, v13
    v_fma_f32 v10, v10, v8, v8
    v_mfma_f32_32x32x16_bf16 v[72:87], v[108:111], v[192:195], v[72:87]
    ds_read_b64_tr_b16 v[104:105], v4 offset:47104
    ds_read_b64_tr_b16 v[106:107], v4 offset:47616
    v_fma_f32 v11, v11, v8, v8
    v_fma_f32 v12, v12, v8, v8
    v_fma_f32 v13, v13, v8, v8
    v_rcp_f32 v10, v10
    s_waitcnt lgkmcnt(6)
    v_mfma_f32_32x32x16_bf16 v[56:71], v[88:91], v[196:199], v[56:71]
    ds_read_b64_tr_b16 v[108:109], v4 offset:47360
    ds_read_b64_tr_b16 v[110:111], v4 offset:47872
    v_rcp_f32 v11, v11
    v_rcp_f32 v12, v12
    v_mfma_f32_32x32x16_bf16 v[72:87], v[92:95], v[196:199], v[72:87]
    v_rcp_f32 v13, v13
    v_mul_f32 v10, v10, v40
    v_mul_f32 v11, v11, v41
    s_waitcnt lgkmcnt(4)
    v_mfma_f32_32x32x16_bf16 v[56:71], v[96:99], v[200:203], v[56:71]
    s_waitcnt vmcnt(6) lgkmcnt(0)
    s_barrier
    ds_read_b64_tr_b16 v[88:89], v5 offset:0
    ds_read_b64_tr_b16 v[90:91], v5 offset:512
    ds_read_b64_tr_b16 v[92:93], v5 offset:256
    ds_read_b64_tr_b16 v[94:95], v5 offset:768
    v_mul_f32 v12, v12, v42
    v_mul_f32 v13, v13, v43
    v_cvt_pk_bf16_f32 v40, v10, v11
    v_cvt_pk_bf16_f32 v41, v12, v13
    v_mul_f32 v10, v44, v44
    v_mfma_f32_32x32x16_bf16 v[72:87], v[100:103], v[200:203], v[72:87]
    ds_read_b64_tr_b16 v[96:97], v5 offset:2048
    ds_read_b64_tr_b16 v[98:99], v5 offset:2560
    v_mul_f32 v11, v45, v45
    v_mul_f32 v12, v46, v46
    v_mul_f32 v13, v47, v47
    v_fma_f32 v10, v10, v7, v6
    v_fma_f32 v11, v11, v7, v6
    v_mfma_f32_32x32x16_bf16 v[56:71], v[104:107], v[204:207], v[56:71]
    ds_read_b64_tr_b16 v[100:101], v5 offset:2304
    ds_read_b64_tr_b16 v[102:103], v5 offset:2816
    v_fma_f32 v12, v12, v7, v6
    v_fma_f32 v13, v13, v7, v6
    v_mul_f32 v10, v10, v44
    v_mul_f32 v11, v11, v45
    v_mfma_f32_32x32x16_bf16 v[72:87], v[108:111], v[204:207], v[72:87]
    ds_read_b64_tr_b16 v[104:105], v5 offset:4096
    ds_read_b64_tr_b16 v[106:107], v5 offset:4608
    v_mul_f32 v12, v12, v46
    v_mul_f32 v13, v13, v47
    v_exp_f32 v10, v10
    v_exp_f32 v11, v11
    s_waitcnt lgkmcnt(6)
    v_mfma_f32_32x32x16_bf16 v[56:71], v[88:91], v[208:211], v[56:71]
    s_add_u32 s26, s50, 3
    s_and_b32 s26, s26, 3
    s_lshl_b32 s26, s26, 1
    s_add_u32 s26, s26, s48
    s_lshl_b32 s26, s26, 10
    s_add_u32 s26, s26, s55
    ds_read_b64_tr_b16 v[108:109], v5 offset:4352
    ds_read_b64_tr_b16 v[110:111], v5 offset:4864
    buffer_load_dwordx4 v[18:21], v1, s[8:11], s26 offen offset:1024 sc1
    v_exp_f32 v12, v12
    v_exp_f32 v13, v13
    v_mfma_f32_32x32x16_bf16 v[72:87], v[92:95], v[208:211], v[72:87]
    ds_read_b64_tr_b16 v[88:89], v5 offset:6144
    ds_read_b64_tr_b16 v[90:91], v5 offset:6656
    v_fma_f32 v10, v10, v8, v8
    v_fma_f32 v11, v11, v8, v8
    v_fma_f32 v12, v12, v8, v8
    v_fma_f32 v13, v13, v8, v8
    s_waitcnt lgkmcnt(6)
    v_mfma_f32_32x32x16_bf16 v[56:71], v[96:99], v[212:215], v[56:71]
    ds_read_b64_tr_b16 v[92:93], v5 offset:6400
    ds_read_b64_tr_b16 v[94:95], v5 offset:6912
    v_rcp_f32 v10, v10
    v_rcp_f32 v11, v11
    v_rcp_f32 v12, v12
    v_mfma_f32_32x32x16_bf16 v[72:87], v[100:103], v[212:215], v[72:87]
    ds_read_b64_tr_b16 v[96:97], v5 offset:8192
    ds_read_b64_tr_b16 v[98:99], v5 offset:8704
    v_rcp_f32 v13, v13
    v_mul_f32 v10, v10, v44
    s_waitcnt lgkmcnt(6)
    v_mfma_f32_32x32x16_bf16 v[56:71], v[104:107], v[216:219], v[56:71]
    s_add_u32 s53, s43, s52
    s_add_u32 m0, s29, 24576
    ds_read_b64_tr_b16 v[100:101], v5 offset:8448
    ds_read_b64_tr_b16 v[102:103], v5 offset:8960
    buffer_load_dwordx4 v3, s[4:7], s53 offen lds
    v_mul_f32 v11, v11, v45
    v_mul_f32 v12, v12, v46
    v_mul_f32 v13, v13, v47
    v_cvt_pk_bf16_f32 v42, v10, v11
    v_cvt_pk_bf16_f32 v43, v12, v13
    v_mfma_f32_32x32x16_bf16 v[72:87], v[108:111], v[216:219], v[72:87]
    ds_read_b64_tr_b16 v[104:105], v5 offset:10240
    ds_read_b64_tr_b16 v[106:107], v5 offset:10752
    buffer_store_dwordx4 v[40:43], v1, s[8:11], s27 offen offset:2048 sc1
    v_mul_f32 v10, v48, v48
    v_mul_f32 v11, v49, v49
    v_mul_f32 v12, v50, v50
    v_mul_f32 v13, v51, v51
    s_waitcnt lgkmcnt(6)
    v_mfma_f32_32x32x16_bf16 v[56:71], v[88:91], v[220:223], v[56:71]
    ds_read_b64_tr_b16 v[108:109], v5 offset:10496
    ds_read_b64_tr_b16 v[110:111], v5 offset:11008
    v_fma_f32 v10, v10, v7, v6
    v_fma_f32 v11, v11, v7, v6
    v_fma_f32 v12, v12, v7, v6
    v_fma_f32 v13, v13, v7, v6
    v_mfma_f32_32x32x16_bf16 v[72:87], v[92:95], v[220:223], v[72:87]
    ds_read_b64_tr_b16 v[88:89], v5 offset:12288
    ds_read_b64_tr_b16 v[90:91], v5 offset:12800
    v_mul_f32 v10, v10, v48
    v_mul_f32 v11, v11, v49
    v_mul_f32 v12, v12, v50
    v_mul_f32 v13, v13, v51
    v_exp_f32 v10, v10
    s_waitcnt lgkmcnt(6)
    v_mfma_f32_32x32x16_bf16 v[56:71], v[96:99], v[224:227], v[56:71]
    ds_read_b64_tr_b16 v[92:93], v5 offset:12544
    ds_read_b64_tr_b16 v[94:95], v5 offset:13056
    v_exp_f32 v11, v11
    v_exp_f32 v12, v12
    v_mfma_f32_32x32x16_bf16 v[72:87], v[100:103], v[224:227], v[72:87]
    s_add_u32 s53, s53, 147456
    s_add_u32 m0, s29, 25600
    ds_read_b64_tr_b16 v[96:97], v5 offset:14336
    ds_read_b64_tr_b16 v[98:99], v5 offset:14848
    buffer_load_dwordx4 v3, s[4:7], s53 offen lds
    v_exp_f32 v13, v13
    v_fma_f32 v10, v10, v8, v8
    v_fma_f32 v11, v11, v8, v8
    s_waitcnt lgkmcnt(6)
    v_mfma_f32_32x32x16_bf16 v[56:71], v[104:107], v[228:231], v[56:71]
    ds_read_b64_tr_b16 v[100:101], v5 offset:14592
    ds_read_b64_tr_b16 v[102:103], v5 offset:15104
    v_fma_f32 v12, v12, v8, v8
    v_fma_f32 v13, v13, v8, v8
    v_rcp_f32 v10, v10
    v_rcp_f32 v11, v11
    v_mfma_f32_32x32x16_bf16 v[72:87], v[108:111], v[228:231], v[72:87]
    ds_read_b64_tr_b16 v[104:105], v5 offset:16384
    ds_read_b64_tr_b16 v[106:107], v5 offset:16896
    v_rcp_f32 v12, v12
    v_rcp_f32 v13, v13
    s_waitcnt lgkmcnt(6)
    v_mfma_f32_32x32x16_bf16 v[56:71], v[88:91], v[232:235], v[56:71]
    ds_read_b64_tr_b16 v[108:109], v5 offset:16640
    ds_read_b64_tr_b16 v[110:111], v5 offset:17152
    v_mul_f32 v10, v10, v48
    v_mul_f32 v11, v11, v49
    v_mul_f32 v12, v12, v50
    v_mul_f32 v13, v13, v51
    v_mfma_f32_32x32x16_bf16 v[72:87], v[92:95], v[232:235], v[72:87]
    ds_read_b64_tr_b16 v[88:89], v5 offset:18432
    ds_read_b64_tr_b16 v[90:91], v5 offset:18944
    v_cvt_pk_bf16_f32 v48, v10, v11
    v_cvt_pk_bf16_f32 v49, v12, v13
    v_mul_f32 v10, v52, v52
    v_mul_f32 v11, v53, v53
    v_mul_f32 v12, v54, v54
    s_waitcnt lgkmcnt(6)
    v_mfma_f32_32x32x16_bf16 v[56:71], v[96:99], v[236:239], v[56:71]
    s_add_u32 s53, s53, 147456
    s_add_u32 m0, s29, 26624
    ds_read_b64_tr_b16 v[92:93], v5 offset:18688
    ds_read_b64_tr_b16 v[94:95], v5 offset:19200
    buffer_load_dwordx4 v3, s[4:7], s53 offen lds
    v_mul_f32 v13, v55, v55
    v_fma_f32 v10, v10, v7, v6
    v_fma_f32 v11, v11, v7, v6
    v_fma_f32 v12, v12, v7, v6
    v_mfma_f32_32x32x16_bf16 v[72:87], v[100:103], v[236:239], v[72:87]
    ds_read_b64_tr_b16 v[96:97], v5 offset:20480
    ds_read_b64_tr_b16 v[98:99], v5 offset:20992
    v_fma_f32 v13, v13, v7, v6
    v_mul_f32 v10, v10, v52
    v_mul_f32 v11, v11, v53
    v_mul_f32 v12, v12, v54
    v_mul_f32 v13, v13, v55
    s_waitcnt lgkmcnt(6)
    v_mfma_f32_32x32x16_bf16 v[56:71], v[104:107], v[240:243], v[56:71]
    ds_read_b64_tr_b16 v[100:101], v5 offset:20736
    ds_read_b64_tr_b16 v[102:103], v5 offset:21248
    v_exp_f32 v10, v10
    v_exp_f32 v11, v11
    v_mfma_f32_32x32x16_bf16 v[72:87], v[108:111], v[240:243], v[72:87]
    s_waitcnt vmcnt(4)
    v_mfma_f32_32x32x16_bf16 v[72:87], v[18:21], v[14:17], v[72:87]
    ds_read_b64_tr_b16 v[104:105], v5 offset:22528
    ds_read_b64_tr_b16 v[106:107], v5 offset:23040
    v_exp_f32 v12, v12
    v_exp_f32 v13, v13
    v_fma_f32 v10, v10, v8, v8
    s_waitcnt lgkmcnt(6)
    v_mfma_f32_32x32x16_bf16 v[56:71], v[88:91], v[244:247], v[56:71]
    ds_read_b64_tr_b16 v[108:109], v5 offset:22784
    ds_read_b64_tr_b16 v[110:111], v5 offset:23296
    v_fma_f32 v11, v11, v8, v8
    v_fma_f32 v12, v12, v8, v8
    v_fma_f32 v13, v13, v8, v8
    v_rcp_f32 v10, v10
    v_mfma_f32_32x32x16_bf16 v[72:87], v[92:95], v[244:247], v[72:87]
    v_rcp_f32 v11, v11
    v_rcp_f32 v12, v12
    s_waitcnt lgkmcnt(4)
    v_mfma_f32_32x32x16_bf16 v[56:71], v[96:99], v[248:251], v[56:71]
    s_waitcnt vmcnt(5) lgkmcnt(0)
    s_barrier
    v_and_b32 v2, 0x200, v1
    v_sub_u32 v4, v4, v2
    v_sub_u32 v5, v5, v2
    ds_read_b64_tr_b16 v[88:89], v4 offset:0
    ds_read_b64_tr_b16 v[90:91], v4 offset:256
    ds_read_b64_tr_b16 v[92:93], v4 offset:1024
    ds_read_b64_tr_b16 v[94:95], v4 offset:1280
    v_rcp_f32 v13, v13
    v_mul_f32 v10, v10, v52
    v_mul_f32 v11, v11, v53
    v_mul_f32 v12, v12, v54
    v_mfma_f32_32x32x16_bf16 v[72:87], v[100:103], v[248:251], v[72:87]
    ds_read_b64_tr_b16 v[96:97], v4 offset:2048
    ds_read_b64_tr_b16 v[98:99], v4 offset:2304
    v_mul_f32 v13, v13, v55
    v_cvt_pk_bf16_f32 v50, v10, v11
    v_cvt_pk_bf16_f32 v51, v12, v13
    buffer_store_dwordx4 v[48:51], v1, s[8:11], s27 offen offset:3072 sc1
    v_mfma_f32_32x32x16_bf16 v[56:71], v[104:107], v[252:255], v[56:71]
    ds_read_b64_tr_b16 v[100:101], v4 offset:3072
    ds_read_b64_tr_b16 v[102:103], v4 offset:3328
    v_mfma_f32_32x32x16_bf16 v[72:87], v[108:111], v[252:255], v[72:87]
    ds_read_b64_tr_b16 v[104:105], v4 offset:4096
    ds_read_b64_tr_b16 v[106:107], v4 offset:4352
    s_waitcnt lgkmcnt(6)
    v_mfma_f32_32x32x16_bf16 v[24:39], v[88:91], v[112:115], 0
    s_add_u32 s53, s44, s52
    s_add_u32 m0, s29, 49152
    ds_read_b64_tr_b16 v[108:109], v4 offset:5120
    ds_read_b64_tr_b16 v[110:111], v4 offset:5376
    buffer_load_dwordx4 v3, s[4:7], s53 offen lds
    v_mfma_f32_32x32x16_bf16 v[24:39], v[92:95], v[116:119], v[24:39]
    ds_read_b64_tr_b16 v[88:89], v4 offset:6144
    ds_read_b64_tr_b16 v[90:91], v4 offset:6400
    s_waitcnt lgkmcnt(6)
    v_mfma_f32_32x32x16_bf16 v[24:39], v[96:99], v[120:123], v[24:39]
    s_add_u32 s53, s53, 147456
    s_add_u32 m0, s29, 50176
    ds_read_b64_tr_b16 v[92:93], v4 offset:7168
    ds_read_b64_tr_b16 v[94:95], v4 offset:7424
    buffer_load_dwordx4 v3, s[4:7], s53 offen lds
    s_add_u32 s27, s50, 3
    s_and_b32 s27, s27, 3
    s_lshl_b32 s27, s27, 1
    s_add_u32 s27, s27, s48
    s_lshl_b32 s27, s27, 11
    s_add_u32 s27, s27, s54
    v_mul_f32 v10, v56, v56
    v_mul_f32 v11, v57, v57
    v_mul_f32 v12, v58, v58
    v_mul_f32 v13, v59, v59
    v_mfma_f32_32x32x16_bf16 v[24:39], v[100:103], v[124:127], v[24:39]
    ds_read_b64_tr_b16 v[96:97], v4 offset:8192
    ds_read_b64_tr_b16 v[98:99], v4 offset:8448
    v_fma_f32 v10, v10, v7, v6
    v_fma_f32 v11, v11, v7, v6
    v_fma_f32 v12, v12, v7, v6
    v_fma_f32 v13, v13, v7, v6
    v_mul_f32 v10, v10, v56
    v_mul_f32 v11, v11, v57
    v_mul_f32 v12, v12, v58
    v_mul_f32 v13, v13, v59
    v_exp_f32 v10, v10
    s_waitcnt lgkmcnt(6)
    v_mfma_f32_32x32x16_bf16 v[24:39], v[104:107], v[128:131], v[24:39]
    s_add_u32 s53, s53, 147456
    s_add_u32 m0, s29, 51200
    ds_read_b64_tr_b16 v[100:101], v4 offset:9216
    ds_read_b64_tr_b16 v[102:103], v4 offset:9472
    buffer_load_dwordx4 v3, s[4:7], s53 offen lds
    v_exp_f32 v11, v11
    v_exp_f32 v12, v12
    v_exp_f32 v13, v13
    v_fma_f32 v10, v10, v8, v8
    v_fma_f32 v11, v11, v8, v8
    v_fma_f32 v12, v12, v8, v8
    v_fma_f32 v13, v13, v8, v8
    v_mfma_f32_32x32x16_bf16 v[24:39], v[108:111], v[132:135], v[24:39]
    ds_read_b64_tr_b16 v[104:105], v4 offset:10240
    ds_read_b64_tr_b16 v[106:107], v4 offset:10496
    v_rcp_f32 v10, v10
    v_rcp_f32 v11, v11
    v_rcp_f32 v12, v12
    v_rcp_f32 v13, v13
    v_mul_f32 v10, v10, v56
    v_mul_f32 v11, v11, v57
    s_waitcnt lgkmcnt(6)
    v_mfma_f32_32x32x16_bf16 v[24:39], v[88:91], v[136:139], v[24:39]
    ds_read_b64_tr_b16 v[108:109], v4 offset:11264
    ds_read_b64_tr_b16 v[110:111], v4 offset:11520
    v_mul_f32 v12, v12, v58
    v_mul_f32 v13, v13, v59
    v_cvt_pk_bf16_f32 v56, v10, v11
    v_cvt_pk_bf16_f32 v57, v12, v13
    v_mul_f32 v10, v60, v60
    v_mul_f32 v11, v61, v61
    v_mul_f32 v12, v62, v62
    v_mul_f32 v13, v63, v63
    v_fma_f32 v10, v10, v7, v6
    v_fma_f32 v11, v11, v7, v6
    v_mfma_f32_32x32x16_bf16 v[24:39], v[92:95], v[140:143], v[24:39]
    v_fma_f32 v12, v12, v7, v6
    v_fma_f32 v13, v13, v7, v6
    v_mul_f32 v10, v10, v60
    v_mul_f32 v11, v11, v61
    v_mul_f32 v12, v12, v62
    v_mul_f32 v13, v13, v63
    v_exp_f32 v10, v10
    v_exp_f32 v11, v11
    s_waitcnt lgkmcnt(4)
    v_mfma_f32_32x32x16_bf16 v[24:39], v[96:99], v[144:147], v[24:39]
    s_waitcnt vmcnt(4) lgkmcnt(0)
    s_barrier
    ds_read_b64_tr_b16 v[88:89], v4 offset:24576
    ds_read_b64_tr_b16 v[90:91], v4 offset:24832
    ds_read_b64_tr_b16 v[92:93], v4 offset:25600
    ds_read_b64_tr_b16 v[94:95], v4 offset:25856
    v_exp_f32 v12, v12
    v_exp_f32 v13, v13
    v_fma_f32 v10, v10, v8, v8
    v_fma_f32 v11, v11, v8, v8
    v_fma_f32 v12, v12, v8, v8
    v_fma_f32 v13, v13, v8, v8
    v_rcp_f32 v10, v10
    v_mfma_f32_32x32x16_bf16 v[24:39], v[100:103], v[148:151], v[24:39]
    ds_read_b64_tr_b16 v[96:97], v4 offset:26624
    ds_read_b64_tr_b16 v[98:99], v4 offset:26880
    v_rcp_f32 v11, v11
    v_rcp_f32 v12, v12
    v_rcp_f32 v13, v13
    v_mul_f32 v10, v10, v60
    v_mul_f32 v11, v11, v61
    v_mul_f32 v12, v12, v62
    v_mfma_f32_32x32x16_bf16 v[24:39], v[104:107], v[152:155], v[24:39]
    ds_read_b64_tr_b16 v[100:101], v4 offset:27648
    ds_read_b64_tr_b16 v[102:103], v4 offset:27904
    v_mul_f32 v13, v13, v63
    v_cvt_pk_bf16_f32 v58, v10, v11
    v_cvt_pk_bf16_f32 v59, v12, v13
    buffer_store_dwordx4 v[56:59], v1, s[8:11], s27 offen offset:0 sc1
    v_mul_f32 v10, v64, v64
    v_mul_f32 v11, v65, v65
    v_mul_f32 v12, v66, v66
    v_mul_f32 v13, v67, v67
    v_fma_f32 v10, v10, v7, v6
    v_fma_f32 v11, v11, v7, v6
    v_mfma_f32_32x32x16_bf16 v[24:39], v[108:111], v[156:159], v[24:39]
    ds_read_b64_tr_b16 v[104:105], v4 offset:28672
    ds_read_b64_tr_b16 v[106:107], v4 offset:28928
    v_fma_f32 v12, v12, v7, v6
    v_fma_f32 v13, v13, v7, v6
    v_mul_f32 v10, v10, v64
    v_mul_f32 v11, v11, v65
    v_mul_f32 v12, v12, v66
    v_mul_f32 v13, v13, v67
    v_exp_f32 v10, v10
    v_exp_f32 v11, v11
    s_waitcnt lgkmcnt(6)
    v_mfma_f32_32x32x16_bf16 v[24:39], v[88:91], v[160:163], v[24:39]
    s_mov_b32 s26, s49
    s_lshl_b32 s26, s26, 10
    s_add_u32 s26, s26, s55
    ds_read_b64_tr_b16 v[108:109], v4 offset:29696
    ds_read_b64_tr_b16 v[110:111], v4 offset:29952
    buffer_load_dwordx4 v[18:21], v1, s[8:11], s26 offen offset:0 sc1
    v_exp_f32 v12, v12
    v_exp_f32 v13, v13
    v_fma_f32 v10, v10, v8, v8
    v_fma_f32 v11, v11, v8, v8
    v_fma_f32 v12, v12, v8, v8
    v_fma_f32 v13, v13, v8, v8
    v_rcp_f32 v10, v10
    v_mfma_f32_32x32x16_bf16 v[24:39], v[92:95], v[164:167], v[24:39]
    ds_read_b64_tr_b16 v[88:89], v4 offset:30720
    ds_read_b64_tr_b16 v[90:91], v4 offset:30976
    v_rcp_f32 v11, v11
    v_rcp_f32 v12, v12
    v_rcp_f32 v13, v13
    v_mul_f32 v10, v10, v64
    v_mul_f32 v11, v11, v65
    v_mul_f32 v12, v12, v66
    s_waitcnt lgkmcnt(6)
    v_mfma_f32_32x32x16_bf16 v[24:39], v[96:99], v[168:171], v[24:39]
    ds_read_b64_tr_b16 v[92:93], v4 offset:31744
    ds_read_b64_tr_b16 v[94:95], v4 offset:32000
    v_mul_f32 v13, v13, v67
    v_cvt_pk_bf16_f32 v64, v10, v11
    v_cvt_pk_bf16_f32 v65, v12, v13
    v_mul_f32 v10, v68, v68
    v_mul_f32 v11, v69, v69
    v_mul_f32 v12, v70, v70
    v_mul_f32 v13, v71, v71
    v_fma_f32 v10, v10, v7, v6
    v_fma_f32 v11, v11, v7, v6
    v_fma_f32 v12, v12, v7, v6
    v_mfma_f32_32x32x16_bf16 v[24:39], v[100:103], v[172:175], v[24:39]
    ds_read_b64_tr_b16 v[96:97], v4 offset:32768
    ds_read_b64_tr_b16 v[98:99], v4 offset:33024
    v_fma_f32 v13, v13, v7, v6
    v_mul_f32 v10, v10, v68
    v_mul_f32 v11, v11, v69
    v_mul_f32 v12, v12, v70
    v_mul_f32 v13, v13, v71
    v_exp_f32 v10, v10
    v_exp_f32 v11, v11
    v_exp_f32 v12, v12
    s_waitcnt lgkmcnt(6)
    v_mfma_f32_32x32x16_bf16 v[24:39], v[104:107], v[176:179], v[24:39]
    ds_read_b64_tr_b16 v[100:101], v4 offset:33792
    ds_read_b64_tr_b16 v[102:103], v4 offset:34048
    v_exp_f32 v13, v13
    v_fma_f32 v10, v10, v8, v8
    v_fma_f32 v11, v11, v8, v8
    v_fma_f32 v12, v12, v8, v8
    v_fma_f32 v13, v13, v8, v8
    v_rcp_f32 v10, v10
    v_rcp_f32 v11, v11
    v_mfma_f32_32x32x16_bf16 v[24:39], v[108:111], v[180:183], v[24:39]
    ds_read_b64_tr_b16 v[104:105], v4 offset:34816
    ds_read_b64_tr_b16 v[106:107], v4 offset:35072
    v_rcp_f32 v12, v12
    v_rcp_f32 v13, v13
    v_mul_f32 v10, v10, v68
    v_mul_f32 v11, v11, v69
    v_mul_f32 v12, v12, v70
    v_mul_f32 v13, v13, v71
    s_waitcnt lgkmcnt(6)
    v_mfma_f32_32x32x16_bf16 v[24:39], v[88:91], v[184:187], v[24:39]
    ds_read_b64_tr_b16 v[108:109], v4 offset:35840
    ds_read_b64_tr_b16 v[110:111], v4 offset:36096
    v_cvt_pk_bf16_f32 v66, v10, v11
    v_cvt_pk_bf16_f32 v67, v12, v13
    buffer_store_dwordx4 v[64:67], v1, s[8:11], s27 offen offset:1024 sc1
    v_mul_f32 v10, v72, v72
    v_mul_f32 v11, v73, v73
    v_mul_f32 v12, v74, v74
    v_mul_f32 v13, v75, v75
    v_fma_f32 v10, v10, v7, v6
    v_fma_f32 v11, v11, v7, v6
    v_fma_f32 v12, v12, v7, v6
    v_mfma_f32_32x32x16_bf16 v[24:39], v[92:95], v[188:191], v[24:39]
    v_fma_f32 v13, v13, v7, v6
    v_mul_f32 v10, v10, v72
    v_mul_f32 v11, v11, v73
    v_mul_f32 v12, v12, v74
    v_mul_f32 v13, v13, v75
    v_exp_f32 v10, v10
    v_exp_f32 v11, v11
    v_exp_f32 v12, v12
    s_waitcnt lgkmcnt(4)
    v_mfma_f32_32x32x16_bf16 v[24:39], v[96:99], v[192:195], v[24:39]
    s_waitcnt vmcnt(1)
    v_mfma_f32_32x32x16_bf16 v[24:39], v[18:21], v[14:17], v[24:39]
    s_waitcnt vmcnt(3) lgkmcnt(0)
    s_barrier
    ds_read_b64_tr_b16 v[88:89], v5 offset:0
    ds_read_b64_tr_b16 v[90:91], v5 offset:256
    ds_read_b64_tr_b16 v[92:93], v5 offset:1024
    ds_read_b64_tr_b16 v[94:95], v5 offset:1280
    v_exp_f32 v13, v13
    v_fma_f32 v10, v10, v8, v8
    v_fma_f32 v11, v11, v8, v8
    v_fma_f32 v12, v12, v8, v8
    v_fma_f32 v13, v13, v8, v8
    v_rcp_f32 v10, v10
    v_rcp_f32 v11, v11
    v_mfma_f32_32x32x16_bf16 v[24:39], v[100:103], v[196:199], v[24:39]
    ds_read_b64_tr_b16 v[96:97], v5 offset:2048
    ds_read_b64_tr_b16 v[98:99], v5 offset:2304
    v_rcp_f32 v12, v12
    v_rcp_f32 v13, v13
    v_mul_f32 v10, v10, v72
    v_mul_f32 v11, v11, v73
    v_mul_f32 v12, v12, v74
    v_mul_f32 v13, v13, v75
    v_cvt_pk_bf16_f32 v72, v10, v11
    v_mfma_f32_32x32x16_bf16 v[24:39], v[104:107], v[200:203], v[24:39]
    ds_read_b64_tr_b16 v[100:101], v5 offset:3072
    ds_read_b64_tr_b16 v[102:103], v5 offset:3328
    v_cvt_pk_bf16_f32 v73, v12, v13
    v_mul_f32 v10, v76, v76
    v_mul_f32 v11, v77, v77
    v_mul_f32 v12, v78, v78
    v_mul_f32 v13, v79, v79
    v_fma_f32 v10, v10, v7, v6
    v_fma_f32 v11, v11, v7, v6
    v_fma_f32 v12, v12, v7, v6
    v_fma_f32 v13, v13, v7, v6
    v_mul_f32 v10, v10, v76
    v_mfma_f32_32x32x16_bf16 v[24:39], v[108:111], v[204:207], v[24:39]
    ds_read_b64_tr_b16 v[104:105], v5 offset:4096
    ds_read_b64_tr_b16 v[106:107], v5 offset:4352
    v_mul_f32 v11, v11, v77
    v_mul_f32 v12, v12, v78
    v_mul_f32 v13, v13, v79
    v_exp_f32 v10, v10
    v_exp_f32 v11, v11
    v_exp_f32 v12, v12
    s_mov_b32 s4, s74
    s_and_b32 s5, s75, 0xffff
    s_mov_b32 s6, 0x00510000
    s_mov_b32 s7, 0x00020000
    s_lshr_b32 s19, s17, 2
    s_and_b32 s50, s17, 3
    s_mul_i32 s21, s50, 9
    s_add_u32 s21, s21, 1
    s_lshr_b32 s21, s21, 1
    s_mul_i32 s26, s50, 288
    s_mul_i32 s25, s19, 1327104
    s_add_u32 s25, s25, s26
    s_mul_i32 s24, s20, 288
    s_mul_i32 s26, s19, 72
    s_add_u32 s24, s24, s26
    s_lshl_b32 s24, s24, 10
    s_add_u32 s24, s24, 16777216
    v_and_b32 v124, 63, v0
    v_and_b32 v126, 3, v0
    s_mov_b32 s35, s21
    s_mul_i32 s28, s18, 5120
    v_lshlrev_b32 v112, 4, v124
    v_lshrrev_b32 v125, 2, v0
    v_mul_u32_u24 v125, 1152, v125
    v_lshl_add_u32 v113, v126, 4, v125
    v_cmp_gt_u32 vcc, 2, v126
    v_mov_b32 v125, 0x80000000
    s_nop 0
    v_cndmask_b32 v114, v125, v113, vcc
    v_bfe_u32 v125, v124, 2, 2
    v_lshlrev_b32 v120, 6, v125
    v_bfe_u32 v125, v124, 4, 1
    v_lshl_add_u32 v120, v125, 5, v120
    v_and_b32 v125, 1, v124
    v_lshl_add_u32 v120, v125, 4, v120
    v_bfe_u32 v125, v124, 1, 1
    v_lshl_add_u32 v120, v125, 3, v120
    v_lshrrev_b32 v125, 5, v124
    v_mul_u32_u24 v125, 512, v125
    v_add_u32 v120, v120, v125
    v_add_u32 v121, 40960, v120
    s_waitcnt lgkmcnt(6)
    v_mfma_f32_32x32x16_bf16 v[24:39], v[88:91], v[208:211], v[24:39]
    s_mul_i32 s22, s21, 73728
    s_add_u32 s22, s22, s25
    s_add_u32 s21, s21, 1
    s_cmp_eq_u32 s21, 18
    s_cselect_b32 s21, 0, s21
    s_add_u32 m0, s28, 0
    ds_read_b64_tr_b16 v[108:109], v5 offset:5120
    ds_read_b64_tr_b16 v[110:111], v5 offset:5376
    buffer_load_dwordx4 v113, s[4:7], s22 offen offset:0 lds
    v_exp_f32 v13, v13
    v_fma_f32 v10, v10, v8, v8
    v_fma_f32 v11, v11, v8, v8
    v_fma_f32 v12, v12, v8, v8
    v_fma_f32 v13, v13, v8, v8
    v_rcp_f32 v10, v10
    v_rcp_f32 v11, v11
    v_mfma_f32_32x32x16_bf16 v[24:39], v[92:95], v[212:215], v[24:39]
    s_add_u32 m0, s28, 960
    ds_read_b64_tr_b16 v[88:89], v5 offset:6144
    ds_read_b64_tr_b16 v[90:91], v5 offset:6400
    buffer_load_dwordx4 v113, s[4:7], s22 offen offset:64 lds
    v_rcp_f32 v12, v12
    v_rcp_f32 v13, v13
    v_mul_f32 v10, v10, v76
    v_mul_f32 v11, v11, v77
    v_mul_f32 v12, v12, v78
    v_mul_f32 v13, v13, v79
    v_cvt_pk_bf16_f32 v74, v10, v11
    v_cvt_pk_bf16_f32 v75, v12, v13
    s_waitcnt lgkmcnt(6)
    v_mfma_f32_32x32x16_bf16 v[24:39], v[96:99], v[216:219], v[24:39]
    s_add_u32 m0, s28, 1920
    ds_read_b64_tr_b16 v[92:93], v5 offset:7168
    ds_read_b64_tr_b16 v[94:95], v5 offset:7424
    buffer_load_dwordx4 v113, s[4:7], s22 offen offset:128 lds
    buffer_store_dwordx4 v[72:75], v1, s[8:11], s27 offen offset:2048 sc1
    v_mul_f32 v10, v80, v80
    v_mul_f32 v11, v81, v81
    v_mul_f32 v12, v82, v82
    v_mul_f32 v13, v83, v83
    v_fma_f32 v10, v10, v7, v6
    v_fma_f32 v11, v11, v7, v6
    v_fma_f32 v12, v12, v7, v6
    v_fma_f32 v13, v13, v7, v6
    v_mul_f32 v10, v10, v80
    v_mfma_f32_32x32x16_bf16 v[24:39], v[100:103], v[220:223], v[24:39]
    s_add_u32 m0, s28, 2880
    ds_read_b64_tr_b16 v[96:97], v5 offset:8192
    ds_read_b64_tr_b16 v[98:99], v5 offset:8448
    buffer_load_dwordx4 v113, s[4:7], s22 offen offset:192 lds
    v_mul_f32 v11, v11, v81
    v_mul_f32 v12, v12, v82
    v_mul_f32 v13, v13, v83
    v_exp_f32 v10, v10
    v_exp_f32 v11, v11
    v_exp_f32 v12, v12
    v_exp_f32 v13, v13
    s_waitcnt lgkmcnt(6)
    v_mfma_f32_32x32x16_bf16 v[24:39], v[104:107], v[224:227], v[24:39]
    s_add_u32 m0, s28, 3840
    ds_read_b64_tr_b16 v[100:101], v5 offset:9216
    ds_read_b64_tr_b16 v[102:103], v5 offset:9472
    buffer_load_dwordx4 v114, s[4:7], s22 offen offset:256 lds
    v_fma_f32 v10, v10, v8, v8
    v_fma_f32 v11, v11, v8, v8
    v_fma_f32 v12, v12, v8, v8
    v_fma_f32 v13, v13, v8, v8
    v_rcp_f32 v10, v10
    v_rcp_f32 v11, v11
    v_mfma_f32_32x32x16_bf16 v[24:39], v[108:111], v[228:231], v[24:39]
    s_mul_i32 s22, s21, 73728
    s_add_u32 s22, s22, s25
    s_add_u32 s21, s21, 1
    s_cmp_eq_u32 s21, 18
    s_cselect_b32 s21, 0, s21
    s_add_u32 m0, s28, 20480
    ds_read_b64_tr_b16 v[104:105], v5 offset:10240
    ds_read_b64_tr_b16 v[106:107], v5 offset:10496
    buffer_load_dwordx4 v113, s[4:7], s22 offen offset:0 lds
    v_rcp_f32 v12, v12
    v_rcp_f32 v13, v13
    v_mul_f32 v10, v10, v80
    v_mul_f32 v11, v11, v81
    v_mul_f32 v12, v12, v82
    v_mul_f32 v13, v13, v83
    v_cvt_pk_bf16_f32 v80, v10, v11
    v_cvt_pk_bf16_f32 v81, v12, v13
    s_waitcnt lgkmcnt(6)
    v_mfma_f32_32x32x16_bf16 v[24:39], v[88:91], v[232:235], v[24:39]
    s_add_u32 m0, s28, 21440
    ds_read_b64_tr_b16 v[108:109], v5 offset:11264
    ds_read_b64_tr_b16 v[110:111], v5 offset:11520
    buffer_load_dwordx4 v113, s[4:7], s22 offen offset:64 lds
    v_mul_f32 v10, v84, v84
    v_mul_f32 v11, v85, v85
    v_mul_f32 v12, v86, v86
    v_mul_f32 v13, v87, v87
    v_fma_f32 v10, v10, v7, v6
    v_fma_f32 v11, v11, v7, v6
    v_fma_f32 v12, v12, v7, v6
    v_fma_f32 v13, v13, v7, v6
    v_mul_f32 v10, v10, v84
    v_mul_f32 v11, v11, v85
    v_mfma_f32_32x32x16_bf16 v[24:39], v[92:95], v[236:239], v[24:39]
    s_add_u32 m0, s28, 22400
    s_nop 0
    buffer_load_dwordx4 v113, s[4:7], s22 offen offset:128 lds
    v_mul_f32 v12, v12, v86
    v_mul_f32 v13, v13, v87
    v_exp_f32 v10, v10
    v_exp_f32 v11, v11
    v_exp_f32 v12, v12
    v_exp_f32 v13, v13
    s_waitcnt lgkmcnt(4)
    v_mfma_f32_32x32x16_bf16 v[24:39], v[96:99], v[240:243], v[24:39]
    s_add_u32 m0, s28, 23360
    s_nop 0
    buffer_load_dwordx4 v113, s[4:7], s22 offen offset:192 lds
    v_fma_f32 v10, v10, v8, v8
    v_fma_f32 v11, v11, v8, v8
    v_fma_f32 v12, v12, v8, v8
    v_fma_f32 v13, v13, v8, v8
    v_rcp_f32 v10, v10
    v_rcp_f32 v11, v11
    v_rcp_f32 v12, v12
    v_mfma_f32_32x32x16_bf16 v[24:39], v[100:103], v[244:247], v[24:39]
    s_add_u32 m0, s28, 24320
    s_nop 0
    buffer_load_dwordx4 v114, s[4:7], s22 offen offset:256 lds
    v_rcp_f32 v13, v13
    v_mul_f32 v10, v10, v84
    v_mul_f32 v11, v11, v85
    v_mul_f32 v12, v12, v86
    v_mul_f32 v13, v13, v87
    v_cvt_pk_bf16_f32 v82, v10, v11
    v_cvt_pk_bf16_f32 v83, v12, v13
    buffer_store_dwordx4 v[80:83], v1, s[8:11], s27 offen offset:3072 sc1
    s_waitcnt lgkmcnt(0)
    v_mfma_f32_32x32x16_bf16 v[24:39], v[104:107], v[248:251], v[24:39]
    v_mfma_f32_32x32x16_bf16 v[24:39], v[108:111], v[252:255], v[24:39]
    s_setprio 3
    s_lshl_b32 s27, s49, 11
    s_add_u32 s27, s27, s54
    s_nop 8
    v_mul_f32 v10, v24, v24
    v_mul_f32 v11, v25, v25
    v_mul_f32 v12, v26, v26
    v_mul_f32 v13, v27, v27
    v_fma_f32 v10, v10, v7, v6
    v_fma_f32 v11, v11, v7, v6
    v_fma_f32 v12, v12, v7, v6
    v_fma_f32 v13, v13, v7, v6
    v_mul_f32 v10, v10, v24
    v_mul_f32 v11, v11, v25
    v_mul_f32 v12, v12, v26
    v_mul_f32 v13, v13, v27
    v_exp_f32 v10, v10
    v_exp_f32 v11, v11
    v_exp_f32 v12, v12
    v_exp_f32 v13, v13
    v_fma_f32 v10, v10, v8, v8
    v_fma_f32 v11, v11, v8, v8
    v_fma_f32 v12, v12, v8, v8
    v_fma_f32 v13, v13, v8, v8
    v_rcp_f32 v10, v10
    v_rcp_f32 v11, v11
    v_rcp_f32 v12, v12
    v_rcp_f32 v13, v13
    v_mul_f32 v10, v10, v24
    v_mul_f32 v11, v11, v25
    v_mul_f32 v12, v12, v26
    v_mul_f32 v13, v13, v27
    v_cvt_pk_bf16_f32 v24, v10, v11
    v_cvt_pk_bf16_f32 v25, v12, v13
    v_mul_f32 v10, v28, v28
    v_mul_f32 v11, v29, v29
    v_mul_f32 v12, v30, v30
    v_mul_f32 v13, v31, v31
    v_fma_f32 v10, v10, v7, v6
    v_fma_f32 v11, v11, v7, v6
    v_fma_f32 v12, v12, v7, v6
    v_fma_f32 v13, v13, v7, v6
    v_mul_f32 v10, v10, v28
    v_mul_f32 v11, v11, v29
    v_mul_f32 v12, v12, v30
    v_mul_f32 v13, v13, v31
    v_exp_f32 v10, v10
    v_exp_f32 v11, v11
    v_exp_f32 v12, v12
    v_exp_f32 v13, v13
    v_fma_f32 v10, v10, v8, v8
    v_fma_f32 v11, v11, v8, v8
    v_fma_f32 v12, v12, v8, v8
    v_fma_f32 v13, v13, v8, v8
    v_rcp_f32 v10, v10
    v_rcp_f32 v11, v11
    v_rcp_f32 v12, v12
    v_rcp_f32 v13, v13
    v_mul_f32 v10, v10, v28
    v_mul_f32 v11, v11, v29
    v_mul_f32 v12, v12, v30
    v_mul_f32 v13, v13, v31
    v_cvt_pk_bf16_f32 v26, v10, v11
    v_cvt_pk_bf16_f32 v27, v12, v13
    buffer_store_dwordx4 v[24:27], v1, s[8:11], s27 offen offset:0 sc1
    v_mul_f32 v10, v32, v32
    v_mul_f32 v11, v33, v33
    v_mul_f32 v12, v34, v34
    v_mul_f32 v13, v35, v35
    v_fma_f32 v10, v10, v7, v6
    v_fma_f32 v11, v11, v7, v6
    v_fma_f32 v12, v12, v7, v6
    v_fma_f32 v13, v13, v7, v6
    v_mul_f32 v10, v10, v32
    v_mul_f32 v11, v11, v33
    v_mul_f32 v12, v12, v34
    v_mul_f32 v13, v13, v35
    v_exp_f32 v10, v10
    v_exp_f32 v11, v11
    v_exp_f32 v12, v12
    v_exp_f32 v13, v13
    v_fma_f32 v10, v10, v8, v8
    v_fma_f32 v11, v11, v8, v8
    v_fma_f32 v12, v12, v8, v8
    v_fma_f32 v13, v13, v8, v8
    v_rcp_f32 v10, v10
    v_rcp_f32 v11, v11
    v_rcp_f32 v12, v12
    v_rcp_f32 v13, v13
    v_mul_f32 v10, v10, v32
    v_mul_f32 v11, v11, v33
    v_mul_f32 v12, v12, v34
    v_mul_f32 v13, v13, v35
    v_cvt_pk_bf16_f32 v32, v10, v11
    v_cvt_pk_bf16_f32 v33, v12, v13
    v_mul_f32 v10, v36, v36
    v_mul_f32 v11, v37, v37
    v_mul_f32 v12, v38, v38
    v_mul_f32 v13, v39, v39
    v_fma_f32 v10, v10, v7, v6
    v_fma_f32 v11, v11, v7, v6
    v_fma_f32 v12, v12, v7, v6
    v_fma_f32 v13, v13, v7, v6
    v_mul_f32 v10, v10, v36
    v_mul_f32 v11, v11, v37
    v_mul_f32 v12, v12, v38
    v_mul_f32 v13, v13, v39
    v_exp_f32 v10, v10
    v_exp_f32 v11, v11
    v_exp_f32 v12, v12
    v_exp_f32 v13, v13
    v_fma_f32 v10, v10, v8, v8
    v_fma_f32 v11, v11, v8, v8
    v_fma_f32 v12, v12, v8, v8
    v_fma_f32 v13, v13, v8, v8
    v_rcp_f32 v10, v10
    v_rcp_f32 v11, v11
    v_rcp_f32 v12, v12
    v_rcp_f32 v13, v13
    v_mul_f32 v10, v10, v36
    v_mul_f32 v11, v11, v37
    v_mul_f32 v12, v12, v38
    v_mul_f32 v13, v13, v39
    v_cvt_pk_bf16_f32 v34, v10, v11
    v_cvt_pk_bf16_f32 v35, v12, v13
    buffer_store_dwordx4 v[32:35], v1, s[8:11], s27 offen offset:1024 sc1
    s_lshl_b32 s56, s16, 2
    s_add_u32 s56, s56, s19
    s_lshl_b32 s56, s56, 7
    s_add_u32 s56, s56, 12322816
    s_waitcnt vmcnt(0)
    s_lshl_b32 s23, s35, 12
    s_add_u32 s23, s23, s24
    s_add_u32 s35, s35, 1
    s_cmp_eq_u32 s35, 18
    s_cselect_b32 s35, 0, s35
    buffer_load_dwordx4 v[152:155], v112, s[8:11], s23 offen offset:0 sc1
    buffer_load_dwordx4 v[156:159], v112, s[8:11], s23 offen offset:1024 sc1
    buffer_load_dwordx4 v[160:163], v112, s[8:11], s23 offen offset:2048 sc1
    buffer_load_dwordx4 v[164:167], v112, s[8:11], s23 offen offset:3072 sc1
    s_lshl_b32 s23, s35, 12
    s_add_u32 s23, s23, s24
    s_add_u32 s35, s35, 1
    s_cmp_eq_u32 s35, 18
    s_cselect_b32 s35, 0, s35
    buffer_load_dwordx4 v[168:171], v112, s[8:11], s23 offen offset:0 sc1
    buffer_load_dwordx4 v[172:175], v112, s[8:11], s23 offen offset:1024 sc1
    buffer_load_dwordx4 v[176:179], v112, s[8:11], s23 offen offset:2048 sc1
    buffer_load_dwordx4 v[180:183], v112, s[8:11], s23 offen offset:3072 sc1
    v_and_b32 v124, 63, v0
    v_and_b32 v126, 3, v0
    v_cmp_gt_u32 vcc, 2, v126
    v_lshrrev_b32 v125, 2, v124
    s_mul_i32 s26, s18, 18
    v_add_u32 v127, s26, v125
    v_mul_u32_u24 v127, 1152, v127
    v_lshl_add_u32 v115, v126, 4, v127
    v_lshrrev_b32 v127, 3, v124
    v_lshl_add_u32 v125, v127, 4, v125
    v_add_u32 v125, 16, v125
    v_mul_u32_u24 v125, 1152, v125
    v_lshl_add_u32 v117, v126, 4, v125
    v_mov_b32 v127, 0x80000000
    v_cndmask_b32 v116, v127, v115, vcc
    v_cndmask_b32 v118, v127, v117, vcc
    v_cmp_gt_u32 vcc, 64, v0
    s_nop 1
    v_cndmask_b32 v117, v127, v117, vcc
    v_cndmask_b32 v118, v127, v118, vcc
    v_and_b32 v125, 31, v0
    v_and_b32 v119, 0x200, v112
    v_lshl_add_u32 v119, v125, 2, v119
    s_mul_i32 s52, s19, 165888
    s_mul_i32 s26, s50, 288
    s_add_u32 s52, s52, s26
    s_add_u32 s53, s52, 82944
    s_mul_i32 s54, s20, 36864
    s_add_u32 s54, s54, 12582912
    s_lshl_b32 s26, s19, 10
    s_add_u32 s55, s54, s26
    s_add_u32 s55, s55, 32768
    s_lshl_b32 s26, s19, 13
    s_add_u32 s54, s54, s26
    s_add_u32 s51, s54, 4096
    s_mov_b32 s12, s64
    s_and_b32 s13, s65, 0xffff
    s_mov_b32 s14, 0x000a2000
    s_mov_b32 s15, 0x00020000
    s_barrier
    s_mov_b32 s59, 3
    s_cmp_lg_u32 s18, 0
    s_cbranch_scc1 L_f_s2_52
    s_mov_b32 s59, 1
    s_atomic_add s59, s[40:41], s56 glc
L_f_s2_52:
    ds_read_b64_tr_b16 v[128:129], v120 offset:0
    ds_read_b64_tr_b16 v[130:131], v120 offset:256
    ds_read_b64_tr_b16 v[132:133], v120 offset:1024
    ds_read_b64_tr_b16 v[134:135], v120 offset:1280
    ds_read_b64_tr_b16 v[136:137], v120 offset:2048
    ds_read_b64_tr_b16 v[138:139], v120 offset:2304
    ds_read_b64_tr_b16 v[140:141], v120 offset:3072
    ds_read_b64_tr_b16 v[142:143], v120 offset:3328
    ds_read_b64_tr_b16 v[144:145], v120 offset:4096
    ds_read_b64_tr_b16 v[146:147], v120 offset:4352
    s_waitcnt vmcnt(4)
    s_setprio 0
    s_waitcnt lgkmcnt(6)
    v_mfma_f32_32x32x16_bf16 v[16:31], v[128:131], v[152:155], 0
    s_mul_i32 s22, s21, 73728
    s_add_u32 s22, s22, s25
    s_add_u32 s21, s21, 1
    s_cmp_eq_u32 s21, 18
    s_cselect_b32 s21, 0, s21
    s_add_u32 m0, s28, 40960
    ds_read_b64_tr_b16 v[148:149], v120 offset:5120
    ds_read_b64_tr_b16 v[150:151], v120 offset:5376
    buffer_load_dwordx4 v113, s[4:7], s22 offen offset:0 lds
    v_mfma_f32_32x32x16_bf16 v[32:47], v[132:135], v[152:155], 0
    s_add_u32 m0, s28, 41920
    ds_read_b64_tr_b16 v[128:129], v120 offset:6144
    ds_read_b64_tr_b16 v[130:131], v120 offset:6400
    buffer_load_dwordx4 v113, s[4:7], s22 offen offset:64 lds
    s_waitcnt lgkmcnt(6)
    v_mfma_f32_32x32x16_bf16 v[48:63], v[136:139], v[152:155], 0
    s_add_u32 m0, s28, 42880
    ds_read_b64_tr_b16 v[132:133], v120 offset:7168
    ds_read_b64_tr_b16 v[134:135], v120 offset:7424
    buffer_load_dwordx4 v113, s[4:7], s22 offen offset:128 lds
    v_mfma_f32_32x32x16_bf16 v[64:79], v[140:143], v[152:155], 0
    s_add_u32 m0, s28, 43840
    ds_read_b64_tr_b16 v[136:137], v120 offset:8192
    ds_read_b64_tr_b16 v[138:139], v120 offset:8448
    buffer_load_dwordx4 v113, s[4:7], s22 offen offset:192 lds
    s_waitcnt lgkmcnt(6)
    v_mfma_f32_32x32x16_bf16 v[80:95], v[144:147], v[152:155], 0
    s_add_u32 m0, s28, 44800
    ds_read_b64_tr_b16 v[140:141], v120 offset:9216
    ds_read_b64_tr_b16 v[142:143], v120 offset:9472
    buffer_load_dwordx4 v114, s[4:7], s22 offen offset:256 lds
    v_mfma_f32_32x32x16_bf16 v[16:31], v[148:151], v[156:159], v[16:31]
    s_lshl_b32 s23, s35, 12
    s_add_u32 s23, s23, s24
    s_add_u32 s35, s35, 1
    s_cmp_eq_u32 s35, 18
    s_cselect_b32 s35, 0, s35
    ds_read_b64_tr_b16 v[144:145], v120 offset:10240
    ds_read_b64_tr_b16 v[146:147], v120 offset:10496
    buffer_load_dwordx4 v[184:187], v112, s[8:11], s23 offen offset:0 sc1
    s_waitcnt lgkmcnt(6)
    v_mfma_f32_32x32x16_bf16 v[32:47], v[128:131], v[156:159], v[32:47]
    ds_read_b64_tr_b16 v[148:149], v120 offset:11264
    ds_read_b64_tr_b16 v[150:151], v120 offset:11520
    buffer_load_dwordx4 v[188:191], v112, s[8:11], s23 offen offset:1024 sc1
    v_mfma_f32_32x32x16_bf16 v[48:63], v[132:135], v[156:159], v[48:63]
    ds_read_b64_tr_b16 v[128:129], v120 offset:12288
    ds_read_b64_tr_b16 v[130:131], v120 offset:12544
    s_waitcnt lgkmcnt(6)
    v_mfma_f32_32x32x16_bf16 v[64:79], v[136:139], v[156:159], v[64:79]
    ds_read_b64_tr_b16 v[132:133], v120 offset:13312
    ds_read_b64_tr_b16 v[134:135], v120 offset:13568
    buffer_load_dwordx4 v[192:195], v112, s[8:11], s23 offen offset:2048 sc1
    v_mfma_f32_32x32x16_bf16 v[80:95], v[140:143], v[156:159], v[80:95]
    ds_read_b64_tr_b16 v[136:137], v120 offset:14336
    ds_read_b64_tr_b16 v[138:139], v120 offset:14592
    buffer_load_dwordx4 v[196:199], v112, s[8:11], s23 offen offset:3072 sc1
    s_waitcnt lgkmcnt(6)
    v_mfma_f32_32x32x16_bf16 v[16:31], v[144:147], v[160:163], v[16:31]
    s_mul_i32 s22, s21, 73728
    s_add_u32 s22, s22, s25
    s_add_u32 s21, s21, 1
    s_cmp_eq_u32 s21, 18
    s_cselect_b32 s21, 0, s21
    s_add_u32 m0, s28, 61440
    ds_read_b64_tr_b16 v[140:141], v120 offset:15360
    ds_read_b64_tr_b16 v[142:143], v120 offset:15616
    buffer_load_dwordx4 v113, s[4:7], s22 offen offset:0 lds
    v_mfma_f32_32x32x16_bf16 v[32:47], v[148:151], v[160:163], v[32:47]
    s_add_u32 m0, s28, 62400
    ds_read_b64_tr_b16 v[144:145], v120 offset:16384
    ds_read_b64_tr_b16 v[146:147], v120 offset:16640
    buffer_load_dwordx4 v113, s[4:7], s22 offen offset:64 lds
    s_waitcnt lgkmcnt(6)
    v_mfma_f32_32x32x16_bf16 v[48:63], v[128:131], v[160:163], v[48:63]
    s_add_u32 m0, s28, 63360
    ds_read_b64_tr_b16 v[148:149], v120 offset:17408
    ds_read_b64_tr_b16 v[150:151], v120 offset:17664
    buffer_load_dwordx4 v113, s[4:7], s22 offen offset:128 lds
    v_mfma_f32_32x32x16_bf16 v[64:79], v[132:135], v[160:163], v[64:79]
    s_add_u32 m0, s28, 64320
    ds_read_b64_tr_b16 v[128:129], v120 offset:18432
    ds_read_b64_tr_b16 v[130:131], v120 offset:18688
    buffer_load_dwordx4 v113, s[4:7], s22 offen offset:192 lds
    s_waitcnt lgkmcnt(6)
    v_mfma_f32_32x32x16_bf16 v[80:95], v[136:139], v[160:163], v[80:95]
    s_add_u32 m0, s28, 65280
    ds_read_b64_tr_b16 v[132:133], v120 offset:19456
    ds_read_b64_tr_b16 v[134:135], v120 offset:19712
    buffer_load_dwordx4 v114, s[4:7], s22 offen offset:256 lds
    v_mfma_f32_32x32x16_bf16 v[16:31], v[140:143], v[164:167], v[16:31]
    s_waitcnt lgkmcnt(4)
    v_mfma_f32_32x32x16_bf16 v[32:47], v[144:147], v[164:167], v[32:47]
    s_waitcnt vmcnt(14) lgkmcnt(0)
    s_barrier
    ds_read_b64_tr_b16 v[136:137], v120 offset:20480
    ds_read_b64_tr_b16 v[138:139], v120 offset:20736
    ds_read_b64_tr_b16 v[140:141], v120 offset:21504
    ds_read_b64_tr_b16 v[142:143], v120 offset:21760
    v_mfma_f32_32x32x16_bf16 v[48:63], v[148:151], v[164:167], v[48:63]
    ds_read_b64_tr_b16 v[144:145], v120 offset:22528
    ds_read_b64_tr_b16 v[146:147], v120 offset:22784
    v_mfma_f32_32x32x16_bf16 v[64:79], v[128:131], v[164:167], v[64:79]
    ds_read_b64_tr_b16 v[148:149], v120 offset:23552
    ds_read_b64_tr_b16 v[150:151], v120 offset:23808
    v_mfma_f32_32x32x16_bf16 v[80:95], v[132:135], v[164:167], v[80:95]
    ds_read_b64_tr_b16 v[128:129], v120 offset:24576
    ds_read_b64_tr_b16 v[130:131], v120 offset:24832
    s_waitcnt lgkmcnt(6)
    v_mfma_f32_32x32x16_bf16 v[16:31], v[136:139], v[168:171], v[16:31]
    s_lshl_b32 s23, s35, 12
    s_add_u32 s23, s23, s24
    s_add_u32 s35, s35, 1
    s_cmp_eq_u32 s35, 18
    s_cselect_b32 s35, 0, s35
    ds_read_b64_tr_b16 v[132:133], v120 offset:25600
    ds_read_b64_tr_b16 v[134:135], v120 offset:25856
    buffer_load_dwordx4 v[152:155], v112, s[8:11], s23 offen offset:0 sc1
    v_mfma_f32_32x32x16_bf16 v[32:47], v[140:143], v[168:171], v[32:47]
    ds_read_b64_tr_b16 v[136:137], v120 offset:26624
    ds_read_b64_tr_b16 v[138:139], v120 offset:26880
    buffer_load_dwordx4 v[156:159], v112, s[8:11], s23 offen offset:1024 sc1
    s_waitcnt lgkmcnt(6)
    v_mfma_f32_32x32x16_bf16 v[48:63], v[144:147], v[168:171], v[48:63]
    ds_read_b64_tr_b16 v[140:141], v120 offset:27648
    ds_read_b64_tr_b16 v[142:143], v120 offset:27904
    v_mfma_f32_32x32x16_bf16 v[64:79], v[148:151], v[168:171], v[64:79]
    ds_read_b64_tr_b16 v[144:145], v120 offset:28672
    ds_read_b64_tr_b16 v[146:147], v120 offset:28928
    buffer_load_dwordx4 v[160:163], v112, s[8:11], s23 offen offset:2048 sc1
    s_waitcnt lgkmcnt(6)
    v_mfma_f32_32x32x16_bf16 v[80:95], v[128:131], v[168:171], v[80:95]
    ds_read_b64_tr_b16 v[148:149], v120 offset:29696
    ds_read_b64_tr_b16 v[150:151], v120 offset:29952
    v_mfma_f32_32x32x16_bf16 v[16:31], v[132:135], v[172:175], v[16:31]
    ds_read_b64_tr_b16 v[128:129], v120 offset:30720
    ds_read_b64_tr_b16 v[130:131], v120 offset:30976
    buffer_load_dwordx4 v[164:167], v112, s[8:11], s23 offen offset:3072 sc1
    s_waitcnt lgkmcnt(6)
    v_mfma_f32_32x32x16_bf16 v[32:47], v[136:139], v[172:175], v[32:47]
    ds_read_b64_tr_b16 v[132:133], v120 offset:31744
    ds_read_b64_tr_b16 v[134:135], v120 offset:32000
    v_mfma_f32_32x32x16_bf16 v[48:63], v[140:143], v[172:175], v[48:63]
    s_mul_i32 s22, s21, 73728
    s_add_u32 s22, s22, s25
    s_add_u32 s21, s21, 1
    s_cmp_eq_u32 s21, 18
    s_cselect_b32 s21, 0, s21
    s_add_u32 m0, s28, 0
    ds_read_b64_tr_b16 v[136:137], v120 offset:32768
    ds_read_b64_tr_b16 v[138:139], v120 offset:33024
    buffer_load_dwordx4 v113, s[4:7], s22 offen offset:0 lds
    s_waitcnt lgkmcnt(6)
    v_mfma_f32_32x32x16_bf16 v[64:79], v[144:147], v[172:175], v[64:79]
    s_add_u32 m0, s28, 960
    ds_read_b64_tr_b16 v[140:141], v120 offset:33792
    ds_read_b64_tr_b16 v[142:143], v120 offset:34048
    buffer_load_dwordx4 v113, s[4:7], s22 offen offset:64 lds
    v_mfma_f32_32x32x16_bf16 v[80:95], v[148:151], v[172:175], v[80:95]
    ds_read_b64_tr_b16 v[144:145], v120 offset:34816
    ds_read_b64_tr_b16 v[146:147], v120 offset:35072
    s_waitcnt lgkmcnt(6)
    v_mfma_f32_32x32x16_bf16 v[16:31], v[128:131], v[176:179], v[16:31]
    s_add_u32 m0, s28, 1920
    ds_read_b64_tr_b16 v[148:149], v120 offset:35840
    ds_read_b64_tr_b16 v[150:151], v120 offset:36096
    buffer_load_dwordx4 v113, s[4:7], s22 offen offset:128 lds
    v_mfma_f32_32x32x16_bf16 v[32:47], v[132:135], v[176:179], v[32:47]
    ds_read_b64_tr_b16 v[128:129], v120 offset:36864
    ds_read_b64_tr_b16 v[130:131], v120 offset:37120
    s_waitcnt lgkmcnt(6)
    v_mfma_f32_32x32x16_bf16 v[48:63], v[136:139], v[176:179], v[48:63]
    s_add_u32 m0, s28, 2880
    ds_read_b64_tr_b16 v[132:133], v120 offset:37888
    ds_read_b64_tr_b16 v[134:135], v120 offset:38144
    buffer_load_dwordx4 v113, s[4:7], s22 offen offset:192 lds
    v_mfma_f32_32x32x16_bf16 v[64:79], v[140:143], v[176:179], v[64:79]
    ds_read_b64_tr_b16 v[136:137], v120 offset:38912
    ds_read_b64_tr_b16 v[138:139], v120 offset:39168
    s_waitcnt lgkmcnt(6)
    v_mfma_f32_32x32x16_bf16 v[80:95], v[144:147], v[176:179], v[80:95]
    s_add_u32 m0, s28, 3840
    ds_read_b64_tr_b16 v[140:141], v120 offset:39936
    ds_read_b64_tr_b16 v[142:143], v120 offset:40192
    buffer_load_dwordx4 v114, s[4:7], s22 offen offset:256 lds
    v_mfma_f32_32x32x16_bf16 v[16:31], v[148:151], v[180:183], v[16:31]
    s_waitcnt lgkmcnt(4)
    v_mfma_f32_32x32x16_bf16 v[32:47], v[128:131], v[180:183], v[32:47]
    s_waitcnt vmcnt(14) lgkmcnt(0)
    s_cmp_ge_u32 s59, 3
    s_cbranch_scc1 L_f_p2_53
    s_cmp_lg_u32 s18, 0
    s_cbranch_scc1 L_f_pw_54
    s_mov_b32 s57, 262144
L_f_pp_55:
    s_mov_b32 s45, 0
    s_atomic_add s45, s[40:41], s56 glc
    s_waitcnt lgkmcnt(0)
    s_cmp_ge_u32 s45, 4
    s_cbranch_scc1 L_f_pw_54
L_f_ps_56:
    s_sleep 2
    s_sub_u32 s57, s57, 1
    s_cmp_gt_i32 s57, 0
    s_cbranch_scc1 L_f_pp_55
L_f_pw_54:
L_f_p2_53:
    s_barrier
    ds_read_b64_tr_b16 v[144:145], v121 offset:0
    ds_read_b64_tr_b16 v[146:147], v121 offset:256
    ds_read_b64_tr_b16 v[148:149], v121 offset:1024
    ds_read_b64_tr_b16 v[150:151], v121 offset:1280
    v_mfma_f32_32x32x16_bf16 v[48:63], v[132:135], v[180:183], v[48:63]
    ds_read_b64_tr_b16 v[128:129], v121 offset:2048
    ds_read_b64_tr_b16 v[130:131], v121 offset:2304
    v_mfma_f32_32x32x16_bf16 v[64:79], v[136:139], v[180:183], v[64:79]
    ds_read_b64_tr_b16 v[132:133], v121 offset:3072
    ds_read_b64_tr_b16 v[134:135], v121 offset:3328
    v_mfma_f32_32x32x16_bf16 v[80:95], v[140:143], v[180:183], v[80:95]
    ds_read_b64_tr_b16 v[136:137], v121 offset:4096
    ds_read_b64_tr_b16 v[138:139], v121 offset:4352
    s_waitcnt lgkmcnt(6)
    v_mfma_f32_32x32x16_bf16 v[16:31], v[144:147], v[184:187], v[16:31]
    s_lshl_b32 s23, s35, 12
    s_add_u32 s23, s23, s24
    s_add_u32 s35, s35, 1
    s_cmp_eq_u32 s35, 18
    s_cselect_b32 s35, 0, s35
    ds_read_b64_tr_b16 v[140:141], v121 offset:5120
    ds_read_b64_tr_b16 v[142:143], v121 offset:5376
    buffer_load_dwordx4 v[168:171], v112, s[8:11], s23 offen offset:0 sc1
    v_mfma_f32_32x32x16_bf16 v[32:47], v[148:151], v[184:187], v[32:47]
    ds_read_b64_tr_b16 v[144:145], v121 offset:6144
    ds_read_b64_tr_b16 v[146:147], v121 offset:6400
    buffer_load_dwordx4 v[172:175], v112, s[8:11], s23 offen offset:1024 sc1
    s_waitcnt lgkmcnt(6)
    v_mfma_f32_32x32x16_bf16 v[48:63], v[128:131], v[184:187], v[48:63]
    ds_read_b64_tr_b16 v[148:149], v121 offset:7168
    ds_read_b64_tr_b16 v[150:151], v121 offset:7424
    v_mfma_f32_32x32x16_bf16 v[64:79], v[132:135], v[184:187], v[64:79]
    ds_read_b64_tr_b16 v[128:129], v121 offset:8192
    ds_read_b64_tr_b16 v[130:131], v121 offset:8448
    buffer_load_dwordx4 v[176:179], v112, s[8:11], s23 offen offset:2048 sc1
    s_waitcnt lgkmcnt(6)
    v_mfma_f32_32x32x16_bf16 v[80:95], v[136:139], v[184:187], v[80:95]
    ds_read_b64_tr_b16 v[132:133], v121 offset:9216
    ds_read_b64_tr_b16 v[134:135], v121 offset:9472
    v_mfma_f32_32x32x16_bf16 v[16:31], v[140:143], v[188:191], v[16:31]
    ds_read_b64_tr_b16 v[136:137], v121 offset:10240
    ds_read_b64_tr_b16 v[138:139], v121 offset:10496
    buffer_load_dwordx4 v[180:183], v112, s[8:11], s23 offen offset:3072 sc1
    s_waitcnt lgkmcnt(6)
    v_mfma_f32_32x32x16_bf16 v[32:47], v[144:147], v[188:191], v[32:47]
    ds_read_b64_tr_b16 v[140:141], v121 offset:11264
    ds_read_b64_tr_b16 v[142:143], v121 offset:11520
    v_mfma_f32_32x32x16_bf16 v[48:63], v[148:151], v[188:191], v[48:63]
    s_mul_i32 s22, s21, 73728
    s_add_u32 s22, s22, s25
    s_add_u32 s21, s21, 1
    s_cmp_eq_u32 s21, 18
    s_cselect_b32 s21, 0, s21
    s_add_u32 m0, s28, 20480
    ds_read_b64_tr_b16 v[144:145], v121 offset:12288
    ds_read_b64_tr_b16 v[146:147], v121 offset:12544
    buffer_load_dwordx4 v113, s[4:7], s22 offen offset:0 lds
    s_waitcnt lgkmcnt(6)
    v_mfma_f32_32x32x16_bf16 v[64:79], v[128:131], v[188:191], v[64:79]
    s_add_u32 m0, s28, 21440
    ds_read_b64_tr_b16 v[148:149], v121 offset:13312
    ds_read_b64_tr_b16 v[150:151], v121 offset:13568
    buffer_load_dwordx4 v113, s[4:7], s22 offen offset:64 lds
    v_mfma_f32_32x32x16_bf16 v[80:95], v[132:135], v[188:191], v[80:95]
    ds_read_b64_tr_b16 v[128:129], v121 offset:14336
    ds_read_b64_tr_b16 v[130:131], v121 offset:14592
    s_waitcnt lgkmcnt(6)
    v_mfma_f32_32x32x16_bf16 v[16:31], v[136:139], v[192:195], v[16:31]
    s_add_u32 m0, s28, 22400
    ds_read_b64_tr_b16 v[132:133], v121 offset:15360
    ds_read_b64_tr_b16 v[134:135], v121 offset:15616
    buffer_load_dwordx4 v113, s[4:7], s22 offen offset:128 lds
    v_mfma_f32_32x32x16_bf16 v[32:47], v[140:143], v[192:195], v[32:47]
    ds_read_b64_tr_b16 v[136:137], v121 offset:16384
    ds_read_b64_tr_b16 v[138:139], v121 offset:16640
    s_waitcnt lgkmcnt(6)
    v_mfma_f32_32x32x16_bf16 v[48:63], v[144:147], v[192:195], v[48:63]
    s_add_u32 m0, s28, 23360
    ds_read_b64_tr_b16 v[140:141], v121 offset:17408
    ds_read_b64_tr_b16 v[142:143], v121 offset:17664
    buffer_load_dwordx4 v113, s[4:7], s22 offen offset:192 lds
    v_mfma_f32_32x32x16_bf16 v[64:79], v[148:151], v[192:195], v[64:79]
    ds_read_b64_tr_b16 v[144:145], v121 offset:18432
    ds_read_b64_tr_b16 v[146:147], v121 offset:18688
    s_waitcnt lgkmcnt(6)
    v_mfma_f32_32x32x16_bf16 v[80:95], v[128:131], v[192:195], v[80:95]
    s_add_u32 m0, s28, 24320
    ds_read_b64_tr_b16 v[148:149], v121 offset:19456
    ds_read_b64_tr_b16 v[150:151], v121 offset:19712
    buffer_load_dwordx4 v114, s[4:7], s22 offen offset:256 lds
    v_mfma_f32_32x32x16_bf16 v[16:31], v[132:135], v[196:199], v[16:31]
    s_waitcnt lgkmcnt(4)
    v_mfma_f32_32x32x16_bf16 v[32:47], v[136:139], v[196:199], v[32:47]
    s_waitcnt vmcnt(14) lgkmcnt(0)
    s_barrier
    ds_read_b64_tr_b16 v[128:129], v121 offset:20480
    ds_read_b64_tr_b16 v[130:131], v121 offset:20736
    ds_read_b64_tr_b16 v[132:133], v121 offset:21504
    ds_read_b64_tr_b16 v[134:135], v121 offset:21760
    v_mfma_f32_32x32x16_bf16 v[48:63], v[140:143], v[196:199], v[48:63]
    ds_read_b64_tr_b16 v[136:137], v121 offset:22528
    ds_read_b64_tr_b16 v[138:139], v121 offset:22784
    v_mfma_f32_32x32x16_bf16 v[64:79], v[144:147], v[196:199], v[64:79]
    ds_read_b64_tr_b16 v[140:141], v121 offset:23552
    ds_read_b64_tr_b16 v[142:143], v121 offset:23808
    v_mfma_f32_32x32x16_bf16 v[80:95], v[148:151], v[196:199], v[80:95]
    ds_read_b64_tr_b16 v[144:145], v121 offset:24576
    ds_read_b64_tr_b16 v[146:147], v121 offset:24832
    s_waitcnt lgkmcnt(6)
    v_mfma_f32_32x32x16_bf16 v[16:31], v[128:131], v[152:155], v[16:31]
    s_lshl_b32 s23, s35, 12
    s_add_u32 s23, s23, s24
    s_add_u32 s35, s35, 1
    s_cmp_eq_u32 s35, 18
    s_cselect_b32 s35, 0, s35
    ds_read_b64_tr_b16 v[148:149], v121 offset:25600
    ds_read_b64_tr_b16 v[150:151], v121 offset:25856
    buffer_load_dwordx4 v[184:187], v112, s[8:11], s23 offen offset:0 sc1
    v_mfma_f32_32x32x16_bf16 v[32:47], v[132:135], v[152:155], v[32:47]
    ds_read_b64_tr_b16 v[128:129], v121 offset:26624
    ds_read_b64_tr_b16 v[130:131], v121 offset:26880
    buffer_load_dwordx4 v[188:191], v112, s[8:11], s23 offen offset:1024 sc1
    s_waitcnt lgkmcnt(6)
    v_mfma_f32_32x32x16_bf16 v[48:63], v[136:139], v[152:155], v[48:63]
    ds_read_b64_tr_b16 v[132:133], v121 offset:27648
    ds_read_b64_tr_b16 v[134:135], v121 offset:27904
    v_mfma_f32_32x32x16_bf16 v[64:79], v[140:143], v[152:155], v[64:79]
    ds_read_b64_tr_b16 v[136:137], v121 offset:28672
    ds_read_b64_tr_b16 v[138:139], v121 offset:28928
    buffer_load_dwordx4 v[192:195], v112, s[8:11], s23 offen offset:2048 sc1
    s_waitcnt lgkmcnt(6)
    v_mfma_f32_32x32x16_bf16 v[80:95], v[144:147], v[152:155], v[80:95]
    ds_read_b64_tr_b16 v[140:141], v121 offset:29696
    ds_read_b64_tr_b16 v[142:143], v121 offset:29952
    v_mfma_f32_32x32x16_bf16 v[16:31], v[148:151], v[156:159], v[16:31]
    ds_read_b64_tr_b16 v[144:145], v121 offset:30720
    ds_read_b64_tr_b16 v[146:147], v121 offset:30976
    buffer_load_dwordx4 v[196:199], v112, s[8:11], s23 offen offset:3072 sc1
    s_waitcnt lgkmcnt(6)
    v_mfma_f32_32x32x16_bf16 v[32:47], v[128:131], v[156:159], v[32:47]
    ds_read_b64_tr_b16 v[148:149], v121 offset:31744
    ds_read_b64_tr_b16 v[150:151], v121 offset:32000
    v_mfma_f32_32x32x16_bf16 v[48:63], v[132:135], v[156:159], v[48:63]
    s_mul_i32 s22, s21, 73728
    s_add_u32 s22, s22, s25
    s_add_u32 s21, s21, 1
    s_cmp_eq_u32 s21, 18
    s_cselect_b32 s21, 0, s21
    s_add_u32 m0, s28, 40960
    ds_read_b64_tr_b16 v[128:129], v121 offset:32768
    ds_read_b64_tr_b16 v[130:131], v121 offset:33024
    buffer_load_dwordx4 v113, s[4:7], s22 offen offset:0 lds
    s_waitcnt lgkmcnt(6)
    v_mfma_f32_32x32x16_bf16 v[64:79], v[136:139], v[156:159], v[64:79]
    s_add_u32 m0, s28, 41920
    ds_read_b64_tr_b16 v[132:133], v121 offset:33792
    ds_read_b64_tr_b16 v[134:135], v121 offset:34048
    buffer_load_dwordx4 v113, s[4:7], s22 offen offset:64 lds
    v_mfma_f32_32x32x16_bf16 v[80:95], v[140:143], v[156:159], v[80:95]
    ds_read_b64_tr_b16 v[136:137], v121 offset:34816
    ds_read_b64_tr_b16 v[138:139], v121 offset:35072
    s_waitcnt lgkmcnt(6)
    v_mfma_f32_32x32x16_bf16 v[16:31], v[144:147], v[160:163], v[16:31]
    s_add_u32 m0, s28, 42880
    ds_read_b64_tr_b16 v[140:141], v121 offset:35840
    ds_read_b64_tr_b16 v[142:143], v121 offset:36096
    buffer_load_dwordx4 v113, s[4:7], s22 offen offset:128 lds
    v_mfma_f32_32x32x16_bf16 v[32:47], v[148:151], v[160:163], v[32:47]
    ds_read_b64_tr_b16 v[144:145], v121 offset:36864
    ds_read_b64_tr_b16 v[146:147], v121 offset:37120
    s_waitcnt lgkmcnt(6)
    v_mfma_f32_32x32x16_bf16 v[48:63], v[128:131], v[160:163], v[48:63]
    s_add_u32 m0, s28, 43840
    ds_read_b64_tr_b16 v[148:149], v121 offset:37888
    ds_read_b64_tr_b16 v[150:151], v121 offset:38144
    buffer_load_dwordx4 v113, s[4:7], s22 offen offset:192 lds
    v_mfma_f32_32x32x16_bf16 v[64:79], v[132:135], v[160:163], v[64:79]
    ds_read_b64_tr_b16 v[128:129], v121 offset:38912
    ds_read_b64_tr_b16 v[130:131], v121 offset:39168
    s_waitcnt lgkmcnt(6)
    v_mfma_f32_32x32x16_bf16 v[80:95], v[136:139], v[160:163], v[80:95]
    s_add_u32 m0, s28, 44800
    ds_read_b64_tr_b16 v[132:133], v121 offset:39936
    ds_read_b64_tr_b16 v[134:135], v121 offset:40192
    buffer_load_dwordx4 v114, s[4:7], s22 offen offset:256 lds
    v_mfma_f32_32x32x16_bf16 v[16:31], v[140:143], v[164:167], v[16:31]
    s_waitcnt lgkmcnt(4)
    v_mfma_f32_32x32x16_bf16 v[32:47], v[144:147], v[164:167], v[32:47]
    s_waitcnt vmcnt(14) lgkmcnt(0)
    s_barrier
    ds_read_b64_tr_b16 v[136:137], v120 offset:0
    ds_read_b64_tr_b16 v[138:139], v120 offset:256
    ds_read_b64_tr_b16 v[140:141], v120 offset:1024
    ds_read_b64_tr_b16 v[142:143], v120 offset:1280
    v_mfma_f32_32x32x16_bf16 v[48:63], v[148:151], v[164:167], v[48:63]
    ds_read_b64_tr_b16 v[144:145], v120 offset:2048
    ds_read_b64_tr_b16 v[146:147], v120 offset:2304
    v_mfma_f32_32x32x16_bf16 v[64:79], v[128:131], v[164:167], v[64:79]
    ds_read_b64_tr_b16 v[148:149], v120 offset:3072
    ds_read_b64_tr_b16 v[150:151], v120 offset:3328
    v_mfma_f32_32x32x16_bf16 v[80:95], v[132:135], v[164:167], v[80:95]
    ds_read_b64_tr_b16 v[128:129], v120 offset:4096
    ds_read_b64_tr_b16 v[130:131], v120 offset:4352
    s_waitcnt lgkmcnt(6)
    v_mfma_f32_32x32x16_bf16 v[16:31], v[136:139], v[168:171], v[16:31]
    s_lshl_b32 s23, s35, 12
    s_add_u32 s23, s23, s24
    s_add_u32 s35, s35, 1
    s_cmp_eq_u32 s35, 18
    s_cselect_b32 s35, 0, s35
    ds_read_b64_tr_b16 v[132:133], v120 offset:5120
    ds_read_b64_tr_b16 v[134:135], v120 offset:5376
    buffer_load_dwordx4 v[152:155], v112, s[8:11], s23 offen offset:0 sc1
    v_mfma_f32_32x32x16_bf16 v[32:47], v[140:143], v[168:171], v[32:47]
    ds_read_b64_tr_b16 v[136:137], v120 offset:6144
    ds_read_b64_tr_b16 v[138:139], v120 offset:6400
    buffer_load_dwordx4 v[156:159], v112, s[8:11], s23 offen offset:1024 sc1
    s_waitcnt lgkmcnt(6)
    v_mfma_f32_32x32x16_bf16 v[48:63], v[144:147], v[168:171], v[48:63]
    ds_read_b64_tr_b16 v[140:141], v120 offset:7168
    ds_read_b64_tr_b16 v[142:143], v120 offset:7424
    v_mfma_f32_32x32x16_bf16 v[64:79], v[148:151], v[168:171], v[64:79]
    ds_read_b64_tr_b16 v[144:145], v120 offset:8192
    ds_read_b64_tr_b16 v[146:147], v120 offset:8448
    buffer_load_dwordx4 v[160:163], v112, s[8:11], s23 offen offset:2048 sc1
    s_waitcnt lgkmcnt(6)
    v_mfma_f32_32x32x16_bf16 v[80:95], v[128:131], v[168:171], v[80:95]
    ds_read_b64_tr_b16 v[148:149], v120 offset:9216
    ds_read_b64_tr_b16 v[150:151], v120 offset:9472
    v_mfma_f32_32x32x16_bf16 v[16:31], v[132:135], v[172:175], v[16:31]
    ds_read_b64_tr_b16 v[128:129], v120 offset:10240
    ds_read_b64_tr_b16 v[130:131], v120 offset:10496
    buffer_load_dwordx4 v[164:167], v112, s[8:11], s23 offen offset:3072 sc1
    s_waitcnt lgkmcnt(6)
    v_mfma_f32_32x32x16_bf16 v[32:47], v[136:139], v[172:175], v[32:47]
    ds_read_b64_tr_b16 v[132:133], v120 offset:11264
    ds_read_b64_tr_b16 v[134:135], v120 offset:11520
    v_mfma_f32_32x32x16_bf16 v[48:63], v[140:143], v[172:175], v[48:63]
    s_mul_i32 s22, s21, 73728
    s_add_u32 s22, s22, s25
    s_add_u32 s21, s21, 1
    s_cmp_eq_u32 s21, 18
    s_cselect_b32 s21, 0, s21
    s_add_u32 m0, s28, 61440
    ds_read_b64_tr_b16 v[136:137], v120 offset:12288
    ds_read_b64_tr_b16 v[138:139], v120 offset:12544
    buffer_load_dwordx4 v113, s[4:7], s22 offen offset:0 lds
    s_waitcnt lgkmcnt(6)
    v_mfma_f32_32x32x16_bf16 v[64:79], v[144:147], v[172:175], v[64:79]
    s_add_u32 m0, s28, 62400
    ds_read_b64_tr_b16 v[140:141], v120 offset:13312
    ds_read_b64_tr_b16 v[142:143], v120 offset:13568
    buffer_load_dwordx4 v113, s[4:7], s22 offen offset:64 lds
    v_mfma_f32_32x32x16_bf16 v[80:95], v[148:151], v[172:175], v[80:95]
    ds_read_b64_tr_b16 v[144:145], v120 offset:14336
    ds_read_b64_tr_b16 v[146:147], v120 offset:14592
    s_waitcnt lgkmcnt(6)
    v_mfma_f32_32x32x16_bf16 v[16:31], v[128:131], v[176:179], v[16:31]
    s_add_u32 m0, s28, 63360
    ds_read_b64_tr_b16 v[148:149], v120 offset:15360
    ds_read_b64_tr_b16 v[150:151], v120 offset:15616
    buffer_load_dwordx4 v113, s[4:7], s22 offen offset:128 lds
    v_mfma_f32_32x32x16_bf16 v[32:47], v[132:135], v[176:179], v[32:47]
    ds_read_b64_tr_b16 v[128:129], v120 offset:16384
    ds_read_b64_tr_b16 v[130:131], v120 offset:16640
    s_waitcnt lgkmcnt(6)
    v_mfma_f32_32x32x16_bf16 v[48:63], v[136:139], v[176:179], v[48:63]
    s_add_u32 m0, s28, 64320
    ds_read_b64_tr_b16 v[132:133], v120 offset:17408
    ds_read_b64_tr_b16 v[134:135], v120 offset:17664
    buffer_load_dwordx4 v113, s[4:7], s22 offen offset:192 lds
    v_mfma_f32_32x32x16_bf16 v[64:79], v[140:143], v[176:179], v[64:79]
    ds_read_b64_tr_b16 v[136:137], v120 offset:18432
    ds_read_b64_tr_b16 v[138:139], v120 offset:18688
    s_waitcnt lgkmcnt(6)
    v_mfma_f32_32x32x16_bf16 v[80:95], v[144:147], v[176:179], v[80:95]
    s_add_u32 m0, s28, 65280
    ds_read_b64_tr_b16 v[140:141], v120 offset:19456
    ds_read_b64_tr_b16 v[142:143], v120 offset:19712
    buffer_load_dwordx4 v114, s[4:7], s22 offen offset:256 lds
    v_mfma_f32_32x32x16_bf16 v[16:31], v[148:151], v[180:183], v[16:31]
    s_waitcnt lgkmcnt(4)
    v_mfma_f32_32x32x16_bf16 v[32:47], v[128:131], v[180:183], v[32:47]
    s_waitcnt vmcnt(14) lgkmcnt(0)
    s_barrier
    ds_read_b64_tr_b16 v[144:145], v120 offset:20480
    ds_read_b64_tr_b16 v[146:147], v120 offset:20736
    ds_read_b64_tr_b16 v[148:149], v120 offset:21504
    ds_read_b64_tr_b16 v[150:151], v120 offset:21760
    v_mfma_f32_32x32x16_bf16 v[48:63], v[132:135], v[180:183], v[48:63]
    ds_read_b64_tr_b16 v[128:129], v120 offset:22528
    ds_read_b64_tr_b16 v[130:131], v120 offset:22784
    v_mfma_f32_32x32x16_bf16 v[64:79], v[136:139], v[180:183], v[64:79]
    ds_read_b64_tr_b16 v[132:133], v120 offset:23552
    ds_read_b64_tr_b16 v[134:135], v120 offset:23808
    v_mfma_f32_32x32x16_bf16 v[80:95], v[140:143], v[180:183], v[80:95]
    ds_read_b64_tr_b16 v[136:137], v120 offset:24576
    ds_read_b64_tr_b16 v[138:139], v120 offset:24832
    s_waitcnt lgkmcnt(6)
    v_mfma_f32_32x32x16_bf16 v[16:31], v[144:147], v[184:187], v[16:31]
    s_lshl_b32 s23, s35, 12
    s_add_u32 s23, s23, s24
    s_add_u32 s35, s35, 1
    s_cmp_eq_u32 s35, 18
    s_cselect_b32 s35, 0, s35
    ds_read_b64_tr_b16 v[140:141], v120 offset:25600
    ds_read_b64_tr_b16 v[142:143], v120 offset:25856
    buffer_load_dwordx4 v[168:171], v112, s[8:11], s23 offen offset:0 sc1
    v_mfma_f32_32x32x16_bf16 v[32:47], v[148:151], v[184:187], v[32:47]
    ds_read_b64_tr_b16 v[144:145], v120 offset:26624
    ds_read_b64_tr_b16 v[146:147], v120 offset:26880
    buffer_load_dwordx4 v[172:175], v112, s[8:11], s23 offen offset:1024 sc1
    s_waitcnt lgkmcnt(6)
    v_mfma_f32_32x32x16_bf16 v[48:63], v[128:131], v[184:187], v[48:63]
    ds_read_b64_tr_b16 v[148:149], v120 offset:27648
    ds_read_b64_tr_b16 v[150:151], v120 offset:27904
    v_mfma_f32_32x32x16_bf16 v[64:79], v[132:135], v[184:187], v[64:79]
    ds_read_b64_tr_b16 v[128:129], v120 offset:28672
    ds_read_b64_tr_b16 v[130:131], v120 offset:28928
    buffer_load_dwordx4 v[176:179], v112, s[8:11], s23 offen offset:2048 sc1
    s_waitcnt lgkmcnt(6)
    v_mfma_f32_32x32x16_bf16 v[80:95], v[136:139], v[184:187], v[80:95]
    ds_read_b64_tr_b16 v[132:133], v120 offset:29696
    ds_read_b64_tr_b16 v[134:135], v120 offset:29952
    v_mfma_f32_32x32x16_bf16 v[16:31], v[140:143], v[188:191], v[16:31]
    ds_read_b64_tr_b16 v[136:137], v120 offset:30720
    ds_read_b64_tr_b16 v[138:139], v120 offset:30976
    buffer_load_dwordx4 v[180:183], v112, s[8:11], s23 offen offset:3072 sc1
    s_waitcnt lgkmcnt(6)
    v_mfma_f32_32x32x16_bf16 v[32:47], v[144:147], v[188:191], v[32:47]
    ds_read_b64_tr_b16 v[140:141], v120 offset:31744
    ds_read_b64_tr_b16 v[142:143], v120 offset:32000
    v_mfma_f32_32x32x16_bf16 v[48:63], v[148:151], v[188:191], v[48:63]
    s_mul_i32 s22, s21, 73728
    s_add_u32 s22, s22, s25
    s_add_u32 s21, s21, 1
    s_cmp_eq_u32 s21, 18
    s_cselect_b32 s21, 0, s21
    s_add_u32 m0, s28, 0
    ds_read_b64_tr_b16 v[144:145], v120 offset:32768
    ds_read_b64_tr_b16 v[146:147], v120 offset:33024
    buffer_load_dwordx4 v113, s[4:7], s22 offen offset:0 lds
    s_waitcnt lgkmcnt(6)
    v_mfma_f32_32x32x16_bf16 v[64:79], v[128:131], v[188:191], v[64:79]
    s_add_u32 m0, s28, 960
    ds_read_b64_tr_b16 v[148:149], v120 offset:33792
    ds_read_b64_tr_b16 v[150:151], v120 offset:34048
    buffer_load_dwordx4 v113, s[4:7], s22 offen offset:64 lds
    v_mfma_f32_32x32x16_bf16 v[80:95], v[132:135], v[188:191], v[80:95]
    ds_read_b64_tr_b16 v[128:129], v120 offset:34816
    ds_read_b64_tr_b16 v[130:131], v120 offset:35072
    s_waitcnt lgkmcnt(6)
    v_mfma_f32_32x32x16_bf16 v[16:31], v[136:139], v[192:195], v[16:31]
    s_add_u32 m0, s28, 1920
    ds_read_b64_tr_b16 v[132:133], v120 offset:35840
    ds_read_b64_tr_b16 v[134:135], v120 offset:36096
    buffer_load_dwordx4 v113, s[4:7], s22 offen offset:128 lds
    v_mfma_f32_32x32x16_bf16 v[32:47], v[140:143], v[192:195], v[32:47]
    ds_read_b64_tr_b16 v[136:137], v120 offset:36864
    ds_read_b64_tr_b16 v[138:139], v120 offset:37120
    s_waitcnt lgkmcnt(6)
    v_mfma_f32_32x32x16_bf16 v[48:63], v[144:147], v[192:195], v[48:63]
    s_add_u32 m0, s28, 2880
    ds_read_b64_tr_b16 v[140:141], v120 offset:37888
    ds_read_b64_tr_b16 v[142:143], v120 offset:38144
    buffer_load_dwordx4 v113, s[4:7], s22 offen offset:192 lds
    v_mfma_f32_32x32x16_bf16 v[64:79], v[148:151], v[192:195], v[64:79]
    ds_read_b64_tr_b16 v[144:145], v120 offset:38912
    ds_read_b64_tr_b16 v[146:147], v120 offset:39168
    s_waitcnt lgkmcnt(6)
    v_mfma_f32_32x32x16_bf16 v[80:95], v[128:131], v[192:195], v[80:95]
    s_add_u32 m0, s28, 3840
    ds_read_b64_tr_b16 v[148:149], v120 offset:39936
    ds_read_b64_tr_b16 v[150:151], v120 offset:40192
    buffer_load_dwordx4 v114, s[4:7], s22 offen offset:256 lds
    v_mfma_f32_32x32x16_bf16 v[16:31], v[132:135], v[196:199], v[16:31]
    s_waitcnt lgkmcnt(4)
    v_mfma_f32_32x32x16_bf16 v[32:47], v[136:139], v[196:199], v[32:47]
    s_waitcnt vmcnt(14) lgkmcnt(0)
    s_setprio 0
    s_barrier
    ds_read_b64_tr_b16 v[128:129], v121 offset:0
    ds_read_b64_tr_b16 v[130:131], v121 offset:256
    ds_read_b64_tr_b16 v[132:133], v121 offset:1024
    ds_read_b64_tr_b16 v[134:135], v121 offset:1280
    v_mfma_f32_32x32x16_bf16 v[48:63], v[140:143], v[196:199], v[48:63]
    ds_read_b64_tr_b16 v[136:137], v121 offset:2048
    ds_read_b64_tr_b16 v[138:139], v121 offset:2304
    v_mfma_f32_32x32x16_bf16 v[64:79], v[144:147], v[196:199], v[64:79]
    ds_read_b64_tr_b16 v[140:141], v121 offset:3072
    ds_read_b64_tr_b16 v[142:143], v121 offset:3328
    v_mfma_f32_32x32x16_bf16 v[80:95], v[148:151], v[196:199], v[80:95]
    ds_read_b64_tr_b16 v[144:145], v121 offset:4096
    ds_read_b64_tr_b16 v[146:147], v121 offset:4352
    s_waitcnt lgkmcnt(6)
    v_mfma_f32_32x32x16_bf16 v[16:31], v[128:131], v[152:155], v[16:31]
    s_lshl_b32 s23, s35, 12
    s_add_u32 s23, s23, s24
    s_add_u32 s35, s35, 1
    s_cmp_eq_u32 s35, 18
    s_cselect_b32 s35, 0, s35
    ds_read_b64_tr_b16 v[148:149], v121 offset:5120
    ds_read_b64_tr_b16 v[150:151], v121 offset:5376
    buffer_load_dwordx4 v[184:187], v112, s[8:11], s23 offen offset:0 sc1
    v_mfma_f32_32x32x16_bf16 v[32:47], v[132:135], v[152:155], v[32:47]
    ds_read_b64_tr_b16 v[128:129], v121 offset:6144
    ds_read_b64_tr_b16 v[130:131], v121 offset:6400
    buffer_load_dwordx4 v[188:191], v112, s[8:11], s23 offen offset:1024 sc1
    s_waitcnt lgkmcnt(6)
    v_mfma_f32_32x32x16_bf16 v[48:63], v[136:139], v[152:155], v[48:63]
    ds_read_b64_tr_b16 v[132:133], v121 offset:7168
    ds_read_b64_tr_b16 v[134:135], v121 offset:7424
    v_mfma_f32_32x32x16_bf16 v[64:79], v[140:143], v[152:155], v[64:79]
    ds_read_b64_tr_b16 v[136:137], v121 offset:8192
    ds_read_b64_tr_b16 v[138:139], v121 offset:8448
    buffer_load_dwordx4 v[192:195], v112, s[8:11], s23 offen offset:2048 sc1
    s_waitcnt lgkmcnt(6)
    v_mfma_f32_32x32x16_bf16 v[80:95], v[144:147], v[152:155], v[80:95]
    ds_read_b64_tr_b16 v[140:141], v121 offset:9216
    ds_read_b64_tr_b16 v[142:143], v121 offset:9472
    v_mfma_f32_32x32x16_bf16 v[16:31], v[148:151], v[156:159], v[16:31]
    ds_read_b64_tr_b16 v[144:145], v121 offset:10240
    ds_read_b64_tr_b16 v[146:147], v121 offset:10496
    buffer_load_dwordx4 v[196:199], v112, s[8:11], s23 offen offset:3072 sc1
    s_waitcnt lgkmcnt(6)
    v_mfma_f32_32x32x16_bf16 v[32:47], v[128:131], v[156:159], v[32:47]
    ds_read_b64_tr_b16 v[148:149], v121 offset:11264
    ds_read_b64_tr_b16 v[150:151], v121 offset:11520
    v_mfma_f32_32x32x16_bf16 v[48:63], v[132:135], v[156:159], v[48:63]
    s_mul_i32 s22, s21, 73728
    s_add_u32 s22, s22, s25
    s_add_u32 s21, s21, 1
    s_cmp_eq_u32 s21, 18
    s_cselect_b32 s21, 0, s21
    s_add_u32 m0, s28, 20480
    ds_read_b64_tr_b16 v[128:129], v121 offset:12288
    ds_read_b64_tr_b16 v[130:131], v121 offset:12544
    buffer_load_dwordx4 v113, s[4:7], s22 offen offset:0 lds
    s_waitcnt lgkmcnt(6)
    v_mfma_f32_32x32x16_bf16 v[64:79], v[136:139], v[156:159], v[64:79]
    s_add_u32 m0, s28, 21440
    ds_read_b64_tr_b16 v[132:133], v121 offset:13312
    ds_read_b64_tr_b16 v[134:135], v121 offset:13568
    buffer_load_dwordx4 v113, s[4:7], s22 offen offset:64 lds
    v_mfma_f32_32x32x16_bf16 v[80:95], v[140:143], v[156:159], v[80:95]
    ds_read_b64_tr_b16 v[136:137], v121 offset:14336
    ds_read_b64_tr_b16 v[138:139], v121 offset:14592
    s_waitcnt lgkmcnt(6)
    v_mfma_f32_32x32x16_bf16 v[16:31], v[144:147], v[160:163], v[16:31]
    s_add_u32 m0, s28, 22400
    ds_read_b64_tr_b16 v[140:141], v121 offset:15360
    ds_read_b64_tr_b16 v[142:143], v121 offset:15616
    buffer_load_dwordx4 v113, s[4:7], s22 offen offset:128 lds
    v_mfma_f32_32x32x16_bf16 v[32:47], v[148:151], v[160:163], v[32:47]
    ds_read_b64_tr_b16 v[144:145], v121 offset:16384
    ds_read_b64_tr_b16 v[146:147], v121 offset:16640
    s_waitcnt lgkmcnt(6)
    v_mfma_f32_32x32x16_bf16 v[48:63], v[128:131], v[160:163], v[48:63]
    s_add_u32 m0, s28, 23360
    ds_read_b64_tr_b16 v[148:149], v121 offset:17408
    ds_read_b64_tr_b16 v[150:151], v121 offset:17664
    buffer_load_dwordx4 v113, s[4:7], s22 offen offset:192 lds
    v_mfma_f32_32x32x16_bf16 v[64:79], v[132:135], v[160:163], v[64:79]
    ds_read_b64_tr_b16 v[128:129], v121 offset:18432
    ds_read_b64_tr_b16 v[130:131], v121 offset:18688
    s_waitcnt lgkmcnt(6)
    v_mfma_f32_32x32x16_bf16 v[80:95], v[136:139], v[160:163], v[80:95]
    s_add_u32 m0, s28, 24320
    ds_read_b64_tr_b16 v[132:133], v121 offset:19456
    ds_read_b64_tr_b16 v[134:135], v121 offset:19712
    buffer_load_dwordx4 v114, s[4:7], s22 offen offset:256 lds
    v_mfma_f32_32x32x16_bf16 v[16:31], v[140:143], v[164:167], v[16:31]
    s_waitcnt lgkmcnt(4)
    v_mfma_f32_32x32x16_bf16 v[32:47], v[144:147], v[164:167], v[32:47]
    s_waitcnt vmcnt(14) lgkmcnt(0)
    s_barrier
    ds_read_b64_tr_b16 v[136:137], v121 offset:20480
    ds_read_b64_tr_b16 v[138:139], v121 offset:20736
    ds_read_b64_tr_b16 v[140:141], v121 offset:21504
    ds_read_b64_tr_b16 v[142:143], v121 offset:21760
    v_mfma_f32_32x32x16_bf16 v[48:63], v[148:151], v[164:167], v[48:63]
    ds_read_b64_tr_b16 v[144:145], v121 offset:22528
    ds_read_b64_tr_b16 v[146:147], v121 offset:22784
    v_mfma_f32_32x32x16_bf16 v[64:79], v[128:131], v[164:167], v[64:79]
    ds_read_b64_tr_b16 v[148:149], v121 offset:23552
    ds_read_b64_tr_b16 v[150:151], v121 offset:23808
    v_mfma_f32_32x32x16_bf16 v[80:95], v[132:135], v[164:167], v[80:95]
    ds_read_b64_tr_b16 v[128:129], v121 offset:24576
    ds_read_b64_tr_b16 v[130:131], v121 offset:24832
    s_waitcnt lgkmcnt(6)
    v_mfma_f32_32x32x16_bf16 v[16:31], v[136:139], v[168:171], v[16:31]
    s_lshl_b32 s23, s35, 12
    s_add_u32 s23, s23, s24
    s_add_u32 s35, s35, 1
    s_cmp_eq_u32 s35, 18
    s_cselect_b32 s35, 0, s35
    ds_read_b64_tr_b16 v[132:133], v121 offset:25600
    ds_read_b64_tr_b16 v[134:135], v121 offset:25856
    buffer_load_dwordx4 v[152:155], v112, s[8:11], s23 offen offset:0 sc1
    v_mfma_f32_32x32x16_bf16 v[32:47], v[140:143], v[168:171], v[32:47]
    ds_read_b64_tr_b16 v[136:137], v121 offset:26624
    ds_read_b64_tr_b16 v[138:139], v121 offset:26880
    buffer_load_dwordx4 v[156:159], v112, s[8:11], s23 offen offset:1024 sc1
    s_waitcnt lgkmcnt(6)
    v_mfma_f32_32x32x16_bf16 v[48:63], v[144:147], v[168:171], v[48:63]
    ds_read_b64_tr_b16 v[140:141], v121 offset:27648
    ds_read_b64_tr_b16 v[142:143], v121 offset:27904
    v_mfma_f32_32x32x16_bf16 v[64:79], v[148:151], v[168:171], v[64:79]
    ds_read_b64_tr_b16 v[144:145], v121 offset:28672
    ds_read_b64_tr_b16 v[146:147], v121 offset:28928
    buffer_load_dwordx4 v[160:163], v112, s[8:11], s23 offen offset:2048 sc1
    s_waitcnt lgkmcnt(6)
    v_mfma_f32_32x32x16_bf16 v[80:95], v[128:131], v[168:171], v[80:95]
    ds_read_b64_tr_b16 v[148:149], v121 offset:29696
    ds_read_b64_tr_b16 v[150:151], v121 offset:29952
    v_mfma_f32_32x32x16_bf16 v[16:31], v[132:135], v[172:175], v[16:31]
    ds_read_b64_tr_b16 v[128:129], v121 offset:30720
    ds_read_b64_tr_b16 v[130:131], v121 offset:30976
    buffer_load_dwordx4 v[164:167], v112, s[8:11], s23 offen offset:3072 sc1
    s_waitcnt lgkmcnt(6)
    v_mfma_f32_32x32x16_bf16 v[32:47], v[136:139], v[172:175], v[32:47]
    ds_read_b64_tr_b16 v[132:133], v121 offset:31744
    ds_read_b64_tr_b16 v[134:135], v121 offset:32000
    v_mfma_f32_32x32x16_bf16 v[48:63], v[140:143], v[172:175], v[48:63]
    s_mul_i32 s22, s21, 73728
    s_add_u32 s22, s22, s25
    s_add_u32 s21, s21, 1
    s_cmp_eq_u32 s21, 18
    s_cselect_b32 s21, 0, s21
    s_add_u32 m0, s28, 40960
    ds_read_b64_tr_b16 v[136:137], v121 offset:32768
    ds_read_b64_tr_b16 v[138:139], v121 offset:33024
    buffer_load_dwordx4 v113, s[4:7], s22 offen offset:0 lds
    s_waitcnt lgkmcnt(6)
    v_mfma_f32_32x32x16_bf16 v[64:79], v[144:147], v[172:175], v[64:79]
    s_add_u32 m0, s28, 41920
    ds_read_b64_tr_b16 v[140:141], v121 offset:33792
    ds_read_b64_tr_b16 v[142:143], v121 offset:34048
    buffer_load_dwordx4 v113, s[4:7], s22 offen offset:64 lds
    v_mfma_f32_32x32x16_bf16 v[80:95], v[148:151], v[172:175], v[80:95]
    ds_read_b64_tr_b16 v[144:145], v121 offset:34816
    ds_read_b64_tr_b16 v[146:147], v121 offset:35072
    s_waitcnt lgkmcnt(6)
    v_mfma_f32_32x32x16_bf16 v[16:31], v[128:131], v[176:179], v[16:31]
    s_add_u32 m0, s28, 42880
    ds_read_b64_tr_b16 v[148:149], v121 offset:35840
    ds_read_b64_tr_b16 v[150:151], v121 offset:36096
    buffer_load_dwordx4 v113, s[4:7], s22 offen offset:128 lds
    v_mfma_f32_32x32x16_bf16 v[32:47], v[132:135], v[176:179], v[32:47]
    ds_read_b64_tr_b16 v[128:129], v121 offset:36864
    ds_read_b64_tr_b16 v[130:131], v121 offset:37120
    s_waitcnt lgkmcnt(6)
    v_mfma_f32_32x32x16_bf16 v[48:63], v[136:139], v[176:179], v[48:63]
    s_add_u32 m0, s28, 43840
    ds_read_b64_tr_b16 v[132:133], v121 offset:37888
    ds_read_b64_tr_b16 v[134:135], v121 offset:38144
    buffer_load_dwordx4 v113, s[4:7], s22 offen offset:192 lds
    v_mfma_f32_32x32x16_bf16 v[64:79], v[140:143], v[176:179], v[64:79]
    ds_read_b64_tr_b16 v[136:137], v121 offset:38912
    ds_read_b64_tr_b16 v[138:139], v121 offset:39168
    s_waitcnt lgkmcnt(6)
    v_mfma_f32_32x32x16_bf16 v[80:95], v[144:147], v[176:179], v[80:95]
    s_add_u32 m0, s28, 44800
    ds_read_b64_tr_b16 v[140:141], v121 offset:39936
    ds_read_b64_tr_b16 v[142:143], v121 offset:40192
    buffer_load_dwordx4 v114, s[4:7], s22 offen offset:256 lds
    v_mfma_f32_32x32x16_bf16 v[16:31], v[148:151], v[180:183], v[16:31]
    s_waitcnt lgkmcnt(4)
    v_mfma_f32_32x32x16_bf16 v[32:47], v[128:131], v[180:183], v[32:47]
    s_waitcnt vmcnt(14) lgkmcnt(0)
    s_barrier
    ds_read_b64_tr_b16 v[144:145], v120 offset:0
    ds_read_b64_tr_b16 v[146:147], v120 offset:256
    ds_read_b64_tr_b16 v[148:149], v120 offset:1024
    ds_read_b64_tr_b16 v[150:151], v120 offset:1280
    v_mfma_f32_32x32x16_bf16 v[48:63], v[132:135], v[180:183], v[48:63]
    ds_read_b64_tr_b16 v[128:129], v120 offset:2048
    ds_read_b64_tr_b16 v[130:131], v120 offset:2304
    v_mfma_f32_32x32x16_bf16 v[64:79], v[136:139], v[180:183], v[64:79]
    ds_read_b64_tr_b16 v[132:133], v120 offset:3072
    ds_read_b64_tr_b16 v[134:135], v120 offset:3328
    v_mfma_f32_32x32x16_bf16 v[80:95], v[140:143], v[180:183], v[80:95]
    ds_read_b64_tr_b16 v[136:137], v120 offset:4096
    ds_read_b64_tr_b16 v[138:139], v120 offset:4352
    s_waitcnt lgkmcnt(6)
    v_mfma_f32_32x32x16_bf16 v[16:31], v[144:147], v[184:187], v[16:31]
    s_lshl_b32 s23, s35, 12
    s_add_u32 s23, s23, s24
    s_add_u32 s35, s35, 1
    s_cmp_eq_u32 s35, 18
    s_cselect_b32 s35, 0, s35
    ds_read_b64_tr_b16 v[140:141], v120 offset:5120
    ds_read_b64_tr_b16 v[142:143], v120 offset:5376
    buffer_load_dwordx4 v[168:171], v112, s[8:11], s23 offen offset:0 sc1
    v_mfma_f32_32x32x16_bf16 v[32:47], v[148:151], v[184:187], v[32:47]
    ds_read_b64_tr_b16 v[144:145], v120 offset:6144
    ds_read_b64_tr_b16 v[146:147], v120 offset:6400
    buffer_load_dwordx4 v[172:175], v112, s[8:11], s23 offen offset:1024 sc1
    s_waitcnt lgkmcnt(6)
    v_mfma_f32_32x32x16_bf16 v[48:63], v[128:131], v[184:187], v[48:63]
    ds_read_b64_tr_b16 v[148:149], v120 offset:7168
    ds_read_b64_tr_b16 v[150:151], v120 offset:7424
    v_mfma_f32_32x32x16_bf16 v[64:79], v[132:135], v[184:187], v[64:79]
    ds_read_b64_tr_b16 v[128:129], v120 offset:8192
    ds_read_b64_tr_b16 v[130:131], v120 offset:8448
    buffer_load_dwordx4 v[176:179], v112, s[8:11], s23 offen offset:2048 sc1
    s_waitcnt lgkmcnt(6)
    v_mfma_f32_32x32x16_bf16 v[80:95], v[136:139], v[184:187], v[80:95]
    ds_read_b64_tr_b16 v[132:133], v120 offset:9216
    ds_read_b64_tr_b16 v[134:135], v120 offset:9472
    v_mfma_f32_32x32x16_bf16 v[16:31], v[140:143], v[188:191], v[16:31]
    ds_read_b64_tr_b16 v[136:137], v120 offset:10240
    ds_read_b64_tr_b16 v[138:139], v120 offset:10496
    buffer_load_dwordx4 v[180:183], v112, s[8:11], s23 offen offset:3072 sc1
    s_waitcnt lgkmcnt(6)
    v_mfma_f32_32x32x16_bf16 v[32:47], v[144:147], v[188:191], v[32:47]
    ds_read_b64_tr_b16 v[140:141], v120 offset:11264
    ds_read_b64_tr_b16 v[142:143], v120 offset:11520
    v_mfma_f32_32x32x16_bf16 v[48:63], v[148:151], v[188:191], v[48:63]
    s_mul_i32 s22, s21, 73728
    s_add_u32 s22, s22, s25
    s_add_u32 s21, s21, 1
    s_cmp_eq_u32 s21, 18
    s_cselect_b32 s21, 0, s21
    s_add_u32 m0, s28, 61440
    ds_read_b64_tr_b16 v[144:145], v120 offset:12288
    ds_read_b64_tr_b16 v[146:147], v120 offset:12544
    buffer_load_dwordx4 v113, s[4:7], s22 offen offset:0 lds
    s_waitcnt lgkmcnt(6)
    v_mfma_f32_32x32x16_bf16 v[64:79], v[128:131], v[188:191], v[64:79]
    s_add_u32 m0, s28, 62400
    ds_read_b64_tr_b16 v[148:149], v120 offset:13312
    ds_read_b64_tr_b16 v[150:151], v120 offset:13568
    buffer_load_dwordx4 v113, s[4:7], s22 offen offset:64 lds
    v_mfma_f32_32x32x16_bf16 v[80:95], v[132:135], v[188:191], v[80:95]
    ds_read_b64_tr_b16 v[128:129], v120 offset:14336
    ds_read_b64_tr_b16 v[130:131], v120 offset:14592
    s_waitcnt lgkmcnt(6)
    v_mfma_f32_32x32x16_bf16 v[16:31], v[136:139], v[192:195], v[16:31]
    s_add_u32 m0, s28, 63360
    ds_read_b64_tr_b16 v[132:133], v120 offset:15360
    ds_read_b64_tr_b16 v[134:135], v120 offset:15616
    buffer_load_dwordx4 v113, s[4:7], s22 offen offset:128 lds
    v_mfma_f32_32x32x16_bf16 v[32:47], v[140:143], v[192:195], v[32:47]
    ds_read_b64_tr_b16 v[136:137], v120 offset:16384
    ds_read_b64_tr_b16 v[138:139], v120 offset:16640
    s_waitcnt lgkmcnt(6)
    v_mfma_f32_32x32x16_bf16 v[48:63], v[144:147], v[192:195], v[48:63]
    s_add_u32 m0, s28, 64320
    ds_read_b64_tr_b16 v[140:141], v120 offset:17408
    ds_read_b64_tr_b16 v[142:143], v120 offset:17664
    buffer_load_dwordx4 v113, s[4:7], s22 offen offset:192 lds
    v_mfma_f32_32x32x16_bf16 v[64:79], v[148:151], v[192:195], v[64:79]
    ds_read_b64_tr_b16 v[144:145], v120 offset:18432
    ds_read_b64_tr_b16 v[146:147], v120 offset:18688
    s_waitcnt lgkmcnt(6)
    v_mfma_f32_32x32x16_bf16 v[80:95], v[128:131], v[192:195], v[80:95]
    s_add_u32 m0, s28, 65280
    ds_read_b64_tr_b16 v[148:149], v120 offset:19456
    ds_read_b64_tr_b16 v[150:151], v120 offset:19712
    buffer_load_dwordx4 v114, s[4:7], s22 offen offset:256 lds
    v_mfma_f32_32x32x16_bf16 v[16:31], v[132:135], v[196:199], v[16:31]
    s_waitcnt lgkmcnt(4)
    v_mfma_f32_32x32x16_bf16 v[32:47], v[136:139], v[196:199], v[32:47]
    s_waitcnt vmcnt(14) lgkmcnt(0)
    s_barrier
    ds_read_b64_tr_b16 v[128:129], v120 offset:20480
    ds_read_b64_tr_b16 v[130:131], v120 offset:20736
    ds_read_b64_tr_b16 v[132:133], v120 offset:21504
    ds_read_b64_tr_b16 v[134:135], v120 offset:21760
    v_mfma_f32_32x32x16_bf16 v[48:63], v[140:143], v[196:199], v[48:63]
    ds_read_b64_tr_b16 v[136:137], v120 offset:22528
    ds_read_b64_tr_b16 v[138:139], v120 offset:22784
    v_mfma_f32_32x32x16_bf16 v[64:79], v[144:147], v[196:199], v[64:79]
    ds_read_b64_tr_b16 v[140:141], v120 offset:23552
    ds_read_b64_tr_b16 v[142:143], v120 offset:23808
    v_mfma_f32_32x32x16_bf16 v[80:95], v[148:151], v[196:199], v[80:95]
    ds_read_b64_tr_b16 v[144:145], v120 offset:24576
    ds_read_b64_tr_b16 v[146:147], v120 offset:24832
    s_waitcnt lgkmcnt(6)
    v_mfma_f32_32x32x16_bf16 v[16:31], v[128:131], v[152:155], v[16:31]
    s_lshl_b32 s23, s35, 12
    s_add_u32 s23, s23, s24
    s_add_u32 s35, s35, 1
    s_cmp_eq_u32 s35, 18
    s_cselect_b32 s35, 0, s35
    ds_read_b64_tr_b16 v[148:149], v120 offset:25600
    ds_read_b64_tr_b16 v[150:151], v120 offset:25856
    buffer_load_dwordx4 v[184:187], v112, s[8:11], s23 offen offset:0 sc1
    v_mfma_f32_32x32x16_bf16 v[32:47], v[132:135], v[152:155], v[32:47]
    ds_read_b64_tr_b16 v[128:129], v120 offset:26624
    ds_read_b64_tr_b16 v[130:131], v120 offset:26880
    buffer_load_dwordx4 v[188:191], v112, s[8:11], s23 offen offset:1024 sc1
    s_waitcnt lgkmcnt(6)
    v_mfma_f32_32x32x16_bf16 v[48:63], v[136:139], v[152:155], v[48:63]
    ds_read_b64_tr_b16 v[132:133], v120 offset:27648
    ds_read_b64_tr_b16 v[134:135], v120 offset:27904
    v_mfma_f32_32x32x16_bf16 v[64:79], v[140:143], v[152:155], v[64:79]
    ds_read_b64_tr_b16 v[136:137], v120 offset:28672
    ds_read_b64_tr_b16 v[138:139], v120 offset:28928
    buffer_load_dwordx4 v[192:195], v112, s[8:11], s23 offen offset:2048 sc1
    s_waitcnt lgkmcnt(6)
    v_mfma_f32_32x32x16_bf16 v[80:95], v[144:147], v[152:155], v[80:95]
    ds_read_b64_tr_b16 v[140:141], v120 offset:29696
    ds_read_b64_tr_b16 v[142:143], v120 offset:29952
    v_mfma_f32_32x32x16_bf16 v[16:31], v[148:151], v[156:159], v[16:31]
    ds_read_b64_tr_b16 v[144:145], v120 offset:30720
    ds_read_b64_tr_b16 v[146:147], v120 offset:30976
    buffer_load_dwordx4 v[196:199], v112, s[8:11], s23 offen offset:3072 sc1
    s_waitcnt lgkmcnt(6)
    v_mfma_f32_32x32x16_bf16 v[32:47], v[128:131], v[156:159], v[32:47]
    ds_read_b64_tr_b16 v[148:149], v120 offset:31744
    ds_read_b64_tr_b16 v[150:151], v120 offset:32000
    v_mfma_f32_32x32x16_bf16 v[48:63], v[132:135], v[156:159], v[48:63]
    s_mul_i32 s22, s21, 73728
    s_add_u32 s22, s22, s25
    s_add_u32 s21, s21, 1
    s_cmp_eq_u32 s21, 18
    s_cselect_b32 s21, 0, s21
    s_add_u32 m0, s28, 0
    ds_read_b64_tr_b16 v[128:129], v120 offset:32768
    ds_read_b64_tr_b16 v[130:131], v120 offset:33024
    buffer_load_dwordx4 v113, s[4:7], s22 offen offset:0 lds
    s_waitcnt lgkmcnt(6)
    v_mfma_f32_32x32x16_bf16 v[64:79], v[136:139], v[156:159], v[64:79]
    s_add_u32 m0, s28, 960
    ds_read_b64_tr_b16 v[132:133], v120 offset:33792
    ds_read_b64_tr_b16 v[134:135], v120 offset:34048
    buffer_load_dwordx4 v113, s[4:7], s22 offen offset:64 lds
    v_mfma_f32_32x32x16_bf16 v[80:95], v[140:143], v[156:159], v[80:95]
    ds_read_b64_tr_b16 v[136:137], v120 offset:34816
    ds_read_b64_tr_b16 v[138:139], v120 offset:35072
    s_waitcnt lgkmcnt(6)
    v_mfma_f32_32x32x16_bf16 v[16:31], v[144:147], v[160:163], v[16:31]
    s_add_u32 m0, s28, 1920
    ds_read_b64_tr_b16 v[140:141], v120 offset:35840
    ds_read_b64_tr_b16 v[142:143], v120 offset:36096
    buffer_load_dwordx4 v113, s[4:7], s22 offen offset:128 lds
    v_mfma_f32_32x32x16_bf16 v[32:47], v[148:151], v[160:163], v[32:47]
    ds_read_b64_tr_b16 v[144:145], v120 offset:36864
    ds_read_b64_tr_b16 v[146:147], v120 offset:37120
    s_waitcnt lgkmcnt(6)
    v_mfma_f32_32x32x16_bf16 v[48:63], v[128:131], v[160:163], v[48:63]
    s_add_u32 m0, s28, 2880
    ds_read_b64_tr_b16 v[148:149], v120 offset:37888
    ds_read_b64_tr_b16 v[150:151], v120 offset:38144
    buffer_load_dwordx4 v113, s[4:7], s22 offen offset:192 lds
    v_mfma_f32_32x32x16_bf16 v[64:79], v[132:135], v[160:163], v[64:79]
    ds_read_b64_tr_b16 v[128:129], v120 offset:38912
    ds_read_b64_tr_b16 v[130:131], v120 offset:39168
    s_waitcnt lgkmcnt(6)
    v_mfma_f32_32x32x16_bf16 v[80:95], v[136:139], v[160:163], v[80:95]
    s_add_u32 m0, s28, 3840
    ds_read_b64_tr_b16 v[132:133], v120 offset:39936
    ds_read_b64_tr_b16 v[134:135], v120 offset:40192
    buffer_load_dwordx4 v114, s[4:7], s22 offen offset:256 lds
    v_mfma_f32_32x32x16_bf16 v[16:31], v[140:143], v[164:167], v[16:31]
    s_waitcnt lgkmcnt(4)
    v_mfma_f32_32x32x16_bf16 v[32:47], v[144:147], v[164:167], v[32:47]
    s_waitcnt vmcnt(14) lgkmcnt(0)
    s_barrier
    ds_read_b64_tr_b16 v[136:137], v121 offset:0
    ds_read_b64_tr_b16 v[138:139], v121 offset:256
    ds_read_b64_tr_b16 v[140:141], v121 offset:1024
    ds_read_b64_tr_b16 v[142:143], v121 offset:1280
    v_mfma_f32_32x32x16_bf16 v[48:63], v[148:151], v[164:167], v[48:63]
    ds_read_b64_tr_b16 v[144:145], v121 offset:2048
    ds_read_b64_tr_b16 v[146:147], v121 offset:2304
    v_mfma_f32_32x32x16_bf16 v[64:79], v[128:131], v[164:167], v[64:79]
    ds_read_b64_tr_b16 v[148:149], v121 offset:3072
    ds_read_b64_tr_b16 v[150:151], v121 offset:3328
    v_mfma_f32_32x32x16_bf16 v[80:95], v[132:135], v[164:167], v[80:95]
    ds_read_b64_tr_b16 v[128:129], v121 offset:4096
    ds_read_b64_tr_b16 v[130:131], v121 offset:4352
    s_waitcnt lgkmcnt(6)
    v_mfma_f32_32x32x16_bf16 v[16:31], v[136:139], v[168:171], v[16:31]
    s_lshl_b32 s23, s35, 12
    s_add_u32 s23, s23, s24
    s_add_u32 s35, s35, 1
    s_cmp_eq_u32 s35, 18
    s_cselect_b32 s35, 0, s35
    ds_read_b64_tr_b16 v[132:133], v121 offset:5120
    ds_read_b64_tr_b16 v[134:135], v121 offset:5376
    buffer_load_dwordx4 v[152:155], v112, s[8:11], s23 offen offset:0 sc1
    v_mfma_f32_32x32x16_bf16 v[32:47], v[140:143], v[168:171], v[32:47]
    ds_read_b64_tr_b16 v[136:137], v121 offset:6144
    ds_read_b64_tr_b16 v[138:139], v121 offset:6400
    buffer_load_dwordx4 v[156:159], v112, s[8:11], s23 offen offset:1024 sc1
    s_waitcnt lgkmcnt(6)
    v_mfma_f32_32x32x16_bf16 v[48:63], v[144:147], v[168:171], v[48:63]
    ds_read_b64_tr_b16 v[140:141], v121 offset:7168
    ds_read_b64_tr_b16 v[142:143], v121 offset:7424
    v_mfma_f32_32x32x16_bf16 v[64:79], v[148:151], v[168:171], v[64:79]
    ds_read_b64_tr_b16 v[144:145], v121 offset:8192
    ds_read_b64_tr_b16 v[146:147], v121 offset:8448
    buffer_load_dwordx4 v[160:163], v112, s[8:11], s23 offen offset:2048 sc1
    s_waitcnt lgkmcnt(6)
    v_mfma_f32_32x32x16_bf16 v[80:95], v[128:131], v[168:171], v[80:95]
    ds_read_b64_tr_b16 v[148:149], v121 offset:9216
    ds_read_b64_tr_b16 v[150:151], v121 offset:9472
    v_mfma_f32_32x32x16_bf16 v[16:31], v[132:135], v[172:175], v[16:31]
    ds_read_b64_tr_b16 v[128:129], v121 offset:10240
    ds_read_b64_tr_b16 v[130:131], v121 offset:10496
    buffer_load_dwordx4 v[164:167], v112, s[8:11], s23 offen offset:3072 sc1
    s_waitcnt lgkmcnt(6)
    v_mfma_f32_32x32x16_bf16 v[32:47], v[136:139], v[172:175], v[32:47]
    ds_read_b64_tr_b16 v[132:133], v121 offset:11264
    ds_read_b64_tr_b16 v[134:135], v121 offset:11520
    v_mfma_f32_32x32x16_bf16 v[48:63], v[140:143], v[172:175], v[48:63]
    s_mul_i32 s22, s21, 73728
    s_add_u32 s22, s22, s25
    s_add_u32 s21, s21, 1
    s_cmp_eq_u32 s21, 18
    s_cselect_b32 s21, 0, s21
    s_add_u32 m0, s28, 20480
    ds_read_b64_tr_b16 v[136:137], v121 offset:12288
    ds_read_b64_tr_b16 v[138:139], v121 offset:12544
    buffer_load_dwordx4 v113, s[4:7], s22 offen offset:0 lds
    s_waitcnt lgkmcnt(6)
    v_mfma_f32_32x32x16_bf16 v[64:79], v[144:147], v[172:175], v[64:79]
    s_add_u32 m0, s28, 21440
    ds_read_b64_tr_b16 v[140:141], v121 offset:13312
    ds_read_b64_tr_b16 v[142:143], v121 offset:13568
    buffer_load_dwordx4 v113, s[4:7], s22 offen offset:64 lds
    v_mfma_f32_32x32x16_bf16 v[80:95], v[148:151], v[172:175], v[80:95]
    ds_read_b64_tr_b16 v[144:145], v121 offset:14336
    ds_read_b64_tr_b16 v[146:147], v121 offset:14592
    s_waitcnt lgkmcnt(6)
    v_mfma_f32_32x32x16_bf16 v[16:31], v[128:131], v[176:179], v[16:31]
    s_add_u32 m0, s28, 22400
    ds_read_b64_tr_b16 v[148:149], v121 offset:15360
    ds_read_b64_tr_b16 v[150:151], v121 offset:15616
    buffer_load_dwordx4 v113, s[4:7], s22 offen offset:128 lds
    v_mfma_f32_32x32x16_bf16 v[32:47], v[132:135], v[176:179], v[32:47]
    ds_read_b64_tr_b16 v[128:129], v121 offset:16384
    ds_read_b64_tr_b16 v[130:131], v121 offset:16640
    s_waitcnt lgkmcnt(6)
    v_mfma_f32_32x32x16_bf16 v[48:63], v[136:139], v[176:179], v[48:63]
    s_add_u32 m0, s28, 23360
    ds_read_b64_tr_b16 v[132:133], v121 offset:17408
    ds_read_b64_tr_b16 v[134:135], v121 offset:17664
    buffer_load_dwordx4 v113, s[4:7], s22 offen offset:192 lds
    v_mfma_f32_32x32x16_bf16 v[64:79], v[140:143], v[176:179], v[64:79]
    ds_read_b64_tr_b16 v[136:137], v121 offset:18432
    ds_read_b64_tr_b16 v[138:139], v121 offset:18688
    s_waitcnt lgkmcnt(6)
    v_mfma_f32_32x32x16_bf16 v[80:95], v[144:147], v[176:179], v[80:95]
    s_add_u32 m0, s28, 24320
    ds_read_b64_tr_b16 v[140:141], v121 offset:19456
    ds_read_b64_tr_b16 v[142:143], v121 offset:19712
    buffer_load_dwordx4 v114, s[4:7], s22 offen offset:256 lds
    v_mfma_f32_32x32x16_bf16 v[16:31], v[148:151], v[180:183], v[16:31]
    s_waitcnt lgkmcnt(4)
    v_mfma_f32_32x32x16_bf16 v[32:47], v[128:131], v[180:183], v[32:47]
    s_waitcnt vmcnt(14) lgkmcnt(0)
    s_barrier
    ds_read_b64_tr_b16 v[144:145], v121 offset:20480
    ds_read_b64_tr_b16 v[146:147], v121 offset:20736
    ds_read_b64_tr_b16 v[148:149], v121 offset:21504
    ds_read_b64_tr_b16 v[150:151], v121 offset:21760
    v_mfma_f32_32x32x16_bf16 v[48:63], v[132:135], v[180:183], v[48:63]
    ds_read_b64_tr_b16 v[128:129], v121 offset:22528
    ds_read_b64_tr_b16 v[130:131], v121 offset:22784
    v_mfma_f32_32x32x16_bf16 v[64:79], v[136:139], v[180:183], v[64:79]
    ds_read_b64_tr_b16 v[132:133], v121 offset:23552
    ds_read_b64_tr_b16 v[134:135], v121 offset:23808
    v_mfma_f32_32x32x16_bf16 v[80:95], v[140:143], v[180:183], v[80:95]
    ds_read_b64_tr_b16 v[136:137], v121 offset:24576
    ds_read_b64_tr_b16 v[138:139], v121 offset:24832
    s_waitcnt lgkmcnt(6)
    v_mfma_f32_32x32x16_bf16 v[16:31], v[144:147], v[184:187], v[16:31]
    s_lshl_b32 s23, s35, 12
    s_add_u32 s23, s23, s24
    s_add_u32 s35, s35, 1
    s_cmp_eq_u32 s35, 18
    s_cselect_b32 s35, 0, s35
    ds_read_b64_tr_b16 v[140:141], v121 offset:25600
    ds_read_b64_tr_b16 v[142:143], v121 offset:25856
    buffer_load_dwordx4 v[168:171], v112, s[8:11], s23 offen offset:0 sc1
    v_mfma_f32_32x32x16_bf16 v[32:47], v[148:151], v[184:187], v[32:47]
    ds_read_b64_tr_b16 v[144:145], v121 offset:26624
    ds_read_b64_tr_b16 v[146:147], v121 offset:26880
    buffer_load_dwordx4 v[172:175], v112, s[8:11], s23 offen offset:1024 sc1
    s_waitcnt lgkmcnt(6)
    v_mfma_f32_32x32x16_bf16 v[48:63], v[128:131], v[184:187], v[48:63]
    ds_read_b64_tr_b16 v[148:149], v121 offset:27648
    ds_read_b64_tr_b16 v[150:151], v121 offset:27904
    v_mfma_f32_32x32x16_bf16 v[64:79], v[132:135], v[184:187], v[64:79]
    ds_read_b64_tr_b16 v[128:129], v121 offset:28672
    ds_read_b64_tr_b16 v[130:131], v121 offset:28928
    buffer_load_dwordx4 v[176:179], v112, s[8:11], s23 offen offset:2048 sc1
    s_waitcnt lgkmcnt(6)
    v_mfma_f32_32x32x16_bf16 v[80:95], v[136:139], v[184:187], v[80:95]
    ds_read_b64_tr_b16 v[132:133], v121 offset:29696
    ds_read_b64_tr_b16 v[134:135], v121 offset:29952
    v_mfma_f32_32x32x16_bf16 v[16:31], v[140:143], v[188:191], v[16:31]
    ds_read_b64_tr_b16 v[136:137], v121 offset:30720
    ds_read_b64_tr_b16 v[138:139], v121 offset:30976
    buffer_load_dwordx4 v[180:183], v112, s[8:11], s23 offen offset:3072 sc1
    s_waitcnt lgkmcnt(6)
    v_mfma_f32_32x32x16_bf16 v[32:47], v[144:147], v[188:191], v[32:47]
    ds_read_b64_tr_b16 v[140:141], v121 offset:31744
    ds_read_b64_tr_b16 v[142:143], v121 offset:32000
    v_mfma_f32_32x32x16_bf16 v[48:63], v[148:151], v[188:191], v[48:63]
    s_mul_i32 s22, s21, 73728
    s_add_u32 s22, s22, s25
    s_add_u32 s21, s21, 1
    s_cmp_eq_u32 s21, 18
    s_cselect_b32 s21, 0, s21
    s_add_u32 m0, s28, 40960
    ds_read_b64_tr_b16 v[144:145], v121 offset:32768
    ds_read_b64_tr_b16 v[146:147], v121 offset:33024
    buffer_load_dwordx4 v113, s[4:7], s22 offen offset:0 lds
    s_waitcnt lgkmcnt(6)
    v_mfma_f32_32x32x16_bf16 v[64:79], v[128:131], v[188:191], v[64:79]
    s_add_u32 m0, s28, 41920
    ds_read_b64_tr_b16 v[148:149], v121 offset:33792
    ds_read_b64_tr_b16 v[150:151], v121 offset:34048
    buffer_load_dwordx4 v113, s[4:7], s22 offen offset:64 lds
    v_mfma_f32_32x32x16_bf16 v[80:95], v[132:135], v[188:191], v[80:95]
    ds_read_b64_tr_b16 v[128:129], v121 offset:34816
    ds_read_b64_tr_b16 v[130:131], v121 offset:35072
    s_waitcnt lgkmcnt(6)
    v_mfma_f32_32x32x16_bf16 v[16:31], v[136:139], v[192:195], v[16:31]
    s_add_u32 m0, s28, 42880
    ds_read_b64_tr_b16 v[132:133], v121 offset:35840
    ds_read_b64_tr_b16 v[134:135], v121 offset:36096
    buffer_load_dwordx4 v113, s[4:7], s22 offen offset:128 lds
    v_mfma_f32_32x32x16_bf16 v[32:47], v[140:143], v[192:195], v[32:47]
    ds_read_b64_tr_b16 v[136:137], v121 offset:36864
    ds_read_b64_tr_b16 v[138:139], v121 offset:37120
    s_waitcnt lgkmcnt(6)
    v_mfma_f32_32x32x16_bf16 v[48:63], v[144:147], v[192:195], v[48:63]
    s_add_u32 m0, s28, 43840
    ds_read_b64_tr_b16 v[140:141], v121 offset:37888
    ds_read_b64_tr_b16 v[142:143], v121 offset:38144
    buffer_load_dwordx4 v113, s[4:7], s22 offen offset:192 lds
    v_mfma_f32_32x32x16_bf16 v[64:79], v[148:151], v[192:195], v[64:79]
    ds_read_b64_tr_b16 v[144:145], v121 offset:38912
    ds_read_b64_tr_b16 v[146:147], v121 offset:39168
    s_waitcnt lgkmcnt(6)
    v_mfma_f32_32x32x16_bf16 v[80:95], v[128:131], v[192:195], v[80:95]
    s_add_u32 m0, s28, 44800
    ds_read_b64_tr_b16 v[148:149], v121 offset:39936
    ds_read_b64_tr_b16 v[150:151], v121 offset:40192
    buffer_load_dwordx4 v114, s[4:7], s22 offen offset:256 lds
    v_mfma_f32_32x32x16_bf16 v[16:31], v[132:135], v[196:199], v[16:31]
    s_waitcnt lgkmcnt(4)
    v_mfma_f32_32x32x16_bf16 v[32:47], v[136:139], v[196:199], v[32:47]
    s_waitcnt vmcnt(14) lgkmcnt(0)
    s_barrier
    ds_read_b64_tr_b16 v[128:129], v120 offset:0
    ds_read_b64_tr_b16 v[130:131], v120 offset:256
    ds_read_b64_tr_b16 v[132:133], v120 offset:1024
    ds_read_b64_tr_b16 v[134:135], v120 offset:1280
    v_mfma_f32_32x32x16_bf16 v[48:63], v[140:143], v[196:199], v[48:63]
    ds_read_b64_tr_b16 v[136:137], v120 offset:2048
    ds_read_b64_tr_b16 v[138:139], v120 offset:2304
    v_mfma_f32_32x32x16_bf16 v[64:79], v[144:147], v[196:199], v[64:79]
    ds_read_b64_tr_b16 v[140:141], v120 offset:3072
    ds_read_b64_tr_b16 v[142:143], v120 offset:3328
    v_mfma_f32_32x32x16_bf16 v[80:95], v[148:151], v[196:199], v[80:95]
    ds_read_b64_tr_b16 v[144:145], v120 offset:4096
    ds_read_b64_tr_b16 v[146:147], v120 offset:4352
    s_waitcnt lgkmcnt(6)
    v_mfma_f32_32x32x16_bf16 v[16:31], v[128:131], v[152:155], v[16:31]
    s_lshl_b32 s23, s35, 12
    s_add_u32 s23, s23, s24
    s_add_u32 s35, s35, 1
    s_cmp_eq_u32 s35, 18
    s_cselect_b32 s35, 0, s35
    ds_read_b64_tr_b16 v[148:149], v120 offset:5120
    ds_read_b64_tr_b16 v[150:151], v120 offset:5376
    buffer_load_dwordx4 v[184:187], v112, s[8:11], s23 offen offset:0 sc1
    v_mfma_f32_32x32x16_bf16 v[32:47], v[132:135], v[152:155], v[32:47]
    ds_read_b64_tr_b16 v[128:129], v120 offset:6144
    ds_read_b64_tr_b16 v[130:131], v120 offset:6400
    buffer_load_dwordx4 v[188:191], v112, s[8:11], s23 offen offset:1024 sc1
    s_waitcnt lgkmcnt(6)
    v_mfma_f32_32x32x16_bf16 v[48:63], v[136:139], v[152:155], v[48:63]
    ds_read_b64_tr_b16 v[132:133], v120 offset:7168
    ds_read_b64_tr_b16 v[134:135], v120 offset:7424
    v_mfma_f32_32x32x16_bf16 v[64:79], v[140:143], v[152:155], v[64:79]
    ds_read_b64_tr_b16 v[136:137], v120 offset:8192
    ds_read_b64_tr_b16 v[138:139], v120 offset:8448
    buffer_load_dwordx4 v[192:195], v112, s[8:11], s23 offen offset:2048 sc1
    s_waitcnt lgkmcnt(6)
    v_mfma_f32_32x32x16_bf16 v[80:95], v[144:147], v[152:155], v[80:95]
    ds_read_b64_tr_b16 v[140:141], v120 offset:9216
    ds_read_b64_tr_b16 v[142:143], v120 offset:9472
    v_mfma_f32_32x32x16_bf16 v[16:31], v[148:151], v[156:159], v[16:31]
    ds_read_b64_tr_b16 v[144:145], v120 offset:10240
    ds_read_b64_tr_b16 v[146:147], v120 offset:10496
    buffer_load_dwordx4 v[196:199], v112, s[8:11], s23 offen offset:3072 sc1
    s_waitcnt lgkmcnt(6)
    v_mfma_f32_32x32x16_bf16 v[32:47], v[128:131], v[156:159], v[32:47]
    ds_read_b64_tr_b16 v[148:149], v120 offset:11264
    ds_read_b64_tr_b16 v[150:151], v120 offset:11520
    v_mfma_f32_32x32x16_bf16 v[48:63], v[132:135], v[156:159], v[48:63]
    s_mul_i32 s22, s21, 73728
    s_add_u32 s22, s22, s25
    s_add_u32 s21, s21, 1
    s_cmp_eq_u32 s21, 18
    s_cselect_b32 s21, 0, s21
    s_add_u32 m0, s28, 61440
    ds_read_b64_tr_b16 v[128:129], v120 offset:12288
    ds_read_b64_tr_b16 v[130:131], v120 offset:12544
    buffer_load_dwordx4 v113, s[4:7], s22 offen offset:0 lds
    s_waitcnt lgkmcnt(6)
    v_mfma_f32_32x32x16_bf16 v[64:79], v[136:139], v[156:159], v[64:79]
    s_add_u32 m0, s28, 62400
    ds_read_b64_tr_b16 v[132:133], v120 offset:13312
    ds_read_b64_tr_b16 v[134:135], v120 offset:13568
    buffer_load_dwordx4 v113, s[4:7], s22 offen offset:64 lds
    v_mfma_f32_32x32x16_bf16 v[80:95], v[140:143], v[156:159], v[80:95]
    ds_read_b64_tr_b16 v[136:137], v120 offset:14336
    ds_read_b64_tr_b16 v[138:139], v120 offset:14592
    s_waitcnt lgkmcnt(6)
    v_mfma_f32_32x32x16_bf16 v[16:31], v[144:147], v[160:163], v[16:31]
    s_add_u32 m0, s28, 63360
    ds_read_b64_tr_b16 v[140:141], v120 offset:15360
    ds_read_b64_tr_b16 v[142:143], v120 offset:15616
    buffer_load_dwordx4 v113, s[4:7], s22 offen offset:128 lds
    v_mfma_f32_32x32x16_bf16 v[32:47], v[148:151], v[160:163], v[32:47]
    ds_read_b64_tr_b16 v[144:145], v120 offset:16384
    ds_read_b64_tr_b16 v[146:147], v120 offset:16640
    s_waitcnt lgkmcnt(6)
    v_mfma_f32_32x32x16_bf16 v[48:63], v[128:131], v[160:163], v[48:63]
    s_add_u32 m0, s28, 64320
    ds_read_b64_tr_b16 v[148:149], v120 offset:17408
    ds_read_b64_tr_b16 v[150:151], v120 offset:17664
    buffer_load_dwordx4 v113, s[4:7], s22 offen offset:192 lds
    v_mfma_f32_32x32x16_bf16 v[64:79], v[132:135], v[160:163], v[64:79]
    ds_read_b64_tr_b16 v[128:129], v120 offset:18432
    ds_read_b64_tr_b16 v[130:131], v120 offset:18688
    s_waitcnt lgkmcnt(6)
    v_mfma_f32_32x32x16_bf16 v[80:95], v[136:139], v[160:163], v[80:95]
    s_add_u32 m0, s28, 65280
    ds_read_b64_tr_b16 v[132:133], v120 offset:19456
    ds_read_b64_tr_b16 v[134:135], v120 offset:19712
    buffer_load_dwordx4 v114, s[4:7], s22 offen offset:256 lds
    v_mfma_f32_32x32x16_bf16 v[16:31], v[140:143], v[164:167], v[16:31]
    s_waitcnt lgkmcnt(4)
    v_mfma_f32_32x32x16_bf16 v[32:47], v[144:147], v[164:167], v[32:47]
    s_waitcnt vmcnt(14) lgkmcnt(0)
    s_barrier
    ds_read_b64_tr_b16 v[136:137], v120 offset:20480
    ds_read_b64_tr_b16 v[138:139], v120 offset:20736
    ds_read_b64_tr_b16 v[140:141], v120 offset:21504
    ds_read_b64_tr_b16 v[142:143], v120 offset:21760
    v_mfma_f32_32x32x16_bf16 v[48:63], v[148:151], v[164:167], v[48:63]
    ds_read_b64_tr_b16 v[144:145], v120 offset:22528
    ds_read_b64_tr_b16 v[146:147], v120 offset:22784
    v_mfma_f32_32x32x16_bf16 v[64:79], v[128:131], v[164:167], v[64:79]
    ds_read_b64_tr_b16 v[148:149], v120 offset:23552
    ds_read_b64_tr_b16 v[150:151], v120 offset:23808
    v_mfma_f32_32x32x16_bf16 v[80:95], v[132:135], v[164:167], v[80:95]
    ds_read_b64_tr_b16 v[128:129], v120 offset:24576
    ds_read_b64_tr_b16 v[130:131], v120 offset:24832
    s_waitcnt lgkmcnt(6)
    v_mfma_f32_32x32x16_bf16 v[16:31], v[136:139], v[168:171], v[16:31]
    s_lshl_b32 s23, s35, 12
    s_add_u32 s23, s23, s24
    s_add_u32 s35, s35, 1
    s_cmp_eq_u32 s35, 18
    s_cselect_b32 s35, 0, s35
    ds_read_b64_tr_b16 v[132:133], v120 offset:25600
    ds_read_b64_tr_b16 v[134:135], v120 offset:25856
    buffer_load_dwordx4 v[152:155], v112, s[8:11], s23 offen offset:0 sc1
    v_mfma_f32_32x32x16_bf16 v[32:47], v[140:143], v[168:171], v[32:47]
    ds_read_b64_tr_b16 v[136:137], v120 offset:26624
    ds_read_b64_tr_b16 v[138:139], v120 offset:26880
    buffer_load_dwordx4 v[156:159], v112, s[8:11], s23 offen offset:1024 sc1
    s_waitcnt lgkmcnt(6)
    v_mfma_f32_32x32x16_bf16 v[48:63], v[144:147], v[168:171], v[48:63]
    ds_read_b64_tr_b16 v[140:141], v120 offset:27648
    ds_read_b64_tr_b16 v[142:143], v120 offset:27904
    v_mfma_f32_32x32x16_bf16 v[64:79], v[148:151], v[168:171], v[64:79]
    ds_read_b64_tr_b16 v[144:145], v120 offset:28672
    ds_read_b64_tr_b16 v[146:147], v120 offset:28928
    buffer_load_dwordx4 v[160:163], v112, s[8:11], s23 offen offset:2048 sc1
    s_waitcnt lgkmcnt(6)
    v_mfma_f32_32x32x16_bf16 v[80:95], v[128:131], v[168:171], v[80:95]
    ds_read_b64_tr_b16 v[148:149], v120 offset:29696
    ds_read_b64_tr_b16 v[150:151], v120 offset:29952
    v_mfma_f32_32x32x16_bf16 v[16:31], v[132:135], v[172:175], v[16:31]
    ds_read_b64_tr_b16 v[128:129], v120 offset:30720
    ds_read_b64_tr_b16 v[130:131], v120 offset:30976
    buffer_load_dwordx4 v[164:167], v112, s[8:11], s23 offen offset:3072 sc1
    s_waitcnt lgkmcnt(6)
    v_mfma_f32_32x32x16_bf16 v[32:47], v[136:139], v[172:175], v[32:47]
    ds_read_b64_tr_b16 v[132:133], v120 offset:31744
    ds_read_b64_tr_b16 v[134:135], v120 offset:32000
    v_mfma_f32_32x32x16_bf16 v[48:63], v[140:143], v[172:175], v[48:63]
    s_mul_i32 s22, s21, 73728
    s_add_u32 s22, s22, s25
    s_add_u32 s21, s21, 1
    s_cmp_eq_u32 s21, 18
    s_cselect_b32 s21, 0, s21
    s_add_u32 m0, s28, 0
    ds_read_b64_tr_b16 v[136:137], v120 offset:32768
    ds_read_b64_tr_b16 v[138:139], v120 offset:33024
    buffer_load_dwordx4 v113, s[4:7], s22 offen offset:0 lds
    s_waitcnt lgkmcnt(6)
    v_mfma_f32_32x32x16_bf16 v[64:79], v[144:147], v[172:175], v[64:79]
    s_add_u32 m0, s28, 960
    ds_read_b64_tr_b16 v[140:141], v120 offset:33792
    ds_read_b64_tr_b16 v[142:143], v120 offset:34048
    buffer_load_dwordx4 v113, s[4:7], s22 offen offset:64 lds
    v_mfma_f32_32x32x16_bf16 v[80:95], v[148:151], v[172:175], v[80:95]
    ds_read_b64_tr_b16 v[144:145], v120 offset:34816
    ds_read_b64_tr_b16 v[146:147], v120 offset:35072
    s_waitcnt lgkmcnt(6)
    v_mfma_f32_32x32x16_bf16 v[16:31], v[128:131], v[176:179], v[16:31]
    s_add_u32 m0, s28, 1920
    ds_read_b64_tr_b16 v[148:149], v120 offset:35840
    ds_read_b64_tr_b16 v[150:151], v120 offset:36096
    buffer_load_dwordx4 v113, s[4:7], s22 offen offset:128 lds
    v_mfma_f32_32x32x16_bf16 v[32:47], v[132:135], v[176:179], v[32:47]
    ds_read_b64_tr_b16 v[128:129], v120 offset:36864
    ds_read_b64_tr_b16 v[130:131], v120 offset:37120
    s_waitcnt lgkmcnt(6)
    v_mfma_f32_32x32x16_bf16 v[48:63], v[136:139], v[176:179], v[48:63]
    s_add_u32 m0, s28, 2880
    ds_read_b64_tr_b16 v[132:133], v120 offset:37888
    ds_read_b64_tr_b16 v[134:135], v120 offset:38144
    buffer_load_dwordx4 v113, s[4:7], s22 offen offset:192 lds
    v_mfma_f32_32x32x16_bf16 v[64:79], v[140:143], v[176:179], v[64:79]
    ds_read_b64_tr_b16 v[136:137], v120 offset:38912
    ds_read_b64_tr_b16 v[138:139], v120 offset:39168
    s_waitcnt lgkmcnt(6)
    v_mfma_f32_32x32x16_bf16 v[80:95], v[144:147], v[176:179], v[80:95]
    s_add_u32 m0, s28, 3840
    ds_read_b64_tr_b16 v[140:141], v120 offset:39936
    ds_read_b64_tr_b16 v[142:143], v120 offset:40192
    buffer_load_dwordx4 v114, s[4:7], s22 offen offset:256 lds
    v_mfma_f32_32x32x16_bf16 v[16:31], v[148:151], v[180:183], v[16:31]
    s_waitcnt lgkmcnt(4)
    v_mfma_f32_32x32x16_bf16 v[32:47], v[128:131], v[180:183], v[32:47]
    s_waitcnt vmcnt(14) lgkmcnt(0)
    s_barrier
    ds_read_b64_tr_b16 v[144:145], v121 offset:0
    ds_read_b64_tr_b16 v[146:147], v121 offset:256
    ds_read_b64_tr_b16 v[148:149], v121 offset:1024
    ds_read_b64_tr_b16 v[150:151], v121 offset:1280
    v_mfma_f32_32x32x16_bf16 v[48:63], v[132:135], v[180:183], v[48:63]
    ds_read_b64_tr_b16 v[128:129], v121 offset:2048
    ds_read_b64_tr_b16 v[130:131], v121 offset:2304
    v_mfma_f32_32x32x16_bf16 v[64:79], v[136:139], v[180:183], v[64:79]
    ds_read_b64_tr_b16 v[132:133], v121 offset:3072
    ds_read_b64_tr_b16 v[134:135], v121 offset:3328
    v_mfma_f32_32x32x16_bf16 v[80:95], v[140:143], v[180:183], v[80:95]
    ds_read_b64_tr_b16 v[136:137], v121 offset:4096
    ds_read_b64_tr_b16 v[138:139], v121 offset:4352
    s_waitcnt lgkmcnt(6)
    v_mfma_f32_32x32x16_bf16 v[16:31], v[144:147], v[184:187], v[16:31]
    s_lshl_b32 s23, s35, 12
    s_add_u32 s23, s23, s24
    s_add_u32 s35, s35, 1
    s_cmp_eq_u32 s35, 18
    s_cselect_b32 s35, 0, s35
    ds_read_b64_tr_b16 v[140:141], v121 offset:5120
    ds_read_b64_tr_b16 v[142:143], v121 offset:5376
    buffer_load_dwordx4 v[168:171], v112, s[8:11], s23 offen offset:0 sc1
    v_mfma_f32_32x32x16_bf16 v[32:47], v[148:151], v[184:187], v[32:47]
    ds_read_b64_tr_b16 v[144:145], v121 offset:6144
    ds_read_b64_tr_b16 v[146:147], v121 offset:6400
    buffer_load_dwordx4 v[172:175], v112, s[8:11], s23 offen offset:1024 sc1
    s_waitcnt lgkmcnt(6)
    v_mfma_f32_32x32x16_bf16 v[48:63], v[128:131], v[184:187], v[48:63]
    ds_read_b64_tr_b16 v[148:149], v121 offset:7168
    ds_read_b64_tr_b16 v[150:151], v121 offset:7424
    v_mfma_f32_32x32x16_bf16 v[64:79], v[132:135], v[184:187], v[64:79]
    ds_read_b64_tr_b16 v[128:129], v121 offset:8192
    ds_read_b64_tr_b16 v[130:131], v121 offset:8448
    buffer_load_dwordx4 v[176:179], v112, s[8:11], s23 offen offset:2048 sc1
    s_waitcnt lgkmcnt(6)
    v_mfma_f32_32x32x16_bf16 v[80:95], v[136:139], v[184:187], v[80:95]
    ds_read_b64_tr_b16 v[132:133], v121 offset:9216
    ds_read_b64_tr_b16 v[134:135], v121 offset:9472
    v_mfma_f32_32x32x16_bf16 v[16:31], v[140:143], v[188:191], v[16:31]
    ds_read_b64_tr_b16 v[136:137], v121 offset:10240
    ds_read_b64_tr_b16 v[138:139], v121 offset:10496
    buffer_load_dwordx4 v[180:183], v112, s[8:11], s23 offen offset:3072 sc1
    s_waitcnt lgkmcnt(6)
    v_mfma_f32_32x32x16_bf16 v[32:47], v[144:147], v[188:191], v[32:47]
    ds_read_b64_tr_b16 v[140:141], v121 offset:11264
    ds_read_b64_tr_b16 v[142:143], v121 offset:11520
    v_mfma_f32_32x32x16_bf16 v[48:63], v[148:151], v[188:191], v[48:63]
    s_mul_i32 s22, s21, 73728
    s_add_u32 s22, s22, s25
    s_add_u32 s21, s21, 1
    s_cmp_eq_u32 s21, 18
    s_cselect_b32 s21, 0, s21
    s_add_u32 m0, s28, 20480
    ds_read_b64_tr_b16 v[144:145], v121 offset:12288
    ds_read_b64_tr_b16 v[146:147], v121 offset:12544
    buffer_load_dwordx4 v113, s[4:7], s22 offen offset:0 lds
    s_waitcnt lgkmcnt(6)
    v_mfma_f32_32x32x16_bf16 v[64:79], v[128:131], v[188:191], v[64:79]
    s_add_u32 m0, s28, 21440
    ds_read_b64_tr_b16 v[148:149], v121 offset:13312
    ds_read_b64_tr_b16 v[150:151], v121 offset:13568
    buffer_load_dwordx4 v113, s[4:7], s22 offen offset:64 lds
    v_mfma_f32_32x32x16_bf16 v[80:95], v[132:135], v[188:191], v[80:95]
    ds_read_b64_tr_b16 v[128:129], v121 offset:14336
    ds_read_b64_tr_b16 v[130:131], v121 offset:14592
    s_waitcnt lgkmcnt(6)
    v_mfma_f32_32x32x16_bf16 v[16:31], v[136:139], v[192:195], v[16:31]
    s_add_u32 m0, s28, 22400
    ds_read_b64_tr_b16 v[132:133], v121 offset:15360
    ds_read_b64_tr_b16 v[134:135], v121 offset:15616
    buffer_load_dwordx4 v113, s[4:7], s22 offen offset:128 lds
    v_mfma_f32_32x32x16_bf16 v[32:47], v[140:143], v[192:195], v[32:47]
    ds_read_b64_tr_b16 v[136:137], v121 offset:16384
    ds_read_b64_tr_b16 v[138:139], v121 offset:16640
    s_waitcnt lgkmcnt(6)
    v_mfma_f32_32x32x16_bf16 v[48:63], v[144:147], v[192:195], v[48:63]
    s_add_u32 m0, s28, 23360
    ds_read_b64_tr_b16 v[140:141], v121 offset:17408
    ds_read_b64_tr_b16 v[142:143], v121 offset:17664
    buffer_load_dwordx4 v113, s[4:7], s22 offen offset:192 lds
    v_mfma_f32_32x32x16_bf16 v[64:79], v[148:151], v[192:195], v[64:79]
    ds_read_b64_tr_b16 v[144:145], v121 offset:18432
    ds_read_b64_tr_b16 v[146:147], v121 offset:18688
    s_waitcnt lgkmcnt(6)
    v_mfma_f32_32x32x16_bf16 v[80:95], v[128:131], v[192:195], v[80:95]
    s_add_u32 m0, s28, 24320
    ds_read_b64_tr_b16 v[148:149], v121 offset:19456
    ds_read_b64_tr_b16 v[150:151], v121 offset:19712
    buffer_load_dwordx4 v114, s[4:7], s22 offen offset:256 lds
    v_mfma_f32_32x32x16_bf16 v[16:31], v[132:135], v[196:199], v[16:31]
    s_waitcnt lgkmcnt(4)
    v_mfma_f32_32x32x16_bf16 v[32:47], v[136:139], v[196:199], v[32:47]
    s_waitcnt vmcnt(14) lgkmcnt(0)
    s_mov_b32 s59, 32
    s_cmp_lg_u32 s18, 0
    s_cbranch_scc1 L_f_sa_57
    s_lshl_b32 s58, s16, 7
    s_add_u32 s58, s58, 12339200
    s_mov_b32 s59, 0
    s_atomic_add s59, s[40:41], s58 glc
L_f_sa_57:
    s_barrier
    ds_read_b64_tr_b16 v[128:129], v121 offset:20480
    ds_read_b64_tr_b16 v[130:131], v121 offset:20736
    ds_read_b64_tr_b16 v[132:133], v121 offset:21504
    ds_read_b64_tr_b16 v[134:135], v121 offset:21760
    v_mfma_f32_32x32x16_bf16 v[48:63], v[140:143], v[196:199], v[48:63]
    ds_read_b64_tr_b16 v[136:137], v121 offset:22528
    ds_read_b64_tr_b16 v[138:139], v121 offset:22784
    v_mfma_f32_32x32x16_bf16 v[64:79], v[144:147], v[196:199], v[64:79]
    ds_read_b64_tr_b16 v[140:141], v121 offset:23552
    ds_read_b64_tr_b16 v[142:143], v121 offset:23808
    v_mfma_f32_32x32x16_bf16 v[80:95], v[148:151], v[196:199], v[80:95]
    ds_read_b64_tr_b16 v[144:145], v121 offset:24576
    ds_read_b64_tr_b16 v[146:147], v121 offset:24832
    s_waitcnt lgkmcnt(6)
    v_mfma_f32_32x32x16_bf16 v[16:31], v[128:131], v[152:155], v[16:31]
    s_lshl_b32 s23, s35, 12
    s_add_u32 s23, s23, s24
    s_add_u32 s35, s35, 1
    s_cmp_eq_u32 s35, 18
    s_cselect_b32 s35, 0, s35
    ds_read_b64_tr_b16 v[148:149], v121 offset:25600
    ds_read_b64_tr_b16 v[150:151], v121 offset:25856
    buffer_load_dwordx4 v[184:187], v112, s[8:11], s23 offen offset:0 sc1
    v_mfma_f32_32x32x16_bf16 v[32:47], v[132:135], v[152:155], v[32:47]
    ds_read_b64_tr_b16 v[128:129], v121 offset:26624
    ds_read_b64_tr_b16 v[130:131], v121 offset:26880
    buffer_load_dwordx4 v[188:191], v112, s[8:11], s23 offen offset:1024 sc1
    s_waitcnt lgkmcnt(6)
    v_mfma_f32_32x32x16_bf16 v[48:63], v[136:139], v[152:155], v[48:63]
    ds_read_b64_tr_b16 v[132:133], v121 offset:27648
    ds_read_b64_tr_b16 v[134:135], v121 offset:27904
    v_mfma_f32_32x32x16_bf16 v[64:79], v[140:143], v[152:155], v[64:79]
    ds_read_b64_tr_b16 v[136:137], v121 offset:28672
    ds_read_b64_tr_b16 v[138:139], v121 offset:28928
    buffer_load_dwordx4 v[192:195], v112, s[8:11], s23 offen offset:2048 sc1
    s_waitcnt lgkmcnt(6)
    v_mfma_f32_32x32x16_bf16 v[80:95], v[144:147], v[152:155], v[80:95]
    ds_read_b64_tr_b16 v[140:141], v121 offset:29696
    ds_read_b64_tr_b16 v[142:143], v121 offset:29952
    v_mfma_f32_32x32x16_bf16 v[16:31], v[148:151], v[156:159], v[16:31]
    ds_read_b64_tr_b16 v[144:145], v121 offset:30720
    ds_read_b64_tr_b16 v[146:147], v121 offset:30976
    buffer_load_dwordx4 v[196:199], v112, s[8:11], s23 offen offset:3072 sc1
    s_waitcnt lgkmcnt(6)
    v_mfma_f32_32x32x16_bf16 v[32:47], v[128:131], v[156:159], v[32:47]
    ds_read_b64_tr_b16 v[148:149], v121 offset:31744
    ds_read_b64_tr_b16 v[150:151], v121 offset:32000
    v_mfma_f32_32x32x16_bf16 v[48:63], v[132:135], v[156:159], v[48:63]
    s_add_u32 m0, s28, 40960
    ds_read_b64_tr_b16 v[128:129], v121 offset:32768
    ds_read_b64_tr_b16 v[130:131], v121 offset:33024
    buffer_load_dwordx4 v115, s[12:15], s52 offen offset:0 lds
    s_waitcnt lgkmcnt(6)
    v_mfma_f32_32x32x16_bf16 v[64:79], v[136:139], v[156:159], v[64:79]
    s_add_u32 m0, s28, 41920
    ds_read_b64_tr_b16 v[132:133], v121 offset:33792
    ds_read_b64_tr_b16 v[134:135], v121 offset:34048
    buffer_load_dwordx4 v115, s[12:15], s52 offen offset:64 lds
    v_mfma_f32_32x32x16_bf16 v[80:95], v[140:143], v[156:159], v[80:95]
    ds_read_b64_tr_b16 v[136:137], v121 offset:34816
    ds_read_b64_tr_b16 v[138:139], v121 offset:35072
    s_waitcnt lgkmcnt(6)
    v_mfma_f32_32x32x16_bf16 v[16:31], v[144:147], v[160:163], v[16:31]
    s_add_u32 m0, s28, 42880
    ds_read_b64_tr_b16 v[140:141], v121 offset:35840
    ds_read_b64_tr_b16 v[142:143], v121 offset:36096
    buffer_load_dwordx4 v115, s[12:15], s52 offen offset:128 lds
    v_mfma_f32_32x32x16_bf16 v[32:47], v[148:151], v[160:163], v[32:47]
    ds_read_b64_tr_b16 v[144:145], v121 offset:36864
    ds_read_b64_tr_b16 v[146:147], v121 offset:37120
    s_waitcnt lgkmcnt(6)
    v_mfma_f32_32x32x16_bf16 v[48:63], v[128:131], v[160:163], v[48:63]
    s_add_u32 m0, s28, 43840
    ds_read_b64_tr_b16 v[148:149], v121 offset:37888
    ds_read_b64_tr_b16 v[150:151], v121 offset:38144
    buffer_load_dwordx4 v115, s[12:15], s52 offen offset:192 lds
    v_mfma_f32_32x32x16_bf16 v[64:79], v[132:135], v[160:163], v[64:79]
    ds_read_b64_tr_b16 v[128:129], v121 offset:38912
    ds_read_b64_tr_b16 v[130:131], v121 offset:39168
    s_waitcnt lgkmcnt(6)
    v_mfma_f32_32x32x16_bf16 v[80:95], v[136:139], v[160:163], v[80:95]
    s_add_u32 m0, s28, 44800
    ds_read_b64_tr_b16 v[132:133], v121 offset:39936
    ds_read_b64_tr_b16 v[134:135], v121 offset:40192
    buffer_load_dwordx4 v116, s[12:15], s52 offen offset:256 lds
    v_mfma_f32_32x32x16_bf16 v[16:31], v[140:143], v[164:167], v[16:31]
    s_waitcnt lgkmcnt(4)
    v_mfma_f32_32x32x16_bf16 v[32:47], v[144:147], v[164:167], v[32:47]
    s_waitcnt vmcnt(14) lgkmcnt(0)
    s_cmp_ge_u32 s59, 32
    s_cbranch_scc1 L_f_pa_58
    s_cmp_lg_u32 s18, 0
    s_cbranch_scc1 L_f_pw_59
    s_mov_b32 s57, 262144
L_f_pp_60:
    s_mov_b32 s45, 0
    s_atomic_add s45, s[40:41], s58 glc
    s_waitcnt lgkmcnt(0)
    s_cmp_ge_u32 s45, 32
    s_cbranch_scc1 L_f_pw_59
L_f_ps_61:
    s_sleep 2
    s_sub_u32 s57, s57, 1
    s_cmp_gt_i32 s57, 0
    s_cbranch_scc1 L_f_pp_60
L_f_pw_59:
L_f_pa_58:
    s_barrier
    ds_read_b64_tr_b16 v[136:137], v120 offset:0
    ds_read_b64_tr_b16 v[138:139], v120 offset:256
    ds_read_b64_tr_b16 v[140:141], v120 offset:1024
    ds_read_b64_tr_b16 v[142:143], v120 offset:1280
    v_mfma_f32_32x32x16_bf16 v[48:63], v[148:151], v[164:167], v[48:63]
    ds_read_b64_tr_b16 v[144:145], v120 offset:2048
    ds_read_b64_tr_b16 v[146:147], v120 offset:2304
    v_mfma_f32_32x32x16_bf16 v[64:79], v[128:131], v[164:167], v[64:79]
    ds_read_b64_tr_b16 v[148:149], v120 offset:3072
    ds_read_b64_tr_b16 v[150:151], v120 offset:3328
    v_mfma_f32_32x32x16_bf16 v[80:95], v[132:135], v[164:167], v[80:95]
    ds_read_b64_tr_b16 v[128:129], v120 offset:4096
    ds_read_b64_tr_b16 v[130:131], v120 offset:4352
    s_waitcnt lgkmcnt(6)
    v_mfma_f32_32x32x16_bf16 v[16:31], v[136:139], v[168:171], v[16:31]
    ds_read_b64_tr_b16 v[132:133], v120 offset:5120
    ds_read_b64_tr_b16 v[134:135], v120 offset:5376
    buffer_load_dwordx4 v[152:155], v112, s[8:11], s54 offen offset:0 sc1
    v_mfma_f32_32x32x16_bf16 v[32:47], v[140:143], v[168:171], v[32:47]
    ds_read_b64_tr_b16 v[136:137], v120 offset:6144
    ds_read_b64_tr_b16 v[138:139], v120 offset:6400
    buffer_load_dwordx4 v[156:159], v112, s[8:11], s54 offen offset:1024 sc1
    s_waitcnt lgkmcnt(6)
    v_mfma_f32_32x32x16_bf16 v[48:63], v[144:147], v[168:171], v[48:63]
    ds_read_b64_tr_b16 v[140:141], v120 offset:7168
    ds_read_b64_tr_b16 v[142:143], v120 offset:7424
    v_mfma_f32_32x32x16_bf16 v[64:79], v[148:151], v[168:171], v[64:79]
    ds_read_b64_tr_b16 v[144:145], v120 offset:8192
    ds_read_b64_tr_b16 v[146:147], v120 offset:8448
    buffer_load_dwordx4 v[160:163], v112, s[8:11], s54 offen offset:2048 sc1
    s_waitcnt lgkmcnt(6)
    v_mfma_f32_32x32x16_bf16 v[80:95], v[128:131], v[168:171], v[80:95]
    ds_read_b64_tr_b16 v[148:149], v120 offset:9216
    ds_read_b64_tr_b16 v[150:151], v120 offset:9472
    v_mfma_f32_32x32x16_bf16 v[16:31], v[132:135], v[172:175], v[16:31]
    ds_read_b64_tr_b16 v[128:129], v120 offset:10240
    ds_read_b64_tr_b16 v[130:131], v120 offset:10496
    buffer_load_dwordx4 v[164:167], v112, s[8:11], s54 offen offset:3072 sc1
    s_waitcnt lgkmcnt(6)
    v_mfma_f32_32x32x16_bf16 v[32:47], v[136:139], v[172:175], v[32:47]
    ds_read_b64_tr_b16 v[132:133], v120 offset:11264
    ds_read_b64_tr_b16 v[134:135], v120 offset:11520
    v_mfma_f32_32x32x16_bf16 v[48:63], v[140:143], v[172:175], v[48:63]
    s_add_u32 m0, s28, 61440
    ds_read_b64_tr_b16 v[136:137], v120 offset:12288
    ds_read_b64_tr_b16 v[138:139], v120 offset:12544
    buffer_load_dwordx4 v115, s[12:15], s53 offen offset:0 lds
    s_waitcnt lgkmcnt(6)
    v_mfma_f32_32x32x16_bf16 v[64:79], v[144:147], v[172:175], v[64:79]
    s_add_u32 m0, s28, 62400
    ds_read_b64_tr_b16 v[140:141], v120 offset:13312
    ds_read_b64_tr_b16 v[142:143], v120 offset:13568
    buffer_load_dwordx4 v115, s[12:15], s53 offen offset:64 lds
    v_mfma_f32_32x32x16_bf16 v[80:95], v[148:151], v[172:175], v[80:95]
    ds_read_b64_tr_b16 v[144:145], v120 offset:14336
    ds_read_b64_tr_b16 v[146:147], v120 offset:14592
    s_waitcnt lgkmcnt(6)
    v_mfma_f32_32x32x16_bf16 v[16:31], v[128:131], v[176:179], v[16:31]
    s_add_u32 m0, s28, 63360
    ds_read_b64_tr_b16 v[148:149], v120 offset:15360
    ds_read_b64_tr_b16 v[150:151], v120 offset:15616
    buffer_load_dwordx4 v115, s[12:15], s53 offen offset:128 lds
    v_mfma_f32_32x32x16_bf16 v[32:47], v[132:135], v[176:179], v[32:47]
    ds_read_b64_tr_b16 v[128:129], v120 offset:16384
    ds_read_b64_tr_b16 v[130:131], v120 offset:16640
    s_waitcnt lgkmcnt(6)
    v_mfma_f32_32x32x16_bf16 v[48:63], v[136:139], v[176:179], v[48:63]
    s_add_u32 m0, s28, 64320
    ds_read_b64_tr_b16 v[132:133], v120 offset:17408
    ds_read_b64_tr_b16 v[134:135], v120 offset:17664
    buffer_load_dwordx4 v115, s[12:15], s53 offen offset:192 lds
    v_mfma_f32_32x32x16_bf16 v[64:79], v[140:143], v[176:179], v[64:79]
    ds_read_b64_tr_b16 v[136:137], v120 offset:18432
    ds_read_b64_tr_b16 v[138:139], v120 offset:18688
    s_waitcnt lgkmcnt(6)
    v_mfma_f32_32x32x16_bf16 v[80:95], v[144:147], v[176:179], v[80:95]
    s_add_u32 m0, s28, 65280
    ds_read_b64_tr_b16 v[140:141], v120 offset:19456
    ds_read_b64_tr_b16 v[142:143], v120 offset:19712
    buffer_load_dwordx4 v116, s[12:15], s53 offen offset:256 lds
    v_mfma_f32_32x32x16_bf16 v[16:31], v[148:151], v[180:183], v[16:31]
    s_waitcnt lgkmcnt(4)
    v_mfma_f32_32x32x16_bf16 v[32:47], v[128:131], v[180:183], v[32:47]
    s_waitcnt vmcnt(14) lgkmcnt(0)
    s_barrier
    ds_read_b64_tr_b16 v[144:145], v120 offset:20480
    ds_read_b64_tr_b16 v[146:147], v120 offset:20736
    ds_read_b64_tr_b16 v[148:149], v120 offset:21504
    ds_read_b64_tr_b16 v[150:151], v120 offset:21760
    v_mfma_f32_32x32x16_bf16 v[48:63], v[132:135], v[180:183], v[48:63]
    ds_read_b64_tr_b16 v[128:129], v120 offset:22528
    ds_read_b64_tr_b16 v[130:131], v120 offset:22784
    v_mfma_f32_32x32x16_bf16 v[64:79], v[136:139], v[180:183], v[64:79]
    ds_read_b64_tr_b16 v[132:133], v120 offset:23552
    ds_read_b64_tr_b16 v[134:135], v120 offset:23808
    v_mfma_f32_32x32x16_bf16 v[80:95], v[140:143], v[180:183], v[80:95]
    ds_read_b64_tr_b16 v[136:137], v120 offset:24576
    ds_read_b64_tr_b16 v[138:139], v120 offset:24832
    s_waitcnt lgkmcnt(6)
    v_mfma_f32_32x32x16_bf16 v[16:31], v[144:147], v[184:187], v[16:31]
    ds_read_b64_tr_b16 v[140:141], v120 offset:25600
    ds_read_b64_tr_b16 v[142:143], v120 offset:25856
    buffer_load_dwordx4 v[168:171], v112, s[8:11], s51 offen offset:0 sc1
    v_mfma_f32_32x32x16_bf16 v[32:47], v[148:151], v[184:187], v[32:47]
    ds_read_b64_tr_b16 v[144:145], v120 offset:26624
    ds_read_b64_tr_b16 v[146:147], v120 offset:26880
    buffer_load_dwordx4 v[172:175], v112, s[8:11], s51 offen offset:1024 sc1
    s_waitcnt lgkmcnt(6)
    v_mfma_f32_32x32x16_bf16 v[48:63], v[128:131], v[184:187], v[48:63]
    ds_read_b64_tr_b16 v[148:149], v120 offset:27648
    ds_read_b64_tr_b16 v[150:151], v120 offset:27904
    v_mfma_f32_32x32x16_bf16 v[64:79], v[132:135], v[184:187], v[64:79]
    ds_read_b64_tr_b16 v[128:129], v120 offset:28672
    ds_read_b64_tr_b16 v[130:131], v120 offset:28928
    buffer_load_dwordx4 v[176:179], v112, s[8:11], s51 offen offset:2048 sc1
    s_waitcnt lgkmcnt(6)
    v_mfma_f32_32x32x16_bf16 v[80:95], v[136:139], v[184:187], v[80:95]
    ds_read_b64_tr_b16 v[132:133], v120 offset:29696
    ds_read_b64_tr_b16 v[134:135], v120 offset:29952
    v_mfma_f32_32x32x16_bf16 v[16:31], v[140:143], v[188:191], v[16:31]
    ds_read_b64_tr_b16 v[136:137], v120 offset:30720
    ds_read_b64_tr_b16 v[138:139], v120 offset:30976
    buffer_load_dwordx4 v[180:183], v112, s[8:11], s51 offen offset:3072 sc1
    s_waitcnt lgkmcnt(6)
    v_mfma_f32_32x32x16_bf16 v[32:47], v[144:147], v[188:191], v[32:47]
    ds_read_b64_tr_b16 v[140:141], v120 offset:31744
    ds_read_b64_tr_b16 v[142:143], v120 offset:32000
    v_mfma_f32_32x32x16_bf16 v[48:63], v[148:151], v[188:191], v[48:63]
    s_add_u32 m0, s28, 0
    ds_read_b64_tr_b16 v[144:145], v120 offset:32768
    ds_read_b64_tr_b16 v[146:147], v120 offset:33024
    buffer_load_dwordx4 v117, s[12:15], s52 offen offset:0 lds
    s_waitcnt lgkmcnt(6)
    v_mfma_f32_32x32x16_bf16 v[64:79], v[128:131], v[188:191], v[64:79]
    s_add_u32 m0, s28, 960
    ds_read_b64_tr_b16 v[148:149], v120 offset:33792
    ds_read_b64_tr_b16 v[150:151], v120 offset:34048
    buffer_load_dwordx4 v117, s[12:15], s52 offen offset:64 lds
    v_mfma_f32_32x32x16_bf16 v[80:95], v[132:135], v[188:191], v[80:95]
    ds_read_b64_tr_b16 v[128:129], v120 offset:34816
    ds_read_b64_tr_b16 v[130:131], v120 offset:35072
    s_waitcnt lgkmcnt(6)
    v_mfma_f32_32x32x16_bf16 v[16:31], v[136:139], v[192:195], v[16:31]
    s_add_u32 m0, s28, 1920
    ds_read_b64_tr_b16 v[132:133], v120 offset:35840
    ds_read_b64_tr_b16 v[134:135], v120 offset:36096
    buffer_load_dwordx4 v117, s[12:15], s52 offen offset:128 lds
    v_mfma_f32_32x32x16_bf16 v[32:47], v[140:143], v[192:195], v[32:47]
    ds_read_b64_tr_b16 v[136:137], v120 offset:36864
    ds_read_b64_tr_b16 v[138:139], v120 offset:37120
    s_waitcnt lgkmcnt(6)
    v_mfma_f32_32x32x16_bf16 v[48:63], v[144:147], v[192:195], v[48:63]
    s_add_u32 m0, s28, 2880
    ds_read_b64_tr_b16 v[140:141], v120 offset:37888
    ds_read_b64_tr_b16 v[142:143], v120 offset:38144
    buffer_load_dwordx4 v117, s[12:15], s52 offen offset:192 lds
    v_mfma_f32_32x32x16_bf16 v[64:79], v[148:151], v[192:195], v[64:79]
    ds_read_b64_tr_b16 v[144:145], v120 offset:38912
    ds_read_b64_tr_b16 v[146:147], v120 offset:39168
    s_waitcnt lgkmcnt(6)
    v_mfma_f32_32x32x16_bf16 v[80:95], v[128:131], v[192:195], v[80:95]
    s_add_u32 m0, s28, 3840
    ds_read_b64_tr_b16 v[148:149], v120 offset:39936
    ds_read_b64_tr_b16 v[150:151], v120 offset:40192
    buffer_load_dwordx4 v118, s[12:15], s52 offen offset:256 lds
    v_mfma_f32_32x32x16_bf16 v[16:31], v[132:135], v[196:199], v[16:31]
    s_waitcnt lgkmcnt(4)
    v_mfma_f32_32x32x16_bf16 v[32:47], v[136:139], v[196:199], v[32:47]
    s_waitcnt vmcnt(14) lgkmcnt(0)
    s_barrier
    ds_read_b64_tr_b16 v[128:129], v121 offset:0
    ds_read_b64_tr_b16 v[130:131], v121 offset:256
    ds_read_b64_tr_b16 v[132:133], v121 offset:1024
    ds_read_b64_tr_b16 v[134:135], v121 offset:1280
    v_mfma_f32_32x32x16_bf16 v[48:63], v[140:143], v[196:199], v[48:63]
    ds_read_b64_tr_b16 v[136:137], v121 offset:2048
    ds_read_b64_tr_b16 v[138:139], v121 offset:2304
    v_mfma_f32_32x32x16_bf16 v[64:79], v[144:147], v[196:199], v[64:79]
    ds_read_b64_tr_b16 v[140:141], v121 offset:3072
    ds_read_b64_tr_b16 v[142:143], v121 offset:3328
    v_mfma_f32_32x32x16_bf16 v[80:95], v[148:151], v[196:199], v[80:95]
    ds_read_b64_tr_b16 v[144:145], v121 offset:4096
    ds_read_b64_tr_b16 v[146:147], v121 offset:4352
    s_waitcnt lgkmcnt(6)
    v_mfma_f32_32x32x16_bf16 v[16:31], v[128:131], v[152:155], v[16:31]
    ds_read_b64_tr_b16 v[148:149], v121 offset:5120
    ds_read_b64_tr_b16 v[150:151], v121 offset:5376
    buffer_load_dword v184, v119, s[8:11], s55 offen offset:0 sc1
    v_mfma_f32_32x32x16_bf16 v[32:47], v[132:135], v[152:155], v[32:47]
    ds_read_b64_tr_b16 v[128:129], v121 offset:6144
    ds_read_b64_tr_b16 v[130:131], v121 offset:6400
    s_waitcnt lgkmcnt(6)
    v_mfma_f32_32x32x16_bf16 v[48:63], v[136:139], v[152:155], v[48:63]
    ds_read_b64_tr_b16 v[132:133], v121 offset:7168
    ds_read_b64_tr_b16 v[134:135], v121 offset:7424
    v_mfma_f32_32x32x16_bf16 v[64:79], v[140:143], v[152:155], v[64:79]
    ds_read_b64_tr_b16 v[136:137], v121 offset:8192
    ds_read_b64_tr_b16 v[138:139], v121 offset:8448
    s_waitcnt lgkmcnt(6)
    v_mfma_f32_32x32x16_bf16 v[80:95], v[144:147], v[152:155], v[80:95]
    ds_read_b64_tr_b16 v[140:141], v121 offset:9216
    ds_read_b64_tr_b16 v[142:143], v121 offset:9472
    buffer_load_dword v185, v119, s[8:11], s55 offen offset:128 sc1
    v_mfma_f32_32x32x16_bf16 v[16:31], v[148:151], v[156:159], v[16:31]
    ds_read_b64_tr_b16 v[144:145], v121 offset:10240
    ds_read_b64_tr_b16 v[146:147], v121 offset:10496
    s_waitcnt lgkmcnt(6)
    v_mfma_f32_32x32x16_bf16 v[32:47], v[128:131], v[156:159], v[32:47]
    ds_read_b64_tr_b16 v[148:149], v121 offset:11264
    ds_read_b64_tr_b16 v[150:151], v121 offset:11520
    v_mfma_f32_32x32x16_bf16 v[48:63], v[132:135], v[156:159], v[48:63]
    ds_read_b64_tr_b16 v[128:129], v121 offset:12288
    ds_read_b64_tr_b16 v[130:131], v121 offset:12544
    s_waitcnt lgkmcnt(6)
    v_mfma_f32_32x32x16_bf16 v[64:79], v[136:139], v[156:159], v[64:79]
    ds_read_b64_tr_b16 v[132:133], v121 offset:13312
    ds_read_b64_tr_b16 v[134:135], v121 offset:13568
    buffer_load_dword v186, v119, s[8:11], s55 offen offset:256 sc1
    v_mfma_f32_32x32x16_bf16 v[80:95], v[140:143], v[156:159], v[80:95]
    ds_read_b64_tr_b16 v[136:137], v121 offset:14336
    ds_read_b64_tr_b16 v[138:139], v121 offset:14592
    s_waitcnt lgkmcnt(6)
    v_mfma_f32_32x32x16_bf16 v[16:31], v[144:147], v[160:163], v[16:31]
    ds_read_b64_tr_b16 v[140:141], v121 offset:15360
    ds_read_b64_tr_b16 v[142:143], v121 offset:15616
    v_mfma_f32_32x32x16_bf16 v[32:47], v[148:151], v[160:163], v[32:47]
    ds_read_b64_tr_b16 v[144:145], v121 offset:16384
    ds_read_b64_tr_b16 v[146:147], v121 offset:16640
    s_waitcnt lgkmcnt(6)
    v_mfma_f32_32x32x16_bf16 v[48:63], v[128:131], v[160:163], v[48:63]
    ds_read_b64_tr_b16 v[148:149], v121 offset:17408
    ds_read_b64_tr_b16 v[150:151], v121 offset:17664
    buffer_load_dword v187, v119, s[8:11], s55 offen offset:384 sc1
    v_mfma_f32_32x32x16_bf16 v[64:79], v[132:135], v[160:163], v[64:79]
    ds_read_b64_tr_b16 v[128:129], v121 offset:18432
    ds_read_b64_tr_b16 v[130:131], v121 offset:18688
    s_waitcnt lgkmcnt(6)
    v_mfma_f32_32x32x16_bf16 v[80:95], v[136:139], v[160:163], v[80:95]
    ds_read_b64_tr_b16 v[132:133], v121 offset:19456
    ds_read_b64_tr_b16 v[134:135], v121 offset:19712
    v_mfma_f32_32x32x16_bf16 v[16:31], v[140:143], v[164:167], v[16:31]
    s_waitcnt lgkmcnt(4)
    v_mfma_f32_32x32x16_bf16 v[32:47], v[144:147], v[164:167], v[32:47]
    s_waitcnt vmcnt(9) lgkmcnt(0)
    s_barrier
    ds_read_b64_tr_b16 v[136:137], v121 offset:20480
    ds_read_b64_tr_b16 v[138:139], v121 offset:20736
    ds_read_b64_tr_b16 v[140:141], v121 offset:21504
    ds_read_b64_tr_b16 v[142:143], v121 offset:21760
    v_mfma_f32_32x32x16_bf16 v[48:63], v[148:151], v[164:167], v[48:63]
    ds_read_b64_tr_b16 v[144:145], v121 offset:22528
    ds_read_b64_tr_b16 v[146:147], v121 offset:22784
    v_mfma_f32_32x32x16_bf16 v[64:79], v[128:131], v[164:167], v[64:79]
    ds_read_b64_tr_b16 v[148:149], v121 offset:23552
    ds_read_b64_tr_b16 v[150:151], v121 offset:23808
    v_mfma_f32_32x32x16_bf16 v[80:95], v[132:135], v[164:167], v[80:95]
    ds_read_b64_tr_b16 v[128:129], v121 offset:24576
    ds_read_b64_tr_b16 v[130:131], v121 offset:24832
    s_waitcnt lgkmcnt(6)
    v_mfma_f32_32x32x16_bf16 v[16:31], v[136:139], v[168:171], v[16:31]
    ds_read_b64_tr_b16 v[132:133], v121 offset:25600
    ds_read_b64_tr_b16 v[134:135], v121 offset:25856
    v_mfma_f32_32x32x16_bf16 v[32:47], v[140:143], v[168:171], v[32:47]
    ds_read_b64_tr_b16 v[136:137], v121 offset:26624
    ds_read_b64_tr_b16 v[138:139], v121 offset:26880
    s_waitcnt lgkmcnt(6)
    v_mfma_f32_32x32x16_bf16 v[48:63], v[144:147], v[168:171], v[48:63]
    ds_read_b64_tr_b16 v[140:141], v121 offset:27648
    ds_read_b64_tr_b16 v[142:143], v121 offset:27904
    v_mfma_f32_32x32x16_bf16 v[64:79], v[148:151], v[168:171], v[64:79]
    ds_read_b64_tr_b16 v[144:145], v121 offset:28672
    ds_read_b64_tr_b16 v[146:147], v121 offset:28928
    s_waitcnt lgkmcnt(6)
    v_mfma_f32_32x32x16_bf16 v[80:95], v[128:131], v[168:171], v[80:95]
    ds_read_b64_tr_b16 v[148:149], v121 offset:29696
    ds_read_b64_tr_b16 v[150:151], v121 offset:29952
    v_mfma_f32_32x32x16_bf16 v[16:31], v[132:135], v[172:175], v[16:31]
    ds_read_b64_tr_b16 v[128:129], v121 offset:30720
    ds_read_b64_tr_b16 v[130:131], v121 offset:30976
    s_waitcnt lgkmcnt(6)
    v_mfma_f32_32x32x16_bf16 v[32:47], v[136:139], v[172:175], v[32:47]
    ds_read_b64_tr_b16 v[132:133], v121 offset:31744
    ds_read_b64_tr_b16 v[134:135], v121 offset:32000
    v_mfma_f32_32x32x16_bf16 v[48:63], v[140:143], v[172:175], v[48:63]
    ds_read_b64_tr_b16 v[136:137], v121 offset:32768
    ds_read_b64_tr_b16 v[138:139], v121 offset:33024
    s_waitcnt lgkmcnt(6)
    v_mfma_f32_32x32x16_bf16 v[64:79], v[144:147], v[172:175], v[64:79]
    ds_read_b64_tr_b16 v[140:141], v121 offset:33792
    ds_read_b64_tr_b16 v[142:143], v121 offset:34048
    v_mfma_f32_32x32x16_bf16 v[80:95], v[148:151], v[172:175], v[80:95]
    ds_read_b64_tr_b16 v[144:145], v121 offset:34816
    ds_read_b64_tr_b16 v[146:147], v121 offset:35072
    s_waitcnt lgkmcnt(6)
    v_mfma_f32_32x32x16_bf16 v[16:31], v[128:131], v[176:179], v[16:31]
    ds_read_b64_tr_b16 v[148:149], v121 offset:35840
    ds_read_b64_tr_b16 v[150:151], v121 offset:36096
    v_mfma_f32_32x32x16_bf16 v[32:47], v[132:135], v[176:179], v[32:47]
    ds_read_b64_tr_b16 v[128:129], v121 offset:36864
    ds_read_b64_tr_b16 v[130:131], v121 offset:37120
    s_waitcnt lgkmcnt(6)
    v_mfma_f32_32x32x16_bf16 v[48:63], v[136:139], v[176:179], v[48:63]
    ds_read_b64_tr_b16 v[132:133], v121 offset:37888
    ds_read_b64_tr_b16 v[134:135], v121 offset:38144
    v_mfma_f32_32x32x16_bf16 v[64:79], v[140:143], v[176:179], v[64:79]
    ds_read_b64_tr_b16 v[136:137], v121 offset:38912
    ds_read_b64_tr_b16 v[138:139], v121 offset:39168
    s_waitcnt lgkmcnt(6)
    v_mfma_f32_32x32x16_bf16 v[80:95], v[144:147], v[176:179], v[80:95]
    ds_read_b64_tr_b16 v[140:141], v121 offset:39936
    ds_read_b64_tr_b16 v[142:143], v121 offset:40192
    v_mfma_f32_32x32x16_bf16 v[16:31], v[148:151], v[180:183], v[16:31]
    s_waitcnt lgkmcnt(4)
    v_mfma_f32_32x32x16_bf16 v[32:47], v[128:131], v[180:183], v[32:47]
    s_waitcnt vmcnt(0) lgkmcnt(0)
    s_barrier
    ds_read_b64_tr_b16 v[144:145], v120 offset:0
    ds_read_b64_tr_b16 v[146:147], v120 offset:256
    ds_read_b64_tr_b16 v[148:149], v120 offset:1024
    ds_read_b64_tr_b16 v[150:151], v120 offset:1280
    v_mfma_f32_32x32x16_bf16 v[48:63], v[132:135], v[180:183], v[48:63]
    ds_read_b64_tr_b16 v[128:129], v120 offset:2048
    ds_read_b64_tr_b16 v[130:131], v120 offset:2304
    v_mfma_f32_32x32x16_bf16 v[64:79], v[136:139], v[180:183], v[64:79]
    ds_read_b64_tr_b16 v[132:133], v120 offset:3072
    ds_read_b64_tr_b16 v[134:135], v120 offset:3328
    v_mfma_f32_32x32x16_bf16 v[80:95], v[140:143], v[180:183], v[80:95]
    ds_read_b64_tr_b16 v[136:137], v120 offset:4096
    ds_read_b64_tr_b16 v[138:139], v120 offset:4352
    s_waitcnt lgkmcnt(6)
    v_mfma_f32_32x32x16_bf16 v[16:31], v[144:147], v[184:187], v[16:31]
    v_mfma_f32_32x32x16_bf16 v[32:47], v[148:151], v[184:187], v[32:47]
    s_waitcnt lgkmcnt(2)
    v_mfma_f32_32x32x16_bf16 v[48:63], v[128:131], v[184:187], v[48:63]
    v_mfma_f32_32x32x16_bf16 v[64:79], v[132:135], v[184:187], v[64:79]
    s_waitcnt lgkmcnt(0)
    v_mfma_f32_32x32x16_bf16 v[80:95], v[136:139], v[184:187], v[80:95]
    s_setprio 3
    s_lshl_b32 s26, s19, 6
    s_add_u32 s26, s26, s20
    s_mul_i32 s26, s26, 36
    s_mul_i32 s27, s50, 9
    s_add_u32 s26, s26, s27
    s_lshl_b32 s26, s26, 10
    s_add_u32 s26, s26, 35651584
    v_cvt_pk_bf16_f32 v152, v16, v17
    v_cvt_pk_bf16_f32 v153, v18, v19
    v_cvt_pk_bf16_f32 v154, v20, v21
    v_cvt_pk_bf16_f32 v155, v22, v23
    buffer_store_dwordx4 v[152:155], v112, s[8:11], s26 offen sc1
    s_add_u32 s26, s26, 1024
    v_cvt_pk_bf16_f32 v156, v24, v25
    v_cvt_pk_bf16_f32 v157, v26, v27
    v_cvt_pk_bf16_f32 v158, v28, v29
    v_cvt_pk_bf16_f32 v159, v30, v31
    buffer_store_dwordx4 v[156:159], v112, s[8:11], s26 offen sc1
    s_add_u32 s26, s26, 1024
    v_cvt_pk_bf16_f32 v160, v32, v33
    v_cvt_pk_bf16_f32 v161, v34, v35
    v_cvt_pk_bf16_f32 v162, v36, v37
    v_cvt_pk_bf16_f32 v163, v38, v39
    buffer_store_dwordx4 v[160:163], v112, s[8:11], s26 offen sc1
    s_add_u32 s26, s26, 1024
    v_cvt_pk_bf16_f32 v164, v40, v41
    v_cvt_pk_bf16_f32 v165, v42, v43
    v_cvt_pk_bf16_f32 v166, v44, v45
    v_cvt_pk_bf16_f32 v167, v46, v47
    buffer_store_dwordx4 v[164:167], v112, s[8:11], s26 offen sc1
    s_add_u32 s26, s26, 1024
    v_cvt_pk_bf16_f32 v168, v48, v49
    v_cvt_pk_bf16_f32 v169, v50, v51
    v_cvt_pk_bf16_f32 v170, v52, v53
    v_cvt_pk_bf16_f32 v171, v54, v55
    buffer_store_dwordx4 v[168:171], v112, s[8:11], s26 offen sc1
    s_add_u32 s26, s26, 1024
    v_cvt_pk_bf16_f32 v172, v56, v57
    v_cvt_pk_bf16_f32 v173, v58, v59
    v_cvt_pk_bf16_f32 v174, v60, v61
    v_cvt_pk_bf16_f32 v175, v62, v63
    buffer_store_dwordx4 v[172:175], v112, s[8:11], s26 offen sc1
    s_add_u32 s26, s26, 1024
    v_cvt_pk_bf16_f32 v176, v64, v65
    v_cvt_pk_bf16_f32 v177, v66, v67
    v_cvt_pk_bf16_f32 v178, v68, v69
    v_cvt_pk_bf16_f32 v179, v70, v71
    buffer_store_dwordx4 v[176:179], v112, s[8:11], s26 offen sc1
    s_add_u32 s26, s26, 1024
    v_cvt_pk_bf16_f32 v180, v72, v73
    v_cvt_pk_bf16_f32 v181, v74, v75
    v_cvt_pk_bf16_f32 v182, v76, v77
    v_cvt_pk_bf16_f32 v183, v78, v79
    buffer_store_dwordx4 v[180:183], v112, s[8:11], s26 offen sc1
    s_add_u32 s26, s26, 1024
    v_cvt_pk_bf16_f32 v184, v80, v81
    v_cvt_pk_bf16_f32 v185, v82, v83
    v_cvt_pk_bf16_f32 v186, v84, v85
    v_cvt_pk_bf16_f32 v187, v86, v87
    buffer_store_dwordx4 v[184:187], v112, s[8:11], s26 offen sc1
    s_add_u32 s26, s26, 1024
    s_mov_b64 s[36:37], s[78:79]
    s_lshl_b32 s56, s16, 2
    s_and_b32 s26, s17, 3
    s_add_u32 s56, s56, s26
    s_lshl_b32 s56, s56, 7
    s_add_u32 s56, s56, 12331008
    s_mov_b32 s12, s36
    s_and_b32 s13, s37, 0xffff
    s_mov_b32 s14, 0x00240000
    s_mov_b32 s15, 0x00020000
    s_lshl_b32 s20, s16, 2
    s_lshr_b32 s26, s17, 2
    s_add_u32 s20, s20, s26
    s_and_b32 s19, s17, 3
    s_mul_i32 s48, s19, 288
    s_mul_i32 s24, s20, 36864
    s_add_u32 s24, s24, 0
    v_and_b32 v4, 7, v0
    s_lshl_b32 s26, s18, 3
    v_add_u32 v4, s26, v4
    v_mul_u32_u24 v2, 1152, v4
    v_lshlrev_b32 v1, 4, v4
    v_bfe_u32 v4, v0, 3, 3
    v_lshl_add_u32 v2, v4, 4, v2
    v_lshl_add_u32 v1, v4, 9, v1
    v_and_b32 v4, 7, v0
    v_lshlrev_b32 v4, 4, v4
    s_lshl_b32 s26, s20, 2
    s_add_u32 s26, s26, s18
    s_lshl_b32 s26, s26, 7
    s_add_u32 s26, s26, 12058624
    buffer_load_dword v6, v4, s[8:11], s26 offen offset:8 sc1
    s_mul_i32 s50, s20, 36
    s_mul_i32 s27, s19, 9
    s_add_u32 s50, s50, s27
    s_lshl_b32 s50, s50, 10
    s_add_u32 s54, s50, 9699328
    s_add_u32 s50, s50, 35651584
    s_add_u32 s51, s50, 2359296
    s_add_u32 s52, s51, 2359296
    s_add_u32 s53, s52, 2359296
    buffer_load_dwordx4 v[32:35], v1, s[8:11], s54 offen sc1
    s_add_u32 s54, s54, 4096
    buffer_load_dwordx4 v[52:55], v1, s[8:11], s54 offen sc1
    s_add_u32 s54, s54, 4096
    s_mov_b64 exec, 0xffff
    buffer_load_dwordx4 v[72:75], v1, s[8:11], s54 offen sc1
    s_add_u32 s54, s54, 4096
    s_mov_b64 exec, -1
    s_waitcnt vmcnt(0)
    s_barrier
    s_cmp_lg_u32 s18, 0
    s_cbranch_scc1 L_f_sp_62
    s_mov_b32 s45, 1
    s_atomic_add s45, s[40:41], s56 glc
    s_waitcnt lgkmcnt(0)
    s_cmp_ge_u32 s45, 3
    s_cbranch_scc1 L_f_sp_62
L_f_ss_63:
    s_cmp_lg_u32 s18, 0
    s_cbranch_scc1 L_f_pw_64
    s_mov_b32 s57, 262144
L_f_pp_65:
    s_mov_b32 s45, 0
    s_atomic_add s45, s[40:41], s56 glc
    s_waitcnt lgkmcnt(0)
    s_cmp_ge_u32 s45, 4
    s_cbranch_scc1 L_f_pw_64
L_f_ps_66:
    s_sleep 2
    s_sub_u32 s57, s57, 1
    s_cmp_gt_i32 s57, 0
    s_cbranch_scc1 L_f_pp_65
L_f_pw_64:
L_f_sp_62:
    s_barrier
    buffer_load_dwordx4 v[16:19], v1, s[8:11], s50 offen sc1
    s_add_u32 s50, s50, 4096
    buffer_load_dwordx4 v[20:23], v1, s[8:11], s51 offen sc1
    s_add_u32 s51, s51, 4096
    buffer_load_dwordx4 v[24:27], v1, s[8:11], s52 offen sc1
    s_add_u32 s52, s52, 4096
    buffer_load_dwordx4 v[28:31], v1, s[8:11], s53 offen sc1
    s_add_u32 s53, s53, 4096
    buffer_load_dwordx4 v[36:39], v1, s[8:11], s50 offen sc1
    s_add_u32 s50, s50, 4096
    buffer_load_dwordx4 v[40:43], v1, s[8:11], s51 offen sc1
    s_add_u32 s51, s51, 4096
    buffer_load_dwordx4 v[44:47], v1, s[8:11], s52 offen sc1
    s_add_u32 s52, s52, 4096
    buffer_load_dwordx4 v[48:51], v1, s[8:11], s53 offen sc1
    s_add_u32 s53, s53, 4096
    s_mov_b64 exec, 0xffff
    buffer_load_dwordx4 v[56:59], v1, s[8:11], s50 offen sc1
    buffer_load_dwordx4 v[60:63], v1, s[8:11], s51 offen sc1
    buffer_load_dwordx4 v[64:67], v1, s[8:11], s52 offen sc1
    buffer_load_dwordx4 v[68:71], v1, s[8:11], s53 offen sc1
    s_mov_b64 exec, -1
    v_sub_f32 v7, 1.0, v6
    s_mul_i32 s26, s20, 36864
    s_add_u32 s26, s26, s48
    s_waitcnt vmcnt(8)
    v_lshlrev_b32 v8, 16, v16
    v_and_b32 v9, 0xffff0000, v16
    v_lshlrev_b32 v10, 16, v20
    v_and_b32 v11, 0xffff0000, v20
    v_pk_add_f32 v[8:9], v[8:9], v[10:11]
    v_lshlrev_b32 v10, 16, v24
    v_and_b32 v11, 0xffff0000, v24
    v_pk_add_f32 v[8:9], v[8:9], v[10:11]
    v_lshlrev_b32 v10, 16, v28
    v_and_b32 v11, 0xffff0000, v28
    v_pk_add_f32 v[8:9], v[8:9], v[10:11]
    v_lshlrev_b32 v10, 16, v32
    v_and_b32 v11, 0xffff0000, v32
    v_pk_fma_f32 v[8:9], v[10:11], v[6:7], v[8:9] op_sel:[0,1,0] op_sel_hi:[1,1,1]
    v_cvt_pk_bf16_f32 v16, v8, v9
    v_lshlrev_b32 v8, 16, v17
    v_and_b32 v9, 0xffff0000, v17
    v_lshlrev_b32 v10, 16, v21
    v_and_b32 v11, 0xffff0000, v21
    v_pk_add_f32 v[8:9], v[8:9], v[10:11]
    v_lshlrev_b32 v10, 16, v25
    v_and_b32 v11, 0xffff0000, v25
    v_pk_add_f32 v[8:9], v[8:9], v[10:11]
    v_lshlrev_b32 v10, 16, v29
    v_and_b32 v11, 0xffff0000, v29
    v_pk_add_f32 v[8:9], v[8:9], v[10:11]
    v_lshlrev_b32 v10, 16, v33
    v_and_b32 v11, 0xffff0000, v33
    v_pk_fma_f32 v[8:9], v[10:11], v[6:7], v[8:9] op_sel:[0,1,0] op_sel_hi:[1,1,1]
    v_cvt_pk_bf16_f32 v17, v8, v9
    v_lshlrev_b32 v8, 16, v18
    v_and_b32 v9, 0xffff0000, v18
    v_lshlrev_b32 v10, 16, v22
    v_and_b32 v11, 0xffff0000, v22
    v_pk_add_f32 v[8:9], v[8:9], v[10:11]
    v_lshlrev_b32 v10, 16, v26
    v_and_b32 v11, 0xffff0000, v26
    v_pk_add_f32 v[8:9], v[8:9], v[10:11]
    v_lshlrev_b32 v10, 16, v30
    v_and_b32 v11, 0xffff0000, v30
    v_pk_add_f32 v[8:9], v[8:9], v[10:11]
    v_lshlrev_b32 v10, 16, v34
    v_and_b32 v11, 0xffff0000, v34
    v_pk_fma_f32 v[8:9], v[10:11], v[6:7], v[8:9] op_sel:[0,1,0] op_sel_hi:[1,1,1]
    v_cvt_pk_bf16_f32 v18, v8, v9
    v_lshlrev_b32 v8, 16, v19
    v_and_b32 v9, 0xffff0000, v19
    v_lshlrev_b32 v10, 16, v23
    v_and_b32 v11, 0xffff0000, v23
    v_pk_add_f32 v[8:9], v[8:9], v[10:11]
    v_lshlrev_b32 v10, 16, v27
    v_and_b32 v11, 0xffff0000, v27
    v_pk_add_f32 v[8:9], v[8:9], v[10:11]
    v_lshlrev_b32 v10, 16, v31
    v_and_b32 v11, 0xffff0000, v31
    v_pk_add_f32 v[8:9], v[8:9], v[10:11]
    v_lshlrev_b32 v10, 16, v35
    v_and_b32 v11, 0xffff0000, v35
    v_pk_fma_f32 v[8:9], v[10:11], v[6:7], v[8:9] op_sel:[0,1,0] op_sel_hi:[1,1,1]
    v_cvt_pk_bf16_f32 v19, v8, v9
    buffer_store_dwordx4 v[16:19], v2, s[12:15], s26 offen offset:0
    s_waitcnt vmcnt(5)
    v_lshlrev_b32 v8, 16, v36
    v_and_b32 v9, 0xffff0000, v36
    v_lshlrev_b32 v10, 16, v40
    v_and_b32 v11, 0xffff0000, v40
    v_pk_add_f32 v[8:9], v[8:9], v[10:11]
    v_lshlrev_b32 v10, 16, v44
    v_and_b32 v11, 0xffff0000, v44
    v_pk_add_f32 v[8:9], v[8:9], v[10:11]
    v_lshlrev_b32 v10, 16, v48
    v_and_b32 v11, 0xffff0000, v48
    v_pk_add_f32 v[8:9], v[8:9], v[10:11]
    v_lshlrev_b32 v10, 16, v52
    v_and_b32 v11, 0xffff0000, v52
    v_pk_fma_f32 v[8:9], v[10:11], v[6:7], v[8:9] op_sel:[0,1,0] op_sel_hi:[1,1,1]
    v_cvt_pk_bf16_f32 v36, v8, v9
    v_lshlrev_b32 v8, 16, v37
    v_and_b32 v9, 0xffff0000, v37
    v_lshlrev_b32 v10, 16, v41
    v_and_b32 v11, 0xffff0000, v41
    v_pk_add_f32 v[8:9], v[8:9], v[10:11]
    v_lshlrev_b32 v10, 16, v45
    v_and_b32 v11, 0xffff0000, v45
    v_pk_add_f32 v[8:9], v[8:9], v[10:11]
    v_lshlrev_b32 v10, 16, v49
    v_and_b32 v11, 0xffff0000, v49
    v_pk_add_f32 v[8:9], v[8:9], v[10:11]
    v_lshlrev_b32 v10, 16, v53
    v_and_b32 v11, 0xffff0000, v53
    v_pk_fma_f32 v[8:9], v[10:11], v[6:7], v[8:9] op_sel:[0,1,0] op_sel_hi:[1,1,1]
    v_cvt_pk_bf16_f32 v37, v8, v9
    v_lshlrev_b32 v8, 16, v38
    v_and_b32 v9, 0xffff0000, v38
    v_lshlrev_b32 v10, 16, v42
    v_and_b32 v11, 0xffff0000, v42
    v_pk_add_f32 v[8:9], v[8:9], v[10:11]
    v_lshlrev_b32 v10, 16, v46
    v_and_b32 v11, 0xffff0000, v46
    v_pk_add_f32 v[8:9], v[8:9], v[10:11]
    v_lshlrev_b32 v10, 16, v50
    v_and_b32 v11, 0xffff0000, v50
    v_pk_add_f32 v[8:9], v[8:9], v[10:11]
    v_lshlrev_b32 v10, 16, v54
    v_and_b32 v11, 0xffff0000, v54
    v_pk_fma_f32 v[8:9], v[10:11], v[6:7], v[8:9] op_sel:[0,1,0] op_sel_hi:[1,1,1]
    v_cvt_pk_bf16_f32 v38, v8, v9
    v_lshlrev_b32 v8, 16, v39
    v_and_b32 v9, 0xffff0000, v39
    v_lshlrev_b32 v10, 16, v43
    v_and_b32 v11, 0xffff0000, v43
    v_pk_add_f32 v[8:9], v[8:9], v[10:11]
    v_lshlrev_b32 v10, 16, v47
    v_and_b32 v11, 0xffff0000, v47
    v_pk_add_f32 v[8:9], v[8:9], v[10:11]
    v_lshlrev_b32 v10, 16, v51
    v_and_b32 v11, 0xffff0000, v51
    v_pk_add_f32 v[8:9], v[8:9], v[10:11]
    v_lshlrev_b32 v10, 16, v55
    v_and_b32 v11, 0xffff0000, v55
    v_pk_fma_f32 v[8:9], v[10:11], v[6:7], v[8:9] op_sel:[0,1,0] op_sel_hi:[1,1,1]
    v_cvt_pk_bf16_f32 v39, v8, v9
    buffer_store_dwordx4 v[36:39], v2, s[12:15], s26 offen offset:128
    s_waitcnt vmcnt(2)
    s_mov_b64 exec, 0xffff
    v_lshlrev_b32 v8, 16, v56
    v_and_b32 v9, 0xffff0000, v56
    v_lshlrev_b32 v10, 16, v60
    v_and_b32 v11, 0xffff0000, v60
    v_pk_add_f32 v[8:9], v[8:9], v[10:11]
    v_lshlrev_b32 v10, 16, v64
    v_and_b32 v11, 0xffff0000, v64
    v_pk_add_f32 v[8:9], v[8:9], v[10:11]
    v_lshlrev_b32 v10, 16, v68
    v_and_b32 v11, 0xffff0000, v68
    v_pk_add_f32 v[8:9], v[8:9], v[10:11]
    v_lshlrev_b32 v10, 16, v72
    v_and_b32 v11, 0xffff0000, v72
    v_pk_fma_f32 v[8:9], v[10:11], v[6:7], v[8:9] op_sel:[0,1,0] op_sel_hi:[1,1,1]
    v_cvt_pk_bf16_f32 v56, v8, v9
    v_lshlrev_b32 v8, 16, v57
    v_and_b32 v9, 0xffff0000, v57
    v_lshlrev_b32 v10, 16, v61
    v_and_b32 v11, 0xffff0000, v61
    v_pk_add_f32 v[8:9], v[8:9], v[10:11]
    v_lshlrev_b32 v10, 16, v65
    v_and_b32 v11, 0xffff0000, v65
    v_pk_add_f32 v[8:9], v[8:9], v[10:11]
    v_lshlrev_b32 v10, 16, v69
    v_and_b32 v11, 0xffff0000, v69
    v_pk_add_f32 v[8:9], v[8:9], v[10:11]
    v_lshlrev_b32 v10, 16, v73
    v_and_b32 v11, 0xffff0000, v73
    v_pk_fma_f32 v[8:9], v[10:11], v[6:7], v[8:9] op_sel:[0,1,0] op_sel_hi:[1,1,1]
    v_cvt_pk_bf16_f32 v57, v8, v9
    v_lshlrev_b32 v8, 16, v58
    v_and_b32 v9, 0xffff0000, v58
    v_lshlrev_b32 v10, 16, v62
    v_and_b32 v11, 0xffff0000, v62
    v_pk_add_f32 v[8:9], v[8:9], v[10:11]
    v_lshlrev_b32 v10, 16, v66
    v_and_b32 v11, 0xffff0000, v66
    v_pk_add_f32 v[8:9], v[8:9], v[10:11]
    v_lshlrev_b32 v10, 16, v70
    v_and_b32 v11, 0xffff0000, v70
    v_pk_add_f32 v[8:9], v[8:9], v[10:11]
    v_lshlrev_b32 v10, 16, v74
    v_and_b32 v11, 0xffff0000, v74
    v_pk_fma_f32 v[8:9], v[10:11], v[6:7], v[8:9] op_sel:[0,1,0] op_sel_hi:[1,1,1]
    v_cvt_pk_bf16_f32 v58, v8, v9
    v_lshlrev_b32 v8, 16, v59
    v_and_b32 v9, 0xffff0000, v59
    v_lshlrev_b32 v10, 16, v63
    v_and_b32 v11, 0xffff0000, v63
    v_pk_add_f32 v[8:9], v[8:9], v[10:11]
    v_lshlrev_b32 v10, 16, v67
    v_and_b32 v11, 0xffff0000, v67
    v_pk_add_f32 v[8:9], v[8:9], v[10:11]
    v_lshlrev_b32 v10, 16, v71
    v_and_b32 v11, 0xffff0000, v71
    v_pk_add_f32 v[8:9], v[8:9], v[10:11]
    v_lshlrev_b32 v10, 16, v75
    v_and_b32 v11, 0xffff0000, v75
    v_pk_fma_f32 v[8:9], v[10:11], v[6:7], v[8:9] op_sel:[0,1,0] op_sel_hi:[1,1,1]
    v_cvt_pk_bf16_f32 v59, v8, v9
    buffer_store_dwordx4 v[56:59], v2, s[12:15], s26 offen offset:256
    s_mov_b64 exec, -1
    s_endpgm
L_exit:
    s_endpgm
.section .rodata,"a"
.p2align 6
.amdhsa_kernel gated_mix__mha_block__mixer_s_mlp__prompt_kernel
  .amdhsa_next_free_vgpr 256
  .amdhsa_next_free_sgpr 102
  .amdhsa_accum_offset 256
  .amdhsa_group_segment_fixed_size 0
  .amdhsa_kernarg_size 96
  .amdhsa_user_sgpr_count 2
  .amdhsa_user_sgpr_kernarg_segment_ptr 1
  .amdhsa_system_sgpr_workgroup_id_x 1
  .amdhsa_float_denorm_mode_32 3
  .amdhsa_float_denorm_mode_16_64 3
.end_amdhsa_kernel
```
